```python
import torch

def _softmax(x, axis=-1):
    return torch.softmax(x, dim=axis)
def _gelu(x):
    return torch.nn.functional.gelu(x, approximate="tanh")
def _silu(x):
    return torch.nn.functional.silu(x)
def _sigmoid(x):
    return torch.sigmoid(x)
def _layernorm(x, axis=-1, eps=1e-5):
    m = x.mean(dim=axis, keepdim=True)
    v = x.var(dim=axis, keepdim=True, unbiased=False)
    return (x - m) / torch.sqrt(v + eps)
def _scatter_add(tgt, idx, src, axis=0):
    return tgt.clone().index_add_(axis, idx, src)
def _segment_sum(src, seg, n):
    out = torch.zeros((n,) + src.shape[1:], dtype=src.dtype)
    return out.index_add_(0, seg, src)
def _pad(x, pw):
    flat = tuple(v for pair in reversed(pw) for v in pair)
    return torch.nn.functional.pad(x, flat)

kernel_name = 'gated_mix__ssm_conv_h3__geglu_ffn__prompt'

def setup_inputs():

    _w = (lambda a: (lambda t: t.to(torch.bfloat16) if t.is_floating_point() else t)(torch.as_tensor(a)))
    def _A_setup():
        B, S, D = 1, 2048, 1024
        ks = 4
        return {
            "q": _w((lambda *s: torch.randn(*s, dtype=torch.bfloat16) * 0.05)(B, S, D)),
            "k": _w((lambda *s: torch.randn(*s, dtype=torch.bfloat16) * 0.4)(B, S, D)),
            "v": _w((lambda *s: torch.randn(*s, dtype=torch.bfloat16) * 0.4)(B, S, D)),
            "shift_k": _w((lambda *s: torch.randn(*s, dtype=torch.bfloat16) * 0.4)(D, ks) * 0.5),
            "ssm_k": _w((lambda *s: torch.randn(*s, dtype=torch.bfloat16) * 0.4)(D, S) * (1.0 / S ** 0.5)),
            "ssm_D": _w((lambda *s: torch.randn(*s, dtype=torch.bfloat16) * 0.4)(D)),
        }
    _A_in = _A_setup()

    def _B_setup():
        B, S, D, F = 1, 2048, 1024, 3584
        return {
            "x": _w((lambda *s: torch.randn(*s, dtype=torch.bfloat16) * 0.05)(B, S, D)),
            "w_gate": _w((lambda *s: torch.randn(*s, dtype=torch.bfloat16) * 0.05)(D, F)),
            "w_up": _w((lambda *s: torch.randn(*s, dtype=torch.bfloat16) * 0.05)(D, F)),
            "w_down": _w((lambda *s: torch.randn(*s, dtype=torch.bfloat16) * 0.05)(F, D)),
        }
    _B_in = _B_setup()

    return {
        "A_q": _A_in["q"],
        "A_k": _A_in["k"],
        "A_v": _A_in["v"],
        "A_shift_k": _A_in["shift_k"],
        "A_ssm_k": _A_in["ssm_k"],
        "A_ssm_D": _A_in["ssm_D"],
        "B_x": _B_in["x"],
        "B_w_gate": _B_in["w_gate"],
        "B_w_up": _B_in["w_up"],
        "B_w_down": _B_in["w_down"],
        "gate_w": _w((lambda *s: torch.randn(*s, dtype=torch.bfloat16) * 0.05)(1024) * 16.0),
    }

def reference(A_q, A_k, A_v, A_shift_k, A_ssm_k, A_ssm_D, B_x, B_w_gate, B_w_up, B_w_down, gate_w):
    def _A_ref(q, k, v, shift_k, ssm_k, ssm_D):
        B, S, D = q.shape
        ks = shift_k.shape[-1]
        k_pad = _pad(k, ((0, 0), (ks - 1, 0), (0, 0)))
        k_shift = torch.zeros_like(k)
        for t in range(ks):
            k_shift = k_shift + k_pad[:, t:t + S, :] * shift_k[:, ks - 1 - t][None, None, :]
        kv = k_shift * v
        L = 2 * S
        kv_pad = _pad(kv, ((0, 0), (0, S), (0, 0)))
        kf_pad = _pad(ssm_k, ((0, 0), (0, S)))
        kv_f = (lambda x, axes=(-2,-1): torch.fft.rfft2(x.float(), dim=axes))(kv_pad[:, None, :, :], axes=(1, 2))
        kf_f = (lambda x, axes=(-2,-1): torch.fft.rfft2(x.float(), dim=axes))(kf_pad[:, None, :], axes=(1, 2))
        kf_f = (lambda x, *d: x.permute(*d))(kf_f, 1, 2, 0)
        y_f = kv_f * kf_f[None, :, :, :]
        y = (lambda x, s, axes=(-2,-1): torch.fft.irfft2(x, s=s, dim=axes).to(torch.bfloat16))(y_f, (1, L), axes=(1, 2))[:, 0, :S, :]
        y = y + kv * ssm_D[None, None, :]
        return q * y

    def _B_ref(x, w_gate, w_up, w_down):
        return (_gelu(x @ w_gate) * (x @ w_up)) @ w_down

    x = A_q
    g = _sigmoid((x * gate_w).sum(-1, keepdims=True))
    a = _A_ref(x, A_k, A_v, A_shift_k, A_ssm_k, A_ssm_D)
    b = _B_ref(x, B_w_gate, B_w_up, B_w_down)
    return g * a + (1 - g) * b
```

```asm
; @launch grid=(256,1,1) block=(256,1,1) lds=163840
.amdgcn_target "amdgcn-amd-amdhsa--gfx950"
.text
.p2align 12
.globl gated_mix__ssm_conv_h3__geglu_ffn__prompt_kernel
.p2align 8
.type gated_mix__ssm_conv_h3__geglu_ffn__prompt_kernel,@function
gated_mix__ssm_conv_h3__geglu_ffn__prompt_kernel:
g1_kernel:
    s_cmp_ge_u32 s2, 256
    s_cbranch_scc1 G_END
    s_add_u32 s2, s2, 32
    s_and_b32 s2, s2, 0xff
    s_cmp_lt_u32 s2, 32
    s_cbranch_scc1 G1_PREP
    s_load_dwordx2 s[24:25], s[0:1], 0
    s_load_dwordx2 s[26:27], s[0:1], 56
    s_load_dwordx2 s[28:29], s[0:1], 64
    s_load_dwordx2 s[30:31], s[0:1], 104
    s_load_dwordx4 s[64:67], s[0:1], 32
    s_lshr_b32 s42, s2, 3
    s_and_b32 s41, s42, 1
    s_lshl_b32 s41, s41, 8
    v_add_u32 v47, s41, v0
    s_getpc_b64 s[76:77]
CT_PC1:
    s_add_u32 s76, s76, g1_kernel-CT_PC1
    s_addc_u32 s77, s77, ((g1_kernel-CT_PC1)>>32)
    s_mov_b32 s78, G1_PREP-g1_kernel
    s_mov_b32 s79, 0x00020000
    v_lshlrev_b32 v45, 7, v47
    buffer_load_dword v46, v45, s[76:79], 0 offen
    s_and_b32 s41, s2, 7
    s_sub_u32 s42, s42, 4
    s_and_b32 s43, s41, 1
    s_lshl_b32 s43, s43, 2
    s_and_b32 s44, s42, 3
    s_add_u32 s43, s43, s44
    s_lshr_b32 s44, s41, 1
    s_mul_i32 s44, s44, 7
    s_lshr_b32 s45, s42, 2
    s_add_u32 s44, s44, s45
    s_lshl_b32 s43, s43, 8
    s_lshl_b32 s44, s44, 7
    v_lshrrev_b32 v1, 6, v0
    v_and_b32 v0, 63, v0
    s_nop 0
    v_readfirstlane_b32 s40, v1
    s_lshl_b32 s22, s40, 13
    s_lshl_b32 s23, s40, 12
    v_lshrrev_b32 v26, 3, v0
    s_lshl_b32 s45, s40, 6
    s_add_u32 s45, s45, s43
    v_add_u32 v26, s45, v26
    v_lshlrev_b32 v26, 11, v26
    v_and_b32 v27, 7, v0
    v_lshrrev_b32 v28, 4, v0
    v_xor_b32 v27, v27, v28
    v_lshlrev_b32 v27, 4, v27
    v_add_u32 v26, v26, v27
    v_xor_b32 v27, 64, v26
    v_add_u32 v2, 0x0, v26
    v_add_u32 v3, 0x3c00, v27
    v_add_u32 v4, 0x7800, v26
    v_add_u32 v5, 0xb400, v27
    v_add_u32 v6, 0x10000, v26
    v_add_u32 v7, 0x13c00, v27
    v_add_u32 v8, 0x17800, v26
    v_add_u32 v9, 0x1b400, v27
    s_lshl_b32 s45, s40, 4
    v_add_u32 v26, s45, v28
    s_movk_i32 s46, 7168
    v_mul_lo_u32 v26, v26, s46
    s_lshl_b32 s45, s44, 1
    v_add_u32 v26, s45, v26
    v_and_b32 v27, 15, v0
    v_lshlrev_b32 v29, 1, v28
    v_xor_b32 v27, v27, v29
    v_lshlrev_b32 v27, 4, v27
    v_add_u32 v26, v26, v27
    v_xor_b32 v27, 0x80, v26
    v_add_u32 v10, 0x0, v26
    v_add_u32 v11, 0x6c00, v26
    v_add_u32 v12, 0xd800, v27
    v_add_u32 v13, 0x14400, v27
    s_mov_b32 s20, 0
    s_mov_b32 s21, 0
    s_waitcnt lgkmcnt(0)
    s_mov_b32 s4, s24
    s_mov_b32 s5, s25
    s_mov_b32 s6, 0x400000
    s_mov_b32 s7, 0x00020000
    s_mov_b32 s8, s26
    s_mov_b32 s9, s27
    s_mov_b32 s10, 0x700000
    s_mov_b32 s11, 0x00020000
    s_mov_b32 s12, s28
    s_mov_b32 s13, s29
    s_mov_b32 s14, 0x700000
    s_mov_b32 s15, 0x00020000
    s_add_u32 m0, s22, 0x10000
    s_nop 0
    buffer_load_dwordx4 v2, s[4:7], s20 offen offset:0 lds
    buffer_load_dwordx4 v3, s[4:7], s20 offen offset:1024 lds
    buffer_load_dwordx4 v4, s[4:7], s20 offen offset:2048 lds
    buffer_load_dwordx4 v5, s[4:7], s20 offen offset:3072 lds
    s_add_u32 m0, s22, 0x11000
    s_nop 0
    buffer_load_dwordx4 v6, s[4:7], s20 offen offset:0 lds
    buffer_load_dwordx4 v7, s[4:7], s20 offen offset:1024 lds
    buffer_load_dwordx4 v8, s[4:7], s20 offen offset:2048 lds
    buffer_load_dwordx4 v9, s[4:7], s20 offen offset:3072 lds
    s_add_u32 s20, s20, 128
    s_add_u32 m0, s23, 0x18000
    s_nop 0
    buffer_load_dwordx4 v10, s[8:11], s21 offen offset:0 lds
    buffer_load_dwordx4 v11, s[8:11], s21 offen offset:1024 lds
    buffer_load_dwordx4 v12, s[8:11], s21 offen offset:2048 lds
    buffer_load_dwordx4 v13, s[8:11], s21 offen offset:3072 lds
    s_add_u32 m0, s23, 0x1c000
    s_nop 0
    buffer_load_dwordx4 v10, s[12:15], s21 offen offset:0 lds
    buffer_load_dwordx4 v11, s[12:15], s21 offen offset:1024 lds
    buffer_load_dwordx4 v12, s[12:15], s21 offen offset:2048 lds
    buffer_load_dwordx4 v13, s[12:15], s21 offen offset:3072 lds
    s_add_u32 s21, s21, 0x70000
    s_mov_b32 s16, s30
    s_mov_b32 s17, s31
    s_mov_b32 s18, 0xe00000
    s_mov_b32 s19, 0x00020000
    s_lshr_b32 s45, s42, 2
    s_mul_i32 s45, s45, 40
    v_add_u32 v26, s45, v0
    v_min_u32 v26, 255, v26
    v_add_u32 v26, s43, v26
    v_lshlrev_b32 v26, 11, v26
    v_lshrrev_b32 v27, 1, v0
    v_and_b32 v27, 15, v27
    v_lshlrev_b32 v27, 2, v27
    s_and_b32 s45, s42, 3
    v_add_u32 v27, s45, v27
    v_mul_lo_u32 v27, v27, s46
    v_and_b32 v29, 1, v0
    v_lshlrev_b32 v29, 7, v29
    v_add_u32 v27, v27, v29
    s_lshl_b32 s45, s44, 1
    v_add_u32 v27, s45, v27
    s_cmp_eq_u32 s40, 1
    s_cselect_b32 s52, s26, s24
    s_cselect_b32 s53, s27, s25
    s_cmp_eq_u32 s40, 2
    s_cselect_b32 s52, s28, s52
    s_cselect_b32 s53, s29, s53
    s_add_u32 s45, s40, -1
    s_mov_b32 s54, 0x400000
    s_movk_i32 s57, 128
    s_cmp_lt_u32 s45, 2
    s_cselect_b32 s54, 0x700000, s54
    s_mov_b32 s55, 0x00020000
    s_cselect_b32 s57, 0x70000, s57
    s_cselect_b64 vcc, -1, 0
    s_nop 1
    v_cndmask_b32 v41, v26, v27, vcc
    s_lshl_b32 s56, s57, 1
    s_lshr_b32 s45, s40, 1
    s_and_b32 s46, s40, 1
    v_and_b32 v26, 15, v0
    s_lshl_b32 s47, s45, 7
    v_add_u32 v26, s47, v26
    v_lshlrev_b32 v26, 7, v26
    v_lshrrev_b32 v27, 1, v0
    v_and_b32 v27, 7, v27
    v_xor_b32 v27, v27, v28
    v_lshlrev_b32 v27, 4, v27
    v_add_u32 v16, v26, v27
    v_xor_b32 v17, 64, v16
    v_add_u32 v34, 0x10000, v16
    v_add_u32 v35, 0x10000, v17
    v_lshrrev_b32 v26, 2, v0
    v_and_b32 v26, 3, v26
    v_lshlrev_b32 v27, 3, v28
    v_add_u32 v27, v27, v26
    v_lshlrev_b32 v27, 8, v27
    v_and_b32 v29, 3, v0
    v_lshlrev_b32 v29, 3, v29
    v_add_u32 v27, v27, v29
    v_add_u32 v27, 0x8000, v27
    v_and_b32 v29, 1, v28
    v_lshlrev_b32 v29, 2, v29
    v_or_b32 v26, v26, v29
    s_lshl_b32 s47, s46, 2
    s_add_u32 s48, s47, 0
    v_xor_b32 v29, s48, v26
    v_lshlrev_b32 v29, 5, v29
    v_add_u32 v22, v27, v29
    v_add_u32 v18, 0x10000, v22
    s_add_u32 s48, s47, 1
    v_xor_b32 v29, s48, v26
    v_lshlrev_b32 v29, 5, v29
    v_add_u32 v23, v27, v29
    v_add_u32 v19, 0x10000, v23
    s_add_u32 s48, s47, 2
    v_xor_b32 v29, s48, v26
    v_lshlrev_b32 v29, 5, v29
    v_add_u32 v24, v27, v29
    v_add_u32 v20, 0x10000, v24
    s_add_u32 s48, s47, 3
    v_xor_b32 v29, s48, v26
    v_lshlrev_b32 v29, 5, v29
    v_add_u32 v25, v27, v29
    v_add_u32 v21, 0x10000, v25
    s_load_dwordx2 s[68:69], s[0:1], 80
    s_load_dwordx2 s[70:71], s[0:1], 96
    s_load_dwordx2 s[72:73], s[0:1], 104
    s_load_dwordx2 s[74:75], s[0:1], 0
    s_load_dwordx2 s[100:101], s[0:1], 72
    s_lshl_b32 s47, s2, 2
    s_add_u32 s47, s47, s40
    s_lshl_b32 s84, s47, 12
    s_load_dword s84, s[64:65], s84
    s_lshr_b32 s47, s47, 1
    s_lshl_b32 s47, s47, 2
    s_load_dword s49, s[66:67], s47
    s_add_u32 m0, s22, 0x0
    s_nop 0
    buffer_load_dwordx4 v2, s[4:7], s20 offen offset:0 lds
    buffer_load_dwordx4 v3, s[4:7], s20 offen offset:1024 lds
    buffer_load_dwordx4 v4, s[4:7], s20 offen offset:2048 lds
    buffer_load_dwordx4 v5, s[4:7], s20 offen offset:3072 lds
    s_add_u32 m0, s22, 0x1000
    s_nop 0
    buffer_load_dwordx4 v6, s[4:7], s20 offen offset:0 lds
    buffer_load_dwordx4 v7, s[4:7], s20 offen offset:1024 lds
    buffer_load_dwordx4 v8, s[4:7], s20 offen offset:2048 lds
    buffer_load_dwordx4 v9, s[4:7], s20 offen offset:3072 lds
    s_add_u32 s20, s20, 128
    s_add_u32 m0, s23, 0x8000
    s_nop 0
    buffer_load_dwordx4 v10, s[8:11], s21 offen offset:0 lds
    buffer_load_dwordx4 v11, s[8:11], s21 offen offset:1024 lds
    buffer_load_dwordx4 v12, s[8:11], s21 offen offset:2048 lds
    buffer_load_dwordx4 v13, s[8:11], s21 offen offset:3072 lds
    s_add_u32 m0, s23, 0xc000
    s_nop 0
    buffer_load_dwordx4 v10, s[12:15], s21 offen offset:0 lds
    buffer_load_dwordx4 v11, s[12:15], s21 offen offset:1024 lds
    buffer_load_dwordx4 v12, s[12:15], s21 offen offset:2048 lds
    buffer_load_dwordx4 v13, s[12:15], s21 offen offset:3072 lds
    s_add_u32 s21, s21, 0x70000
    buffer_load_dword v42, v41, s[52:55], s56 offen
    s_add_u32 s56, s56, s57
    buffer_load_dword v42, v41, s[52:55], s56 offen
    s_add_u32 s56, s56, s57
    s_mov_b64 exec, 0
    s_cmp_eq_u32 s40, 0
    s_cbranch_scc1 IW_P1
    s_cmp_eq_u32 s40, 1
    s_cbranch_scc1 IW_P2
    s_cmp_eq_u32 s40, 2
    s_cbranch_scc1 IW_P3
    s_cmp_eq_u32 s40, 3
    s_cbranch_scc1 IW_P4
IW_R0:
    s_mov_b64 exec, -1
    s_waitcnt vmcnt(18)
    s_barrier
    ds_read_b64_tr_b16 a[64:65], v18 offset:0
    ds_read_b64_tr_b16 a[66:67], v18 offset:1024
    ds_read_b64_tr_b16 a[68:69], v18 offset:8192
    ds_read_b64_tr_b16 a[70:71], v18 offset:9216
    ds_read_b128 a[0:3], v34 offset:0
    ds_read_b128 a[4:7], v35 offset:0
    ds_read_b64_tr_b16 a[96:97], v18 offset:16384
    ds_read_b64_tr_b16 a[98:99], v18 offset:17408
    ds_read_b128 a[8:11], v34 offset:2048
    ds_read_b128 a[12:15], v35 offset:2048
    ds_read_b64_tr_b16 a[100:101], v18 offset:24576
    ds_read_b64_tr_b16 a[102:103], v18 offset:25600
    ds_read_b128 a[16:19], v34 offset:4096
    ds_read_b128 a[20:23], v35 offset:4096
    ds_read_b64_tr_b16 a[72:73], v19 offset:0
    ds_read_b64_tr_b16 a[74:75], v19 offset:1024
    ds_read_b128 a[24:27], v34 offset:6144
    ds_read_b128 a[28:31], v35 offset:6144
    ds_read_b64_tr_b16 a[76:77], v19 offset:8192
    ds_read_b64_tr_b16 a[78:79], v19 offset:9216
    ds_read_b64_tr_b16 a[104:105], v19 offset:16384
    ds_read_b64_tr_b16 a[106:107], v19 offset:17408
    ds_read_b64_tr_b16 a[108:109], v19 offset:24576
    ds_read_b64_tr_b16 a[110:111], v19 offset:25600
    s_waitcnt lgkmcnt(0)
    v_mfma_f32_16x16x32_bf16 v[64:67], a[64:67], a[0:3], 0
    ds_read_b128 a[32:35], v34 offset:8192
    v_mfma_f32_16x16x32_bf16 v[64:67], a[68:71], a[4:7], v[64:67]
    s_mov_b32 s80, s70
    v_mfma_f32_16x16x32_bf16 a[128:131], a[100:103], a[4:7], 0
    ds_read_b128 a[36:39], v35 offset:8192
    v_mfma_f32_16x16x32_bf16 a[128:131], a[96:99], a[0:3], a[128:131]
    v_mfma_f32_16x16x32_bf16 v[96:99], a[72:75], a[0:3], 0
    ds_read_b128 a[40:43], v34 offset:10240
    v_mfma_f32_16x16x32_bf16 v[96:99], a[76:79], a[4:7], v[96:99]
    v_mfma_f32_16x16x32_bf16 a[160:163], a[108:111], a[4:7], 0
    ds_read_b128 a[44:47], v35 offset:10240
    v_mfma_f32_16x16x32_bf16 a[160:163], a[104:107], a[0:3], a[160:163]
    v_mfma_f32_16x16x32_bf16 a[164:167], a[104:107], a[8:11], 0
    ds_read_b128 a[48:51], v34 offset:12288
    v_mfma_f32_16x16x32_bf16 a[164:167], a[108:111], a[12:15], a[164:167]
    v_mfma_f32_16x16x32_bf16 v[100:103], a[76:79], a[12:15], 0
    ds_read_b128 a[52:55], v35 offset:12288
    v_mfma_f32_16x16x32_bf16 v[100:103], a[72:75], a[8:11], v[100:103]
    v_mfma_f32_16x16x32_bf16 a[132:135], a[96:99], a[8:11], 0
    ds_read_b128 a[56:59], v34 offset:14336
    v_mfma_f32_16x16x32_bf16 a[132:135], a[100:103], a[12:15], a[132:135]
    v_mfma_f32_16x16x32_bf16 v[68:71], a[68:71], a[12:15], 0
    ds_read_b128 a[60:63], v35 offset:14336
    v_mfma_f32_16x16x32_bf16 v[68:71], a[64:67], a[8:11], v[68:71]
    v_mfma_f32_16x16x32_bf16 v[72:75], a[64:67], a[16:19], 0
    ds_read_b64_tr_b16 a[80:81], v20 offset:0
    v_mfma_f32_16x16x32_bf16 v[72:75], a[68:71], a[20:23], v[72:75]
    s_mov_b32 s81, s71
    v_mfma_f32_16x16x32_bf16 a[136:139], a[100:103], a[20:23], 0
    ds_read_b64_tr_b16 a[82:83], v20 offset:1024
    v_mfma_f32_16x16x32_bf16 a[136:139], a[96:99], a[16:19], a[136:139]
    v_mfma_f32_16x16x32_bf16 v[104:107], a[72:75], a[16:19], 0
    ds_read_b64_tr_b16 a[84:85], v20 offset:8192
    v_mfma_f32_16x16x32_bf16 v[104:107], a[76:79], a[20:23], v[104:107]
    v_mfma_f32_16x16x32_bf16 a[168:171], a[108:111], a[20:23], 0
    ds_read_b64_tr_b16 a[86:87], v20 offset:9216
    v_mfma_f32_16x16x32_bf16 a[168:171], a[104:107], a[16:19], a[168:171]
    v_mfma_f32_16x16x32_bf16 a[172:175], a[104:107], a[24:27], 0
    ds_read_b64_tr_b16 a[112:113], v20 offset:16384
    v_mfma_f32_16x16x32_bf16 a[172:175], a[108:111], a[28:31], a[172:175]
    v_mfma_f32_16x16x32_bf16 v[108:111], a[76:79], a[28:31], 0
    ds_read_b64_tr_b16 a[114:115], v20 offset:17408
    v_mfma_f32_16x16x32_bf16 v[108:111], a[72:75], a[24:27], v[108:111]
    v_mfma_f32_16x16x32_bf16 a[140:143], a[96:99], a[24:27], 0
    ds_read_b64_tr_b16 a[116:117], v20 offset:24576
    v_mfma_f32_16x16x32_bf16 a[140:143], a[100:103], a[28:31], a[140:143]
    v_mfma_f32_16x16x32_bf16 v[76:79], a[68:71], a[28:31], 0
    ds_read_b64_tr_b16 a[118:119], v20 offset:25600
    v_mfma_f32_16x16x32_bf16 v[76:79], a[64:67], a[24:27], v[76:79]
    s_waitcnt lgkmcnt(8)
    v_mfma_f32_16x16x32_bf16 v[80:83], a[64:67], a[32:35], 0
    ds_read_b64_tr_b16 a[88:89], v21 offset:0
    v_mfma_f32_16x16x32_bf16 v[80:83], a[68:71], a[36:39], v[80:83]
    s_cmp_eq_u32 s40, 0
    s_cselect_b32 s82, 0x100, 0
    v_mfma_f32_16x16x32_bf16 a[144:147], a[100:103], a[36:39], 0
    ds_read_b64_tr_b16 a[90:91], v21 offset:1024
    v_mfma_f32_16x16x32_bf16 a[144:147], a[96:99], a[32:35], a[144:147]
    v_mfma_f32_16x16x32_bf16 v[112:115], a[72:75], a[32:35], 0
    ds_read_b64_tr_b16 a[92:93], v21 offset:8192
    v_mfma_f32_16x16x32_bf16 v[112:115], a[76:79], a[36:39], v[112:115]
    v_mfma_f32_16x16x32_bf16 a[176:179], a[108:111], a[36:39], 0
    ds_read_b64_tr_b16 a[94:95], v21 offset:9216
    v_mfma_f32_16x16x32_bf16 a[176:179], a[104:107], a[32:35], a[176:179]
    v_mfma_f32_16x16x32_bf16 a[180:183], a[104:107], a[40:43], 0
    ds_read_b64_tr_b16 a[120:121], v21 offset:16384
    v_mfma_f32_16x16x32_bf16 a[180:183], a[108:111], a[44:47], a[180:183]
    v_mfma_f32_16x16x32_bf16 v[116:119], a[76:79], a[44:47], 0
    ds_read_b64_tr_b16 a[122:123], v21 offset:17408
    v_mfma_f32_16x16x32_bf16 v[116:119], a[72:75], a[40:43], v[116:119]
    v_mfma_f32_16x16x32_bf16 a[148:151], a[96:99], a[40:43], 0
    ds_read_b64_tr_b16 a[124:125], v21 offset:24576
    v_mfma_f32_16x16x32_bf16 a[148:151], a[100:103], a[44:47], a[148:151]
    v_mfma_f32_16x16x32_bf16 v[84:87], a[68:71], a[44:47], 0
    ds_read_b64_tr_b16 a[126:127], v21 offset:25600
    v_mfma_f32_16x16x32_bf16 v[84:87], a[64:67], a[40:43], v[84:87]
    v_mfma_f32_16x16x32_bf16 v[88:91], a[64:67], a[48:51], 0
    v_mfma_f32_16x16x32_bf16 v[88:91], a[68:71], a[52:55], v[88:91]
    v_mfma_f32_16x16x32_bf16 a[152:155], a[100:103], a[52:55], 0
    v_mfma_f32_16x16x32_bf16 a[152:155], a[96:99], a[48:51], a[152:155]
    v_mfma_f32_16x16x32_bf16 v[120:123], a[72:75], a[48:51], 0
    v_mfma_f32_16x16x32_bf16 v[120:123], a[76:79], a[52:55], v[120:123]
    v_mfma_f32_16x16x32_bf16 a[184:187], a[108:111], a[52:55], 0
    v_mfma_f32_16x16x32_bf16 a[184:187], a[104:107], a[48:51], a[184:187]
    v_mfma_f32_16x16x32_bf16 a[188:191], a[104:107], a[56:59], 0
    s_mov_b32 s83, 0x00020000
    v_mfma_f32_16x16x32_bf16 a[188:191], a[108:111], a[60:63], a[188:191]
    v_mfma_f32_16x16x32_bf16 v[124:127], a[76:79], a[60:63], 0
    v_mfma_f32_16x16x32_bf16 v[124:127], a[72:75], a[56:59], v[124:127]
    v_mfma_f32_16x16x32_bf16 a[156:159], a[96:99], a[56:59], 0
    v_mfma_f32_16x16x32_bf16 a[156:159], a[100:103], a[60:63], a[156:159]
    v_mfma_f32_16x16x32_bf16 v[92:95], a[68:71], a[60:63], 0
    v_mfma_f32_16x16x32_bf16 v[92:95], a[64:67], a[56:59], v[92:95]
    s_waitcnt lgkmcnt(0)
    s_add_u32 m0, s22, 0x10000
    s_mov_b64 exec, 0
    s_cmp_eq_u32 s40, 0
    s_cbranch_scc1 IW_P5
    s_cmp_eq_u32 s40, 1
    s_cbranch_scc1 IW_P6
    s_cmp_eq_u32 s40, 2
    s_cbranch_scc1 IW_P7
    s_cmp_eq_u32 s40, 3
    s_cbranch_scc1 IW_P8
IW_R1:
    s_mov_b64 exec, -1
    s_waitcnt vmcnt(2)
    s_barrier
    v_mfma_f32_16x16x32_bf16 v[128:131], a[80:83], a[0:3], 0
    ds_read_b64_tr_b16 a[64:65], v22 offset:0
    v_mfma_f32_16x16x32_bf16 v[128:131], a[84:87], a[4:7], v[128:131]
    buffer_load_dwordx4 v2, s[4:7], s20 offen offset:0 lds
    v_mfma_f32_16x16x32_bf16 a[192:195], a[116:119], a[4:7], 0
    ds_read_b64_tr_b16 a[66:67], v22 offset:1024
    v_mfma_f32_16x16x32_bf16 a[192:195], a[112:115], a[0:3], a[192:195]
    v_mfma_f32_16x16x32_bf16 v[160:163], a[88:91], a[0:3], 0
    ds_read_b64_tr_b16 a[68:69], v22 offset:8192
    v_mfma_f32_16x16x32_bf16 v[160:163], a[92:95], a[4:7], v[160:163]
    buffer_load_dwordx4 v3, s[4:7], s20 offen offset:1024 lds
    v_mfma_f32_16x16x32_bf16 a[224:227], a[124:127], a[4:7], 0
    ds_read_b64_tr_b16 a[70:71], v22 offset:9216
    v_mfma_f32_16x16x32_bf16 a[224:227], a[120:123], a[0:3], a[224:227]
    v_mfma_f32_16x16x32_bf16 a[228:231], a[120:123], a[8:11], 0
    ds_read_b128 a[0:3], v16 offset:0
    v_mfma_f32_16x16x32_bf16 a[228:231], a[124:127], a[12:15], a[228:231]
    buffer_load_dwordx4 v4, s[4:7], s20 offen offset:2048 lds
    v_mfma_f32_16x16x32_bf16 v[164:167], a[92:95], a[12:15], 0
    ds_read_b128 a[4:7], v17 offset:0
    v_mfma_f32_16x16x32_bf16 v[164:167], a[88:91], a[8:11], v[164:167]
    v_mfma_f32_16x16x32_bf16 a[196:199], a[112:115], a[8:11], 0
    ds_read_b64_tr_b16 a[96:97], v22 offset:16384
    v_mfma_f32_16x16x32_bf16 a[196:199], a[116:119], a[12:15], a[196:199]
    buffer_load_dwordx4 v5, s[4:7], s20 offen offset:3072 lds
    v_mfma_f32_16x16x32_bf16 v[132:135], a[84:87], a[12:15], 0
    ds_read_b64_tr_b16 a[98:99], v22 offset:17408
    v_mfma_f32_16x16x32_bf16 v[132:135], a[80:83], a[8:11], v[132:135]
    s_add_u32 m0, s22, 0x11000
    v_mfma_f32_16x16x32_bf16 v[136:139], a[80:83], a[16:19], 0
    ds_read_b128 a[8:11], v16 offset:2048
    v_mfma_f32_16x16x32_bf16 v[136:139], a[84:87], a[20:23], v[136:139]
    buffer_load_dwordx4 v6, s[4:7], s20 offen offset:0 lds
    v_mfma_f32_16x16x32_bf16 a[200:203], a[116:119], a[20:23], 0
    ds_read_b128 a[12:15], v17 offset:2048
    v_mfma_f32_16x16x32_bf16 a[200:203], a[112:115], a[16:19], a[200:203]
    v_mfma_f32_16x16x32_bf16 v[168:171], a[88:91], a[16:19], 0
    ds_read_b64_tr_b16 a[100:101], v22 offset:24576
    v_mfma_f32_16x16x32_bf16 v[168:171], a[92:95], a[20:23], v[168:171]
    buffer_load_dwordx4 v7, s[4:7], s20 offen offset:1024 lds
    v_mfma_f32_16x16x32_bf16 a[232:235], a[124:127], a[20:23], 0
    ds_read_b64_tr_b16 a[102:103], v22 offset:25600
    v_mfma_f32_16x16x32_bf16 a[232:235], a[120:123], a[16:19], a[232:235]
    v_mfma_f32_16x16x32_bf16 a[236:239], a[120:123], a[24:27], 0
    ds_read_b128 a[16:19], v16 offset:4096
    v_mfma_f32_16x16x32_bf16 a[236:239], a[124:127], a[28:31], a[236:239]
    buffer_load_dwordx4 v8, s[4:7], s20 offen offset:2048 lds
    v_mfma_f32_16x16x32_bf16 v[172:175], a[92:95], a[28:31], 0
    ds_read_b128 a[20:23], v17 offset:4096
    v_mfma_f32_16x16x32_bf16 v[172:175], a[88:91], a[24:27], v[172:175]
    v_mfma_f32_16x16x32_bf16 a[204:207], a[112:115], a[24:27], 0
    ds_read_b64_tr_b16 a[72:73], v23 offset:0
    v_mfma_f32_16x16x32_bf16 a[204:207], a[116:119], a[28:31], a[204:207]
    buffer_load_dwordx4 v9, s[4:7], s20 offen offset:3072 lds
    v_mfma_f32_16x16x32_bf16 v[140:143], a[84:87], a[28:31], 0
    ds_read_b64_tr_b16 a[74:75], v23 offset:1024
    v_mfma_f32_16x16x32_bf16 v[140:143], a[80:83], a[24:27], v[140:143]
    s_add_u32 s20, s20, 128
    s_add_u32 m0, s23, 0x18000
    v_mfma_f32_16x16x32_bf16 v[144:147], a[80:83], a[32:35], 0
    ds_read_b128 a[24:27], v16 offset:6144
    v_mfma_f32_16x16x32_bf16 v[144:147], a[84:87], a[36:39], v[144:147]
    buffer_load_dwordx4 v10, s[8:11], s21 offen offset:0 lds
    v_mfma_f32_16x16x32_bf16 a[208:211], a[116:119], a[36:39], 0
    ds_read_b128 a[28:31], v17 offset:6144
    v_mfma_f32_16x16x32_bf16 a[208:211], a[112:115], a[32:35], a[208:211]
    v_mfma_f32_16x16x32_bf16 v[176:179], a[88:91], a[32:35], 0
    ds_read_b64_tr_b16 a[76:77], v23 offset:8192
    v_mfma_f32_16x16x32_bf16 v[176:179], a[92:95], a[36:39], v[176:179]
    buffer_load_dwordx4 v11, s[8:11], s21 offen offset:1024 lds
    v_mfma_f32_16x16x32_bf16 a[240:243], a[124:127], a[36:39], 0
    ds_read_b64_tr_b16 a[78:79], v23 offset:9216
    v_mfma_f32_16x16x32_bf16 a[240:243], a[120:123], a[32:35], a[240:243]
    v_mfma_f32_16x16x32_bf16 a[244:247], a[120:123], a[40:43], 0
    ds_read_b64_tr_b16 a[104:105], v23 offset:16384
    v_mfma_f32_16x16x32_bf16 a[244:247], a[124:127], a[44:47], a[244:247]
    buffer_load_dwordx4 v12, s[8:11], s21 offen offset:2048 lds
    v_mfma_f32_16x16x32_bf16 v[180:183], a[92:95], a[44:47], 0
    ds_read_b64_tr_b16 a[106:107], v23 offset:17408
    v_mfma_f32_16x16x32_bf16 v[180:183], a[88:91], a[40:43], v[180:183]
    v_mfma_f32_16x16x32_bf16 a[212:215], a[112:115], a[40:43], 0
    ds_read_b64_tr_b16 a[108:109], v23 offset:24576
    v_mfma_f32_16x16x32_bf16 a[212:215], a[116:119], a[44:47], a[212:215]
    buffer_load_dwordx4 v13, s[8:11], s21 offen offset:3072 lds
    v_mfma_f32_16x16x32_bf16 v[148:151], a[84:87], a[44:47], 0
    ds_read_b64_tr_b16 a[110:111], v23 offset:25600
    v_mfma_f32_16x16x32_bf16 v[148:151], a[80:83], a[40:43], v[148:151]
    s_add_u32 m0, s23, 0x1c000
    v_mfma_f32_16x16x32_bf16 v[152:155], a[80:83], a[48:51], 0
    v_mfma_f32_16x16x32_bf16 v[152:155], a[84:87], a[52:55], v[152:155]
    buffer_load_dwordx4 v10, s[12:15], s21 offen offset:0 lds
    v_mfma_f32_16x16x32_bf16 a[216:219], a[116:119], a[52:55], 0
    v_mfma_f32_16x16x32_bf16 a[216:219], a[112:115], a[48:51], a[216:219]
    v_mfma_f32_16x16x32_bf16 v[184:187], a[88:91], a[48:51], 0
    buffer_load_dwordx4 v11, s[12:15], s21 offen offset:1024 lds
    v_mfma_f32_16x16x32_bf16 v[184:187], a[92:95], a[52:55], v[184:187]
    v_mfma_f32_16x16x32_bf16 a[248:251], a[124:127], a[52:55], 0
    v_mfma_f32_16x16x32_bf16 a[248:251], a[120:123], a[48:51], a[248:251]
    buffer_load_dwordx4 v12, s[12:15], s21 offen offset:2048 lds
    v_mfma_f32_16x16x32_bf16 a[252:255], a[120:123], a[56:59], 0
    v_mfma_f32_16x16x32_bf16 a[252:255], a[124:127], a[60:63], a[252:255]
    v_mfma_f32_16x16x32_bf16 v[188:191], a[92:95], a[60:63], 0
    buffer_load_dwordx4 v13, s[12:15], s21 offen offset:3072 lds
    v_mfma_f32_16x16x32_bf16 v[188:191], a[88:91], a[56:59], v[188:191]
    v_mfma_f32_16x16x32_bf16 a[220:223], a[112:115], a[56:59], 0
    s_add_u32 s21, s21, 0x70000
    v_mfma_f32_16x16x32_bf16 a[220:223], a[116:119], a[60:63], a[220:223]
    buffer_load_dword v42, v41, s[52:55], s56 offen
    v_mfma_f32_16x16x32_bf16 v[156:159], a[84:87], a[60:63], 0
    s_add_u32 s56, s56, s57
    v_mfma_f32_16x16x32_bf16 v[156:159], a[80:83], a[56:59], v[156:159]
    s_waitcnt lgkmcnt(0)
    v_mfma_f32_16x16x32_bf16 v[64:67], a[64:67], a[0:3], v[64:67]
    ds_read_b128 a[32:35], v16 offset:8192
    s_and_b32 s47, s2, 7
    v_mfma_f32_16x16x32_bf16 v[64:67], a[68:71], a[4:7], v[64:67]
    s_lshr_b32 s48, s2, 3
    v_mfma_f32_16x16x32_bf16 a[128:131], a[100:103], a[4:7], a[128:131]
    ds_read_b128 a[36:39], v17 offset:8192
    v_mfma_f32_16x16x32_bf16 a[128:131], a[96:99], a[0:3], a[128:131]
    s_lshr_b32 s58, s47, 2
    s_and_b32 s63, s47, 2
    v_mfma_f32_16x16x32_bf16 v[96:99], a[72:75], a[0:3], v[96:99]
    ds_read_b128 a[40:43], v16 offset:10240
    v_mfma_f32_16x16x32_bf16 v[96:99], a[76:79], a[4:7], v[96:99]
    s_lshl_b32 s63, s63, 1
    v_mfma_f32_16x16x32_bf16 a[160:163], a[108:111], a[4:7], a[160:163]
    ds_read_b128 a[44:47], v17 offset:10240
    v_mfma_f32_16x16x32_bf16 a[160:163], a[104:107], a[0:3], a[160:163]
    s_lshr_b32 s59, s48, 3
    s_add_u32 s63, s63, s59
    v_mfma_f32_16x16x32_bf16 a[164:167], a[104:107], a[8:11], a[164:167]
    ds_read_b128 a[48:51], v16 offset:12288
    v_mfma_f32_16x16x32_bf16 a[164:167], a[108:111], a[12:15], a[164:167]
    s_add_u32 s30, s59, s48
    v_mfma_f32_16x16x32_bf16 v[100:103], a[76:79], a[12:15], v[100:103]
    ds_read_b128 a[52:55], v17 offset:12288
    v_mfma_f32_16x16x32_bf16 v[100:103], a[72:75], a[8:11], v[100:103]
    s_and_b32 s30, s30, 3
    s_lshr_b32 s47, s40, 1
    v_mfma_f32_16x16x32_bf16 a[132:135], a[96:99], a[8:11], a[132:135]
    ds_read_b128 a[56:59], v16 offset:14336
    v_mfma_f32_16x16x32_bf16 a[132:135], a[100:103], a[12:15], a[132:135]
    s_mul_i32 s59, s58, 56
    v_mfma_f32_16x16x32_bf16 v[68:71], a[68:71], a[12:15], v[68:71]
    ds_read_b128 a[60:63], v17 offset:14336
    v_mfma_f32_16x16x32_bf16 v[68:71], a[64:67], a[8:11], v[68:71]
    s_mul_i32 s48, s47, 28
    s_add_u32 s59, s59, s48
    v_mfma_f32_16x16x32_bf16 v[72:75], a[64:67], a[16:19], v[72:75]
    ds_read_b64_tr_b16 a[80:81], v24 offset:0
    v_mfma_f32_16x16x32_bf16 v[72:75], a[68:71], a[20:23], v[72:75]
    s_add_u32 s70, s30, 3
    v_mfma_f32_16x16x32_bf16 a[136:139], a[100:103], a[20:23], a[136:139]
    ds_read_b64_tr_b16 a[82:83], v24 offset:1024
    s_and_b32 s70, s70, 3
    v_mfma_f32_16x16x32_bf16 a[136:139], a[96:99], a[16:19], a[136:139]
    s_add_u32 s70, s70, s59
    v_mfma_f32_16x16x32_bf16 v[104:107], a[72:75], a[16:19], v[104:107]
    ds_read_b64_tr_b16 a[84:85], v24 offset:8192
    v_mfma_f32_16x16x32_bf16 v[104:107], a[76:79], a[20:23], v[104:107]
    s_lshl_b32 s70, s70, 16
    v_mfma_f32_16x16x32_bf16 a[168:171], a[108:111], a[20:23], a[168:171]
    ds_read_b64_tr_b16 a[86:87], v24 offset:9216
    s_add_u32 s28, s30, 0
    v_mfma_f32_16x16x32_bf16 a[168:171], a[104:107], a[16:19], a[168:171]
    s_and_b32 s28, s28, 3
    v_mfma_f32_16x16x32_bf16 a[172:175], a[104:107], a[24:27], a[172:175]
    ds_read_b64_tr_b16 a[112:113], v24 offset:16384
    v_mfma_f32_16x16x32_bf16 a[172:175], a[108:111], a[28:31], a[172:175]
    s_add_u32 s28, s28, s59
    v_mfma_f32_16x16x32_bf16 v[108:111], a[76:79], a[28:31], v[108:111]
    ds_read_b64_tr_b16 a[114:115], v24 offset:17408
    s_lshl_b32 s28, s28, 16
    v_mfma_f32_16x16x32_bf16 v[108:111], a[72:75], a[24:27], v[108:111]
    s_add_u32 s29, s30, 1
    v_mfma_f32_16x16x32_bf16 a[140:143], a[96:99], a[24:27], a[140:143]
    ds_read_b64_tr_b16 a[116:117], v24 offset:24576
    v_mfma_f32_16x16x32_bf16 a[140:143], a[100:103], a[28:31], a[140:143]
    s_and_b32 s29, s29, 3
    v_mfma_f32_16x16x32_bf16 v[76:79], a[68:71], a[28:31], v[76:79]
    ds_read_b64_tr_b16 a[118:119], v24 offset:25600
    s_add_u32 s29, s29, s59
    v_mfma_f32_16x16x32_bf16 v[76:79], a[64:67], a[24:27], v[76:79]
    s_waitcnt lgkmcnt(8)
    s_lshl_b32 s29, s29, 16
    v_mfma_f32_16x16x32_bf16 v[80:83], a[64:67], a[32:35], v[80:83]
    ds_read_b64_tr_b16 a[88:89], v25 offset:0
    v_mfma_f32_16x16x32_bf16 v[80:83], a[68:71], a[36:39], v[80:83]
    s_add_u32 s30, s30, 2
    s_and_b32 s30, s30, 3
    v_mfma_f32_16x16x32_bf16 a[144:147], a[100:103], a[36:39], a[144:147]
    ds_read_b64_tr_b16 a[90:91], v25 offset:1024
    v_mfma_f32_16x16x32_bf16 a[144:147], a[96:99], a[32:35], a[144:147]
    s_add_u32 s30, s30, s59
    v_mfma_f32_16x16x32_bf16 v[112:115], a[72:75], a[32:35], v[112:115]
    ds_read_b64_tr_b16 a[92:93], v25 offset:8192
    v_mfma_f32_16x16x32_bf16 v[112:115], a[76:79], a[36:39], v[112:115]
    s_lshl_b32 s30, s30, 16
    s_and_b32 s62, s40, 1
    v_mfma_f32_16x16x32_bf16 a[176:179], a[108:111], a[36:39], a[176:179]
    ds_read_b64_tr_b16 a[94:95], v25 offset:9216
    v_mfma_f32_16x16x32_bf16 a[176:179], a[104:107], a[32:35], a[176:179]
    s_mul_i32 s31, s47, 98304
    v_mfma_f32_16x16x32_bf16 a[180:183], a[104:107], a[40:43], a[180:183]
    ds_read_b64_tr_b16 a[120:121], v25 offset:16384
    v_mfma_f32_16x16x32_bf16 a[180:183], a[108:111], a[44:47], a[180:183]
    s_lshl_b32 s59, s62, 12
    s_add_u32 s31, s31, s59
    v_mfma_f32_16x16x32_bf16 v[116:119], a[76:79], a[44:47], v[116:119]
    ds_read_b64_tr_b16 a[122:123], v25 offset:17408
    v_mfma_f32_16x16x32_bf16 v[116:119], a[72:75], a[40:43], v[116:119]
    s_lshl_b32 s63, s63, 7
    v_mfma_f32_16x16x32_bf16 a[148:151], a[96:99], a[40:43], a[148:151]
    ds_read_b64_tr_b16 a[124:125], v25 offset:24576
    v_mfma_f32_16x16x32_bf16 a[148:151], a[100:103], a[44:47], a[148:151]
    v_lshrrev_b32 v43, 3, v0
    s_lshl_b32 s59, s62, 4
    v_mfma_f32_16x16x32_bf16 v[84:87], a[68:71], a[44:47], v[84:87]
    ds_read_b64_tr_b16 a[126:127], v25 offset:25600
    v_mfma_f32_16x16x32_bf16 v[84:87], a[64:67], a[40:43], v[84:87]
    v_add_u32 v43, s59, v43
    v_mfma_f32_16x16x32_bf16 v[88:91], a[64:67], a[48:51], v[88:91]
    v_lshlrev_b32 v43, 11, v43
    s_lshl_b32 s59, s58, 6
    v_mfma_f32_16x16x32_bf16 v[88:91], a[68:71], a[52:55], v[88:91]
    s_add_u32 s59, s59, s63
    v_mfma_f32_16x16x32_bf16 a[152:155], a[100:103], a[52:55], a[152:155]
    s_lshl_b32 s59, s59, 1
    v_mfma_f32_16x16x32_bf16 a[152:155], a[96:99], a[48:51], a[152:155]
    v_add_u32 v43, s59, v43
    v_mfma_f32_16x16x32_bf16 v[120:123], a[72:75], a[48:51], v[120:123]
    v_and_b32 v44, 7, v0
    v_lshrrev_b32 v45, 3, v0
    v_mfma_f32_16x16x32_bf16 v[120:123], a[76:79], a[52:55], v[120:123]
IW_P1:
    s_cbranch_execz IW_R0
    v_and_b32 v45, 2, v45
    v_mfma_f32_16x16x32_bf16 a[184:187], a[108:111], a[52:55], a[184:187]
    v_xor_b32 v44, v44, v45
    v_mfma_f32_16x16x32_bf16 a[184:187], a[104:107], a[48:51], a[184:187]
    v_lshlrev_b32 v44, 4, v44
    v_mfma_f32_16x16x32_bf16 a[188:191], a[104:107], a[56:59], a[188:191]
    v_add_u32 v30, v43, v44
    v_xor_b32 v44, 64, v30
    v_mfma_f32_16x16x32_bf16 a[188:191], a[108:111], a[60:63], a[188:191]
    v_xor_b32 v1, 0x80, v30
    v_mfma_f32_16x16x32_bf16 v[124:127], a[76:79], a[60:63], v[124:127]
    v_xor_b32 v46, 0x80, v44
    v_mfma_f32_16x16x32_bf16 v[124:127], a[72:75], a[56:59], v[124:127]
    v_add_u32 v29, 0x3c00, v46
    v_mfma_f32_16x16x32_bf16 a[156:159], a[96:99], a[56:59], a[156:159]
    v_add_u32 v31, 0x3c00, v44
    s_mov_b32 s24, s100
    v_mfma_f32_16x16x32_bf16 a[156:159], a[100:103], a[60:63], a[156:159]
    s_mov_b32 s25, s101
    v_mfma_f32_16x16x32_bf16 v[92:95], a[68:71], a[60:63], v[92:95]
    s_mov_b32 s26, 0x700000
    v_mfma_f32_16x16x32_bf16 v[92:95], a[64:67], a[56:59], v[92:95]
    s_mov_b32 s27, 0x00020000
    s_waitcnt lgkmcnt(0)
    s_add_u32 m0, s22, 0x0
    s_waitcnt vmcnt(1)
    s_barrier
    v_mfma_f32_16x16x32_bf16 v[128:131], a[80:83], a[0:3], v[128:131]
    ds_read_b64_tr_b16 a[64:65], v18 offset:0
    v_mfma_f32_16x16x32_bf16 v[128:131], a[84:87], a[4:7], v[128:131]
    buffer_load_dwordx4 v2, s[4:7], s20 offen offset:0 lds
    v_mfma_f32_16x16x32_bf16 a[192:195], a[116:119], a[4:7], a[192:195]
    ds_read_b64_tr_b16 a[66:67], v18 offset:1024
    v_mfma_f32_16x16x32_bf16 a[192:195], a[112:115], a[0:3], a[192:195]
    v_mfma_f32_16x16x32_bf16 v[160:163], a[88:91], a[0:3], v[160:163]
    ds_read_b64_tr_b16 a[68:69], v18 offset:8192
    v_mfma_f32_16x16x32_bf16 v[160:163], a[92:95], a[4:7], v[160:163]
    buffer_load_dwordx4 v3, s[4:7], s20 offen offset:1024 lds
    v_mfma_f32_16x16x32_bf16 a[224:227], a[124:127], a[4:7], a[224:227]
    ds_read_b64_tr_b16 a[70:71], v18 offset:9216
    v_mfma_f32_16x16x32_bf16 a[224:227], a[120:123], a[0:3], a[224:227]
    v_mfma_f32_16x16x32_bf16 a[228:231], a[120:123], a[8:11], a[228:231]
    ds_read_b128 a[0:3], v34 offset:0
    v_mfma_f32_16x16x32_bf16 a[228:231], a[124:127], a[12:15], a[228:231]
    buffer_load_dwordx4 v4, s[4:7], s20 offen offset:2048 lds
    v_mfma_f32_16x16x32_bf16 v[164:167], a[92:95], a[12:15], v[164:167]
    ds_read_b128 a[4:7], v35 offset:0
    v_mfma_f32_16x16x32_bf16 v[164:167], a[88:91], a[8:11], v[164:167]
    v_mfma_f32_16x16x32_bf16 a[196:199], a[112:115], a[8:11], a[196:199]
    ds_read_b64_tr_b16 a[96:97], v18 offset:16384
    v_mfma_f32_16x16x32_bf16 a[196:199], a[116:119], a[12:15], a[196:199]
    buffer_load_dwordx4 v5, s[4:7], s20 offen offset:3072 lds
    v_mfma_f32_16x16x32_bf16 v[132:135], a[84:87], a[12:15], v[132:135]
    ds_read_b64_tr_b16 a[98:99], v18 offset:17408
    v_mfma_f32_16x16x32_bf16 v[132:135], a[80:83], a[8:11], v[132:135]
    s_add_u32 m0, s22, 0x1000
    v_mfma_f32_16x16x32_bf16 v[136:139], a[80:83], a[16:19], v[136:139]
    ds_read_b128 a[8:11], v34 offset:2048
    v_mfma_f32_16x16x32_bf16 v[136:139], a[84:87], a[20:23], v[136:139]
    buffer_load_dwordx4 v6, s[4:7], s20 offen offset:0 lds
    v_mfma_f32_16x16x32_bf16 a[200:203], a[116:119], a[20:23], a[200:203]
    ds_read_b128 a[12:15], v35 offset:2048
    v_mfma_f32_16x16x32_bf16 a[200:203], a[112:115], a[16:19], a[200:203]
    v_mfma_f32_16x16x32_bf16 v[168:171], a[88:91], a[16:19], v[168:171]
    ds_read_b64_tr_b16 a[100:101], v18 offset:24576
    v_mfma_f32_16x16x32_bf16 v[168:171], a[92:95], a[20:23], v[168:171]
    buffer_load_dwordx4 v7, s[4:7], s20 offen offset:1024 lds
    v_mfma_f32_16x16x32_bf16 a[232:235], a[124:127], a[20:23], a[232:235]
    ds_read_b64_tr_b16 a[102:103], v18 offset:25600
    v_mfma_f32_16x16x32_bf16 a[232:235], a[120:123], a[16:19], a[232:235]
    v_mfma_f32_16x16x32_bf16 a[236:239], a[120:123], a[24:27], a[236:239]
    ds_read_b128 a[16:19], v34 offset:4096
    v_mfma_f32_16x16x32_bf16 a[236:239], a[124:127], a[28:31], a[236:239]
    buffer_load_dwordx4 v8, s[4:7], s20 offen offset:2048 lds
    v_mfma_f32_16x16x32_bf16 v[172:175], a[92:95], a[28:31], v[172:175]
    ds_read_b128 a[20:23], v35 offset:4096
    v_mfma_f32_16x16x32_bf16 v[172:175], a[88:91], a[24:27], v[172:175]
    v_mfma_f32_16x16x32_bf16 a[204:207], a[112:115], a[24:27], a[204:207]
    ds_read_b64_tr_b16 a[72:73], v19 offset:0
    v_mfma_f32_16x16x32_bf16 a[204:207], a[116:119], a[28:31], a[204:207]
    buffer_load_dwordx4 v9, s[4:7], s20 offen offset:3072 lds
    v_mfma_f32_16x16x32_bf16 v[140:143], a[84:87], a[28:31], v[140:143]
    ds_read_b64_tr_b16 a[74:75], v19 offset:1024
    v_mfma_f32_16x16x32_bf16 v[140:143], a[80:83], a[24:27], v[140:143]
    s_add_u32 s20, s20, 128
    s_add_u32 m0, s23, 0x8000
    v_mfma_f32_16x16x32_bf16 v[144:147], a[80:83], a[32:35], v[144:147]
    ds_read_b128 a[24:27], v34 offset:6144
    v_mfma_f32_16x16x32_bf16 v[144:147], a[84:87], a[36:39], v[144:147]
    buffer_load_dwordx4 v10, s[8:11], s21 offen offset:0 lds
    v_mfma_f32_16x16x32_bf16 a[208:211], a[116:119], a[36:39], a[208:211]
    ds_read_b128 a[28:31], v35 offset:6144
    v_mfma_f32_16x16x32_bf16 a[208:211], a[112:115], a[32:35], a[208:211]
    v_mfma_f32_16x16x32_bf16 v[176:179], a[88:91], a[32:35], v[176:179]
    ds_read_b64_tr_b16 a[76:77], v19 offset:8192
    v_mfma_f32_16x16x32_bf16 v[176:179], a[92:95], a[36:39], v[176:179]
    buffer_load_dwordx4 v11, s[8:11], s21 offen offset:1024 lds
    v_mfma_f32_16x16x32_bf16 a[240:243], a[124:127], a[36:39], a[240:243]
    ds_read_b64_tr_b16 a[78:79], v19 offset:9216
    v_mfma_f32_16x16x32_bf16 a[240:243], a[120:123], a[32:35], a[240:243]
    v_mfma_f32_16x16x32_bf16 a[244:247], a[120:123], a[40:43], a[244:247]
    ds_read_b64_tr_b16 a[104:105], v19 offset:16384
    v_mfma_f32_16x16x32_bf16 a[244:247], a[124:127], a[44:47], a[244:247]
    buffer_load_dwordx4 v12, s[8:11], s21 offen offset:2048 lds
    v_mfma_f32_16x16x32_bf16 v[180:183], a[92:95], a[44:47], v[180:183]
    ds_read_b64_tr_b16 a[106:107], v19 offset:17408
    v_mfma_f32_16x16x32_bf16 v[180:183], a[88:91], a[40:43], v[180:183]
    v_mfma_f32_16x16x32_bf16 a[212:215], a[112:115], a[40:43], a[212:215]
    ds_read_b64_tr_b16 a[108:109], v19 offset:24576
    v_mfma_f32_16x16x32_bf16 a[212:215], a[116:119], a[44:47], a[212:215]
    buffer_load_dwordx4 v13, s[8:11], s21 offen offset:3072 lds
    v_mfma_f32_16x16x32_bf16 v[148:151], a[84:87], a[44:47], v[148:151]
    ds_read_b64_tr_b16 a[110:111], v19 offset:25600
    v_mfma_f32_16x16x32_bf16 v[148:151], a[80:83], a[40:43], v[148:151]
    s_add_u32 m0, s23, 0xc000
    v_mfma_f32_16x16x32_bf16 v[152:155], a[80:83], a[48:51], v[152:155]
    v_mfma_f32_16x16x32_bf16 v[152:155], a[84:87], a[52:55], v[152:155]
    buffer_load_dwordx4 v10, s[12:15], s21 offen offset:0 lds
    v_mfma_f32_16x16x32_bf16 a[216:219], a[116:119], a[52:55], a[216:219]
    v_mfma_f32_16x16x32_bf16 a[216:219], a[112:115], a[48:51], a[216:219]
    v_mfma_f32_16x16x32_bf16 v[184:187], a[88:91], a[48:51], v[184:187]
    buffer_load_dwordx4 v11, s[12:15], s21 offen offset:1024 lds
    v_mfma_f32_16x16x32_bf16 v[184:187], a[92:95], a[52:55], v[184:187]
    v_mfma_f32_16x16x32_bf16 a[248:251], a[124:127], a[52:55], a[248:251]
    v_mfma_f32_16x16x32_bf16 a[248:251], a[120:123], a[48:51], a[248:251]
    buffer_load_dwordx4 v12, s[12:15], s21 offen offset:2048 lds
    v_mfma_f32_16x16x32_bf16 a[252:255], a[120:123], a[56:59], a[252:255]
    v_mfma_f32_16x16x32_bf16 a[252:255], a[124:127], a[60:63], a[252:255]
    v_mfma_f32_16x16x32_bf16 v[188:191], a[92:95], a[60:63], v[188:191]
    buffer_load_dwordx4 v13, s[12:15], s21 offen offset:3072 lds
    v_mfma_f32_16x16x32_bf16 v[188:191], a[88:91], a[56:59], v[188:191]
    v_mfma_f32_16x16x32_bf16 a[220:223], a[112:115], a[56:59], a[220:223]
    s_add_u32 s21, s21, 0x70000
    v_mfma_f32_16x16x32_bf16 a[220:223], a[116:119], a[60:63], a[220:223]
    buffer_load_dword v42, v41, s[52:55], s56 offen
    v_mfma_f32_16x16x32_bf16 v[156:159], a[84:87], a[60:63], v[156:159]
    s_add_u32 s56, s56, s57
    v_mfma_f32_16x16x32_bf16 v[156:159], a[80:83], a[56:59], v[156:159]
    s_movk_i32 s3, 4
G1_LOOP:
    s_waitcnt lgkmcnt(0)
    v_mfma_f32_16x16x32_bf16 v[64:67], a[64:67], a[0:3], v[64:67]
    ds_read_b128 a[32:35], v34 offset:8192
    v_mfma_f32_16x16x32_bf16 v[64:67], a[68:71], a[4:7], v[64:67]
    v_mfma_f32_16x16x32_bf16 a[128:131], a[100:103], a[4:7], a[128:131]
    ds_read_b128 a[36:39], v35 offset:8192
    v_mfma_f32_16x16x32_bf16 a[128:131], a[96:99], a[0:3], a[128:131]
    v_mfma_f32_16x16x32_bf16 v[96:99], a[72:75], a[0:3], v[96:99]
    ds_read_b128 a[40:43], v34 offset:10240
    v_mfma_f32_16x16x32_bf16 v[96:99], a[76:79], a[4:7], v[96:99]
    v_mfma_f32_16x16x32_bf16 a[160:163], a[108:111], a[4:7], a[160:163]
    ds_read_b128 a[44:47], v35 offset:10240
    v_mfma_f32_16x16x32_bf16 a[160:163], a[104:107], a[0:3], a[160:163]
    v_mfma_f32_16x16x32_bf16 a[164:167], a[104:107], a[8:11], a[164:167]
    ds_read_b128 a[48:51], v34 offset:12288
    v_mfma_f32_16x16x32_bf16 a[164:167], a[108:111], a[12:15], a[164:167]
    v_mfma_f32_16x16x32_bf16 v[100:103], a[76:79], a[12:15], v[100:103]
    ds_read_b128 a[52:55], v35 offset:12288
    v_mfma_f32_16x16x32_bf16 v[100:103], a[72:75], a[8:11], v[100:103]
    v_mfma_f32_16x16x32_bf16 a[132:135], a[96:99], a[8:11], a[132:135]
    ds_read_b128 a[56:59], v34 offset:14336
    v_mfma_f32_16x16x32_bf16 a[132:135], a[100:103], a[12:15], a[132:135]
    v_mfma_f32_16x16x32_bf16 v[68:71], a[68:71], a[12:15], v[68:71]
    ds_read_b128 a[60:63], v35 offset:14336
    v_mfma_f32_16x16x32_bf16 v[68:71], a[64:67], a[8:11], v[68:71]
    v_mfma_f32_16x16x32_bf16 v[72:75], a[64:67], a[16:19], v[72:75]
    ds_read_b64_tr_b16 a[80:81], v20 offset:0
    v_mfma_f32_16x16x32_bf16 v[72:75], a[68:71], a[20:23], v[72:75]
    v_mfma_f32_16x16x32_bf16 a[136:139], a[100:103], a[20:23], a[136:139]
    ds_read_b64_tr_b16 a[82:83], v20 offset:1024
    v_mfma_f32_16x16x32_bf16 a[136:139], a[96:99], a[16:19], a[136:139]
    v_mfma_f32_16x16x32_bf16 v[104:107], a[72:75], a[16:19], v[104:107]
    ds_read_b64_tr_b16 a[84:85], v20 offset:8192
    v_mfma_f32_16x16x32_bf16 v[104:107], a[76:79], a[20:23], v[104:107]
    v_mfma_f32_16x16x32_bf16 a[168:171], a[108:111], a[20:23], a[168:171]
    ds_read_b64_tr_b16 a[86:87], v20 offset:9216
    v_mfma_f32_16x16x32_bf16 a[168:171], a[104:107], a[16:19], a[168:171]
    v_mfma_f32_16x16x32_bf16 a[172:175], a[104:107], a[24:27], a[172:175]
    ds_read_b64_tr_b16 a[112:113], v20 offset:16384
    v_mfma_f32_16x16x32_bf16 a[172:175], a[108:111], a[28:31], a[172:175]
    v_mfma_f32_16x16x32_bf16 v[108:111], a[76:79], a[28:31], v[108:111]
    ds_read_b64_tr_b16 a[114:115], v20 offset:17408
    v_mfma_f32_16x16x32_bf16 v[108:111], a[72:75], a[24:27], v[108:111]
    v_mfma_f32_16x16x32_bf16 a[140:143], a[96:99], a[24:27], a[140:143]
    ds_read_b64_tr_b16 a[116:117], v20 offset:24576
    v_mfma_f32_16x16x32_bf16 a[140:143], a[100:103], a[28:31], a[140:143]
    v_mfma_f32_16x16x32_bf16 v[76:79], a[68:71], a[28:31], v[76:79]
    ds_read_b64_tr_b16 a[118:119], v20 offset:25600
    v_mfma_f32_16x16x32_bf16 v[76:79], a[64:67], a[24:27], v[76:79]
    s_waitcnt lgkmcnt(8)
    v_mfma_f32_16x16x32_bf16 v[80:83], a[64:67], a[32:35], v[80:83]
    ds_read_b64_tr_b16 a[88:89], v21 offset:0
    v_mfma_f32_16x16x32_bf16 v[80:83], a[68:71], a[36:39], v[80:83]
    v_mfma_f32_16x16x32_bf16 a[144:147], a[100:103], a[36:39], a[144:147]
    ds_read_b64_tr_b16 a[90:91], v21 offset:1024
    v_mfma_f32_16x16x32_bf16 a[144:147], a[96:99], a[32:35], a[144:147]
    v_mfma_f32_16x16x32_bf16 v[112:115], a[72:75], a[32:35], v[112:115]
    ds_read_b64_tr_b16 a[92:93], v21 offset:8192
    v_mfma_f32_16x16x32_bf16 v[112:115], a[76:79], a[36:39], v[112:115]
    v_mfma_f32_16x16x32_bf16 a[176:179], a[108:111], a[36:39], a[176:179]
    ds_read_b64_tr_b16 a[94:95], v21 offset:9216
    v_mfma_f32_16x16x32_bf16 a[176:179], a[104:107], a[32:35], a[176:179]
    v_mfma_f32_16x16x32_bf16 a[180:183], a[104:107], a[40:43], a[180:183]
    ds_read_b64_tr_b16 a[120:121], v21 offset:16384
    v_mfma_f32_16x16x32_bf16 a[180:183], a[108:111], a[44:47], a[180:183]
    v_mfma_f32_16x16x32_bf16 v[116:119], a[76:79], a[44:47], v[116:119]
    ds_read_b64_tr_b16 a[122:123], v21 offset:17408
    v_mfma_f32_16x16x32_bf16 v[116:119], a[72:75], a[40:43], v[116:119]
    v_mfma_f32_16x16x32_bf16 a[148:151], a[96:99], a[40:43], a[148:151]
    ds_read_b64_tr_b16 a[124:125], v21 offset:24576
    v_mfma_f32_16x16x32_bf16 a[148:151], a[100:103], a[44:47], a[148:151]
    v_mfma_f32_16x16x32_bf16 v[84:87], a[68:71], a[44:47], v[84:87]
    ds_read_b64_tr_b16 a[126:127], v21 offset:25600
    v_mfma_f32_16x16x32_bf16 v[84:87], a[64:67], a[40:43], v[84:87]
    v_mfma_f32_16x16x32_bf16 v[88:91], a[64:67], a[48:51], v[88:91]
    v_mfma_f32_16x16x32_bf16 v[88:91], a[68:71], a[52:55], v[88:91]
    v_mfma_f32_16x16x32_bf16 a[152:155], a[100:103], a[52:55], a[152:155]
    v_mfma_f32_16x16x32_bf16 a[152:155], a[96:99], a[48:51], a[152:155]
    v_mfma_f32_16x16x32_bf16 v[120:123], a[72:75], a[48:51], v[120:123]
    v_mfma_f32_16x16x32_bf16 v[120:123], a[76:79], a[52:55], v[120:123]
    v_mfma_f32_16x16x32_bf16 a[184:187], a[108:111], a[52:55], a[184:187]
    v_mfma_f32_16x16x32_bf16 a[184:187], a[104:107], a[48:51], a[184:187]
    v_mfma_f32_16x16x32_bf16 a[188:191], a[104:107], a[56:59], a[188:191]
    v_mfma_f32_16x16x32_bf16 a[188:191], a[108:111], a[60:63], a[188:191]
    v_mfma_f32_16x16x32_bf16 v[124:127], a[76:79], a[60:63], v[124:127]
    v_mfma_f32_16x16x32_bf16 v[124:127], a[72:75], a[56:59], v[124:127]
    v_mfma_f32_16x16x32_bf16 a[156:159], a[96:99], a[56:59], a[156:159]
    v_mfma_f32_16x16x32_bf16 a[156:159], a[100:103], a[60:63], a[156:159]
    v_mfma_f32_16x16x32_bf16 v[92:95], a[68:71], a[60:63], v[92:95]
    v_mfma_f32_16x16x32_bf16 v[92:95], a[64:67], a[56:59], v[92:95]
    s_waitcnt lgkmcnt(0)
    s_add_u32 m0, s22, 0x10000
    s_waitcnt vmcnt(1)
    s_barrier
    v_mfma_f32_16x16x32_bf16 v[128:131], a[80:83], a[0:3], v[128:131]
    ds_read_b64_tr_b16 a[64:65], v22 offset:0
    v_mfma_f32_16x16x32_bf16 v[128:131], a[84:87], a[4:7], v[128:131]
    buffer_load_dwordx4 v2, s[4:7], s20 offen offset:0 lds
    v_mfma_f32_16x16x32_bf16 a[192:195], a[116:119], a[4:7], a[192:195]
    ds_read_b64_tr_b16 a[66:67], v22 offset:1024
    v_mfma_f32_16x16x32_bf16 a[192:195], a[112:115], a[0:3], a[192:195]
    v_mfma_f32_16x16x32_bf16 v[160:163], a[88:91], a[0:3], v[160:163]
    ds_read_b64_tr_b16 a[68:69], v22 offset:8192
    v_mfma_f32_16x16x32_bf16 v[160:163], a[92:95], a[4:7], v[160:163]
    buffer_load_dwordx4 v3, s[4:7], s20 offen offset:1024 lds
    v_mfma_f32_16x16x32_bf16 a[224:227], a[124:127], a[4:7], a[224:227]
    ds_read_b64_tr_b16 a[70:71], v22 offset:9216
    v_mfma_f32_16x16x32_bf16 a[224:227], a[120:123], a[0:3], a[224:227]
    v_mfma_f32_16x16x32_bf16 a[228:231], a[120:123], a[8:11], a[228:231]
    ds_read_b128 a[0:3], v16 offset:0
    v_mfma_f32_16x16x32_bf16 a[228:231], a[124:127], a[12:15], a[228:231]
    buffer_load_dwordx4 v4, s[4:7], s20 offen offset:2048 lds
    v_mfma_f32_16x16x32_bf16 v[164:167], a[92:95], a[12:15], v[164:167]
    ds_read_b128 a[4:7], v17 offset:0
    v_mfma_f32_16x16x32_bf16 v[164:167], a[88:91], a[8:11], v[164:167]
    v_mfma_f32_16x16x32_bf16 a[196:199], a[112:115], a[8:11], a[196:199]
    ds_read_b64_tr_b16 a[96:97], v22 offset:16384
    v_mfma_f32_16x16x32_bf16 a[196:199], a[116:119], a[12:15], a[196:199]
    buffer_load_dwordx4 v5, s[4:7], s20 offen offset:3072 lds
    v_mfma_f32_16x16x32_bf16 v[132:135], a[84:87], a[12:15], v[132:135]
    ds_read_b64_tr_b16 a[98:99], v22 offset:17408
    v_mfma_f32_16x16x32_bf16 v[132:135], a[80:83], a[8:11], v[132:135]
    s_add_u32 m0, s22, 0x11000
    v_mfma_f32_16x16x32_bf16 v[136:139], a[80:83], a[16:19], v[136:139]
    ds_read_b128 a[8:11], v16 offset:2048
    v_mfma_f32_16x16x32_bf16 v[136:139], a[84:87], a[20:23], v[136:139]
    buffer_load_dwordx4 v6, s[4:7], s20 offen offset:0 lds
    v_mfma_f32_16x16x32_bf16 a[200:203], a[116:119], a[20:23], a[200:203]
    ds_read_b128 a[12:15], v17 offset:2048
    v_mfma_f32_16x16x32_bf16 a[200:203], a[112:115], a[16:19], a[200:203]
    v_mfma_f32_16x16x32_bf16 v[168:171], a[88:91], a[16:19], v[168:171]
    ds_read_b64_tr_b16 a[100:101], v22 offset:24576
    v_mfma_f32_16x16x32_bf16 v[168:171], a[92:95], a[20:23], v[168:171]
    buffer_load_dwordx4 v7, s[4:7], s20 offen offset:1024 lds
    v_mfma_f32_16x16x32_bf16 a[232:235], a[124:127], a[20:23], a[232:235]
    ds_read_b64_tr_b16 a[102:103], v22 offset:25600
    v_mfma_f32_16x16x32_bf16 a[232:235], a[120:123], a[16:19], a[232:235]
    v_mfma_f32_16x16x32_bf16 a[236:239], a[120:123], a[24:27], a[236:239]
    ds_read_b128 a[16:19], v16 offset:4096
    v_mfma_f32_16x16x32_bf16 a[236:239], a[124:127], a[28:31], a[236:239]
    buffer_load_dwordx4 v8, s[4:7], s20 offen offset:2048 lds
    v_mfma_f32_16x16x32_bf16 v[172:175], a[92:95], a[28:31], v[172:175]
    ds_read_b128 a[20:23], v17 offset:4096
    v_mfma_f32_16x16x32_bf16 v[172:175], a[88:91], a[24:27], v[172:175]
    v_mfma_f32_16x16x32_bf16 a[204:207], a[112:115], a[24:27], a[204:207]
    ds_read_b64_tr_b16 a[72:73], v23 offset:0
    v_mfma_f32_16x16x32_bf16 a[204:207], a[116:119], a[28:31], a[204:207]
    buffer_load_dwordx4 v9, s[4:7], s20 offen offset:3072 lds
    v_mfma_f32_16x16x32_bf16 v[140:143], a[84:87], a[28:31], v[140:143]
    ds_read_b64_tr_b16 a[74:75], v23 offset:1024
    v_mfma_f32_16x16x32_bf16 v[140:143], a[80:83], a[24:27], v[140:143]
    s_add_u32 s20, s20, 128
    s_add_u32 m0, s23, 0x18000
    v_mfma_f32_16x16x32_bf16 v[144:147], a[80:83], a[32:35], v[144:147]
    ds_read_b128 a[24:27], v16 offset:6144
    v_mfma_f32_16x16x32_bf16 v[144:147], a[84:87], a[36:39], v[144:147]
    buffer_load_dwordx4 v10, s[8:11], s21 offen offset:0 lds
    v_mfma_f32_16x16x32_bf16 a[208:211], a[116:119], a[36:39], a[208:211]
    ds_read_b128 a[28:31], v17 offset:6144
    v_mfma_f32_16x16x32_bf16 a[208:211], a[112:115], a[32:35], a[208:211]
    v_mfma_f32_16x16x32_bf16 v[176:179], a[88:91], a[32:35], v[176:179]
    ds_read_b64_tr_b16 a[76:77], v23 offset:8192
    v_mfma_f32_16x16x32_bf16 v[176:179], a[92:95], a[36:39], v[176:179]
    buffer_load_dwordx4 v11, s[8:11], s21 offen offset:1024 lds
    v_mfma_f32_16x16x32_bf16 a[240:243], a[124:127], a[36:39], a[240:243]
    ds_read_b64_tr_b16 a[78:79], v23 offset:9216
    v_mfma_f32_16x16x32_bf16 a[240:243], a[120:123], a[32:35], a[240:243]
    v_mfma_f32_16x16x32_bf16 a[244:247], a[120:123], a[40:43], a[244:247]
    ds_read_b64_tr_b16 a[104:105], v23 offset:16384
    v_mfma_f32_16x16x32_bf16 a[244:247], a[124:127], a[44:47], a[244:247]
    buffer_load_dwordx4 v12, s[8:11], s21 offen offset:2048 lds
    v_mfma_f32_16x16x32_bf16 v[180:183], a[92:95], a[44:47], v[180:183]
    ds_read_b64_tr_b16 a[106:107], v23 offset:17408
    v_mfma_f32_16x16x32_bf16 v[180:183], a[88:91], a[40:43], v[180:183]
    v_mfma_f32_16x16x32_bf16 a[212:215], a[112:115], a[40:43], a[212:215]
    ds_read_b64_tr_b16 a[108:109], v23 offset:24576
    v_mfma_f32_16x16x32_bf16 a[212:215], a[116:119], a[44:47], a[212:215]
    buffer_load_dwordx4 v13, s[8:11], s21 offen offset:3072 lds
    v_mfma_f32_16x16x32_bf16 v[148:151], a[84:87], a[44:47], v[148:151]
    ds_read_b64_tr_b16 a[110:111], v23 offset:25600
    v_mfma_f32_16x16x32_bf16 v[148:151], a[80:83], a[40:43], v[148:151]
    s_add_u32 m0, s23, 0x1c000
    v_mfma_f32_16x16x32_bf16 v[152:155], a[80:83], a[48:51], v[152:155]
    v_mfma_f32_16x16x32_bf16 v[152:155], a[84:87], a[52:55], v[152:155]
    buffer_load_dwordx4 v10, s[12:15], s21 offen offset:0 lds
    v_mfma_f32_16x16x32_bf16 a[216:219], a[116:119], a[52:55], a[216:219]
    v_mfma_f32_16x16x32_bf16 a[216:219], a[112:115], a[48:51], a[216:219]
    v_mfma_f32_16x16x32_bf16 v[184:187], a[88:91], a[48:51], v[184:187]
    buffer_load_dwordx4 v11, s[12:15], s21 offen offset:1024 lds
    v_mfma_f32_16x16x32_bf16 v[184:187], a[92:95], a[52:55], v[184:187]
    v_mfma_f32_16x16x32_bf16 a[248:251], a[124:127], a[52:55], a[248:251]
    v_mfma_f32_16x16x32_bf16 a[248:251], a[120:123], a[48:51], a[248:251]
    buffer_load_dwordx4 v12, s[12:15], s21 offen offset:2048 lds
    v_mfma_f32_16x16x32_bf16 a[252:255], a[120:123], a[56:59], a[252:255]
    v_mfma_f32_16x16x32_bf16 a[252:255], a[124:127], a[60:63], a[252:255]
    v_mfma_f32_16x16x32_bf16 v[188:191], a[92:95], a[60:63], v[188:191]
    buffer_load_dwordx4 v13, s[12:15], s21 offen offset:3072 lds
    v_mfma_f32_16x16x32_bf16 v[188:191], a[88:91], a[56:59], v[188:191]
    v_mfma_f32_16x16x32_bf16 a[220:223], a[112:115], a[56:59], a[220:223]
    s_add_u32 s21, s21, 0x70000
    v_mfma_f32_16x16x32_bf16 a[220:223], a[116:119], a[60:63], a[220:223]
    buffer_load_dword v42, v41, s[52:55], s56 offen
    v_mfma_f32_16x16x32_bf16 v[156:159], a[84:87], a[60:63], v[156:159]
    s_add_u32 s56, s56, s57
    v_mfma_f32_16x16x32_bf16 v[156:159], a[80:83], a[56:59], v[156:159]
    s_waitcnt lgkmcnt(0)
    v_mfma_f32_16x16x32_bf16 v[64:67], a[64:67], a[0:3], v[64:67]
    ds_read_b128 a[32:35], v16 offset:8192
    v_mfma_f32_16x16x32_bf16 v[64:67], a[68:71], a[4:7], v[64:67]
    v_mfma_f32_16x16x32_bf16 a[128:131], a[100:103], a[4:7], a[128:131]
    ds_read_b128 a[36:39], v17 offset:8192
    v_mfma_f32_16x16x32_bf16 a[128:131], a[96:99], a[0:3], a[128:131]
    v_mfma_f32_16x16x32_bf16 v[96:99], a[72:75], a[0:3], v[96:99]
    ds_read_b128 a[40:43], v16 offset:10240
    v_mfma_f32_16x16x32_bf16 v[96:99], a[76:79], a[4:7], v[96:99]
    v_mfma_f32_16x16x32_bf16 a[160:163], a[108:111], a[4:7], a[160:163]
    ds_read_b128 a[44:47], v17 offset:10240
    v_mfma_f32_16x16x32_bf16 a[160:163], a[104:107], a[0:3], a[160:163]
    v_mfma_f32_16x16x32_bf16 a[164:167], a[104:107], a[8:11], a[164:167]
    ds_read_b128 a[48:51], v16 offset:12288
    v_mfma_f32_16x16x32_bf16 a[164:167], a[108:111], a[12:15], a[164:167]
    v_mfma_f32_16x16x32_bf16 v[100:103], a[76:79], a[12:15], v[100:103]
    ds_read_b128 a[52:55], v17 offset:12288
    v_mfma_f32_16x16x32_bf16 v[100:103], a[72:75], a[8:11], v[100:103]
    v_mfma_f32_16x16x32_bf16 a[132:135], a[96:99], a[8:11], a[132:135]
    ds_read_b128 a[56:59], v16 offset:14336
    v_mfma_f32_16x16x32_bf16 a[132:135], a[100:103], a[12:15], a[132:135]
    v_mfma_f32_16x16x32_bf16 v[68:71], a[68:71], a[12:15], v[68:71]
    ds_read_b128 a[60:63], v17 offset:14336
    v_mfma_f32_16x16x32_bf16 v[68:71], a[64:67], a[8:11], v[68:71]
    v_mfma_f32_16x16x32_bf16 v[72:75], a[64:67], a[16:19], v[72:75]
    ds_read_b64_tr_b16 a[80:81], v24 offset:0
    v_mfma_f32_16x16x32_bf16 v[72:75], a[68:71], a[20:23], v[72:75]
    v_mfma_f32_16x16x32_bf16 a[136:139], a[100:103], a[20:23], a[136:139]
    ds_read_b64_tr_b16 a[82:83], v24 offset:1024
    v_mfma_f32_16x16x32_bf16 a[136:139], a[96:99], a[16:19], a[136:139]
    v_mfma_f32_16x16x32_bf16 v[104:107], a[72:75], a[16:19], v[104:107]
    ds_read_b64_tr_b16 a[84:85], v24 offset:8192
    v_mfma_f32_16x16x32_bf16 v[104:107], a[76:79], a[20:23], v[104:107]
    v_mfma_f32_16x16x32_bf16 a[168:171], a[108:111], a[20:23], a[168:171]
    ds_read_b64_tr_b16 a[86:87], v24 offset:9216
    v_mfma_f32_16x16x32_bf16 a[168:171], a[104:107], a[16:19], a[168:171]
    v_mfma_f32_16x16x32_bf16 a[172:175], a[104:107], a[24:27], a[172:175]
    ds_read_b64_tr_b16 a[112:113], v24 offset:16384
    v_mfma_f32_16x16x32_bf16 a[172:175], a[108:111], a[28:31], a[172:175]
    v_mfma_f32_16x16x32_bf16 v[108:111], a[76:79], a[28:31], v[108:111]
    ds_read_b64_tr_b16 a[114:115], v24 offset:17408
    v_mfma_f32_16x16x32_bf16 v[108:111], a[72:75], a[24:27], v[108:111]
    v_mfma_f32_16x16x32_bf16 a[140:143], a[96:99], a[24:27], a[140:143]
    ds_read_b64_tr_b16 a[116:117], v24 offset:24576
    v_mfma_f32_16x16x32_bf16 a[140:143], a[100:103], a[28:31], a[140:143]
    v_mfma_f32_16x16x32_bf16 v[76:79], a[68:71], a[28:31], v[76:79]
    ds_read_b64_tr_b16 a[118:119], v24 offset:25600
    v_mfma_f32_16x16x32_bf16 v[76:79], a[64:67], a[24:27], v[76:79]
    s_waitcnt lgkmcnt(8)
    v_mfma_f32_16x16x32_bf16 v[80:83], a[64:67], a[32:35], v[80:83]
    ds_read_b64_tr_b16 a[88:89], v25 offset:0
    v_mfma_f32_16x16x32_bf16 v[80:83], a[68:71], a[36:39], v[80:83]
    v_mfma_f32_16x16x32_bf16 a[144:147], a[100:103], a[36:39], a[144:147]
    ds_read_b64_tr_b16 a[90:91], v25 offset:1024
    v_mfma_f32_16x16x32_bf16 a[144:147], a[96:99], a[32:35], a[144:147]
    v_mfma_f32_16x16x32_bf16 v[112:115], a[72:75], a[32:35], v[112:115]
    ds_read_b64_tr_b16 a[92:93], v25 offset:8192
    v_mfma_f32_16x16x32_bf16 v[112:115], a[76:79], a[36:39], v[112:115]
    v_mfma_f32_16x16x32_bf16 a[176:179], a[108:111], a[36:39], a[176:179]
    ds_read_b64_tr_b16 a[94:95], v25 offset:9216
    v_mfma_f32_16x16x32_bf16 a[176:179], a[104:107], a[32:35], a[176:179]
    v_mfma_f32_16x16x32_bf16 a[180:183], a[104:107], a[40:43], a[180:183]
    ds_read_b64_tr_b16 a[120:121], v25 offset:16384
    v_mfma_f32_16x16x32_bf16 a[180:183], a[108:111], a[44:47], a[180:183]
    v_mfma_f32_16x16x32_bf16 v[116:119], a[76:79], a[44:47], v[116:119]
    ds_read_b64_tr_b16 a[122:123], v25 offset:17408
    v_mfma_f32_16x16x32_bf16 v[116:119], a[72:75], a[40:43], v[116:119]
    v_mfma_f32_16x16x32_bf16 a[148:151], a[96:99], a[40:43], a[148:151]
    ds_read_b64_tr_b16 a[124:125], v25 offset:24576
    v_mfma_f32_16x16x32_bf16 a[148:151], a[100:103], a[44:47], a[148:151]
    v_mfma_f32_16x16x32_bf16 v[84:87], a[68:71], a[44:47], v[84:87]
    ds_read_b64_tr_b16 a[126:127], v25 offset:25600
    v_mfma_f32_16x16x32_bf16 v[84:87], a[64:67], a[40:43], v[84:87]
    v_mfma_f32_16x16x32_bf16 v[88:91], a[64:67], a[48:51], v[88:91]
    v_mfma_f32_16x16x32_bf16 v[88:91], a[68:71], a[52:55], v[88:91]
    v_mfma_f32_16x16x32_bf16 a[152:155], a[100:103], a[52:55], a[152:155]
    v_mfma_f32_16x16x32_bf16 a[152:155], a[96:99], a[48:51], a[152:155]
    v_mfma_f32_16x16x32_bf16 v[120:123], a[72:75], a[48:51], v[120:123]
    v_mfma_f32_16x16x32_bf16 v[120:123], a[76:79], a[52:55], v[120:123]
    v_mfma_f32_16x16x32_bf16 a[184:187], a[108:111], a[52:55], a[184:187]
    v_mfma_f32_16x16x32_bf16 a[184:187], a[104:107], a[48:51], a[184:187]
    v_mfma_f32_16x16x32_bf16 a[188:191], a[104:107], a[56:59], a[188:191]
    v_mfma_f32_16x16x32_bf16 a[188:191], a[108:111], a[60:63], a[188:191]
    v_mfma_f32_16x16x32_bf16 v[124:127], a[76:79], a[60:63], v[124:127]
    v_mfma_f32_16x16x32_bf16 v[124:127], a[72:75], a[56:59], v[124:127]
    v_mfma_f32_16x16x32_bf16 a[156:159], a[96:99], a[56:59], a[156:159]
    v_mfma_f32_16x16x32_bf16 a[156:159], a[100:103], a[60:63], a[156:159]
    v_mfma_f32_16x16x32_bf16 v[92:95], a[68:71], a[60:63], v[92:95]
    v_mfma_f32_16x16x32_bf16 v[92:95], a[64:67], a[56:59], v[92:95]
    s_waitcnt lgkmcnt(0)
    s_add_u32 m0, s22, 0x0
    s_waitcnt vmcnt(1)
    s_barrier
    v_mfma_f32_16x16x32_bf16 v[128:131], a[80:83], a[0:3], v[128:131]
    ds_read_b64_tr_b16 a[64:65], v18 offset:0
    v_mfma_f32_16x16x32_bf16 v[128:131], a[84:87], a[4:7], v[128:131]
    buffer_load_dwordx4 v2, s[4:7], s20 offen offset:0 lds
    v_mfma_f32_16x16x32_bf16 a[192:195], a[116:119], a[4:7], a[192:195]
    ds_read_b64_tr_b16 a[66:67], v18 offset:1024
    v_mfma_f32_16x16x32_bf16 a[192:195], a[112:115], a[0:3], a[192:195]
    v_mfma_f32_16x16x32_bf16 v[160:163], a[88:91], a[0:3], v[160:163]
    ds_read_b64_tr_b16 a[68:69], v18 offset:8192
    v_mfma_f32_16x16x32_bf16 v[160:163], a[92:95], a[4:7], v[160:163]
    buffer_load_dwordx4 v3, s[4:7], s20 offen offset:1024 lds
    v_mfma_f32_16x16x32_bf16 a[224:227], a[124:127], a[4:7], a[224:227]
    ds_read_b64_tr_b16 a[70:71], v18 offset:9216
    v_mfma_f32_16x16x32_bf16 a[224:227], a[120:123], a[0:3], a[224:227]
    v_mfma_f32_16x16x32_bf16 a[228:231], a[120:123], a[8:11], a[228:231]
    ds_read_b128 a[0:3], v34 offset:0
    v_mfma_f32_16x16x32_bf16 a[228:231], a[124:127], a[12:15], a[228:231]
    buffer_load_dwordx4 v4, s[4:7], s20 offen offset:2048 lds
    v_mfma_f32_16x16x32_bf16 v[164:167], a[92:95], a[12:15], v[164:167]
    ds_read_b128 a[4:7], v35 offset:0
    v_mfma_f32_16x16x32_bf16 v[164:167], a[88:91], a[8:11], v[164:167]
    v_mfma_f32_16x16x32_bf16 a[196:199], a[112:115], a[8:11], a[196:199]
    ds_read_b64_tr_b16 a[96:97], v18 offset:16384
    v_mfma_f32_16x16x32_bf16 a[196:199], a[116:119], a[12:15], a[196:199]
    buffer_load_dwordx4 v5, s[4:7], s20 offen offset:3072 lds
    v_mfma_f32_16x16x32_bf16 v[132:135], a[84:87], a[12:15], v[132:135]
    ds_read_b64_tr_b16 a[98:99], v18 offset:17408
    v_mfma_f32_16x16x32_bf16 v[132:135], a[80:83], a[8:11], v[132:135]
    s_add_u32 m0, s22, 0x1000
    v_mfma_f32_16x16x32_bf16 v[136:139], a[80:83], a[16:19], v[136:139]
    ds_read_b128 a[8:11], v34 offset:2048
    v_mfma_f32_16x16x32_bf16 v[136:139], a[84:87], a[20:23], v[136:139]
    buffer_load_dwordx4 v6, s[4:7], s20 offen offset:0 lds
    v_mfma_f32_16x16x32_bf16 a[200:203], a[116:119], a[20:23], a[200:203]
    ds_read_b128 a[12:15], v35 offset:2048
    v_mfma_f32_16x16x32_bf16 a[200:203], a[112:115], a[16:19], a[200:203]
    v_mfma_f32_16x16x32_bf16 v[168:171], a[88:91], a[16:19], v[168:171]
    ds_read_b64_tr_b16 a[100:101], v18 offset:24576
    v_mfma_f32_16x16x32_bf16 v[168:171], a[92:95], a[20:23], v[168:171]
    buffer_load_dwordx4 v7, s[4:7], s20 offen offset:1024 lds
    v_mfma_f32_16x16x32_bf16 a[232:235], a[124:127], a[20:23], a[232:235]
    ds_read_b64_tr_b16 a[102:103], v18 offset:25600
    v_mfma_f32_16x16x32_bf16 a[232:235], a[120:123], a[16:19], a[232:235]
    v_mfma_f32_16x16x32_bf16 a[236:239], a[120:123], a[24:27], a[236:239]
    ds_read_b128 a[16:19], v34 offset:4096
    v_mfma_f32_16x16x32_bf16 a[236:239], a[124:127], a[28:31], a[236:239]
    buffer_load_dwordx4 v8, s[4:7], s20 offen offset:2048 lds
    v_mfma_f32_16x16x32_bf16 v[172:175], a[92:95], a[28:31], v[172:175]
    ds_read_b128 a[20:23], v35 offset:4096
    v_mfma_f32_16x16x32_bf16 v[172:175], a[88:91], a[24:27], v[172:175]
    v_mfma_f32_16x16x32_bf16 a[204:207], a[112:115], a[24:27], a[204:207]
    ds_read_b64_tr_b16 a[72:73], v19 offset:0
    v_mfma_f32_16x16x32_bf16 a[204:207], a[116:119], a[28:31], a[204:207]
    buffer_load_dwordx4 v9, s[4:7], s20 offen offset:3072 lds
    v_mfma_f32_16x16x32_bf16 v[140:143], a[84:87], a[28:31], v[140:143]
    ds_read_b64_tr_b16 a[74:75], v19 offset:1024
    v_mfma_f32_16x16x32_bf16 v[140:143], a[80:83], a[24:27], v[140:143]
    s_add_u32 s20, s20, 128
    s_add_u32 m0, s23, 0x8000
    v_mfma_f32_16x16x32_bf16 v[144:147], a[80:83], a[32:35], v[144:147]
    ds_read_b128 a[24:27], v34 offset:6144
    v_mfma_f32_16x16x32_bf16 v[144:147], a[84:87], a[36:39], v[144:147]
    buffer_load_dwordx4 v10, s[8:11], s21 offen offset:0 lds
    v_mfma_f32_16x16x32_bf16 a[208:211], a[116:119], a[36:39], a[208:211]
    ds_read_b128 a[28:31], v35 offset:6144
    v_mfma_f32_16x16x32_bf16 a[208:211], a[112:115], a[32:35], a[208:211]
    v_mfma_f32_16x16x32_bf16 v[176:179], a[88:91], a[32:35], v[176:179]
    ds_read_b64_tr_b16 a[76:77], v19 offset:8192
    v_mfma_f32_16x16x32_bf16 v[176:179], a[92:95], a[36:39], v[176:179]
    buffer_load_dwordx4 v11, s[8:11], s21 offen offset:1024 lds
    v_mfma_f32_16x16x32_bf16 a[240:243], a[124:127], a[36:39], a[240:243]
    ds_read_b64_tr_b16 a[78:79], v19 offset:9216
    v_mfma_f32_16x16x32_bf16 a[240:243], a[120:123], a[32:35], a[240:243]
    v_mfma_f32_16x16x32_bf16 a[244:247], a[120:123], a[40:43], a[244:247]
    ds_read_b64_tr_b16 a[104:105], v19 offset:16384
    v_mfma_f32_16x16x32_bf16 a[244:247], a[124:127], a[44:47], a[244:247]
    buffer_load_dwordx4 v12, s[8:11], s21 offen offset:2048 lds
    v_mfma_f32_16x16x32_bf16 v[180:183], a[92:95], a[44:47], v[180:183]
    ds_read_b64_tr_b16 a[106:107], v19 offset:17408
    v_mfma_f32_16x16x32_bf16 v[180:183], a[88:91], a[40:43], v[180:183]
    v_mfma_f32_16x16x32_bf16 a[212:215], a[112:115], a[40:43], a[212:215]
    ds_read_b64_tr_b16 a[108:109], v19 offset:24576
    v_mfma_f32_16x16x32_bf16 a[212:215], a[116:119], a[44:47], a[212:215]
    buffer_load_dwordx4 v13, s[8:11], s21 offen offset:3072 lds
    v_mfma_f32_16x16x32_bf16 v[148:151], a[84:87], a[44:47], v[148:151]
    ds_read_b64_tr_b16 a[110:111], v19 offset:25600
IW_P2:
    s_cbranch_execz IW_R0
    v_mfma_f32_16x16x32_bf16 v[148:151], a[80:83], a[40:43], v[148:151]
    s_add_u32 m0, s23, 0xc000
    v_mfma_f32_16x16x32_bf16 v[152:155], a[80:83], a[48:51], v[152:155]
    v_mfma_f32_16x16x32_bf16 v[152:155], a[84:87], a[52:55], v[152:155]
    buffer_load_dwordx4 v10, s[12:15], s21 offen offset:0 lds
    v_mfma_f32_16x16x32_bf16 a[216:219], a[116:119], a[52:55], a[216:219]
    v_mfma_f32_16x16x32_bf16 a[216:219], a[112:115], a[48:51], a[216:219]
    v_mfma_f32_16x16x32_bf16 v[184:187], a[88:91], a[48:51], v[184:187]
    buffer_load_dwordx4 v11, s[12:15], s21 offen offset:1024 lds
    v_mfma_f32_16x16x32_bf16 v[184:187], a[92:95], a[52:55], v[184:187]
    v_mfma_f32_16x16x32_bf16 a[248:251], a[124:127], a[52:55], a[248:251]
    v_mfma_f32_16x16x32_bf16 a[248:251], a[120:123], a[48:51], a[248:251]
    buffer_load_dwordx4 v12, s[12:15], s21 offen offset:2048 lds
    v_mfma_f32_16x16x32_bf16 a[252:255], a[120:123], a[56:59], a[252:255]
    v_mfma_f32_16x16x32_bf16 a[252:255], a[124:127], a[60:63], a[252:255]
    v_mfma_f32_16x16x32_bf16 v[188:191], a[92:95], a[60:63], v[188:191]
    buffer_load_dwordx4 v13, s[12:15], s21 offen offset:3072 lds
    v_mfma_f32_16x16x32_bf16 v[188:191], a[88:91], a[56:59], v[188:191]
    v_mfma_f32_16x16x32_bf16 a[220:223], a[112:115], a[56:59], a[220:223]
    s_add_u32 s21, s21, 0x70000
    v_mfma_f32_16x16x32_bf16 a[220:223], a[116:119], a[60:63], a[220:223]
    buffer_load_dword v42, v41, s[52:55], s56 offen
    v_mfma_f32_16x16x32_bf16 v[156:159], a[84:87], a[60:63], v[156:159]
    s_add_u32 s56, s56, s57
    v_mfma_f32_16x16x32_bf16 v[156:159], a[80:83], a[56:59], v[156:159]
    s_sub_u32 s3, s3, 1
    s_cmp_lg_u32 s3, 0
    s_cbranch_scc1 G1_LOOP
    s_waitcnt lgkmcnt(0)
    v_mfma_f32_16x16x32_bf16 v[64:67], a[64:67], a[0:3], v[64:67]
    ds_read_b128 a[32:35], v34 offset:8192
    v_mfma_f32_16x16x32_bf16 v[64:67], a[68:71], a[4:7], v[64:67]
    v_mfma_f32_16x16x32_bf16 a[128:131], a[100:103], a[4:7], a[128:131]
    ds_read_b128 a[36:39], v35 offset:8192
    v_mfma_f32_16x16x32_bf16 a[128:131], a[96:99], a[0:3], a[128:131]
    v_mfma_f32_16x16x32_bf16 v[96:99], a[72:75], a[0:3], v[96:99]
    ds_read_b128 a[40:43], v34 offset:10240
    v_mfma_f32_16x16x32_bf16 v[96:99], a[76:79], a[4:7], v[96:99]
    v_mfma_f32_16x16x32_bf16 a[160:163], a[108:111], a[4:7], a[160:163]
    ds_read_b128 a[44:47], v35 offset:10240
    v_mfma_f32_16x16x32_bf16 a[160:163], a[104:107], a[0:3], a[160:163]
    v_mfma_f32_16x16x32_bf16 a[164:167], a[104:107], a[8:11], a[164:167]
    ds_read_b128 a[48:51], v34 offset:12288
    v_mfma_f32_16x16x32_bf16 a[164:167], a[108:111], a[12:15], a[164:167]
    v_mfma_f32_16x16x32_bf16 v[100:103], a[76:79], a[12:15], v[100:103]
    ds_read_b128 a[52:55], v35 offset:12288
    v_mfma_f32_16x16x32_bf16 v[100:103], a[72:75], a[8:11], v[100:103]
    v_mfma_f32_16x16x32_bf16 a[132:135], a[96:99], a[8:11], a[132:135]
    ds_read_b128 a[56:59], v34 offset:14336
    v_mfma_f32_16x16x32_bf16 a[132:135], a[100:103], a[12:15], a[132:135]
    v_mfma_f32_16x16x32_bf16 v[68:71], a[68:71], a[12:15], v[68:71]
    ds_read_b128 a[60:63], v35 offset:14336
    v_mfma_f32_16x16x32_bf16 v[68:71], a[64:67], a[8:11], v[68:71]
    v_mfma_f32_16x16x32_bf16 v[72:75], a[64:67], a[16:19], v[72:75]
    ds_read_b64_tr_b16 a[80:81], v20 offset:0
    v_mfma_f32_16x16x32_bf16 v[72:75], a[68:71], a[20:23], v[72:75]
    v_mfma_f32_16x16x32_bf16 a[136:139], a[100:103], a[20:23], a[136:139]
    ds_read_b64_tr_b16 a[82:83], v20 offset:1024
    v_mfma_f32_16x16x32_bf16 a[136:139], a[96:99], a[16:19], a[136:139]
    v_mfma_f32_16x16x32_bf16 v[104:107], a[72:75], a[16:19], v[104:107]
    ds_read_b64_tr_b16 a[84:85], v20 offset:8192
    v_mfma_f32_16x16x32_bf16 v[104:107], a[76:79], a[20:23], v[104:107]
    v_mfma_f32_16x16x32_bf16 a[168:171], a[108:111], a[20:23], a[168:171]
    ds_read_b64_tr_b16 a[86:87], v20 offset:9216
    v_mfma_f32_16x16x32_bf16 a[168:171], a[104:107], a[16:19], a[168:171]
    v_mfma_f32_16x16x32_bf16 a[172:175], a[104:107], a[24:27], a[172:175]
    ds_read_b64_tr_b16 a[112:113], v20 offset:16384
    v_mfma_f32_16x16x32_bf16 a[172:175], a[108:111], a[28:31], a[172:175]
    v_mfma_f32_16x16x32_bf16 v[108:111], a[76:79], a[28:31], v[108:111]
    ds_read_b64_tr_b16 a[114:115], v20 offset:17408
    v_mfma_f32_16x16x32_bf16 v[108:111], a[72:75], a[24:27], v[108:111]
    v_mfma_f32_16x16x32_bf16 a[140:143], a[96:99], a[24:27], a[140:143]
    ds_read_b64_tr_b16 a[116:117], v20 offset:24576
    v_mfma_f32_16x16x32_bf16 a[140:143], a[100:103], a[28:31], a[140:143]
    v_mfma_f32_16x16x32_bf16 v[76:79], a[68:71], a[28:31], v[76:79]
    ds_read_b64_tr_b16 a[118:119], v20 offset:25600
    v_mfma_f32_16x16x32_bf16 v[76:79], a[64:67], a[24:27], v[76:79]
    s_waitcnt lgkmcnt(8)
    v_mfma_f32_16x16x32_bf16 v[80:83], a[64:67], a[32:35], v[80:83]
    ds_read_b64_tr_b16 a[88:89], v21 offset:0
    v_mfma_f32_16x16x32_bf16 v[80:83], a[68:71], a[36:39], v[80:83]
    v_mfma_f32_16x16x32_bf16 a[144:147], a[100:103], a[36:39], a[144:147]
    ds_read_b64_tr_b16 a[90:91], v21 offset:1024
    v_mfma_f32_16x16x32_bf16 a[144:147], a[96:99], a[32:35], a[144:147]
    v_mfma_f32_16x16x32_bf16 v[112:115], a[72:75], a[32:35], v[112:115]
    ds_read_b64_tr_b16 a[92:93], v21 offset:8192
    v_mfma_f32_16x16x32_bf16 v[112:115], a[76:79], a[36:39], v[112:115]
    v_mfma_f32_16x16x32_bf16 a[176:179], a[108:111], a[36:39], a[176:179]
    ds_read_b64_tr_b16 a[94:95], v21 offset:9216
    v_mfma_f32_16x16x32_bf16 a[176:179], a[104:107], a[32:35], a[176:179]
    v_mfma_f32_16x16x32_bf16 a[180:183], a[104:107], a[40:43], a[180:183]
    ds_read_b64_tr_b16 a[120:121], v21 offset:16384
    v_mfma_f32_16x16x32_bf16 a[180:183], a[108:111], a[44:47], a[180:183]
    v_mfma_f32_16x16x32_bf16 v[116:119], a[76:79], a[44:47], v[116:119]
    ds_read_b64_tr_b16 a[122:123], v21 offset:17408
    v_mfma_f32_16x16x32_bf16 v[116:119], a[72:75], a[40:43], v[116:119]
    v_mfma_f32_16x16x32_bf16 a[148:151], a[96:99], a[40:43], a[148:151]
    ds_read_b64_tr_b16 a[124:125], v21 offset:24576
    v_mfma_f32_16x16x32_bf16 a[148:151], a[100:103], a[44:47], a[148:151]
    v_mfma_f32_16x16x32_bf16 v[84:87], a[68:71], a[44:47], v[84:87]
    ds_read_b64_tr_b16 a[126:127], v21 offset:25600
    v_mfma_f32_16x16x32_bf16 v[84:87], a[64:67], a[40:43], v[84:87]
    v_mfma_f32_16x16x32_bf16 v[88:91], a[64:67], a[48:51], v[88:91]
    v_mfma_f32_16x16x32_bf16 v[88:91], a[68:71], a[52:55], v[88:91]
    v_mfma_f32_16x16x32_bf16 a[152:155], a[100:103], a[52:55], a[152:155]
    v_mfma_f32_16x16x32_bf16 a[152:155], a[96:99], a[48:51], a[152:155]
    v_mfma_f32_16x16x32_bf16 v[120:123], a[72:75], a[48:51], v[120:123]
    v_mfma_f32_16x16x32_bf16 v[120:123], a[76:79], a[52:55], v[120:123]
    v_mfma_f32_16x16x32_bf16 a[184:187], a[108:111], a[52:55], a[184:187]
    v_mfma_f32_16x16x32_bf16 a[184:187], a[104:107], a[48:51], a[184:187]
    v_mfma_f32_16x16x32_bf16 a[188:191], a[104:107], a[56:59], a[188:191]
    v_mfma_f32_16x16x32_bf16 a[188:191], a[108:111], a[60:63], a[188:191]
    v_mfma_f32_16x16x32_bf16 v[124:127], a[76:79], a[60:63], v[124:127]
    v_mfma_f32_16x16x32_bf16 v[124:127], a[72:75], a[56:59], v[124:127]
    v_mfma_f32_16x16x32_bf16 a[156:159], a[96:99], a[56:59], a[156:159]
    v_mfma_f32_16x16x32_bf16 a[156:159], a[100:103], a[60:63], a[156:159]
    v_mfma_f32_16x16x32_bf16 v[92:95], a[68:71], a[60:63], v[92:95]
    v_mfma_f32_16x16x32_bf16 v[92:95], a[64:67], a[56:59], v[92:95]
    s_waitcnt lgkmcnt(0)
    s_add_u32 m0, s22, 0x10000
    s_waitcnt vmcnt(1)
    s_barrier
    v_mfma_f32_16x16x32_bf16 v[128:131], a[80:83], a[0:3], v[128:131]
    ds_read_b64_tr_b16 a[64:65], v22 offset:0
    v_mfma_f32_16x16x32_bf16 v[128:131], a[84:87], a[4:7], v[128:131]
    buffer_load_dwordx4 v2, s[4:7], s20 offen offset:0 lds
    v_mfma_f32_16x16x32_bf16 a[192:195], a[116:119], a[4:7], a[192:195]
    ds_read_b64_tr_b16 a[66:67], v22 offset:1024
    v_mfma_f32_16x16x32_bf16 a[192:195], a[112:115], a[0:3], a[192:195]
    v_mfma_f32_16x16x32_bf16 v[160:163], a[88:91], a[0:3], v[160:163]
    ds_read_b64_tr_b16 a[68:69], v22 offset:8192
    v_mfma_f32_16x16x32_bf16 v[160:163], a[92:95], a[4:7], v[160:163]
    buffer_load_dwordx4 v3, s[4:7], s20 offen offset:1024 lds
    v_mfma_f32_16x16x32_bf16 a[224:227], a[124:127], a[4:7], a[224:227]
    ds_read_b64_tr_b16 a[70:71], v22 offset:9216
    v_mfma_f32_16x16x32_bf16 a[224:227], a[120:123], a[0:3], a[224:227]
    v_mfma_f32_16x16x32_bf16 a[228:231], a[120:123], a[8:11], a[228:231]
    ds_read_b128 a[0:3], v16 offset:0
    v_mfma_f32_16x16x32_bf16 a[228:231], a[124:127], a[12:15], a[228:231]
    buffer_load_dwordx4 v4, s[4:7], s20 offen offset:2048 lds
    v_mfma_f32_16x16x32_bf16 v[164:167], a[92:95], a[12:15], v[164:167]
    ds_read_b128 a[4:7], v17 offset:0
    v_mfma_f32_16x16x32_bf16 v[164:167], a[88:91], a[8:11], v[164:167]
    v_mfma_f32_16x16x32_bf16 a[196:199], a[112:115], a[8:11], a[196:199]
    ds_read_b64_tr_b16 a[96:97], v22 offset:16384
    v_mfma_f32_16x16x32_bf16 a[196:199], a[116:119], a[12:15], a[196:199]
    buffer_load_dwordx4 v5, s[4:7], s20 offen offset:3072 lds
    v_mfma_f32_16x16x32_bf16 v[132:135], a[84:87], a[12:15], v[132:135]
    ds_read_b64_tr_b16 a[98:99], v22 offset:17408
    v_mfma_f32_16x16x32_bf16 v[132:135], a[80:83], a[8:11], v[132:135]
    s_add_u32 m0, s22, 0x11000
    v_mfma_f32_16x16x32_bf16 v[136:139], a[80:83], a[16:19], v[136:139]
    ds_read_b128 a[8:11], v16 offset:2048
    v_mfma_f32_16x16x32_bf16 v[136:139], a[84:87], a[20:23], v[136:139]
    buffer_load_dwordx4 v6, s[4:7], s20 offen offset:0 lds
    v_mfma_f32_16x16x32_bf16 a[200:203], a[116:119], a[20:23], a[200:203]
    ds_read_b128 a[12:15], v17 offset:2048
    v_mfma_f32_16x16x32_bf16 a[200:203], a[112:115], a[16:19], a[200:203]
    v_mfma_f32_16x16x32_bf16 v[168:171], a[88:91], a[16:19], v[168:171]
    ds_read_b64_tr_b16 a[100:101], v22 offset:24576
    v_mfma_f32_16x16x32_bf16 v[168:171], a[92:95], a[20:23], v[168:171]
    buffer_load_dwordx4 v7, s[4:7], s20 offen offset:1024 lds
    v_mfma_f32_16x16x32_bf16 a[232:235], a[124:127], a[20:23], a[232:235]
    ds_read_b64_tr_b16 a[102:103], v22 offset:25600
    v_mfma_f32_16x16x32_bf16 a[232:235], a[120:123], a[16:19], a[232:235]
    v_mfma_f32_16x16x32_bf16 a[236:239], a[120:123], a[24:27], a[236:239]
    ds_read_b128 a[16:19], v16 offset:4096
    v_mfma_f32_16x16x32_bf16 a[236:239], a[124:127], a[28:31], a[236:239]
    buffer_load_dwordx4 v8, s[4:7], s20 offen offset:2048 lds
    v_mfma_f32_16x16x32_bf16 v[172:175], a[92:95], a[28:31], v[172:175]
    ds_read_b128 a[20:23], v17 offset:4096
    v_mfma_f32_16x16x32_bf16 v[172:175], a[88:91], a[24:27], v[172:175]
    v_mfma_f32_16x16x32_bf16 a[204:207], a[112:115], a[24:27], a[204:207]
    ds_read_b64_tr_b16 a[72:73], v23 offset:0
    v_mfma_f32_16x16x32_bf16 a[204:207], a[116:119], a[28:31], a[204:207]
    buffer_load_dwordx4 v9, s[4:7], s20 offen offset:3072 lds
    v_mfma_f32_16x16x32_bf16 v[140:143], a[84:87], a[28:31], v[140:143]
    ds_read_b64_tr_b16 a[74:75], v23 offset:1024
    v_mfma_f32_16x16x32_bf16 v[140:143], a[80:83], a[24:27], v[140:143]
    s_add_u32 s20, s20, 128
    s_add_u32 m0, s23, 0x18000
    v_mfma_f32_16x16x32_bf16 v[144:147], a[80:83], a[32:35], v[144:147]
    ds_read_b128 a[24:27], v16 offset:6144
    v_mfma_f32_16x16x32_bf16 v[144:147], a[84:87], a[36:39], v[144:147]
    buffer_load_dwordx4 v10, s[8:11], s21 offen offset:0 lds
    v_mfma_f32_16x16x32_bf16 a[208:211], a[116:119], a[36:39], a[208:211]
    ds_read_b128 a[28:31], v17 offset:6144
    v_mfma_f32_16x16x32_bf16 a[208:211], a[112:115], a[32:35], a[208:211]
    v_mfma_f32_16x16x32_bf16 v[176:179], a[88:91], a[32:35], v[176:179]
    ds_read_b64_tr_b16 a[76:77], v23 offset:8192
    v_mfma_f32_16x16x32_bf16 v[176:179], a[92:95], a[36:39], v[176:179]
    buffer_load_dwordx4 v11, s[8:11], s21 offen offset:1024 lds
    v_mfma_f32_16x16x32_bf16 a[240:243], a[124:127], a[36:39], a[240:243]
    ds_read_b64_tr_b16 a[78:79], v23 offset:9216
    v_mfma_f32_16x16x32_bf16 a[240:243], a[120:123], a[32:35], a[240:243]
    v_mfma_f32_16x16x32_bf16 a[244:247], a[120:123], a[40:43], a[244:247]
    ds_read_b64_tr_b16 a[104:105], v23 offset:16384
    v_mfma_f32_16x16x32_bf16 a[244:247], a[124:127], a[44:47], a[244:247]
    buffer_load_dwordx4 v12, s[8:11], s21 offen offset:2048 lds
    v_mfma_f32_16x16x32_bf16 v[180:183], a[92:95], a[44:47], v[180:183]
    ds_read_b64_tr_b16 a[106:107], v23 offset:17408
    v_mfma_f32_16x16x32_bf16 v[180:183], a[88:91], a[40:43], v[180:183]
    v_mfma_f32_16x16x32_bf16 a[212:215], a[112:115], a[40:43], a[212:215]
    ds_read_b64_tr_b16 a[108:109], v23 offset:24576
    v_mfma_f32_16x16x32_bf16 a[212:215], a[116:119], a[44:47], a[212:215]
    buffer_load_dwordx4 v13, s[8:11], s21 offen offset:3072 lds
    v_mfma_f32_16x16x32_bf16 v[148:151], a[84:87], a[44:47], v[148:151]
    ds_read_b64_tr_b16 a[110:111], v23 offset:25600
    v_mfma_f32_16x16x32_bf16 v[148:151], a[80:83], a[40:43], v[148:151]
    s_add_u32 m0, s23, 0x1c000
    v_mfma_f32_16x16x32_bf16 v[152:155], a[80:83], a[48:51], v[152:155]
    v_mfma_f32_16x16x32_bf16 v[152:155], a[84:87], a[52:55], v[152:155]
    buffer_load_dwordx4 v10, s[12:15], s21 offen offset:0 lds
    v_mfma_f32_16x16x32_bf16 a[216:219], a[116:119], a[52:55], a[216:219]
    v_mfma_f32_16x16x32_bf16 a[216:219], a[112:115], a[48:51], a[216:219]
    v_mfma_f32_16x16x32_bf16 v[184:187], a[88:91], a[48:51], v[184:187]
    buffer_load_dwordx4 v11, s[12:15], s21 offen offset:1024 lds
    v_mfma_f32_16x16x32_bf16 v[184:187], a[92:95], a[52:55], v[184:187]
    v_mfma_f32_16x16x32_bf16 a[248:251], a[124:127], a[52:55], a[248:251]
    v_mfma_f32_16x16x32_bf16 a[248:251], a[120:123], a[48:51], a[248:251]
    buffer_load_dwordx4 v12, s[12:15], s21 offen offset:2048 lds
    v_mfma_f32_16x16x32_bf16 a[252:255], a[120:123], a[56:59], a[252:255]
    v_mfma_f32_16x16x32_bf16 a[252:255], a[124:127], a[60:63], a[252:255]
    v_mfma_f32_16x16x32_bf16 v[188:191], a[92:95], a[60:63], v[188:191]
    buffer_load_dwordx4 v13, s[12:15], s21 offen offset:3072 lds
    v_mfma_f32_16x16x32_bf16 v[188:191], a[88:91], a[56:59], v[188:191]
    v_mfma_f32_16x16x32_bf16 a[220:223], a[112:115], a[56:59], a[220:223]
    s_add_u32 s21, s21, 0x70000
    v_mfma_f32_16x16x32_bf16 a[220:223], a[116:119], a[60:63], a[220:223]
    v_and_b32 v52, 3, v0
    v_lshlrev_b32 v52, 6, v52
    buffer_load_dword v55, v52, s[80:83], 0 offen sc1
    v_mfma_f32_16x16x32_bf16 v[156:159], a[84:87], a[60:63], v[156:159]
    buffer_load_dword v42, v41, s[52:55], s56 offen
    s_add_u32 s56, s56, s57
    v_mfma_f32_16x16x32_bf16 v[156:159], a[80:83], a[56:59], v[156:159]
    s_waitcnt lgkmcnt(0)
    v_mfma_f32_16x16x32_bf16 v[64:67], a[64:67], a[0:3], v[64:67]
    ds_read_b128 a[32:35], v16 offset:8192
    v_mfma_f32_16x16x32_bf16 v[64:67], a[68:71], a[4:7], v[64:67]
    v_mfma_f32_16x16x32_bf16 a[128:131], a[100:103], a[4:7], a[128:131]
    ds_read_b128 a[36:39], v17 offset:8192
    v_mfma_f32_16x16x32_bf16 a[128:131], a[96:99], a[0:3], a[128:131]
    v_mfma_f32_16x16x32_bf16 v[96:99], a[72:75], a[0:3], v[96:99]
    ds_read_b128 a[40:43], v16 offset:10240
    v_mfma_f32_16x16x32_bf16 v[96:99], a[76:79], a[4:7], v[96:99]
    v_mfma_f32_16x16x32_bf16 a[160:163], a[108:111], a[4:7], a[160:163]
    ds_read_b128 a[44:47], v17 offset:10240
    v_mfma_f32_16x16x32_bf16 a[160:163], a[104:107], a[0:3], a[160:163]
    v_mfma_f32_16x16x32_bf16 a[164:167], a[104:107], a[8:11], a[164:167]
    ds_read_b128 a[48:51], v16 offset:12288
    v_mfma_f32_16x16x32_bf16 a[164:167], a[108:111], a[12:15], a[164:167]
    v_mfma_f32_16x16x32_bf16 v[100:103], a[76:79], a[12:15], v[100:103]
    ds_read_b128 a[52:55], v17 offset:12288
    v_mfma_f32_16x16x32_bf16 v[100:103], a[72:75], a[8:11], v[100:103]
    v_mfma_f32_16x16x32_bf16 a[132:135], a[96:99], a[8:11], a[132:135]
    ds_read_b128 a[56:59], v16 offset:14336
    v_mfma_f32_16x16x32_bf16 a[132:135], a[100:103], a[12:15], a[132:135]
    v_mfma_f32_16x16x32_bf16 v[68:71], a[68:71], a[12:15], v[68:71]
    ds_read_b128 a[60:63], v17 offset:14336
    v_mfma_f32_16x16x32_bf16 v[68:71], a[64:67], a[8:11], v[68:71]
    v_mfma_f32_16x16x32_bf16 v[72:75], a[64:67], a[16:19], v[72:75]
    ds_read_b64_tr_b16 a[80:81], v24 offset:0
    v_mfma_f32_16x16x32_bf16 v[72:75], a[68:71], a[20:23], v[72:75]
    v_mfma_f32_16x16x32_bf16 a[136:139], a[100:103], a[20:23], a[136:139]
    ds_read_b64_tr_b16 a[82:83], v24 offset:1024
    v_mfma_f32_16x16x32_bf16 a[136:139], a[96:99], a[16:19], a[136:139]
    v_mfma_f32_16x16x32_bf16 v[104:107], a[72:75], a[16:19], v[104:107]
    ds_read_b64_tr_b16 a[84:85], v24 offset:8192
    v_mfma_f32_16x16x32_bf16 v[104:107], a[76:79], a[20:23], v[104:107]
    v_mfma_f32_16x16x32_bf16 a[168:171], a[108:111], a[20:23], a[168:171]
    ds_read_b64_tr_b16 a[86:87], v24 offset:9216
    v_mfma_f32_16x16x32_bf16 a[168:171], a[104:107], a[16:19], a[168:171]
    v_mfma_f32_16x16x32_bf16 a[172:175], a[104:107], a[24:27], a[172:175]
    ds_read_b64_tr_b16 a[112:113], v24 offset:16384
    v_mfma_f32_16x16x32_bf16 a[172:175], a[108:111], a[28:31], a[172:175]
    v_mfma_f32_16x16x32_bf16 v[108:111], a[76:79], a[28:31], v[108:111]
    ds_read_b64_tr_b16 a[114:115], v24 offset:17408
    v_mfma_f32_16x16x32_bf16 v[108:111], a[72:75], a[24:27], v[108:111]
    v_mfma_f32_16x16x32_bf16 a[140:143], a[96:99], a[24:27], a[140:143]
    ds_read_b64_tr_b16 a[116:117], v24 offset:24576
    v_mfma_f32_16x16x32_bf16 a[140:143], a[100:103], a[28:31], a[140:143]
    v_mfma_f32_16x16x32_bf16 v[76:79], a[68:71], a[28:31], v[76:79]
    ds_read_b64_tr_b16 a[118:119], v24 offset:25600
    v_mfma_f32_16x16x32_bf16 v[76:79], a[64:67], a[24:27], v[76:79]
    s_waitcnt lgkmcnt(8)
    v_mfma_f32_16x16x32_bf16 v[80:83], a[64:67], a[32:35], v[80:83]
    ds_read_b64_tr_b16 a[88:89], v25 offset:0
    v_mfma_f32_16x16x32_bf16 v[80:83], a[68:71], a[36:39], v[80:83]
    v_mfma_f32_16x16x32_bf16 a[144:147], a[100:103], a[36:39], a[144:147]
    ds_read_b64_tr_b16 a[90:91], v25 offset:1024
    v_mfma_f32_16x16x32_bf16 a[144:147], a[96:99], a[32:35], a[144:147]
    v_mfma_f32_16x16x32_bf16 v[112:115], a[72:75], a[32:35], v[112:115]
    ds_read_b64_tr_b16 a[92:93], v25 offset:8192
    v_mfma_f32_16x16x32_bf16 v[112:115], a[76:79], a[36:39], v[112:115]
    v_mfma_f32_16x16x32_bf16 a[176:179], a[108:111], a[36:39], a[176:179]
    ds_read_b64_tr_b16 a[94:95], v25 offset:9216
    v_mfma_f32_16x16x32_bf16 a[176:179], a[104:107], a[32:35], a[176:179]
    v_mfma_f32_16x16x32_bf16 a[180:183], a[104:107], a[40:43], a[180:183]
    ds_read_b64_tr_b16 a[120:121], v25 offset:16384
    v_mfma_f32_16x16x32_bf16 a[180:183], a[108:111], a[44:47], a[180:183]
    v_mfma_f32_16x16x32_bf16 v[116:119], a[76:79], a[44:47], v[116:119]
    ds_read_b64_tr_b16 a[122:123], v25 offset:17408
    v_mfma_f32_16x16x32_bf16 v[116:119], a[72:75], a[40:43], v[116:119]
    v_mfma_f32_16x16x32_bf16 a[148:151], a[96:99], a[40:43], a[148:151]
    ds_read_b64_tr_b16 a[124:125], v25 offset:24576
    v_mfma_f32_16x16x32_bf16 a[148:151], a[100:103], a[44:47], a[148:151]
    v_mfma_f32_16x16x32_bf16 v[84:87], a[68:71], a[44:47], v[84:87]
    ds_read_b64_tr_b16 a[126:127], v25 offset:25600
    v_mfma_f32_16x16x32_bf16 v[84:87], a[64:67], a[40:43], v[84:87]
    v_mfma_f32_16x16x32_bf16 v[88:91], a[64:67], a[48:51], v[88:91]
    v_mfma_f32_16x16x32_bf16 v[88:91], a[68:71], a[52:55], v[88:91]
    v_mfma_f32_16x16x32_bf16 a[152:155], a[100:103], a[52:55], a[152:155]
    v_mfma_f32_16x16x32_bf16 a[152:155], a[96:99], a[48:51], a[152:155]
    v_mfma_f32_16x16x32_bf16 v[120:123], a[72:75], a[48:51], v[120:123]
    v_mfma_f32_16x16x32_bf16 v[120:123], a[76:79], a[52:55], v[120:123]
    v_mfma_f32_16x16x32_bf16 a[184:187], a[108:111], a[52:55], a[184:187]
    v_mfma_f32_16x16x32_bf16 a[184:187], a[104:107], a[48:51], a[184:187]
    v_mfma_f32_16x16x32_bf16 a[188:191], a[104:107], a[56:59], a[188:191]
    v_mfma_f32_16x16x32_bf16 a[188:191], a[108:111], a[60:63], a[188:191]
    v_mfma_f32_16x16x32_bf16 v[124:127], a[76:79], a[60:63], v[124:127]
    v_mfma_f32_16x16x32_bf16 v[124:127], a[72:75], a[56:59], v[124:127]
    v_mfma_f32_16x16x32_bf16 a[156:159], a[96:99], a[56:59], a[156:159]
    v_mfma_f32_16x16x32_bf16 a[156:159], a[100:103], a[60:63], a[156:159]
    v_mfma_f32_16x16x32_bf16 v[92:95], a[68:71], a[60:63], v[92:95]
    v_mfma_f32_16x16x32_bf16 v[92:95], a[64:67], a[56:59], v[92:95]
    s_waitcnt lgkmcnt(0)
    s_add_u32 m0, s22, 0x0
    s_waitcnt vmcnt(2)
    s_barrier
    v_mfma_f32_16x16x32_bf16 v[128:131], a[80:83], a[0:3], v[128:131]
    ds_read_b64_tr_b16 a[64:65], v18 offset:0
    v_mfma_f32_16x16x32_bf16 v[128:131], a[84:87], a[4:7], v[128:131]
    buffer_load_dwordx4 v2, s[4:7], s20 offen offset:0 lds
    v_mfma_f32_16x16x32_bf16 a[192:195], a[116:119], a[4:7], a[192:195]
    ds_read_b64_tr_b16 a[66:67], v18 offset:1024
    v_mfma_f32_16x16x32_bf16 a[192:195], a[112:115], a[0:3], a[192:195]
    v_mfma_f32_16x16x32_bf16 v[160:163], a[88:91], a[0:3], v[160:163]
    ds_read_b64_tr_b16 a[68:69], v18 offset:8192
    v_mfma_f32_16x16x32_bf16 v[160:163], a[92:95], a[4:7], v[160:163]
    buffer_load_dwordx4 v3, s[4:7], s20 offen offset:1024 lds
    v_mfma_f32_16x16x32_bf16 a[224:227], a[124:127], a[4:7], a[224:227]
    ds_read_b64_tr_b16 a[70:71], v18 offset:9216
    v_mfma_f32_16x16x32_bf16 a[224:227], a[120:123], a[0:3], a[224:227]
    v_mfma_f32_16x16x32_bf16 a[228:231], a[120:123], a[8:11], a[228:231]
    ds_read_b128 a[0:3], v34 offset:0
    v_mfma_f32_16x16x32_bf16 a[228:231], a[124:127], a[12:15], a[228:231]
    buffer_load_dwordx4 v4, s[4:7], s20 offen offset:2048 lds
    v_mfma_f32_16x16x32_bf16 v[164:167], a[92:95], a[12:15], v[164:167]
    ds_read_b128 a[4:7], v35 offset:0
    v_mfma_f32_16x16x32_bf16 v[164:167], a[88:91], a[8:11], v[164:167]
    v_mfma_f32_16x16x32_bf16 a[196:199], a[112:115], a[8:11], a[196:199]
    ds_read_b64_tr_b16 a[96:97], v18 offset:16384
    v_mfma_f32_16x16x32_bf16 a[196:199], a[116:119], a[12:15], a[196:199]
    buffer_load_dwordx4 v5, s[4:7], s20 offen offset:3072 lds
    v_mfma_f32_16x16x32_bf16 v[132:135], a[84:87], a[12:15], v[132:135]
    ds_read_b64_tr_b16 a[98:99], v18 offset:17408
    v_mfma_f32_16x16x32_bf16 v[132:135], a[80:83], a[8:11], v[132:135]
    s_add_u32 m0, s22, 0x1000
    v_mfma_f32_16x16x32_bf16 v[136:139], a[80:83], a[16:19], v[136:139]
    ds_read_b128 a[8:11], v34 offset:2048
    v_mfma_f32_16x16x32_bf16 v[136:139], a[84:87], a[20:23], v[136:139]
    buffer_load_dwordx4 v6, s[4:7], s20 offen offset:0 lds
    v_mfma_f32_16x16x32_bf16 a[200:203], a[116:119], a[20:23], a[200:203]
    ds_read_b128 a[12:15], v35 offset:2048
    v_mfma_f32_16x16x32_bf16 a[200:203], a[112:115], a[16:19], a[200:203]
    v_mfma_f32_16x16x32_bf16 v[168:171], a[88:91], a[16:19], v[168:171]
    ds_read_b64_tr_b16 a[100:101], v18 offset:24576
    v_mfma_f32_16x16x32_bf16 v[168:171], a[92:95], a[20:23], v[168:171]
    buffer_load_dwordx4 v7, s[4:7], s20 offen offset:1024 lds
    v_mfma_f32_16x16x32_bf16 a[232:235], a[124:127], a[20:23], a[232:235]
    ds_read_b64_tr_b16 a[102:103], v18 offset:25600
    v_mfma_f32_16x16x32_bf16 a[232:235], a[120:123], a[16:19], a[232:235]
    v_mfma_f32_16x16x32_bf16 a[236:239], a[120:123], a[24:27], a[236:239]
    ds_read_b128 a[16:19], v34 offset:4096
    v_mfma_f32_16x16x32_bf16 a[236:239], a[124:127], a[28:31], a[236:239]
    buffer_load_dwordx4 v8, s[4:7], s20 offen offset:2048 lds
    v_mfma_f32_16x16x32_bf16 v[172:175], a[92:95], a[28:31], v[172:175]
    ds_read_b128 a[20:23], v35 offset:4096
    v_mfma_f32_16x16x32_bf16 v[172:175], a[88:91], a[24:27], v[172:175]
    v_mfma_f32_16x16x32_bf16 a[204:207], a[112:115], a[24:27], a[204:207]
    ds_read_b64_tr_b16 a[72:73], v19 offset:0
    v_mfma_f32_16x16x32_bf16 a[204:207], a[116:119], a[28:31], a[204:207]
    buffer_load_dwordx4 v9, s[4:7], s20 offen offset:3072 lds
    v_mfma_f32_16x16x32_bf16 v[140:143], a[84:87], a[28:31], v[140:143]
    ds_read_b64_tr_b16 a[74:75], v19 offset:1024
    v_mfma_f32_16x16x32_bf16 v[140:143], a[80:83], a[24:27], v[140:143]
    s_add_u32 s20, s20, 128
    s_add_u32 m0, s23, 0x8000
    v_mfma_f32_16x16x32_bf16 v[144:147], a[80:83], a[32:35], v[144:147]
    ds_read_b128 a[24:27], v34 offset:6144
    v_mfma_f32_16x16x32_bf16 v[144:147], a[84:87], a[36:39], v[144:147]
    buffer_load_dwordx4 v10, s[8:11], s21 offen offset:0 lds
    v_mfma_f32_16x16x32_bf16 a[208:211], a[116:119], a[36:39], a[208:211]
    ds_read_b128 a[28:31], v35 offset:6144
    v_mfma_f32_16x16x32_bf16 a[208:211], a[112:115], a[32:35], a[208:211]
    v_mfma_f32_16x16x32_bf16 v[176:179], a[88:91], a[32:35], v[176:179]
    ds_read_b64_tr_b16 a[76:77], v19 offset:8192
    v_mfma_f32_16x16x32_bf16 v[176:179], a[92:95], a[36:39], v[176:179]
    buffer_load_dwordx4 v11, s[8:11], s21 offen offset:1024 lds
    v_mfma_f32_16x16x32_bf16 a[240:243], a[124:127], a[36:39], a[240:243]
    ds_read_b64_tr_b16 a[78:79], v19 offset:9216
    v_mfma_f32_16x16x32_bf16 a[240:243], a[120:123], a[32:35], a[240:243]
    v_mfma_f32_16x16x32_bf16 a[244:247], a[120:123], a[40:43], a[244:247]
    ds_read_b64_tr_b16 a[104:105], v19 offset:16384
    v_mfma_f32_16x16x32_bf16 a[244:247], a[124:127], a[44:47], a[244:247]
    buffer_load_dwordx4 v12, s[8:11], s21 offen offset:2048 lds
    v_mfma_f32_16x16x32_bf16 v[180:183], a[92:95], a[44:47], v[180:183]
    ds_read_b64_tr_b16 a[106:107], v19 offset:17408
    v_mfma_f32_16x16x32_bf16 v[180:183], a[88:91], a[40:43], v[180:183]
    v_mfma_f32_16x16x32_bf16 a[212:215], a[112:115], a[40:43], a[212:215]
    ds_read_b64_tr_b16 a[108:109], v19 offset:24576
    v_mfma_f32_16x16x32_bf16 a[212:215], a[116:119], a[44:47], a[212:215]
    buffer_load_dwordx4 v13, s[8:11], s21 offen offset:3072 lds
    v_mfma_f32_16x16x32_bf16 v[148:151], a[84:87], a[44:47], v[148:151]
    ds_read_b64_tr_b16 a[110:111], v19 offset:25600
    v_mfma_f32_16x16x32_bf16 v[148:151], a[80:83], a[40:43], v[148:151]
    s_add_u32 m0, s23, 0xc000
    v_mfma_f32_16x16x32_bf16 v[152:155], a[80:83], a[48:51], v[152:155]
    v_mfma_f32_16x16x32_bf16 v[152:155], a[84:87], a[52:55], v[152:155]
    buffer_load_dwordx4 v10, s[12:15], s21 offen offset:0 lds
    v_mfma_f32_16x16x32_bf16 a[216:219], a[116:119], a[52:55], a[216:219]
    v_mfma_f32_16x16x32_bf16 a[216:219], a[112:115], a[48:51], a[216:219]
    v_mfma_f32_16x16x32_bf16 v[184:187], a[88:91], a[48:51], v[184:187]
    buffer_load_dwordx4 v11, s[12:15], s21 offen offset:1024 lds
    v_mfma_f32_16x16x32_bf16 v[184:187], a[92:95], a[52:55], v[184:187]
    v_mfma_f32_16x16x32_bf16 a[248:251], a[124:127], a[52:55], a[248:251]
    v_mfma_f32_16x16x32_bf16 a[248:251], a[120:123], a[48:51], a[248:251]
    buffer_load_dwordx4 v12, s[12:15], s21 offen offset:2048 lds
    v_mfma_f32_16x16x32_bf16 a[252:255], a[120:123], a[56:59], a[252:255]
    v_mfma_f32_16x16x32_bf16 a[252:255], a[124:127], a[60:63], a[252:255]
    v_mfma_f32_16x16x32_bf16 v[188:191], a[92:95], a[60:63], v[188:191]
    buffer_load_dwordx4 v13, s[12:15], s21 offen offset:3072 lds
    v_mfma_f32_16x16x32_bf16 v[188:191], a[88:91], a[56:59], v[188:191]
    v_mfma_f32_16x16x32_bf16 a[220:223], a[112:115], a[56:59], a[220:223]
    s_add_u32 s21, s21, 0x70000
    v_mfma_f32_16x16x32_bf16 a[220:223], a[116:119], a[60:63], a[220:223]
    buffer_load_dword v42, v41, s[52:55], s56 offen
    v_mfma_f32_16x16x32_bf16 v[156:159], a[84:87], a[60:63], v[156:159]
    s_add_u32 s56, s56, s57
    v_mfma_f32_16x16x32_bf16 v[156:159], a[80:83], a[56:59], v[156:159]
    s_waitcnt lgkmcnt(0)
    v_mfma_f32_16x16x32_bf16 v[64:67], a[64:67], a[0:3], v[64:67]
    ds_read_b128 a[32:35], v34 offset:8192
    v_mfma_f32_16x16x32_bf16 v[64:67], a[68:71], a[4:7], v[64:67]
    v_mfma_f32_16x16x32_bf16 a[128:131], a[100:103], a[4:7], a[128:131]
    ds_read_b128 a[36:39], v35 offset:8192
    v_mfma_f32_16x16x32_bf16 a[128:131], a[96:99], a[0:3], a[128:131]
    v_mfma_f32_16x16x32_bf16 v[96:99], a[72:75], a[0:3], v[96:99]
    ds_read_b128 a[40:43], v34 offset:10240
    v_mfma_f32_16x16x32_bf16 v[96:99], a[76:79], a[4:7], v[96:99]
    v_mfma_f32_16x16x32_bf16 a[160:163], a[108:111], a[4:7], a[160:163]
    ds_read_b128 a[44:47], v35 offset:10240
    v_mfma_f32_16x16x32_bf16 a[160:163], a[104:107], a[0:3], a[160:163]
    s_lshl_b32 s60, s2, 2
    s_add_u32 s60, s60, s40
    s_lshl_b32 s62, s60, 12
    v_lshlrev_b32 v27, 4, v0
    s_mov_b32 s76, s68
    s_mov_b32 s77, s69
    s_mov_b32 s78, 0x800
    s_mov_b32 s79, 0x00020000
    buffer_load_dwordx4 v[212:215], v27, s[76:79], 0 offen
    v_mfma_f32_16x16x32_bf16 a[164:167], a[104:107], a[8:11], a[164:167]
    ds_read_b128 a[48:51], v34 offset:12288
    v_mfma_f32_16x16x32_bf16 a[164:167], a[108:111], a[12:15], a[164:167]
    v_mfma_f32_16x16x32_bf16 v[100:103], a[76:79], a[12:15], v[100:103]
    ds_read_b128 a[52:55], v35 offset:12288
    v_mfma_f32_16x16x32_bf16 v[100:103], a[72:75], a[8:11], v[100:103]
    v_mfma_f32_16x16x32_bf16 a[132:135], a[96:99], a[8:11], a[132:135]
    ds_read_b128 a[56:59], v34 offset:14336
    v_mfma_f32_16x16x32_bf16 a[132:135], a[100:103], a[12:15], a[132:135]
    v_mfma_f32_16x16x32_bf16 v[68:71], a[68:71], a[12:15], v[68:71]
    ds_read_b128 a[60:63], v35 offset:14336
    v_mfma_f32_16x16x32_bf16 v[68:71], a[64:67], a[8:11], v[68:71]
    buffer_load_dwordx4 v[216:219], v27, s[76:79], 0 offen offset:1024
    v_mfma_f32_16x16x32_bf16 v[72:75], a[64:67], a[16:19], v[72:75]
    ds_read_b64_tr_b16 a[80:81], v20 offset:0
    v_mfma_f32_16x16x32_bf16 v[72:75], a[68:71], a[20:23], v[72:75]
    v_mfma_f32_16x16x32_bf16 a[136:139], a[100:103], a[20:23], a[136:139]
    ds_read_b64_tr_b16 a[82:83], v20 offset:1024
    v_mfma_f32_16x16x32_bf16 a[136:139], a[96:99], a[16:19], a[136:139]
    v_mfma_f32_16x16x32_bf16 v[104:107], a[72:75], a[16:19], v[104:107]
    ds_read_b64_tr_b16 a[84:85], v20 offset:8192
    v_mfma_f32_16x16x32_bf16 v[104:107], a[76:79], a[20:23], v[104:107]
    v_mfma_f32_16x16x32_bf16 a[168:171], a[108:111], a[20:23], a[168:171]
    ds_read_b64_tr_b16 a[86:87], v20 offset:9216
    v_mfma_f32_16x16x32_bf16 a[168:171], a[104:107], a[16:19], a[168:171]
    s_mov_b32 s76, s74
    s_mov_b32 s77, s75
    s_mov_b32 s78, 0x400000
    buffer_load_dwordx4 v[220:223], v27, s[76:79], s62 offen offset:0
    v_mfma_f32_16x16x32_bf16 a[172:175], a[104:107], a[24:27], a[172:175]
    ds_read_b64_tr_b16 a[112:113], v20 offset:16384
    v_mfma_f32_16x16x32_bf16 a[172:175], a[108:111], a[28:31], a[172:175]
    v_mfma_f32_16x16x32_bf16 v[108:111], a[76:79], a[28:31], v[108:111]
    ds_read_b64_tr_b16 a[114:115], v20 offset:17408
    v_mfma_f32_16x16x32_bf16 v[108:111], a[72:75], a[24:27], v[108:111]
    v_mfma_f32_16x16x32_bf16 a[140:143], a[96:99], a[24:27], a[140:143]
    ds_read_b64_tr_b16 a[116:117], v20 offset:24576
    v_mfma_f32_16x16x32_bf16 a[140:143], a[100:103], a[28:31], a[140:143]
    v_mfma_f32_16x16x32_bf16 v[76:79], a[68:71], a[28:31], v[76:79]
    ds_read_b64_tr_b16 a[118:119], v20 offset:25600
    v_mfma_f32_16x16x32_bf16 v[76:79], a[64:67], a[24:27], v[76:79]
    s_waitcnt lgkmcnt(8)
    buffer_load_dwordx4 v[224:227], v27, s[76:79], s62 offen offset:1024
    v_mfma_f32_16x16x32_bf16 v[80:83], a[64:67], a[32:35], v[80:83]
    ds_read_b64_tr_b16 a[88:89], v21 offset:0
    v_mfma_f32_16x16x32_bf16 v[80:83], a[68:71], a[36:39], v[80:83]
    v_mfma_f32_16x16x32_bf16 a[144:147], a[100:103], a[36:39], a[144:147]
    ds_read_b64_tr_b16 a[90:91], v21 offset:1024
    v_mfma_f32_16x16x32_bf16 a[144:147], a[96:99], a[32:35], a[144:147]
    v_mfma_f32_16x16x32_bf16 v[112:115], a[72:75], a[32:35], v[112:115]
    ds_read_b64_tr_b16 a[92:93], v21 offset:8192
    v_mfma_f32_16x16x32_bf16 v[112:115], a[76:79], a[36:39], v[112:115]
    v_mfma_f32_16x16x32_bf16 a[176:179], a[108:111], a[36:39], a[176:179]
    ds_read_b64_tr_b16 a[94:95], v21 offset:9216
    v_mfma_f32_16x16x32_bf16 a[176:179], a[104:107], a[32:35], a[176:179]
    buffer_load_dwordx4 v[228:231], v27, s[76:79], s62 offen offset:2048
    v_mfma_f32_16x16x32_bf16 a[180:183], a[104:107], a[40:43], a[180:183]
    ds_read_b64_tr_b16 a[120:121], v21 offset:16384
    v_mfma_f32_16x16x32_bf16 a[180:183], a[108:111], a[44:47], a[180:183]
    v_mfma_f32_16x16x32_bf16 v[116:119], a[76:79], a[44:47], v[116:119]
    ds_read_b64_tr_b16 a[122:123], v21 offset:17408
    v_mfma_f32_16x16x32_bf16 v[116:119], a[72:75], a[40:43], v[116:119]
    v_mfma_f32_16x16x32_bf16 a[148:151], a[96:99], a[40:43], a[148:151]
IW_P3:
    s_cbranch_execz IW_R0
    ds_read_b64_tr_b16 a[124:125], v21 offset:24576
    v_mfma_f32_16x16x32_bf16 a[148:151], a[100:103], a[44:47], a[148:151]
    v_mfma_f32_16x16x32_bf16 v[84:87], a[68:71], a[44:47], v[84:87]
    ds_read_b64_tr_b16 a[126:127], v21 offset:25600
    v_mfma_f32_16x16x32_bf16 v[84:87], a[64:67], a[40:43], v[84:87]
    buffer_load_dwordx4 v[232:235], v27, s[76:79], s62 offen offset:3072
    v_mfma_f32_16x16x32_bf16 v[88:91], a[64:67], a[48:51], v[88:91]
    v_mfma_f32_16x16x32_bf16 v[88:91], a[68:71], a[52:55], v[88:91]
    v_mfma_f32_16x16x32_bf16 a[152:155], a[100:103], a[52:55], a[152:155]
    v_mfma_f32_16x16x32_bf16 a[152:155], a[96:99], a[48:51], a[152:155]
    v_mfma_f32_16x16x32_bf16 v[120:123], a[72:75], a[48:51], v[120:123]
    v_mfma_f32_16x16x32_bf16 v[120:123], a[76:79], a[52:55], v[120:123]
    v_mfma_f32_16x16x32_bf16 a[184:187], a[108:111], a[52:55], a[184:187]
    v_mfma_f32_16x16x32_bf16 a[184:187], a[104:107], a[48:51], a[184:187]
    v_mfma_f32_16x16x32_bf16 a[188:191], a[104:107], a[56:59], a[188:191]
    v_mfma_f32_16x16x32_bf16 a[188:191], a[108:111], a[60:63], a[188:191]
    v_mfma_f32_16x16x32_bf16 v[124:127], a[76:79], a[60:63], v[124:127]
    v_mfma_f32_16x16x32_bf16 v[124:127], a[72:75], a[56:59], v[124:127]
    v_mfma_f32_16x16x32_bf16 a[156:159], a[96:99], a[56:59], a[156:159]
    v_mfma_f32_16x16x32_bf16 a[156:159], a[100:103], a[60:63], a[156:159]
    v_mfma_f32_16x16x32_bf16 v[92:95], a[68:71], a[60:63], v[92:95]
    v_mfma_f32_16x16x32_bf16 v[92:95], a[64:67], a[56:59], v[92:95]
    s_waitcnt lgkmcnt(0)
    s_add_u32 m0, s22, 0x10000
    s_waitcnt vmcnt(7)
    s_cmp_lg_u32 s40, 0
    s_cbranch_scc1 G1_C2_OK
    s_movk_i32 s3, 0x4000
G1_C2_L:
    v_cmp_eq_u32 vcc, 8, v55
    s_nop 1
    s_cmp_eq_u64 vcc, -1
    s_cbranch_scc1 G1_C2_OK
    s_sub_u32 s3, s3, 1
    s_cmp_eq_u32 s3, 0
    s_cbranch_scc1 G1_C2_OK
    s_sleep 8
    v_and_b32 v52, 3, v0
    v_lshlrev_b32 v52, 6, v52
    buffer_load_dword v55, v52, s[80:83], 0 offen sc1
    s_waitcnt vmcnt(0)
    s_branch G1_C2_L
G1_C2_OK:
    s_barrier
    v_mfma_f32_16x16x32_bf16 v[128:131], a[80:83], a[0:3], v[128:131]
    ds_read_b64_tr_b16 a[64:65], v22 offset:0
    v_mfma_f32_16x16x32_bf16 v[128:131], a[84:87], a[4:7], v[128:131]
    buffer_load_dwordx4 v2, s[4:7], s20 offen offset:0 lds
    v_mfma_f32_16x16x32_bf16 a[192:195], a[116:119], a[4:7], a[192:195]
    ds_read_b64_tr_b16 a[66:67], v22 offset:1024
    v_mfma_f32_16x16x32_bf16 a[192:195], a[112:115], a[0:3], a[192:195]
    v_mfma_f32_16x16x32_bf16 v[160:163], a[88:91], a[0:3], v[160:163]
    ds_read_b64_tr_b16 a[68:69], v22 offset:8192
    v_mfma_f32_16x16x32_bf16 v[160:163], a[92:95], a[4:7], v[160:163]
    buffer_load_dwordx4 v3, s[4:7], s20 offen offset:1024 lds
    v_mfma_f32_16x16x32_bf16 a[224:227], a[124:127], a[4:7], a[224:227]
    ds_read_b64_tr_b16 a[70:71], v22 offset:9216
    v_mfma_f32_16x16x32_bf16 a[224:227], a[120:123], a[0:3], a[224:227]
    v_mfma_f32_16x16x32_bf16 a[228:231], a[120:123], a[8:11], a[228:231]
    ds_read_b128 a[0:3], v16 offset:0
    v_mfma_f32_16x16x32_bf16 a[228:231], a[124:127], a[12:15], a[228:231]
    buffer_load_dwordx4 v4, s[4:7], s20 offen offset:2048 lds
    v_mfma_f32_16x16x32_bf16 v[164:167], a[92:95], a[12:15], v[164:167]
    ds_read_b128 a[4:7], v17 offset:0
    v_mfma_f32_16x16x32_bf16 v[164:167], a[88:91], a[8:11], v[164:167]
    v_mfma_f32_16x16x32_bf16 a[196:199], a[112:115], a[8:11], a[196:199]
    ds_read_b64_tr_b16 a[96:97], v22 offset:16384
    v_mfma_f32_16x16x32_bf16 a[196:199], a[116:119], a[12:15], a[196:199]
    buffer_load_dwordx4 v5, s[4:7], s20 offen offset:3072 lds
    v_mfma_f32_16x16x32_bf16 v[132:135], a[84:87], a[12:15], v[132:135]
    ds_read_b64_tr_b16 a[98:99], v22 offset:17408
    v_mfma_f32_16x16x32_bf16 v[132:135], a[80:83], a[8:11], v[132:135]
    s_add_u32 m0, s22, 0x11000
    v_mfma_f32_16x16x32_bf16 v[136:139], a[80:83], a[16:19], v[136:139]
    ds_read_b128 a[8:11], v16 offset:2048
    v_mfma_f32_16x16x32_bf16 v[136:139], a[84:87], a[20:23], v[136:139]
    buffer_load_dwordx4 v6, s[4:7], s20 offen offset:0 lds
    v_mfma_f32_16x16x32_bf16 a[200:203], a[116:119], a[20:23], a[200:203]
    ds_read_b128 a[12:15], v17 offset:2048
    v_mfma_f32_16x16x32_bf16 a[200:203], a[112:115], a[16:19], a[200:203]
    v_mfma_f32_16x16x32_bf16 v[168:171], a[88:91], a[16:19], v[168:171]
    ds_read_b64_tr_b16 a[100:101], v22 offset:24576
    v_mfma_f32_16x16x32_bf16 v[168:171], a[92:95], a[20:23], v[168:171]
    buffer_load_dwordx4 v7, s[4:7], s20 offen offset:1024 lds
    v_mfma_f32_16x16x32_bf16 a[232:235], a[124:127], a[20:23], a[232:235]
    ds_read_b64_tr_b16 a[102:103], v22 offset:25600
    v_mfma_f32_16x16x32_bf16 a[232:235], a[120:123], a[16:19], a[232:235]
    v_mfma_f32_16x16x32_bf16 a[236:239], a[120:123], a[24:27], a[236:239]
    ds_read_b128 a[16:19], v16 offset:4096
    v_mfma_f32_16x16x32_bf16 a[236:239], a[124:127], a[28:31], a[236:239]
    buffer_load_dwordx4 v8, s[4:7], s20 offen offset:2048 lds
    v_mfma_f32_16x16x32_bf16 v[172:175], a[92:95], a[28:31], v[172:175]
    ds_read_b128 a[20:23], v17 offset:4096
    v_mfma_f32_16x16x32_bf16 v[172:175], a[88:91], a[24:27], v[172:175]
    v_mfma_f32_16x16x32_bf16 a[204:207], a[112:115], a[24:27], a[204:207]
    ds_read_b64_tr_b16 a[72:73], v23 offset:0
    v_mfma_f32_16x16x32_bf16 a[204:207], a[116:119], a[28:31], a[204:207]
    buffer_load_dwordx4 v9, s[4:7], s20 offen offset:3072 lds
    v_mfma_f32_16x16x32_bf16 v[140:143], a[84:87], a[28:31], v[140:143]
    ds_read_b64_tr_b16 a[74:75], v23 offset:1024
    v_mfma_f32_16x16x32_bf16 v[140:143], a[80:83], a[24:27], v[140:143]
    s_add_u32 s20, s20, 128
    s_add_u32 m0, s23, 0x18000
    v_mfma_f32_16x16x32_bf16 v[144:147], a[80:83], a[32:35], v[144:147]
    ds_read_b128 a[24:27], v16 offset:6144
    v_mfma_f32_16x16x32_bf16 v[144:147], a[84:87], a[36:39], v[144:147]
    buffer_load_dwordx4 v10, s[8:11], s21 offen offset:0 lds
    v_mfma_f32_16x16x32_bf16 a[208:211], a[116:119], a[36:39], a[208:211]
    ds_read_b128 a[28:31], v17 offset:6144
    v_mfma_f32_16x16x32_bf16 a[208:211], a[112:115], a[32:35], a[208:211]
    v_mfma_f32_16x16x32_bf16 v[176:179], a[88:91], a[32:35], v[176:179]
    ds_read_b64_tr_b16 a[76:77], v23 offset:8192
    v_mfma_f32_16x16x32_bf16 v[176:179], a[92:95], a[36:39], v[176:179]
    buffer_load_dwordx4 v11, s[8:11], s21 offen offset:1024 lds
    v_mfma_f32_16x16x32_bf16 a[240:243], a[124:127], a[36:39], a[240:243]
    ds_read_b64_tr_b16 a[78:79], v23 offset:9216
    v_mfma_f32_16x16x32_bf16 a[240:243], a[120:123], a[32:35], a[240:243]
    v_mfma_f32_16x16x32_bf16 a[244:247], a[120:123], a[40:43], a[244:247]
    ds_read_b64_tr_b16 a[104:105], v23 offset:16384
    v_mfma_f32_16x16x32_bf16 a[244:247], a[124:127], a[44:47], a[244:247]
    buffer_load_dwordx4 v12, s[8:11], s21 offen offset:2048 lds
    v_mfma_f32_16x16x32_bf16 v[180:183], a[92:95], a[44:47], v[180:183]
    ds_read_b64_tr_b16 a[106:107], v23 offset:17408
    v_mfma_f32_16x16x32_bf16 v[180:183], a[88:91], a[40:43], v[180:183]
    v_mfma_f32_16x16x32_bf16 a[212:215], a[112:115], a[40:43], a[212:215]
    ds_read_b64_tr_b16 a[108:109], v23 offset:24576
    v_mfma_f32_16x16x32_bf16 a[212:215], a[116:119], a[44:47], a[212:215]
    buffer_load_dwordx4 v13, s[8:11], s21 offen offset:3072 lds
    v_mfma_f32_16x16x32_bf16 v[148:151], a[84:87], a[44:47], v[148:151]
    ds_read_b64_tr_b16 a[110:111], v23 offset:25600
    v_mfma_f32_16x16x32_bf16 v[148:151], a[80:83], a[40:43], v[148:151]
    s_add_u32 m0, s23, 0x1c000
    v_mfma_f32_16x16x32_bf16 v[152:155], a[80:83], a[48:51], v[152:155]
    v_mfma_f32_16x16x32_bf16 v[152:155], a[84:87], a[52:55], v[152:155]
    buffer_load_dwordx4 v10, s[12:15], s21 offen offset:0 lds
    v_mfma_f32_16x16x32_bf16 a[216:219], a[116:119], a[52:55], a[216:219]
    v_mfma_f32_16x16x32_bf16 a[216:219], a[112:115], a[48:51], a[216:219]
    v_mfma_f32_16x16x32_bf16 v[184:187], a[88:91], a[48:51], v[184:187]
    buffer_load_dwordx4 v11, s[12:15], s21 offen offset:1024 lds
    v_mfma_f32_16x16x32_bf16 v[184:187], a[92:95], a[52:55], v[184:187]
    v_mfma_f32_16x16x32_bf16 a[248:251], a[124:127], a[52:55], a[248:251]
    v_mfma_f32_16x16x32_bf16 a[248:251], a[120:123], a[48:51], a[248:251]
    buffer_load_dwordx4 v12, s[12:15], s21 offen offset:2048 lds
    v_mfma_f32_16x16x32_bf16 a[252:255], a[120:123], a[56:59], a[252:255]
    v_mfma_f32_16x16x32_bf16 a[252:255], a[124:127], a[60:63], a[252:255]
    v_mfma_f32_16x16x32_bf16 v[188:191], a[92:95], a[60:63], v[188:191]
    buffer_load_dwordx4 v13, s[12:15], s21 offen offset:3072 lds
    v_mfma_f32_16x16x32_bf16 v[188:191], a[88:91], a[56:59], v[188:191]
    v_mfma_f32_16x16x32_bf16 a[220:223], a[112:115], a[56:59], a[220:223]
    s_add_u32 s21, s21, 0x70000
    v_mfma_f32_16x16x32_bf16 a[220:223], a[116:119], a[60:63], a[220:223]
    s_lshl_b32 s60, s2, 2
    s_add_u32 s60, s60, s40
    s_lshl_b32 s62, s60, 12
    s_mov_b32 s76, s64
    s_mov_b32 s77, s65
    s_mov_b32 s78, 0x400000
    s_mov_b32 s79, 0x00020000
    v_and_b32 v208, 31, v0
    v_lshlrev_b32 v208, 7, v208
    buffer_load_dword v209, v208, s[76:79], s62 offen
    v_mfma_f32_16x16x32_bf16 v[156:159], a[84:87], a[60:63], v[156:159]
    v_mfma_f32_16x16x32_bf16 v[156:159], a[80:83], a[56:59], v[156:159]
    s_waitcnt vmcnt(17) lgkmcnt(0)
    v_mfma_f32_16x16x32_bf16 v[64:67], a[64:67], a[0:3], v[64:67]
    ds_read_b128 a[32:35], v16 offset:8192
    v_lshlrev_b32 v236, 16, v212
    v_mfma_f32_16x16x32_bf16 v[64:67], a[68:71], a[4:7], v[64:67]
    v_and_b32 v237, 0xffff0000, v212
    v_mfma_f32_16x16x32_bf16 a[128:131], a[100:103], a[4:7], a[128:131]
    ds_read_b128 a[36:39], v17 offset:8192
    v_lshlrev_b32 v238, 16, v213
    v_mfma_f32_16x16x32_bf16 a[128:131], a[96:99], a[0:3], a[128:131]
    v_and_b32 v239, 0xffff0000, v213
    v_mfma_f32_16x16x32_bf16 v[96:99], a[72:75], a[0:3], v[96:99]
    ds_read_b128 a[40:43], v16 offset:10240
    v_lshlrev_b32 v240, 16, v214
    v_mfma_f32_16x16x32_bf16 v[96:99], a[76:79], a[4:7], v[96:99]
    v_and_b32 v241, 0xffff0000, v214
    v_mfma_f32_16x16x32_bf16 a[160:163], a[108:111], a[4:7], a[160:163]
    ds_read_b128 a[44:47], v17 offset:10240
    v_lshlrev_b32 v242, 16, v215
    v_mfma_f32_16x16x32_bf16 a[160:163], a[104:107], a[0:3], a[160:163]
    v_and_b32 v243, 0xffff0000, v215
    v_mfma_f32_16x16x32_bf16 a[164:167], a[104:107], a[8:11], a[164:167]
    ds_read_b128 a[48:51], v16 offset:12288
    v_lshlrev_b32 v244, 16, v216
    v_mfma_f32_16x16x32_bf16 a[164:167], a[108:111], a[12:15], a[164:167]
    v_and_b32 v245, 0xffff0000, v216
    v_mfma_f32_16x16x32_bf16 v[100:103], a[76:79], a[12:15], v[100:103]
    ds_read_b128 a[52:55], v17 offset:12288
    v_lshlrev_b32 v246, 16, v217
    v_mfma_f32_16x16x32_bf16 v[100:103], a[72:75], a[8:11], v[100:103]
    v_and_b32 v247, 0xffff0000, v217
    v_mfma_f32_16x16x32_bf16 a[132:135], a[96:99], a[8:11], a[132:135]
    ds_read_b128 a[56:59], v16 offset:14336
    v_lshlrev_b32 v248, 16, v218
    v_mfma_f32_16x16x32_bf16 a[132:135], a[100:103], a[12:15], a[132:135]
    v_and_b32 v249, 0xffff0000, v218
    v_mfma_f32_16x16x32_bf16 v[68:71], a[68:71], a[12:15], v[68:71]
    ds_read_b128 a[60:63], v17 offset:14336
    v_lshlrev_b32 v250, 16, v219
    v_mfma_f32_16x16x32_bf16 v[68:71], a[64:67], a[8:11], v[68:71]
    v_and_b32 v251, 0xffff0000, v219
    v_mfma_f32_16x16x32_bf16 v[72:75], a[64:67], a[16:19], v[72:75]
    ds_read_b64_tr_b16 a[80:81], v24 offset:0
    v_mfma_f32_16x16x32_bf16 v[72:75], a[68:71], a[20:23], v[72:75]
    v_lshlrev_b32 v252, 16, v220
    v_and_b32 v253, 0xffff0000, v220
    v_mfma_f32_16x16x32_bf16 a[136:139], a[100:103], a[20:23], a[136:139]
    ds_read_b64_tr_b16 a[82:83], v24 offset:1024
    v_mfma_f32_16x16x32_bf16 a[136:139], a[96:99], a[16:19], a[136:139]
    v_mul_f32 v252, v252, v236
    v_mul_f32 v253, v253, v237
    v_mfma_f32_16x16x32_bf16 v[104:107], a[72:75], a[16:19], v[104:107]
    ds_read_b64_tr_b16 a[84:85], v24 offset:8192
    v_mfma_f32_16x16x32_bf16 v[104:107], a[76:79], a[20:23], v[104:107]
    v_cvt_pk_bf16_f32 v252, v252, v253
    v_lshlrev_b32 v253, 16, v252
    v_mfma_f32_16x16x32_bf16 a[168:171], a[108:111], a[20:23], a[168:171]
    ds_read_b64_tr_b16 a[86:87], v24 offset:9216
    v_mfma_f32_16x16x32_bf16 a[168:171], a[104:107], a[16:19], a[168:171]
    v_and_b32 v252, 0xffff0000, v252
    v_add_f32 v26, v252, v253
    v_mfma_f32_16x16x32_bf16 a[172:175], a[104:107], a[24:27], a[172:175]
    ds_read_b64_tr_b16 a[112:113], v24 offset:16384
    v_mfma_f32_16x16x32_bf16 a[172:175], a[108:111], a[28:31], a[172:175]
    v_lshlrev_b32 v254, 16, v221
    v_and_b32 v255, 0xffff0000, v221
    v_mfma_f32_16x16x32_bf16 v[108:111], a[76:79], a[28:31], v[108:111]
    ds_read_b64_tr_b16 a[114:115], v24 offset:17408
    v_mfma_f32_16x16x32_bf16 v[108:111], a[72:75], a[24:27], v[108:111]
    v_mul_f32 v254, v254, v238
    v_mul_f32 v255, v255, v239
    v_mfma_f32_16x16x32_bf16 a[140:143], a[96:99], a[24:27], a[140:143]
    ds_read_b64_tr_b16 a[116:117], v24 offset:24576
    v_mfma_f32_16x16x32_bf16 a[140:143], a[100:103], a[28:31], a[140:143]
    v_cvt_pk_bf16_f32 v254, v254, v255
    v_lshlrev_b32 v255, 16, v254
    v_mfma_f32_16x16x32_bf16 v[76:79], a[68:71], a[28:31], v[76:79]
    ds_read_b64_tr_b16 a[118:119], v24 offset:25600
    v_mfma_f32_16x16x32_bf16 v[76:79], a[64:67], a[24:27], v[76:79]
    s_waitcnt lgkmcnt(8)
    v_and_b32 v254, 0xffff0000, v254
    v_mfma_f32_16x16x32_bf16 v[80:83], a[64:67], a[32:35], v[80:83]
    ds_read_b64_tr_b16 a[88:89], v25 offset:0
    v_add_f32 v254, v254, v255
    v_mfma_f32_16x16x32_bf16 v[80:83], a[68:71], a[36:39], v[80:83]
    v_add_f32 v26, v26, v254
    v_mfma_f32_16x16x32_bf16 a[144:147], a[100:103], a[36:39], a[144:147]
    ds_read_b64_tr_b16 a[90:91], v25 offset:1024
    v_lshlrev_b32 v252, 16, v222
    v_mfma_f32_16x16x32_bf16 a[144:147], a[96:99], a[32:35], a[144:147]
    v_and_b32 v253, 0xffff0000, v222
    v_mfma_f32_16x16x32_bf16 v[112:115], a[72:75], a[32:35], v[112:115]
    ds_read_b64_tr_b16 a[92:93], v25 offset:8192
    v_mul_f32 v252, v252, v240
    v_mfma_f32_16x16x32_bf16 v[112:115], a[76:79], a[36:39], v[112:115]
    v_mul_f32 v253, v253, v241
    v_mfma_f32_16x16x32_bf16 a[176:179], a[108:111], a[36:39], a[176:179]
    ds_read_b64_tr_b16 a[94:95], v25 offset:9216
    v_cvt_pk_bf16_f32 v252, v252, v253
    v_mfma_f32_16x16x32_bf16 a[176:179], a[104:107], a[32:35], a[176:179]
    v_lshlrev_b32 v253, 16, v252
    v_mfma_f32_16x16x32_bf16 a[180:183], a[104:107], a[40:43], a[180:183]
    ds_read_b64_tr_b16 a[120:121], v25 offset:16384
    v_and_b32 v252, 0xffff0000, v252
    v_mfma_f32_16x16x32_bf16 a[180:183], a[108:111], a[44:47], a[180:183]
    v_add_f32 v252, v252, v253
    v_mfma_f32_16x16x32_bf16 v[116:119], a[76:79], a[44:47], v[116:119]
    ds_read_b64_tr_b16 a[122:123], v25 offset:17408
    v_add_f32 v26, v26, v252
    v_mfma_f32_16x16x32_bf16 v[116:119], a[72:75], a[40:43], v[116:119]
    v_lshlrev_b32 v254, 16, v223
    v_mfma_f32_16x16x32_bf16 a[148:151], a[96:99], a[40:43], a[148:151]
    ds_read_b64_tr_b16 a[124:125], v25 offset:24576
    v_and_b32 v255, 0xffff0000, v223
    v_mfma_f32_16x16x32_bf16 a[148:151], a[100:103], a[44:47], a[148:151]
    v_mul_f32 v254, v254, v242
    v_mfma_f32_16x16x32_bf16 v[84:87], a[68:71], a[44:47], v[84:87]
    ds_read_b64_tr_b16 a[126:127], v25 offset:25600
    v_mul_f32 v255, v255, v243
    v_mfma_f32_16x16x32_bf16 v[84:87], a[64:67], a[40:43], v[84:87]
    v_cvt_pk_bf16_f32 v254, v254, v255
    v_mfma_f32_16x16x32_bf16 v[88:91], a[64:67], a[48:51], v[88:91]
    v_lshlrev_b32 v255, 16, v254
    v_mfma_f32_16x16x32_bf16 v[88:91], a[68:71], a[52:55], v[88:91]
    v_and_b32 v254, 0xffff0000, v254
    v_add_f32 v254, v254, v255
    v_mfma_f32_16x16x32_bf16 a[152:155], a[100:103], a[52:55], a[152:155]
    v_add_f32 v26, v26, v254
    v_mfma_f32_16x16x32_bf16 a[152:155], a[96:99], a[48:51], a[152:155]
    v_lshlrev_b32 v252, 16, v224
    v_and_b32 v253, 0xffff0000, v224
    v_mfma_f32_16x16x32_bf16 v[120:123], a[72:75], a[48:51], v[120:123]
    v_mul_f32 v252, v252, v244
    v_mfma_f32_16x16x32_bf16 v[120:123], a[76:79], a[52:55], v[120:123]
    v_mul_f32 v253, v253, v245
    v_cvt_pk_bf16_f32 v252, v252, v253
    v_mfma_f32_16x16x32_bf16 a[184:187], a[108:111], a[52:55], a[184:187]
    v_lshlrev_b32 v253, 16, v252
    v_mfma_f32_16x16x32_bf16 a[184:187], a[104:107], a[48:51], a[184:187]
    v_and_b32 v252, 0xffff0000, v252
    v_add_f32 v252, v252, v253
    v_mfma_f32_16x16x32_bf16 a[188:191], a[104:107], a[56:59], a[188:191]
    v_add_f32 v26, v26, v252
    v_mfma_f32_16x16x32_bf16 a[188:191], a[108:111], a[60:63], a[188:191]
    v_lshlrev_b32 v254, 16, v225
    v_and_b32 v255, 0xffff0000, v225
    v_mfma_f32_16x16x32_bf16 v[124:127], a[76:79], a[60:63], v[124:127]
    v_mul_f32 v254, v254, v246
    v_mfma_f32_16x16x32_bf16 v[124:127], a[72:75], a[56:59], v[124:127]
    v_mul_f32 v255, v255, v247
    v_cvt_pk_bf16_f32 v254, v254, v255
    v_mfma_f32_16x16x32_bf16 a[156:159], a[96:99], a[56:59], a[156:159]
    v_lshlrev_b32 v255, 16, v254
    v_mfma_f32_16x16x32_bf16 a[156:159], a[100:103], a[60:63], a[156:159]
    v_and_b32 v254, 0xffff0000, v254
    v_add_f32 v254, v254, v255
    v_mfma_f32_16x16x32_bf16 v[92:95], a[68:71], a[60:63], v[92:95]
    v_add_f32 v26, v26, v254
    v_mfma_f32_16x16x32_bf16 v[92:95], a[64:67], a[56:59], v[92:95]
    v_lshlrev_b32 v252, 16, v226
    s_waitcnt lgkmcnt(0)
    s_add_u32 m0, s22, 0x0
    s_waitcnt vmcnt(1)
    s_barrier
    v_mfma_f32_16x16x32_bf16 v[128:131], a[80:83], a[0:3], v[128:131]
    ds_read_b64_tr_b16 a[64:65], v18 offset:0
    s_load_dwordx2 s[68:69], s[0:1], 88
    v_mfma_f32_16x16x32_bf16 v[128:131], a[84:87], a[4:7], v[128:131]
    buffer_load_dwordx4 v2, s[4:7], s20 offen offset:0 lds
    v_and_b32 v253, 0xffff0000, v226
    v_mfma_f32_16x16x32_bf16 a[192:195], a[116:119], a[4:7], a[192:195]
    ds_read_b64_tr_b16 a[66:67], v18 offset:1024
    v_mfma_f32_16x16x32_bf16 a[192:195], a[112:115], a[0:3], a[192:195]
    v_mul_f32 v252, v252, v248
    v_mul_f32 v253, v253, v249
    v_mfma_f32_16x16x32_bf16 v[160:163], a[88:91], a[0:3], v[160:163]
    ds_read_b64_tr_b16 a[68:69], v18 offset:8192
    v_mfma_f32_16x16x32_bf16 v[160:163], a[92:95], a[4:7], v[160:163]
    buffer_load_dwordx4 v3, s[4:7], s20 offen offset:1024 lds
    v_cvt_pk_bf16_f32 v252, v252, v253
    v_mfma_f32_16x16x32_bf16 a[224:227], a[124:127], a[4:7], a[224:227]
    ds_read_b64_tr_b16 a[70:71], v18 offset:9216
    v_mfma_f32_16x16x32_bf16 a[224:227], a[120:123], a[0:3], a[224:227]
    v_lshlrev_b32 v253, 16, v252
    v_and_b32 v252, 0xffff0000, v252
    v_mfma_f32_16x16x32_bf16 a[228:231], a[120:123], a[8:11], a[228:231]
    ds_read_b128 a[0:3], v34 offset:0
    v_mfma_f32_16x16x32_bf16 a[228:231], a[124:127], a[12:15], a[228:231]
    buffer_load_dwordx4 v4, s[4:7], s20 offen offset:2048 lds
    v_add_f32 v252, v252, v253
    v_mfma_f32_16x16x32_bf16 v[164:167], a[92:95], a[12:15], v[164:167]
    ds_read_b128 a[4:7], v35 offset:0
    v_mfma_f32_16x16x32_bf16 v[164:167], a[88:91], a[8:11], v[164:167]
    v_add_f32 v26, v26, v252
    v_lshlrev_b32 v254, 16, v227
    v_mfma_f32_16x16x32_bf16 a[196:199], a[112:115], a[8:11], a[196:199]
    ds_read_b64_tr_b16 a[96:97], v18 offset:16384
    v_mfma_f32_16x16x32_bf16 a[196:199], a[116:119], a[12:15], a[196:199]
    buffer_load_dwordx4 v5, s[4:7], s20 offen offset:3072 lds
    v_and_b32 v255, 0xffff0000, v227
    v_mfma_f32_16x16x32_bf16 v[132:135], a[84:87], a[12:15], v[132:135]
    ds_read_b64_tr_b16 a[98:99], v18 offset:17408
    v_mfma_f32_16x16x32_bf16 v[132:135], a[80:83], a[8:11], v[132:135]
    s_add_u32 m0, s22, 0x1000
    v_mul_f32 v254, v254, v250
    v_mfma_f32_16x16x32_bf16 v[136:139], a[80:83], a[16:19], v[136:139]
    ds_read_b128 a[8:11], v34 offset:2048
    v_mfma_f32_16x16x32_bf16 v[136:139], a[84:87], a[20:23], v[136:139]
    buffer_load_dwordx4 v6, s[4:7], s20 offen offset:0 lds
    v_mul_f32 v255, v255, v251
    v_mfma_f32_16x16x32_bf16 a[200:203], a[116:119], a[20:23], a[200:203]
    ds_read_b128 a[12:15], v35 offset:2048
    v_mfma_f32_16x16x32_bf16 a[200:203], a[112:115], a[16:19], a[200:203]
    v_cvt_pk_bf16_f32 v254, v254, v255
    v_lshlrev_b32 v255, 16, v254
    v_mfma_f32_16x16x32_bf16 v[168:171], a[88:91], a[16:19], v[168:171]
    ds_read_b64_tr_b16 a[100:101], v18 offset:24576
    v_mfma_f32_16x16x32_bf16 v[168:171], a[92:95], a[20:23], v[168:171]
    buffer_load_dwordx4 v7, s[4:7], s20 offen offset:1024 lds
    v_and_b32 v254, 0xffff0000, v254
    v_mfma_f32_16x16x32_bf16 a[232:235], a[124:127], a[20:23], a[232:235]
    ds_read_b64_tr_b16 a[102:103], v18 offset:25600
    v_mfma_f32_16x16x32_bf16 a[232:235], a[120:123], a[16:19], a[232:235]
    v_add_f32 v254, v254, v255
    v_add_f32 v26, v26, v254
    v_mfma_f32_16x16x32_bf16 a[236:239], a[120:123], a[24:27], a[236:239]
    ds_read_b128 a[16:19], v34 offset:4096
    v_mfma_f32_16x16x32_bf16 a[236:239], a[124:127], a[28:31], a[236:239]
    buffer_load_dwordx4 v8, s[4:7], s20 offen offset:2048 lds
    v_lshlrev_b32 v252, 16, v228
    v_mfma_f32_16x16x32_bf16 v[172:175], a[92:95], a[28:31], v[172:175]
    ds_read_b128 a[20:23], v35 offset:4096
    v_mfma_f32_16x16x32_bf16 v[172:175], a[88:91], a[24:27], v[172:175]
    v_and_b32 v253, 0xffff0000, v228
    v_mul_f32 v252, v252, v236
    v_mfma_f32_16x16x32_bf16 a[204:207], a[112:115], a[24:27], a[204:207]
    ds_read_b64_tr_b16 a[72:73], v19 offset:0
    v_mfma_f32_16x16x32_bf16 a[204:207], a[116:119], a[28:31], a[204:207]
    buffer_load_dwordx4 v9, s[4:7], s20 offen offset:3072 lds
    v_mul_f32 v253, v253, v237
    v_mfma_f32_16x16x32_bf16 v[140:143], a[84:87], a[28:31], v[140:143]
    ds_read_b64_tr_b16 a[74:75], v19 offset:1024
    v_mfma_f32_16x16x32_bf16 v[140:143], a[80:83], a[24:27], v[140:143]
    s_add_u32 s20, s20, 128
    s_add_u32 m0, s23, 0x8000
    v_mfma_f32_16x16x32_bf16 v[144:147], a[80:83], a[32:35], v[144:147]
    ds_read_b128 a[24:27], v34 offset:6144
    v_mfma_f32_16x16x32_bf16 v[144:147], a[84:87], a[36:39], v[144:147]
    buffer_load_dwordx4 v10, s[8:11], s21 offen offset:0 lds
    v_cvt_pk_bf16_f32 v252, v252, v253
    v_mfma_f32_16x16x32_bf16 a[208:211], a[116:119], a[36:39], a[208:211]
    ds_read_b128 a[28:31], v35 offset:6144
    v_mfma_f32_16x16x32_bf16 a[208:211], a[112:115], a[32:35], a[208:211]
    v_lshlrev_b32 v253, 16, v252
    v_and_b32 v252, 0xffff0000, v252
    v_mfma_f32_16x16x32_bf16 v[176:179], a[88:91], a[32:35], v[176:179]
    ds_read_b64_tr_b16 a[76:77], v19 offset:8192
    v_mfma_f32_16x16x32_bf16 v[176:179], a[92:95], a[36:39], v[176:179]
    buffer_load_dwordx4 v11, s[8:11], s21 offen offset:1024 lds
    v_add_f32 v27, v252, v253
    v_mfma_f32_16x16x32_bf16 a[240:243], a[124:127], a[36:39], a[240:243]
    ds_read_b64_tr_b16 a[78:79], v19 offset:9216
    v_mfma_f32_16x16x32_bf16 a[240:243], a[120:123], a[32:35], a[240:243]
    v_lshlrev_b32 v254, 16, v229
    v_and_b32 v255, 0xffff0000, v229
    v_mfma_f32_16x16x32_bf16 a[244:247], a[120:123], a[40:43], a[244:247]
    ds_read_b64_tr_b16 a[104:105], v19 offset:16384
    v_mfma_f32_16x16x32_bf16 a[244:247], a[124:127], a[44:47], a[244:247]
    buffer_load_dwordx4 v12, s[8:11], s21 offen offset:2048 lds
    v_mul_f32 v254, v254, v238
    v_mfma_f32_16x16x32_bf16 v[180:183], a[92:95], a[44:47], v[180:183]
    ds_read_b64_tr_b16 a[106:107], v19 offset:17408
    v_mfma_f32_16x16x32_bf16 v[180:183], a[88:91], a[40:43], v[180:183]
    v_mul_f32 v255, v255, v239
    v_cvt_pk_bf16_f32 v254, v254, v255
    v_mfma_f32_16x16x32_bf16 a[212:215], a[112:115], a[40:43], a[212:215]
    ds_read_b64_tr_b16 a[108:109], v19 offset:24576
    v_mfma_f32_16x16x32_bf16 a[212:215], a[116:119], a[44:47], a[212:215]
    buffer_load_dwordx4 v13, s[8:11], s21 offen offset:3072 lds
    v_lshlrev_b32 v255, 16, v254
    v_mfma_f32_16x16x32_bf16 v[148:151], a[84:87], a[44:47], v[148:151]
    ds_read_b64_tr_b16 a[110:111], v19 offset:25600
    v_mfma_f32_16x16x32_bf16 v[148:151], a[80:83], a[40:43], v[148:151]
    s_add_u32 m0, s23, 0xc000
    v_and_b32 v254, 0xffff0000, v254
    v_mfma_f32_16x16x32_bf16 v[152:155], a[80:83], a[48:51], v[152:155]
    v_add_f32 v254, v254, v255
    v_mfma_f32_16x16x32_bf16 v[152:155], a[84:87], a[52:55], v[152:155]
    buffer_load_dwordx4 v10, s[12:15], s21 offen offset:0 lds
    v_add_f32 v27, v27, v254
    v_mfma_f32_16x16x32_bf16 a[216:219], a[116:119], a[52:55], a[216:219]
    v_lshlrev_b32 v252, 16, v230
    v_mfma_f32_16x16x32_bf16 a[216:219], a[112:115], a[48:51], a[216:219]
    v_and_b32 v253, 0xffff0000, v230
    v_mul_f32 v252, v252, v240
    v_mfma_f32_16x16x32_bf16 v[184:187], a[88:91], a[48:51], v[184:187]
    buffer_load_dwordx4 v11, s[12:15], s21 offen offset:1024 lds
    v_mfma_f32_16x16x32_bf16 v[184:187], a[92:95], a[52:55], v[184:187]
    v_mul_f32 v253, v253, v241
    v_cvt_pk_bf16_f32 v252, v252, v253
    v_mfma_f32_16x16x32_bf16 a[248:251], a[124:127], a[52:55], a[248:251]
    v_lshlrev_b32 v253, 16, v252
    v_mfma_f32_16x16x32_bf16 a[248:251], a[120:123], a[48:51], a[248:251]
    buffer_load_dwordx4 v12, s[12:15], s21 offen offset:2048 lds
    v_and_b32 v252, 0xffff0000, v252
    v_mfma_f32_16x16x32_bf16 a[252:255], a[120:123], a[56:59], a[252:255]
    v_add_f32 v252, v252, v253
    v_mfma_f32_16x16x32_bf16 a[252:255], a[124:127], a[60:63], a[252:255]
    v_add_f32 v27, v27, v252
    v_lshlrev_b32 v254, 16, v231
    v_mfma_f32_16x16x32_bf16 v[188:191], a[92:95], a[60:63], v[188:191]
    buffer_load_dwordx4 v13, s[12:15], s21 offen offset:3072 lds
    v_mfma_f32_16x16x32_bf16 v[188:191], a[88:91], a[56:59], v[188:191]
    v_and_b32 v255, 0xffff0000, v231
    v_mul_f32 v254, v254, v242
    v_mfma_f32_16x16x32_bf16 a[220:223], a[112:115], a[56:59], a[220:223]
    s_add_u32 s21, s21, 0x70000
    v_mfma_f32_16x16x32_bf16 a[220:223], a[116:119], a[60:63], a[220:223]
    v_mul_f32 v255, v255, v243
    v_cvt_pk_bf16_f32 v254, v254, v255
    v_mfma_f32_16x16x32_bf16 v[156:159], a[84:87], a[60:63], v[156:159]
    v_lshlrev_b32 v255, 16, v254
    v_mfma_f32_16x16x32_bf16 v[156:159], a[80:83], a[56:59], v[156:159]
    v_and_b32 v254, 0xffff0000, v254
    s_waitcnt lgkmcnt(0)
    v_mfma_f32_16x16x32_bf16 v[64:67], a[64:67], a[0:3], v[64:67]
    ds_read_b128 a[32:35], v34 offset:8192
    v_add_f32 v254, v254, v255
    v_mfma_f32_16x16x32_bf16 v[64:67], a[68:71], a[4:7], v[64:67]
    v_add_f32 v27, v27, v254
    v_lshlrev_b32 v252, 16, v232
    v_mfma_f32_16x16x32_bf16 a[128:131], a[100:103], a[4:7], a[128:131]
    ds_read_b128 a[36:39], v35 offset:8192
    v_and_b32 v253, 0xffff0000, v232
    v_mfma_f32_16x16x32_bf16 a[128:131], a[96:99], a[0:3], a[128:131]
    v_mul_f32 v252, v252, v244
    v_mul_f32 v253, v253, v245
    v_mfma_f32_16x16x32_bf16 v[96:99], a[72:75], a[0:3], v[96:99]
    ds_read_b128 a[40:43], v34 offset:10240
    v_cvt_pk_bf16_f32 v252, v252, v253
    v_mfma_f32_16x16x32_bf16 v[96:99], a[76:79], a[4:7], v[96:99]
    v_lshlrev_b32 v253, 16, v252
    v_and_b32 v252, 0xffff0000, v252
    v_mfma_f32_16x16x32_bf16 a[160:163], a[108:111], a[4:7], a[160:163]
    ds_read_b128 a[44:47], v35 offset:10240
    v_add_f32 v252, v252, v253
    v_mfma_f32_16x16x32_bf16 a[160:163], a[104:107], a[0:3], a[160:163]
    v_add_f32 v27, v27, v252
    v_lshlrev_b32 v254, 16, v233
    v_mfma_f32_16x16x32_bf16 a[164:167], a[104:107], a[8:11], a[164:167]
    ds_read_b128 a[48:51], v34 offset:12288
    v_and_b32 v255, 0xffff0000, v233
    v_mfma_f32_16x16x32_bf16 a[164:167], a[108:111], a[12:15], a[164:167]
    v_mul_f32 v254, v254, v246
    v_mfma_f32_16x16x32_bf16 v[100:103], a[76:79], a[12:15], v[100:103]
    ds_read_b128 a[52:55], v35 offset:12288
    v_mul_f32 v255, v255, v247
    v_mfma_f32_16x16x32_bf16 v[100:103], a[72:75], a[8:11], v[100:103]
    v_cvt_pk_bf16_f32 v254, v254, v255
    v_lshlrev_b32 v255, 16, v254
    v_mfma_f32_16x16x32_bf16 a[132:135], a[96:99], a[8:11], a[132:135]
    ds_read_b128 a[56:59], v34 offset:14336
    v_and_b32 v254, 0xffff0000, v254
    v_mfma_f32_16x16x32_bf16 a[132:135], a[100:103], a[12:15], a[132:135]
    v_add_f32 v254, v254, v255
    v_add_f32 v27, v27, v254
    v_mfma_f32_16x16x32_bf16 v[68:71], a[68:71], a[12:15], v[68:71]
    ds_read_b128 a[60:63], v35 offset:14336
    v_lshlrev_b32 v252, 16, v234
    v_mfma_f32_16x16x32_bf16 v[68:71], a[64:67], a[8:11], v[68:71]
    v_and_b32 v253, 0xffff0000, v234
    v_mul_f32 v252, v252, v248
    v_mfma_f32_16x16x32_bf16 v[72:75], a[64:67], a[16:19], v[72:75]
    ds_read_b64_tr_b16 a[80:81], v20 offset:0
    v_mul_f32 v253, v253, v249
    v_mfma_f32_16x16x32_bf16 v[72:75], a[68:71], a[20:23], v[72:75]
    v_cvt_pk_bf16_f32 v252, v252, v253
    v_lshlrev_b32 v253, 16, v252
    v_mfma_f32_16x16x32_bf16 a[136:139], a[100:103], a[20:23], a[136:139]
    ds_read_b64_tr_b16 a[82:83], v20 offset:1024
    v_mfma_f32_16x16x32_bf16 a[136:139], a[96:99], a[16:19], a[136:139]
    v_and_b32 v252, 0xffff0000, v252
    v_add_f32 v252, v252, v253
    v_mfma_f32_16x16x32_bf16 v[104:107], a[72:75], a[16:19], v[104:107]
    ds_read_b64_tr_b16 a[84:85], v20 offset:8192
    v_add_f32 v27, v27, v252
    v_mfma_f32_16x16x32_bf16 v[104:107], a[76:79], a[20:23], v[104:107]
    v_lshlrev_b32 v254, 16, v235
    v_and_b32 v255, 0xffff0000, v235
    v_mfma_f32_16x16x32_bf16 a[168:171], a[108:111], a[20:23], a[168:171]
    ds_read_b64_tr_b16 a[86:87], v20 offset:9216
    v_mul_f32 v254, v254, v250
    v_mfma_f32_16x16x32_bf16 a[168:171], a[104:107], a[16:19], a[168:171]
    v_mul_f32 v255, v255, v251
    v_cvt_pk_bf16_f32 v254, v254, v255
    v_mfma_f32_16x16x32_bf16 a[172:175], a[104:107], a[24:27], a[172:175]
    ds_read_b64_tr_b16 a[112:113], v20 offset:16384
    v_lshlrev_b32 v255, 16, v254
    v_mfma_f32_16x16x32_bf16 a[172:175], a[108:111], a[28:31], a[172:175]
    v_and_b32 v254, 0xffff0000, v254
    v_add_f32 v254, v254, v255
    v_mfma_f32_16x16x32_bf16 v[108:111], a[76:79], a[28:31], v[108:111]
    ds_read_b64_tr_b16 a[114:115], v20 offset:17408
    v_add_f32 v27, v27, v254
    v_mfma_f32_16x16x32_bf16 v[108:111], a[72:75], a[24:27], v[108:111]
    s_nop 1
    v_add_f32_dpp v26, v26, v26 row_shr:1 row_mask:0xf bank_mask:0xf bound_ctrl:0
    v_add_f32_dpp v27, v27, v27 row_shr:1 row_mask:0xf bank_mask:0xf bound_ctrl:0
    v_mfma_f32_16x16x32_bf16 a[140:143], a[96:99], a[24:27], a[140:143]
    ds_read_b64_tr_b16 a[116:117], v20 offset:24576
    v_mfma_f32_16x16x32_bf16 a[140:143], a[100:103], a[28:31], a[140:143]
    s_lshl_b32 s60, s2, 2
    v_mfma_f32_16x16x32_bf16 v[76:79], a[68:71], a[28:31], v[76:79]
    ds_read_b64_tr_b16 a[118:119], v20 offset:25600
    s_add_u32 s60, s60, s40
    v_mfma_f32_16x16x32_bf16 v[76:79], a[64:67], a[24:27], v[76:79]
    s_waitcnt lgkmcnt(8)
    s_mul_i32 s61, s40, 19712
    s_add_u32 s61, s61, 65536
    v_mfma_f32_16x16x32_bf16 v[80:83], a[64:67], a[32:35], v[80:83]
IW_P4:
    s_cbranch_execz IW_R0
    ds_read_b64_tr_b16 a[88:89], v21 offset:0
    v_mov_b32 v204, 0
    v_mfma_f32_16x16x32_bf16 v[80:83], a[68:71], a[36:39], v[80:83]
    v_mov_b32 v205, 0
    v_mov_b32 v206, 0
    v_mfma_f32_16x16x32_bf16 a[144:147], a[100:103], a[36:39], a[144:147]
    ds_read_b64_tr_b16 a[90:91], v21 offset:1024
    v_mov_b32 v207, 0
    v_mfma_f32_16x16x32_bf16 a[144:147], a[96:99], a[32:35], a[144:147]
    v_lshlrev_b32 v200, 4, v0
    v_add_u32 v210, s61, v200
    v_mfma_f32_16x16x32_bf16 v[112:115], a[72:75], a[32:35], v[112:115]
    ds_read_b64_tr_b16 a[92:93], v21 offset:8192
    v_mfma_f32_16x16x32_bf16 v[112:115], a[76:79], a[36:39], v[112:115]
    s_add_u32 s4, s72, 0x1000000
    s_addc_u32 s5, s73, 0
    v_mfma_f32_16x16x32_bf16 a[176:179], a[108:111], a[36:39], a[176:179]
    ds_read_b64_tr_b16 a[94:95], v21 offset:9216
    s_mov_b32 s6, 0x420000
    v_mfma_f32_16x16x32_bf16 a[176:179], a[104:107], a[32:35], a[176:179]
    s_mov_b32 s7, 0x00020000
    v_lshrrev_b32 v201, 4, v0
    v_mfma_f32_16x16x32_bf16 a[180:183], a[104:107], a[40:43], a[180:183]
    ds_read_b64_tr_b16 a[120:121], v21 offset:16384
    v_and_b32 v201, 1, v201
    v_mfma_f32_16x16x32_bf16 a[180:183], a[108:111], a[44:47], a[180:183]
    v_lshlrev_b32 v201, 1, v201
    v_xor_b32 v201, v201, v0
    v_mfma_f32_16x16x32_bf16 v[116:119], a[76:79], a[44:47], v[116:119]
    ds_read_b64_tr_b16 a[122:123], v21 offset:17408
    v_lshlrev_b32 v201, 4, v201
    v_mfma_f32_16x16x32_bf16 v[116:119], a[72:75], a[40:43], v[116:119]
    s_mul_i32 s77, s60, 4224
    s_mul_i32 s85, s40, 8960
    v_mfma_f32_16x16x32_bf16 a[148:151], a[96:99], a[40:43], a[148:151]
    ds_read_b64_tr_b16 a[124:125], v21 offset:24576
    v_add_u32 v211, s85, v200
    v_mfma_f32_16x16x32_bf16 a[148:151], a[100:103], a[44:47], a[148:151]
    s_mov_b32 s8, s64
    v_mfma_f32_16x16x32_bf16 v[84:87], a[68:71], a[44:47], v[84:87]
    ds_read_b64_tr_b16 a[126:127], v21 offset:25600
    s_mov_b32 s9, s65
    v_mfma_f32_16x16x32_bf16 v[84:87], a[64:67], a[40:43], v[84:87]
    s_mov_b32 s10, 0x400000
    s_mov_b32 s11, 0x00020000
    v_mfma_f32_16x16x32_bf16 v[88:91], a[64:67], a[48:51], v[88:91]
    s_add_u32 s12, s72, 0x1c00000
    s_addc_u32 s13, s73, 0
    v_mfma_f32_16x16x32_bf16 v[88:91], a[68:71], a[52:55], v[88:91]
    s_mov_b32 s14, 0x400000
    s_mov_b32 s15, 0x00020000
    v_mfma_f32_16x16x32_bf16 a[152:155], a[100:103], a[52:55], a[152:155]
    v_and_b32 v8, 15, v0
    v_lshrrev_b32 v9, 4, v0
    v_mfma_f32_16x16x32_bf16 a[152:155], a[96:99], a[48:51], a[152:155]
    v_lshlrev_b32 v10, 7, v9
    v_lshlrev_b32 v11, 3, v8
    v_mfma_f32_16x16x32_bf16 v[120:123], a[72:75], a[48:51], v[120:123]
    v_add_u32 v10, v10, v11
    v_lshlrev_b32 v12, 1, v10
    v_mfma_f32_16x16x32_bf16 v[120:123], a[76:79], a[52:55], v[120:123]
    v_add_u32 v13, v8, v9
    v_lshlrev_b32 v13, 4, v13
    v_mfma_f32_16x16x32_bf16 a[184:187], a[108:111], a[52:55], a[184:187]
    v_add_u32 v13, s85, v13
    v_mfma_f32_16x16x32_bf16 a[184:187], a[104:107], a[48:51], a[184:187]
    v_lshrrev_b32 v4, 2, v8
    v_and_b32 v5, 3, v8
    v_mfma_f32_16x16x32_bf16 a[188:191], a[104:107], a[56:59], a[188:191]
    s_movk_i32 s63, 4928
    v_mul_lo_u32 v5, v5, s63
    v_mfma_f32_16x16x32_bf16 a[188:191], a[108:111], a[60:63], a[188:191]
    v_sub_u32 v6, 3, v4
    v_lshlrev_b32 v6, 8, v6
    v_mfma_f32_16x16x32_bf16 v[124:127], a[76:79], a[60:63], v[124:127]
    v_add_u32 v5, v5, v6
    v_add_u32 v5, s61, v5
    v_mfma_f32_16x16x32_bf16 v[124:127], a[72:75], a[56:59], v[124:127]
    v_and_b32 v6, 1, v4
    v_lshlrev_b32 v6, 1, v6
    v_mfma_f32_16x16x32_bf16 a[156:159], a[96:99], a[56:59], a[156:159]
    v_xor_b32 v7, v9, v6
    v_xor_b32 v6, 2, v7
    v_mfma_f32_16x16x32_bf16 a[156:159], a[100:103], a[60:63], a[156:159]
    v_lshlrev_b32 v6, 4, v6
    v_lshlrev_b32 v7, 4, v7
    v_mfma_f32_16x16x32_bf16 v[92:95], a[68:71], a[60:63], v[92:95]
    v_add_u32 v14, v5, v6
    v_add_u32 v15, v5, v7
    v_mfma_f32_16x16x32_bf16 v[92:95], a[64:67], a[56:59], v[92:95]
    s_mov_b32 s76, 0xffff0000
    s_waitcnt lgkmcnt(0)
    s_waitcnt vmcnt(0)
    s_barrier
    v_mfma_f32_16x16x32_bf16 v[128:131], a[80:83], a[0:3], v[128:131]
    ds_read_b64_tr_b16 a[64:65], v22 offset:0
    s_nop 1
    v_add_f32_dpp v26, v26, v26 row_shr:2 row_mask:0xf bank_mask:0xf bound_ctrl:0
    v_add_f32_dpp v27, v27, v27 row_shr:2 row_mask:0xf bank_mask:0xf bound_ctrl:0
    v_mfma_f32_16x16x32_bf16 v[128:131], a[84:87], a[4:7], v[128:131]
    s_mov_b32 exec_hi, 0x7ffff
    ds_write_b128 v210, v[204:207] offset:18896
    s_mov_b32 exec_hi, -1
    s_add_u32 s79, s77, 0x78
    s_add_u32 m0, s61, 14784
    s_nop 0
    buffer_load_dwordx4 v201, s[4:7], s79 offen offset:0 sc1 lds
    v_mfma_f32_16x16x32_bf16 a[192:195], a[116:119], a[4:7], a[192:195]
    ds_read_b64_tr_b16 a[66:67], v22 offset:1024
    v_mfma_f32_16x16x32_bf16 a[192:195], a[112:115], a[0:3], a[192:195]
    v_mfma_f32_16x16x32_bf16 v[160:163], a[88:91], a[0:3], v[160:163]
    ds_read_b64_tr_b16 a[68:69], v22 offset:8192
    s_nop 1
    v_add_f32_dpp v26, v26, v26 row_shr:4 row_mask:0xf bank_mask:0xf bound_ctrl:0
    v_add_f32_dpp v27, v27, v27 row_shr:4 row_mask:0xf bank_mask:0xf bound_ctrl:0
    v_mfma_f32_16x16x32_bf16 v[160:163], a[92:95], a[4:7], v[160:163]
    v_mfma_f32_16x16x32_bf16 a[224:227], a[124:127], a[4:7], a[224:227]
    ds_read_b64_tr_b16 a[70:71], v22 offset:9216
    v_mfma_f32_16x16x32_bf16 a[224:227], a[120:123], a[0:3], a[224:227]
    s_nop 1
    v_add_f32_dpp v26, v26, v26 row_shr:8 row_mask:0xf bank_mask:0xf bound_ctrl:0
    v_add_f32_dpp v27, v27, v27 row_shr:8 row_mask:0xf bank_mask:0xf bound_ctrl:0
    v_mfma_f32_16x16x32_bf16 a[228:231], a[120:123], a[8:11], a[228:231]
    ds_read_b128 a[0:3], v16 offset:0
    v_mfma_f32_16x16x32_bf16 a[228:231], a[124:127], a[12:15], a[228:231]
    s_nop 1
    v_add_f32_dpp v26, v26, v26 row_bcast:15 row_mask:0xa bank_mask:0xf
    v_add_f32_dpp v27, v27, v27 row_bcast:15 row_mask:0xa bank_mask:0xf
    v_mfma_f32_16x16x32_bf16 v[164:167], a[92:95], a[12:15], v[164:167]
    ds_read_b128 a[4:7], v17 offset:0
    v_mfma_f32_16x16x32_bf16 v[164:167], a[88:91], a[8:11], v[164:167]
    buffer_load_dwordx4 v201, s[4:7], s79 offen offset:1024 sc1 lds
    v_mfma_f32_16x16x32_bf16 a[196:199], a[112:115], a[8:11], a[196:199]
    ds_read_b64_tr_b16 a[96:97], v22 offset:16384
    v_mfma_f32_16x16x32_bf16 a[196:199], a[116:119], a[12:15], a[196:199]
    s_nop 1
    v_add_f32_dpp v26, v26, v26 row_bcast:31 row_mask:0xc bank_mask:0xf
    v_add_f32_dpp v27, v27, v27 row_bcast:31 row_mask:0xc bank_mask:0xf
    v_mfma_f32_16x16x32_bf16 v[132:135], a[84:87], a[12:15], v[132:135]
    ds_read_b64_tr_b16 a[98:99], v22 offset:17408
    v_mfma_f32_16x16x32_bf16 v[132:135], a[80:83], a[8:11], v[132:135]
    v_cvt_pk_bf16_f32 v26, v26, v26
    v_cvt_pk_bf16_f32 v27, v27, v27
    v_mfma_f32_16x16x32_bf16 v[136:139], a[80:83], a[16:19], v[136:139]
    ds_read_b128 a[8:11], v16 offset:2048
    v_mfma_f32_16x16x32_bf16 v[136:139], a[84:87], a[20:23], v[136:139]
    v_lshlrev_b32 v26, 16, v26
    v_lshlrev_b32 v27, 16, v27
    v_mfma_f32_16x16x32_bf16 a[200:203], a[116:119], a[20:23], a[200:203]
    ds_read_b128 a[12:15], v17 offset:2048
    v_mfma_f32_16x16x32_bf16 a[200:203], a[112:115], a[16:19], a[200:203]
    v_mul_f32 v26, 0xbfb8aa3b, v26
    v_mul_f32 v27, 0xbfb8aa3b, v27
    v_mfma_f32_16x16x32_bf16 v[168:171], a[88:91], a[16:19], v[168:171]
    ds_read_b64_tr_b16 a[100:101], v22 offset:24576
    v_exp_f32 v26, v26
    v_exp_f32 v27, v27
    v_mfma_f32_16x16x32_bf16 v[168:171], a[92:95], a[20:23], v[168:171]
    buffer_load_dwordx4 v201, s[4:7], s79 offen offset:2048 sc1 lds
    v_mfma_f32_16x16x32_bf16 a[232:235], a[124:127], a[20:23], a[232:235]
    ds_read_b64_tr_b16 a[102:103], v22 offset:25600
    v_mfma_f32_16x16x32_bf16 a[232:235], a[120:123], a[16:19], a[232:235]
    s_nop 0
    v_add_f32 v26, 1.0, v26
    v_add_f32 v27, 1.0, v27
    v_mfma_f32_16x16x32_bf16 a[236:239], a[120:123], a[24:27], a[236:239]
    ds_read_b128 a[16:19], v16 offset:4096
    v_mfma_f32_16x16x32_bf16 a[236:239], a[124:127], a[28:31], a[236:239]
    v_rcp_f32 v26, v26
    v_rcp_f32 v27, v27
    v_mfma_f32_16x16x32_bf16 v[172:175], a[92:95], a[28:31], v[172:175]
    ds_read_b128 a[20:23], v17 offset:4096
    v_mfma_f32_16x16x32_bf16 v[172:175], a[88:91], a[24:27], v[172:175]
    s_nop 0
    v_mfma_f32_16x16x32_bf16 a[204:207], a[112:115], a[24:27], a[204:207]
    ds_read_b64_tr_b16 a[72:73], v23 offset:0
    v_cvt_pk_bf16_f32 v26, v26, v26
    v_cvt_pk_bf16_f32 v27, v27, v27
    v_mfma_f32_16x16x32_bf16 a[204:207], a[116:119], a[28:31], a[204:207]
    v_lshlrev_b32 v26, 16, v26
    v_lshlrev_b32 v27, 16, v27
    v_mfma_f32_16x16x32_bf16 v[140:143], a[84:87], a[28:31], v[140:143]
    ds_read_b64_tr_b16 a[74:75], v23 offset:1024
    v_mfma_f32_16x16x32_bf16 v[140:143], a[80:83], a[24:27], v[140:143]
    buffer_load_dwordx4 v201, s[4:7], s79 offen offset:3072 sc1 lds
    v_mfma_f32_16x16x32_bf16 v[144:147], a[80:83], a[32:35], v[144:147]
    ds_read_b128 a[24:27], v16 offset:6144
    v_mfma_f32_16x16x32_bf16 v[144:147], a[84:87], a[36:39], v[144:147]
    s_lshl_b32 s62, s60, 3
    s_add_u32 s52, s72, 0x2100000
    s_addc_u32 s53, s73, 0
    s_mov_b32 s54, 0x2000
    s_mov_b32 s55, 0x00020000
    v_mov_b32 v252, 0
    v_mfma_f32_16x16x32_bf16 a[208:211], a[116:119], a[36:39], a[208:211]
    ds_read_b128 a[28:31], v17 offset:6144
    v_mfma_f32_16x16x32_bf16 a[208:211], a[112:115], a[32:35], a[208:211]
    v_mfma_f32_16x16x32_bf16 v[176:179], a[88:91], a[32:35], v[176:179]
    ds_read_b64_tr_b16 a[76:77], v23 offset:8192
    v_mfma_f32_16x16x32_bf16 v[176:179], a[92:95], a[36:39], v[176:179]
    s_mov_b32 exec_lo, 0
    s_mov_b32 exec_hi, 0x80000000
    buffer_store_dwordx2 v[26:27], v252, s[52:55], s62 offen sc1
    s_mov_b64 exec, -1
    v_mfma_f32_16x16x32_bf16 a[240:243], a[124:127], a[36:39], a[240:243]
    ds_read_b64_tr_b16 a[78:79], v23 offset:9216
    v_mfma_f32_16x16x32_bf16 a[240:243], a[120:123], a[32:35], a[240:243]
    v_mfma_f32_16x16x32_bf16 a[244:247], a[120:123], a[40:43], a[244:247]
    ds_read_b64_tr_b16 a[104:105], v23 offset:16384
    v_mfma_f32_16x16x32_bf16 a[244:247], a[124:127], a[44:47], a[244:247]
    s_add_u32 s79, s77, 0x1078
    s_add_u32 m0, s61, 18880
    s_mov_b64 exec, 1
    buffer_load_dwordx4 v201, s[4:7], s79 offen sc1 lds
    s_mov_b64 exec, -1
    v_mfma_f32_16x16x32_bf16 v[180:183], a[92:95], a[44:47], v[180:183]
    ds_read_b64_tr_b16 a[106:107], v23 offset:17408
    v_mfma_f32_16x16x32_bf16 v[180:183], a[88:91], a[40:43], v[180:183]
    s_lshr_b32 s47, s43, 7
    s_add_u32 s47, s47, s45
    v_mfma_f32_16x16x32_bf16 a[212:215], a[112:115], a[40:43], a[212:215]
    ds_read_b64_tr_b16 a[108:109], v23 offset:24576
    s_mul_i32 s47, s47, 112
    v_mfma_f32_16x16x32_bf16 a[212:215], a[116:119], a[44:47], a[212:215]
    s_lshr_b32 s48, s44, 5
    v_mfma_f32_16x16x32_bf16 v[148:151], a[84:87], a[44:47], v[148:151]
    ds_read_b64_tr_b16 a[110:111], v23 offset:25600
    s_add_u32 s47, s47, s48
    v_mfma_f32_16x16x32_bf16 v[148:151], a[80:83], a[40:43], v[148:151]
    s_lshl_b32 s48, s46, 1
    s_add_u32 s47, s47, s48
    v_mfma_f32_16x16x32_bf16 v[152:155], a[80:83], a[48:51], v[152:155]
    s_lshl_b32 s47, s47, 13
    v_mfma_f32_16x16x32_bf16 v[152:155], a[84:87], a[52:55], v[152:155]
    v_and_b32 v26, 15, v0
    v_lshlrev_b32 v26, 4, v26
    v_mfma_f32_16x16x32_bf16 a[216:219], a[116:119], a[52:55], a[216:219]
    v_lshrrev_b32 v27, 1, v28
    v_lshlrev_b32 v27, 8, v27
    v_mfma_f32_16x16x32_bf16 a[216:219], a[112:115], a[48:51], a[216:219]
    s_mov_b32 exec_hi, 0x7ffff
    ds_write_b128 v210, v[204:207] offset:9040
    s_mov_b32 exec_hi, -1
    s_add_u32 s79, s77, 0x7c
    s_add_u32 m0, s61, 4928
    s_nop 0
    buffer_load_dwordx4 v201, s[4:7], s79 offen offset:0 sc1 lds
    v_mfma_f32_16x16x32_bf16 v[184:187], a[88:91], a[48:51], v[184:187]
    v_add_u32 v26, v26, v27
    v_mfma_f32_16x16x32_bf16 v[184:187], a[92:95], a[52:55], v[184:187]
    v_and_b32 v27, 1, v28
    v_lshlrev_b32 v27, 10, v27
    v_mfma_f32_16x16x32_bf16 a[248:251], a[124:127], a[52:55], a[248:251]
    v_add_u32 v26, v26, v27
    v_add_u32 v2, s47, v26
    v_mfma_f32_16x16x32_bf16 a[248:251], a[120:123], a[48:51], a[248:251]
    s_mov_b32 s56, 0
    v_mfma_f32_16x16x32_bf16 a[252:255], a[120:123], a[56:59], a[252:255]
    s_movk_i32 s57, 4096
    s_movk_i32 s58, 8192
    v_mfma_f32_16x16x32_bf16 a[252:255], a[124:127], a[60:63], a[252:255]
    s_movk_i32 s59, 12288
    s_mov_b32 s50, 0xc0135761
    v_mfma_f32_16x16x32_bf16 v[188:191], a[92:95], a[60:63], v[188:191]
    s_mov_b32 s51, 0xbdd2d3e8
    v_mfma_f32_16x16x32_bf16 v[188:191], a[88:91], a[56:59], v[188:191]
    v_mov_b32 v3, s50
    s_mov_b32 s20, s51
    v_mfma_f32_16x16x32_bf16 a[220:223], a[112:115], a[56:59], a[220:223]
    s_mov_b32 s21, s51
    s_mov_b32 s22, 1.0
    v_mfma_f32_16x16x32_bf16 a[220:223], a[116:119], a[60:63], a[220:223]
    buffer_load_dwordx4 v201, s[4:7], s79 offen offset:1024 sc1 lds
    v_mfma_f32_16x16x32_bf16 v[156:159], a[84:87], a[60:63], v[156:159]
    s_mov_b32 s23, 1.0
    v_mov_b32 v254, s50
    v_mfma_f32_16x16x32_bf16 v[156:159], a[80:83], a[56:59], v[156:159]
    v_mov_b32 v255, s50
    s_waitcnt lgkmcnt(0)
    v_mfma_f32_16x16x32_bf16 v[64:67], a[64:67], a[0:3], v[64:67]
    ds_read_b128 a[32:35], v16 offset:8192
    v_mfma_f32_16x16x32_bf16 v[64:67], a[68:71], a[4:7], v[64:67]
    ds_read_b128 a[36:39], v17 offset:8192
    v_mfma_f32_16x16x32_bf16 a[128:131], a[100:103], a[4:7], a[128:131]
    ds_read_b128 a[40:43], v16 offset:10240
    v_mfma_f32_16x16x32_bf16 a[128:131], a[96:99], a[0:3], a[128:131]
    ds_read_b128 a[44:47], v17 offset:10240
    v_mfma_f32_16x16x32_bf16 v[96:99], a[72:75], a[0:3], v[96:99]
    ds_read_b128 a[48:51], v16 offset:12288
    v_mfma_f32_16x16x32_bf16 v[96:99], a[76:79], a[4:7], v[96:99]
    ds_read_b128 a[52:55], v17 offset:12288
    v_mfma_f32_16x16x32_bf16 a[160:163], a[108:111], a[4:7], a[160:163]
    ds_read_b128 a[56:59], v16 offset:14336
    v_mfma_f32_16x16x32_bf16 a[160:163], a[104:107], a[0:3], a[160:163]
    ds_read_b128 a[60:63], v17 offset:14336
    buffer_load_dwordx4 v201, s[4:7], s79 offen offset:2048 sc1 lds
    v_mfma_f32_16x16x32_bf16 a[164:167], a[104:107], a[8:11], a[164:167]
    ds_read_b64_tr_b16 a[80:81], v24 offset:0
    v_mfma_f32_16x16x32_bf16 a[164:167], a[108:111], a[12:15], a[164:167]
    ds_read_b64_tr_b16 a[82:83], v24 offset:1024
    v_mfma_f32_16x16x32_bf16 v[100:103], a[76:79], a[12:15], v[100:103]
    ds_read_b64_tr_b16 a[84:85], v24 offset:8192
    v_mfma_f32_16x16x32_bf16 v[100:103], a[72:75], a[8:11], v[100:103]
    ds_read_b64_tr_b16 a[86:87], v24 offset:9216
    v_mfma_f32_16x16x32_bf16 a[132:135], a[96:99], a[8:11], a[132:135]
    ds_read_b64_tr_b16 a[112:113], v24 offset:16384
    v_mfma_f32_16x16x32_bf16 a[132:135], a[100:103], a[12:15], a[132:135]
    ds_read_b64_tr_b16 a[114:115], v24 offset:17408
    v_mfma_f32_16x16x32_bf16 v[68:71], a[68:71], a[12:15], v[68:71]
    ds_read_b64_tr_b16 a[116:117], v24 offset:24576
    v_mfma_f32_16x16x32_bf16 v[68:71], a[64:67], a[8:11], v[68:71]
    ds_read_b64_tr_b16 a[118:119], v24 offset:25600
    v_mfma_f32_16x16x32_bf16 v[72:75], a[64:67], a[16:19], v[72:75]
    ds_read_b64_tr_b16 a[88:89], v25 offset:0
    v_mfma_f32_16x16x32_bf16 v[72:75], a[68:71], a[20:23], v[72:75]
    ds_read_b64_tr_b16 a[90:91], v25 offset:1024
    buffer_load_dwordx4 v201, s[4:7], s79 offen offset:3072 sc1 lds
    v_mfma_f32_16x16x32_bf16 a[136:139], a[100:103], a[20:23], a[136:139]
    ds_read_b64_tr_b16 a[92:93], v25 offset:8192
    v_mfma_f32_16x16x32_bf16 a[136:139], a[96:99], a[16:19], a[136:139]
    ds_read_b64_tr_b16 a[94:95], v25 offset:9216
    v_mfma_f32_16x16x32_bf16 v[104:107], a[72:75], a[16:19], v[104:107]
    ds_read_b64_tr_b16 a[120:121], v25 offset:16384
    v_mul_f32 v228, v64, v64
    v_mul_f32 v229, v65, v65
    v_mul_f32 v230, v66, v66
    v_mfma_f32_16x16x32_bf16 v[104:107], a[76:79], a[20:23], v[104:107]
    ds_read_b64_tr_b16 a[122:123], v25 offset:17408
    v_mul_f32 v231, v67, v67
    v_mul_f32 v232, v68, v68
    v_mfma_f32_16x16x32_bf16 a[168:171], a[108:111], a[20:23], a[168:171]
    ds_read_b64_tr_b16 a[124:125], v25 offset:24576
    v_mul_f32 v233, v69, v69
    v_mul_f32 v234, v70, v70
    v_mfma_f32_16x16x32_bf16 a[168:171], a[104:107], a[16:19], a[168:171]
    ds_read_b64_tr_b16 a[126:127], v25 offset:25600
    v_mul_f32 v235, v71, v71
    v_fma_f32 v228, v228, s51, v3
    v_mfma_f32_16x16x32_bf16 a[172:175], a[104:107], a[24:27], a[172:175]
    v_fma_f32 v229, v229, s51, v3
    v_fma_f32 v230, v230, s51, v3
    v_fma_f32 v231, v231, s51, v3
    v_mfma_f32_16x16x32_bf16 a[172:175], a[108:111], a[28:31], a[172:175]
    v_fma_f32 v232, v232, s51, v3
    v_fma_f32 v233, v233, s51, v3
    v_mfma_f32_16x16x32_bf16 v[108:111], a[76:79], a[28:31], v[108:111]
    v_fma_f32 v234, v234, s51, v3
    v_fma_f32 v235, v235, s51, v3
    v_mfma_f32_16x16x32_bf16 v[108:111], a[72:75], a[24:27], v[108:111]
    s_add_u32 s79, s77, 0x107c
    s_add_u32 m0, s61, 9024
    s_mov_b64 exec, 1
    buffer_load_dwordx4 v201, s[4:7], s79 offen sc1 lds
    s_mov_b64 exec, -1
    v_mul_f32 v228, v228, v64
    v_mul_f32 v229, v229, v65
    v_mfma_f32_16x16x32_bf16 a[140:143], a[96:99], a[24:27], a[140:143]
    v_mul_f32 v230, v230, v66
    v_mul_f32 v231, v231, v67
    v_mul_f32 v232, v232, v68
    v_mfma_f32_16x16x32_bf16 a[140:143], a[100:103], a[28:31], a[140:143]
    v_mul_f32 v233, v233, v69
    v_mul_f32 v234, v234, v70
    v_mfma_f32_16x16x32_bf16 v[76:79], a[68:71], a[28:31], v[76:79]
    v_mul_f32 v235, v235, v71
    v_exp_f32 v228, v228
    v_mfma_f32_16x16x32_bf16 v[76:79], a[64:67], a[24:27], v[76:79]
    s_waitcnt lgkmcnt(15)
    v_accvgpr_read_b32 v220, a128
    v_exp_f32 v229, v229
    v_mfma_f32_16x16x32_bf16 v[80:83], a[64:67], a[32:35], v[80:83]
    v_accvgpr_read_b32 v221, a129
    v_exp_f32 v230, v230
    v_accvgpr_read_b32 v222, a130
    v_mfma_f32_16x16x32_bf16 v[80:83], a[68:71], a[36:39], v[80:83]
    v_exp_f32 v231, v231
    v_accvgpr_read_b32 v223, a131
    v_mfma_f32_16x16x32_bf16 a[144:147], a[100:103], a[36:39], a[144:147]
    v_exp_f32 v232, v232
    v_accvgpr_read_b32 v224, a132
    v_mfma_f32_16x16x32_bf16 a[144:147], a[96:99], a[32:35], a[144:147]
    v_exp_f32 v233, v233
    v_accvgpr_read_b32 v225, a133
    v_mfma_f32_16x16x32_bf16 v[112:115], a[72:75], a[32:35], v[112:115]
    v_exp_f32 v234, v234
    v_accvgpr_read_b32 v226, a134
    v_exp_f32 v235, v235
    v_mfma_f32_16x16x32_bf16 v[112:115], a[76:79], a[36:39], v[112:115]
    s_mov_b32 exec_hi, 0x7ffff
    ds_write_b128 v210, v[204:207] offset:13968
    s_mov_b32 exec_hi, -1
    s_add_u32 s79, s77, 0x7a
    s_add_u32 m0, s61, 9856
    s_nop 0
    buffer_load_dwordx4 v201, s[4:7], s79 offen offset:0 sc1 lds
    v_accvgpr_read_b32 v227, a135
    v_add_f32 v228, 1.0, v228
    v_mfma_f32_16x16x32_bf16 a[176:179], a[108:111], a[36:39], a[176:179]
    v_add_f32 v229, 1.0, v229
    v_add_f32 v230, 1.0, v230
    v_mfma_f32_16x16x32_bf16 a[176:179], a[104:107], a[32:35], a[176:179]
    v_add_f32 v231, 1.0, v231
    v_add_f32 v232, 1.0, v232
    v_mfma_f32_16x16x32_bf16 a[180:183], a[104:107], a[40:43], a[180:183]
    v_add_f32 v233, 1.0, v233
    v_add_f32 v234, 1.0, v234
    v_add_f32 v235, 1.0, v235
    v_mfma_f32_16x16x32_bf16 a[180:183], a[108:111], a[44:47], a[180:183]
    v_rcp_f32 v228, v228
    v_mul_f32 v220, v220, v64
    v_mfma_f32_16x16x32_bf16 v[116:119], a[76:79], a[44:47], v[116:119]
    v_rcp_f32 v229, v229
    v_mul_f32 v221, v221, v65
    v_mfma_f32_16x16x32_bf16 v[116:119], a[72:75], a[40:43], v[116:119]
    v_rcp_f32 v230, v230
    v_mul_f32 v222, v222, v66
    v_mfma_f32_16x16x32_bf16 a[148:151], a[96:99], a[40:43], a[148:151]
    v_rcp_f32 v231, v231
    v_mul_f32 v223, v223, v67
    v_rcp_f32 v232, v232
    v_mfma_f32_16x16x32_bf16 a[148:151], a[100:103], a[44:47], a[148:151]
    v_mul_f32 v224, v224, v68
    v_rcp_f32 v233, v233
    v_mfma_f32_16x16x32_bf16 v[84:87], a[68:71], a[44:47], v[84:87]
    v_mul_f32 v225, v225, v69
    v_rcp_f32 v234, v234
    v_mfma_f32_16x16x32_bf16 v[84:87], a[64:67], a[40:43], v[84:87]
    buffer_load_dwordx4 v201, s[4:7], s79 offen offset:1024 sc1 lds
    v_mul_f32 v226, v226, v70
    v_rcp_f32 v235, v235
    v_mfma_f32_16x16x32_bf16 v[88:91], a[64:67], a[48:51], v[88:91]
    v_mul_f32 v227, v227, v71
    v_mul_f32 v220, v220, v228
    v_mul_f32 v221, v221, v229
    v_mfma_f32_16x16x32_bf16 v[88:91], a[68:71], a[52:55], v[88:91]
    v_mul_f32 v222, v222, v230
    v_mul_f32 v223, v223, v231
    v_mfma_f32_16x16x32_bf16 a[152:155], a[100:103], a[52:55], a[152:155]
    v_mul_f32 v224, v224, v232
    v_mul_f32 v225, v225, v233
    v_mfma_f32_16x16x32_bf16 a[152:155], a[96:99], a[48:51], a[152:155]
    v_mul_f32 v226, v226, v234
    v_mul_f32 v227, v227, v235
    v_mfma_f32_16x16x32_bf16 v[120:123], a[72:75], a[48:51], v[120:123]
    v_cvt_pk_bf16_f32 v236, v220, v221
    v_cvt_pk_bf16_f32 v237, v222, v223
    v_cvt_pk_bf16_f32 v238, v224, v225
    v_mfma_f32_16x16x32_bf16 v[120:123], a[76:79], a[52:55], v[120:123]
    v_cvt_pk_bf16_f32 v239, v226, v227
    s_nop 1
    v_mfma_f32_16x16x32_bf16 a[184:187], a[108:111], a[52:55], a[184:187]
    v_permlane16_swap_b32 v236, v238
    v_permlane16_swap_b32 v237, v239
    v_mfma_f32_16x16x32_bf16 a[184:187], a[104:107], a[48:51], a[184:187]
    s_nop 0
    buffer_store_dwordx4 v[236:239], v2, s[16:19], s56 offen offset:0 sc1
    v_mfma_f32_16x16x32_bf16 a[188:191], a[104:107], a[56:59], a[188:191]
    v_mul_f32 v228, v96, v96
    v_mul_f32 v229, v97, v97
    v_mul_f32 v230, v98, v98
    v_mfma_f32_16x16x32_bf16 a[188:191], a[108:111], a[60:63], a[188:191]
    buffer_load_dwordx4 v201, s[4:7], s79 offen offset:2048 sc1 lds
    v_mul_f32 v231, v99, v99
    v_mul_f32 v232, v100, v100
    v_mfma_f32_16x16x32_bf16 v[124:127], a[76:79], a[60:63], v[124:127]
    v_mul_f32 v233, v101, v101
    v_mul_f32 v234, v102, v102
    v_mfma_f32_16x16x32_bf16 v[124:127], a[72:75], a[56:59], v[124:127]
    v_mul_f32 v235, v103, v103
    v_fma_f32 v228, v228, s51, v3
    v_mfma_f32_16x16x32_bf16 a[156:159], a[96:99], a[56:59], a[156:159]
    v_fma_f32 v229, v229, s51, v3
    v_fma_f32 v230, v230, s51, v3
    v_fma_f32 v231, v231, s51, v3
    v_mfma_f32_16x16x32_bf16 a[156:159], a[100:103], a[60:63], a[156:159]
    v_fma_f32 v232, v232, s51, v3
    v_fma_f32 v233, v233, s51, v3
    v_mfma_f32_16x16x32_bf16 v[92:95], a[68:71], a[60:63], v[92:95]
    v_fma_f32 v234, v234, s51, v3
    v_fma_f32 v235, v235, s51, v3
    v_mfma_f32_16x16x32_bf16 v[92:95], a[64:67], a[56:59], v[92:95]
    s_waitcnt lgkmcnt(0)
    v_mul_f32 v228, v228, v96
    v_mul_f32 v229, v229, v97
    v_mfma_f32_16x16x32_bf16 v[128:131], a[80:83], a[0:3], v[128:131]
    v_mul_f32 v230, v230, v98
    v_mul_f32 v231, v231, v99
    v_mul_f32 v232, v232, v100
    v_mfma_f32_16x16x32_bf16 v[128:131], a[84:87], a[4:7], v[128:131]
    v_mul_f32 v233, v233, v101
    v_mul_f32 v234, v234, v102
    v_mfma_f32_16x16x32_bf16 a[192:195], a[116:119], a[4:7], a[192:195]
    v_mul_f32 v235, v235, v103
    v_exp_f32 v228, v228
    v_mfma_f32_16x16x32_bf16 a[192:195], a[112:115], a[0:3], a[192:195]
    buffer_load_dwordx4 v201, s[4:7], s79 offen offset:3072 sc1 lds
    v_accvgpr_read_b32 v220, a160
    v_exp_f32 v229, v229
    v_mfma_f32_16x16x32_bf16 v[160:163], a[88:91], a[0:3], v[160:163]
    v_accvgpr_read_b32 v221, a161
    v_exp_f32 v230, v230
    v_accvgpr_read_b32 v222, a162
    v_mfma_f32_16x16x32_bf16 v[160:163], a[92:95], a[4:7], v[160:163]
    v_exp_f32 v231, v231
    v_accvgpr_read_b32 v223, a163
    v_mfma_f32_16x16x32_bf16 a[224:227], a[124:127], a[4:7], a[224:227]
    v_exp_f32 v232, v232
    v_accvgpr_read_b32 v224, a164
    v_mfma_f32_16x16x32_bf16 a[224:227], a[120:123], a[0:3], a[224:227]
    v_exp_f32 v233, v233
    v_accvgpr_read_b32 v225, a165
    v_mfma_f32_16x16x32_bf16 a[228:231], a[120:123], a[8:11], a[228:231]
    v_exp_f32 v234, v234
    v_accvgpr_read_b32 v226, a166
    v_exp_f32 v235, v235
    v_mfma_f32_16x16x32_bf16 a[228:231], a[124:127], a[12:15], a[228:231]
    v_accvgpr_read_b32 v227, a167
    v_add_f32 v228, 1.0, v228
    v_mfma_f32_16x16x32_bf16 v[164:167], a[92:95], a[12:15], v[164:167]
    v_add_f32 v229, 1.0, v229
    v_add_f32 v230, 1.0, v230
    v_mfma_f32_16x16x32_bf16 v[164:167], a[88:91], a[8:11], v[164:167]
    v_add_f32 v231, 1.0, v231
    v_add_f32 v232, 1.0, v232
    v_mfma_f32_16x16x32_bf16 a[196:199], a[112:115], a[8:11], a[196:199]
    v_add_f32 v233, 1.0, v233
    v_add_f32 v234, 1.0, v234
    v_add_f32 v235, 1.0, v235
    v_mfma_f32_16x16x32_bf16 a[196:199], a[116:119], a[12:15], a[196:199]
    s_add_u32 s79, s77, 0x107a
    s_add_u32 m0, s61, 13952
    s_mov_b64 exec, 1
    buffer_load_dwordx4 v201, s[4:7], s79 offen sc1 lds
    s_mov_b64 exec, -1
    v_rcp_f32 v228, v228
    v_mul_f32 v220, v220, v96
    v_mfma_f32_16x16x32_bf16 v[132:135], a[84:87], a[12:15], v[132:135]
    v_rcp_f32 v229, v229
    v_mul_f32 v221, v221, v97
    v_mfma_f32_16x16x32_bf16 v[132:135], a[80:83], a[8:11], v[132:135]
    v_rcp_f32 v230, v230
    v_mul_f32 v222, v222, v98
    v_mfma_f32_16x16x32_bf16 v[136:139], a[80:83], a[16:19], v[136:139]
    v_rcp_f32 v231, v231
    v_mul_f32 v223, v223, v99
    v_rcp_f32 v232, v232
    v_mfma_f32_16x16x32_bf16 v[136:139], a[84:87], a[20:23], v[136:139]
    v_mul_f32 v224, v224, v100
    v_rcp_f32 v233, v233
    v_mfma_f32_16x16x32_bf16 a[200:203], a[116:119], a[20:23], a[200:203]
    v_mul_f32 v225, v225, v101
    v_rcp_f32 v234, v234
    v_mfma_f32_16x16x32_bf16 a[200:203], a[112:115], a[16:19], a[200:203]
    v_mul_f32 v226, v226, v102
    v_rcp_f32 v235, v235
    v_mfma_f32_16x16x32_bf16 v[168:171], a[88:91], a[16:19], v[168:171]
    v_mul_f32 v227, v227, v103
    v_mul_f32 v220, v220, v228
    v_mul_f32 v221, v221, v229
    v_mfma_f32_16x16x32_bf16 v[168:171], a[92:95], a[20:23], v[168:171]
    v_mul_f32 v222, v222, v230
    v_mul_f32 v223, v223, v231
    v_mfma_f32_16x16x32_bf16 a[232:235], a[124:127], a[20:23], a[232:235]
    v_mul_f32 v224, v224, v232
    v_mul_f32 v225, v225, v233
    v_mfma_f32_16x16x32_bf16 a[232:235], a[120:123], a[16:19], a[232:235]
    s_mov_b32 exec_hi, 0x7ffff
    ds_write_b128 v210, v[204:207] offset:4112
    s_mov_b32 exec_hi, -1
    s_add_u32 s79, s77, 0x7e
    s_add_u32 m0, s61, 0
    s_nop 0
    buffer_load_dwordx4 v201, s[4:7], s79 offen offset:0 sc1 lds
    v_mul_f32 v226, v226, v234
    v_mul_f32 v227, v227, v235
    v_mfma_f32_16x16x32_bf16 a[236:239], a[120:123], a[24:27], a[236:239]
    v_cvt_pk_bf16_f32 v240, v220, v221
    v_cvt_pk_bf16_f32 v241, v222, v223
    v_cvt_pk_bf16_f32 v242, v224, v225
    v_mfma_f32_16x16x32_bf16 a[236:239], a[124:127], a[28:31], a[236:239]
    v_cvt_pk_bf16_f32 v243, v226, v227
    s_nop 1
    v_mfma_f32_16x16x32_bf16 v[172:175], a[92:95], a[28:31], v[172:175]
    v_permlane16_swap_b32 v240, v242
    v_permlane16_swap_b32 v241, v243
    v_mfma_f32_16x16x32_bf16 v[172:175], a[88:91], a[24:27], v[172:175]
    s_nop 0
    buffer_store_dwordx4 v[240:243], v2, s[16:19], s56 offen offset:512 sc1
    v_mfma_f32_16x16x32_bf16 a[204:207], a[112:115], a[24:27], a[204:207]
    v_mul_f32 v228, v72, v72
    v_mul_f32 v229, v73, v73
    v_mul_f32 v230, v74, v74
    v_mfma_f32_16x16x32_bf16 a[204:207], a[116:119], a[28:31], a[204:207]
    v_mul_f32 v231, v75, v75
    v_mul_f32 v232, v76, v76
    v_mfma_f32_16x16x32_bf16 v[140:143], a[84:87], a[28:31], v[140:143]
    v_mul_f32 v233, v77, v77
    v_mul_f32 v234, v78, v78
    v_mfma_f32_16x16x32_bf16 v[140:143], a[80:83], a[24:27], v[140:143]
    v_mul_f32 v235, v79, v79
    v_fma_f32 v228, v228, s51, v3
    v_mfma_f32_16x16x32_bf16 v[144:147], a[80:83], a[32:35], v[144:147]
    v_fma_f32 v229, v229, s51, v3
    v_fma_f32 v230, v230, s51, v3
    v_fma_f32 v231, v231, s51, v3
    v_mfma_f32_16x16x32_bf16 v[144:147], a[84:87], a[36:39], v[144:147]
    buffer_load_dwordx4 v201, s[4:7], s79 offen offset:1024 sc1 lds
    v_fma_f32 v232, v232, s51, v3
    v_fma_f32 v233, v233, s51, v3
    v_mfma_f32_16x16x32_bf16 a[208:211], a[116:119], a[36:39], a[208:211]
    v_fma_f32 v234, v234, s51, v3
    v_fma_f32 v235, v235, s51, v3
    v_mfma_f32_16x16x32_bf16 a[208:211], a[112:115], a[32:35], a[208:211]
    v_mul_f32 v228, v228, v72
    v_mul_f32 v229, v229, v73
    v_mfma_f32_16x16x32_bf16 v[176:179], a[88:91], a[32:35], v[176:179]
    v_mul_f32 v230, v230, v74
    v_mul_f32 v231, v231, v75
    v_mul_f32 v232, v232, v76
    v_mfma_f32_16x16x32_bf16 v[176:179], a[92:95], a[36:39], v[176:179]
    v_mul_f32 v233, v233, v77
    v_mul_f32 v234, v234, v78
    v_mfma_f32_16x16x32_bf16 a[240:243], a[124:127], a[36:39], a[240:243]
    v_mul_f32 v235, v235, v79
    v_exp_f32 v228, v228
    v_mfma_f32_16x16x32_bf16 a[240:243], a[120:123], a[32:35], a[240:243]
    v_accvgpr_read_b32 v220, a136
    v_exp_f32 v229, v229
    v_mfma_f32_16x16x32_bf16 a[244:247], a[120:123], a[40:43], a[244:247]
    v_accvgpr_read_b32 v221, a137
    v_exp_f32 v230, v230
    v_accvgpr_read_b32 v222, a138
    v_mfma_f32_16x16x32_bf16 a[244:247], a[124:127], a[44:47], a[244:247]
    v_exp_f32 v231, v231
    v_accvgpr_read_b32 v223, a139
    v_mfma_f32_16x16x32_bf16 v[180:183], a[92:95], a[44:47], v[180:183]
IW_P5:
    s_cbranch_execz IW_P9
    v_exp_f32 v232, v232
    v_accvgpr_read_b32 v224, a140
    v_mfma_f32_16x16x32_bf16 v[180:183], a[88:91], a[40:43], v[180:183]
    buffer_load_dwordx4 v201, s[4:7], s79 offen offset:2048 sc1 lds
    v_exp_f32 v233, v233
    v_accvgpr_read_b32 v225, a141
    v_mfma_f32_16x16x32_bf16 a[212:215], a[112:115], a[40:43], a[212:215]
    v_exp_f32 v234, v234
    v_accvgpr_read_b32 v226, a142
    v_exp_f32 v235, v235
    v_mfma_f32_16x16x32_bf16 a[212:215], a[116:119], a[44:47], a[212:215]
    v_accvgpr_read_b32 v227, a143
    v_add_f32 v228, 1.0, v228
    v_mfma_f32_16x16x32_bf16 v[148:151], a[84:87], a[44:47], v[148:151]
    v_add_f32 v229, 1.0, v229
    v_add_f32 v230, 1.0, v230
    v_mfma_f32_16x16x32_bf16 v[148:151], a[80:83], a[40:43], v[148:151]
    v_add_f32 v231, 1.0, v231
    v_add_f32 v232, 1.0, v232
    v_mfma_f32_16x16x32_bf16 v[152:155], a[80:83], a[48:51], v[152:155]
    v_add_f32 v233, 1.0, v233
    v_add_f32 v234, 1.0, v234
    v_add_f32 v235, 1.0, v235
    v_mfma_f32_16x16x32_bf16 v[152:155], a[84:87], a[52:55], v[152:155]
    v_rcp_f32 v228, v228
    v_mul_f32 v220, v220, v72
    v_mfma_f32_16x16x32_bf16 a[216:219], a[116:119], a[52:55], a[216:219]
    v_rcp_f32 v229, v229
    v_mul_f32 v221, v221, v73
    v_mfma_f32_16x16x32_bf16 a[216:219], a[112:115], a[48:51], a[216:219]
    v_rcp_f32 v230, v230
    v_mul_f32 v222, v222, v74
    v_mfma_f32_16x16x32_bf16 v[184:187], a[88:91], a[48:51], v[184:187]
    v_rcp_f32 v231, v231
    v_mul_f32 v223, v223, v75
    v_rcp_f32 v232, v232
    v_mfma_f32_16x16x32_bf16 v[184:187], a[92:95], a[52:55], v[184:187]
    buffer_load_dwordx4 v201, s[4:7], s79 offen offset:3072 sc1 lds
    v_mul_f32 v224, v224, v76
    v_rcp_f32 v233, v233
    v_mfma_f32_16x16x32_bf16 a[248:251], a[124:127], a[52:55], a[248:251]
    v_mul_f32 v225, v225, v77
    v_rcp_f32 v234, v234
    v_mfma_f32_16x16x32_bf16 a[248:251], a[120:123], a[48:51], a[248:251]
    v_mul_f32 v226, v226, v78
    v_rcp_f32 v235, v235
    v_mfma_f32_16x16x32_bf16 a[252:255], a[120:123], a[56:59], a[252:255]
    v_mul_f32 v227, v227, v79
    v_mul_f32 v220, v220, v228
    v_mul_f32 v221, v221, v229
    v_mfma_f32_16x16x32_bf16 a[252:255], a[124:127], a[60:63], a[252:255]
    v_mul_f32 v222, v222, v230
    v_mul_f32 v223, v223, v231
    v_mfma_f32_16x16x32_bf16 v[188:191], a[92:95], a[60:63], v[188:191]
    v_mul_f32 v224, v224, v232
    v_mul_f32 v225, v225, v233
    v_mfma_f32_16x16x32_bf16 v[188:191], a[88:91], a[56:59], v[188:191]
    v_mul_f32 v226, v226, v234
    v_mul_f32 v227, v227, v235
    v_mfma_f32_16x16x32_bf16 a[220:223], a[112:115], a[56:59], a[220:223]
    v_cvt_pk_bf16_f32 v244, v220, v221
    v_cvt_pk_bf16_f32 v245, v222, v223
    v_cvt_pk_bf16_f32 v246, v224, v225
    v_mfma_f32_16x16x32_bf16 a[220:223], a[116:119], a[60:63], a[220:223]
    v_cvt_pk_bf16_f32 v247, v226, v227
    s_nop 1
    v_mfma_f32_16x16x32_bf16 v[156:159], a[84:87], a[60:63], v[156:159]
    v_permlane16_swap_b32 v244, v246
    v_permlane16_swap_b32 v245, v247
    v_mfma_f32_16x16x32_bf16 v[156:159], a[80:83], a[56:59], v[156:159]
    s_add_u32 s79, s77, 0x107e
    s_add_u32 m0, s61, 4096
    s_mov_b64 exec, 1
    buffer_load_dwordx4 v201, s[4:7], s79 offen sc1 lds
    s_mov_b64 exec, -1
    s_nop 0
    buffer_store_dwordx4 v[244:247], v2, s[16:19], s56 offen offset:2048 sc1
    s_barrier
    s_lshl_b32 s62, s60, 12
    s_lshl_b32 s63, s49, 16
    s_and_b32 s78, s49, 0xffff0000
    s_bitcmp0_b32 s60, 0
    s_cselect_b32 s78, s63, s78
    s_lshl_b32 s79, s84, 16
    v_mov_b32 v202, s78
    v_add_f32 v202, s79, v202
    v_mov_b32 v203, s85
    v_cvt_pk_bf16_f32 v202, v202, v202
    v_accvgpr_read_b32 v192, a168
    s_add_u32 m0, s85, 256
    s_nop 0
    buffer_load_dwordx4 v200, s[8:11], s62 offen offset:0 lds
    v_accvgpr_read_b32 v193, a169
    v_accvgpr_read_b32 v194, a170
    v_accvgpr_read_b32 v195, a171
    v_accvgpr_read_b32 v196, a172
    v_accvgpr_read_b32 v197, a173
    v_accvgpr_read_b32 v198, a174
    v_accvgpr_read_b32 v199, a175
    s_nop 0
    buffer_load_dwordx4 v200, s[8:11], s62 offen offset:1024 lds
    v_pk_mul_f32 v[228:229], v[104:105], v[104:105]
    v_pk_mul_f32 v[230:231], v[106:107], v[106:107]
    v_pk_mul_f32 v[232:233], v[108:109], v[108:109]
    v_pk_mul_f32 v[234:235], v[110:111], v[110:111]
    v_pk_fma_f32 v[228:229], v[228:229], s[20:21], v[254:255]
    v_pk_fma_f32 v[230:231], v[230:231], s[20:21], v[254:255]
    v_pk_fma_f32 v[232:233], v[232:233], s[20:21], v[254:255]
    v_pk_fma_f32 v[234:235], v[234:235], s[20:21], v[254:255]
    buffer_load_dwordx4 v200, s[8:11], s62 offen offset:2048 lds
    v_pk_mul_f32 v[192:193], v[192:193], v[104:105]
    v_pk_mul_f32 v[194:195], v[194:195], v[106:107]
    v_pk_mul_f32 v[196:197], v[196:197], v[108:109]
    v_pk_mul_f32 v[198:199], v[198:199], v[110:111]
    v_pk_mul_f32 v[104:105], v[228:229], v[104:105]
    v_pk_mul_f32 v[106:107], v[230:231], v[106:107]
    v_pk_mul_f32 v[108:109], v[232:233], v[108:109]
    v_pk_mul_f32 v[110:111], v[234:235], v[110:111]
    buffer_load_dwordx4 v200, s[8:11], s62 offen offset:3072 lds
    v_exp_f32 v104, v104
    v_accvgpr_read_b32 v212, a144
    v_exp_f32 v105, v105
    v_accvgpr_read_b32 v213, a145
    v_exp_f32 v106, v106
    v_accvgpr_read_b32 v214, a146
    v_exp_f32 v107, v107
    v_accvgpr_read_b32 v215, a147
    s_add_u32 m0, s85, 4728
    s_nop 0
    buffer_load_dwordx4 v200, s[8:11], s62 offen offset:0 lds
    v_exp_f32 v108, v108
    v_accvgpr_read_b32 v216, a148
    v_exp_f32 v109, v109
    v_accvgpr_read_b32 v217, a149
    v_exp_f32 v110, v110
    v_accvgpr_read_b32 v218, a150
    v_exp_f32 v111, v111
    v_accvgpr_read_b32 v219, a151
    buffer_load_dwordx4 v200, s[8:11], s62 offen offset:1024 lds
    s_nop 0
    v_pk_mul_f32 v[228:229], v[80:81], v[80:81]
    v_pk_mul_f32 v[230:231], v[82:83], v[82:83]
    v_pk_mul_f32 v[232:233], v[84:85], v[84:85]
    v_pk_mul_f32 v[234:235], v[86:87], v[86:87]
    v_pk_fma_f32 v[228:229], v[228:229], s[20:21], v[254:255]
    v_pk_fma_f32 v[230:231], v[230:231], s[20:21], v[254:255]
    v_pk_fma_f32 v[232:233], v[232:233], s[20:21], v[254:255]
    buffer_load_dwordx4 v200, s[8:11], s62 offen offset:2048 lds
    v_pk_fma_f32 v[234:235], v[234:235], s[20:21], v[254:255]
    v_pk_mul_f32 v[212:213], v[212:213], v[80:81]
    v_pk_mul_f32 v[214:215], v[214:215], v[82:83]
    v_pk_mul_f32 v[216:217], v[216:217], v[84:85]
    v_pk_mul_f32 v[218:219], v[218:219], v[86:87]
    v_pk_mul_f32 v[80:81], v[228:229], v[80:81]
    v_pk_mul_f32 v[82:83], v[230:231], v[82:83]
    v_pk_mul_f32 v[84:85], v[232:233], v[84:85]
    buffer_load_dwordx4 v200, s[8:11], s62 offen offset:3072 lds
    v_pk_mul_f32 v[86:87], v[234:235], v[86:87]
    v_pk_add_f32 v[104:105], v[104:105], s[22:23]
    v_pk_add_f32 v[106:107], v[106:107], s[22:23]
    v_pk_add_f32 v[108:109], v[108:109], s[22:23]
    v_pk_add_f32 v[110:111], v[110:111], s[22:23]
    v_exp_f32 v80, v80
    v_accvgpr_read_b32 v220, a176
    v_exp_f32 v81, v81
    s_add_u32 m0, s31, 49152
    s_nop 0
    buffer_load_dwordx4 v1, s[24:27], s28 offen offset:0 lds
    v_accvgpr_read_b32 v221, a177
    v_exp_f32 v82, v82
    v_accvgpr_read_b32 v222, a178
    v_exp_f32 v83, v83
    v_accvgpr_read_b32 v223, a179
    v_exp_f32 v84, v84
    v_accvgpr_read_b32 v224, a180
    v_exp_f32 v85, v85
    v_accvgpr_read_b32 v225, a181
    v_exp_f32 v86, v86
    v_accvgpr_read_b32 v226, a182
    v_exp_f32 v87, v87
    v_accvgpr_read_b32 v227, a183
    v_rcp_f32 v104, v104
    v_rcp_f32 v105, v105
    v_rcp_f32 v106, v106
    buffer_load_dwordx4 v29, s[24:27], s28 offen offset:1024 lds
    v_rcp_f32 v107, v107
    v_rcp_f32 v108, v108
    v_rcp_f32 v109, v109
    v_rcp_f32 v110, v110
    v_rcp_f32 v111, v111
    v_pk_mul_f32 v[228:229], v[112:113], v[112:113]
    v_pk_mul_f32 v[230:231], v[114:115], v[114:115]
    v_pk_mul_f32 v[232:233], v[116:117], v[116:117]
    v_pk_mul_f32 v[234:235], v[118:119], v[118:119]
    v_pk_fma_f32 v[228:229], v[228:229], s[20:21], v[254:255]
    v_pk_fma_f32 v[230:231], v[230:231], s[20:21], v[254:255]
    v_pk_fma_f32 v[232:233], v[232:233], s[20:21], v[254:255]
    v_pk_fma_f32 v[234:235], v[234:235], s[20:21], v[254:255]
    v_pk_mul_f32 v[220:221], v[220:221], v[112:113]
    v_pk_mul_f32 v[222:223], v[222:223], v[114:115]
    v_pk_mul_f32 v[224:225], v[224:225], v[116:117]
    s_add_u32 m0, s31, 51200
    s_nop 0
    buffer_load_dwordx4 v30, s[24:27], s28 offen offset:0 lds
    v_pk_mul_f32 v[226:227], v[226:227], v[118:119]
    v_pk_mul_f32 v[112:113], v[228:229], v[112:113]
    v_pk_mul_f32 v[114:115], v[230:231], v[114:115]
    v_pk_mul_f32 v[116:117], v[232:233], v[116:117]
    v_pk_mul_f32 v[118:119], v[234:235], v[118:119]
    v_pk_add_f32 v[80:81], v[80:81], s[22:23]
    v_pk_add_f32 v[82:83], v[82:83], s[22:23]
    v_pk_add_f32 v[84:85], v[84:85], s[22:23]
    v_pk_add_f32 v[86:87], v[86:87], s[22:23]
    v_pk_mul_f32 v[192:193], v[192:193], v[104:105]
    v_pk_mul_f32 v[194:195], v[194:195], v[106:107]
    v_pk_mul_f32 v[196:197], v[196:197], v[108:109]
    v_pk_mul_f32 v[198:199], v[198:199], v[110:111]
    v_cvt_pk_bf16_f32 v236, v192, v193
    v_cvt_pk_bf16_f32 v237, v194, v195
    v_cvt_pk_bf16_f32 v238, v196, v197
    buffer_load_dwordx4 v31, s[24:27], s28 offen offset:1024 lds
    s_add_u32 s28, s28, 0x40000
    v_cvt_pk_bf16_f32 v239, v198, v199
    v_exp_f32 v112, v112
    v_accvgpr_read_b32 v192, a152
    v_exp_f32 v113, v113
    v_accvgpr_read_b32 v193, a153
    v_exp_f32 v114, v114
    v_accvgpr_read_b32 v194, a154
    v_permlane16_swap_b32 v236, v238
    v_permlane16_swap_b32 v237, v239
    v_exp_f32 v115, v115
    v_accvgpr_read_b32 v195, a155
    v_exp_f32 v116, v116
    v_accvgpr_read_b32 v196, a156
    buffer_store_dwordx4 v[236:239], v2, s[16:19], s56 offen offset:2560 sc1
    v_exp_f32 v117, v117
    v_accvgpr_read_b32 v197, a157
    s_add_u32 m0, s31, 57344
    s_nop 0
    buffer_load_dwordx4 v1, s[24:27], s29 offen offset:0 lds
    v_exp_f32 v118, v118
    v_accvgpr_read_b32 v198, a158
    v_exp_f32 v119, v119
    v_accvgpr_read_b32 v199, a159
    v_rcp_f32 v80, v80
    v_rcp_f32 v81, v81
    v_rcp_f32 v82, v82
    v_rcp_f32 v83, v83
    v_rcp_f32 v84, v84
    v_rcp_f32 v85, v85
    v_rcp_f32 v86, v86
    v_rcp_f32 v87, v87
    v_pk_mul_f32 v[228:229], v[88:89], v[88:89]
    v_pk_mul_f32 v[230:231], v[90:91], v[90:91]
    v_pk_mul_f32 v[232:233], v[92:93], v[92:93]
    v_pk_mul_f32 v[234:235], v[94:95], v[94:95]
    buffer_load_dwordx4 v29, s[24:27], s29 offen offset:1024 lds
    v_pk_fma_f32 v[228:229], v[228:229], s[20:21], v[254:255]
    v_pk_fma_f32 v[230:231], v[230:231], s[20:21], v[254:255]
    v_pk_fma_f32 v[232:233], v[232:233], s[20:21], v[254:255]
    v_pk_fma_f32 v[234:235], v[234:235], s[20:21], v[254:255]
    v_pk_mul_f32 v[192:193], v[192:193], v[88:89]
    v_pk_mul_f32 v[194:195], v[194:195], v[90:91]
    v_pk_mul_f32 v[196:197], v[196:197], v[92:93]
    v_pk_mul_f32 v[198:199], v[198:199], v[94:95]
    v_pk_mul_f32 v[88:89], v[228:229], v[88:89]
    v_pk_mul_f32 v[90:91], v[230:231], v[90:91]
    v_pk_mul_f32 v[92:93], v[232:233], v[92:93]
    v_pk_mul_f32 v[94:95], v[234:235], v[94:95]
    v_pk_add_f32 v[112:113], v[112:113], s[22:23]
    v_pk_add_f32 v[114:115], v[114:115], s[22:23]
    v_pk_add_f32 v[116:117], v[116:117], s[22:23]
    v_pk_add_f32 v[118:119], v[118:119], s[22:23]
    s_add_u32 m0, s31, 59392
    s_nop 0
    buffer_load_dwordx4 v30, s[24:27], s29 offen offset:0 lds
    v_pk_mul_f32 v[212:213], v[212:213], v[80:81]
    v_pk_mul_f32 v[214:215], v[214:215], v[82:83]
    v_pk_mul_f32 v[216:217], v[216:217], v[84:85]
    v_pk_mul_f32 v[218:219], v[218:219], v[86:87]
    v_cvt_pk_bf16_f32 v240, v212, v213
    v_cvt_pk_bf16_f32 v241, v214, v215
    v_cvt_pk_bf16_f32 v242, v216, v217
    v_cvt_pk_bf16_f32 v243, v218, v219
    v_exp_f32 v88, v88
    v_accvgpr_read_b32 v212, a184
    v_exp_f32 v89, v89
    v_accvgpr_read_b32 v213, a185
    v_exp_f32 v90, v90
    v_accvgpr_read_b32 v214, a186
    v_permlane16_swap_b32 v240, v242
    v_permlane16_swap_b32 v241, v243
    buffer_load_dwordx4 v31, s[24:27], s29 offen offset:1024 lds
    s_add_u32 s29, s29, 0x40000
    v_exp_f32 v91, v91
    v_accvgpr_read_b32 v215, a187
    v_exp_f32 v92, v92
    v_accvgpr_read_b32 v216, a188
    buffer_store_dwordx4 v[240:243], v2, s[16:19], s57 offen offset:0 sc1
    v_exp_f32 v93, v93
    v_accvgpr_read_b32 v217, a189
    v_exp_f32 v94, v94
    v_accvgpr_read_b32 v218, a190
    v_exp_f32 v95, v95
    v_accvgpr_read_b32 v219, a191
    v_rcp_f32 v112, v112
    v_rcp_f32 v113, v113
    v_rcp_f32 v114, v114
    v_rcp_f32 v115, v115
    v_rcp_f32 v116, v116
    buffer_load_dwordx4 a[0:3], v1, s[24:27], s30 offen offset:0
    v_rcp_f32 v117, v117
    v_rcp_f32 v118, v118
    v_rcp_f32 v119, v119
    v_pk_mul_f32 v[228:229], v[120:121], v[120:121]
    v_pk_mul_f32 v[230:231], v[122:123], v[122:123]
    v_pk_mul_f32 v[232:233], v[124:125], v[124:125]
    v_pk_mul_f32 v[234:235], v[126:127], v[126:127]
    v_pk_fma_f32 v[228:229], v[228:229], s[20:21], v[254:255]
    v_pk_fma_f32 v[230:231], v[230:231], s[20:21], v[254:255]
    v_pk_fma_f32 v[232:233], v[232:233], s[20:21], v[254:255]
    v_pk_fma_f32 v[234:235], v[234:235], s[20:21], v[254:255]
    v_pk_mul_f32 v[212:213], v[212:213], v[120:121]
    v_pk_mul_f32 v[214:215], v[214:215], v[122:123]
    v_pk_mul_f32 v[216:217], v[216:217], v[124:125]
    v_pk_mul_f32 v[218:219], v[218:219], v[126:127]
    v_pk_mul_f32 v[120:121], v[228:229], v[120:121]
    v_pk_mul_f32 v[122:123], v[230:231], v[122:123]
    v_pk_mul_f32 v[124:125], v[232:233], v[124:125]
    v_pk_mul_f32 v[126:127], v[234:235], v[126:127]
    v_pk_add_f32 v[88:89], v[88:89], s[22:23]
    v_pk_add_f32 v[90:91], v[90:91], s[22:23]
    v_pk_add_f32 v[92:93], v[92:93], s[22:23]
    v_pk_add_f32 v[94:95], v[94:95], s[22:23]
    v_pk_mul_f32 v[220:221], v[220:221], v[112:113]
    v_pk_mul_f32 v[222:223], v[222:223], v[114:115]
    v_pk_mul_f32 v[224:225], v[224:225], v[116:117]
    v_pk_mul_f32 v[226:227], v[226:227], v[118:119]
    buffer_load_dwordx4 a[4:7], v29, s[24:27], s30 offen offset:1024
    v_cvt_pk_bf16_f32 v244, v220, v221
    v_cvt_pk_bf16_f32 v245, v222, v223
    v_cvt_pk_bf16_f32 v246, v224, v225
    v_cvt_pk_bf16_f32 v247, v226, v227
    v_exp_f32 v120, v120
    v_accvgpr_read_b32 v220, a192
    v_exp_f32 v121, v121
    v_accvgpr_read_b32 v221, a193
    v_exp_f32 v122, v122
    v_accvgpr_read_b32 v222, a194
    v_permlane16_swap_b32 v244, v246
    v_permlane16_swap_b32 v245, v247
    v_exp_f32 v123, v123
    v_accvgpr_read_b32 v223, a195
    v_exp_f32 v124, v124
    v_accvgpr_read_b32 v224, a196
    buffer_load_dwordx4 a[128:131], v30, s[24:27], s30 offen offset:0
    buffer_store_dwordx4 v[244:247], v2, s[16:19], s57 offen offset:512 sc1
    v_exp_f32 v125, v125
    v_accvgpr_read_b32 v225, a197
    v_exp_f32 v126, v126
    v_accvgpr_read_b32 v226, a198
    v_exp_f32 v127, v127
    v_accvgpr_read_b32 v227, a199
    v_rcp_f32 v88, v88
    v_rcp_f32 v89, v89
    v_rcp_f32 v90, v90
    v_rcp_f32 v91, v91
    v_rcp_f32 v92, v92
    v_rcp_f32 v93, v93
    v_rcp_f32 v94, v94
    v_rcp_f32 v95, v95
    v_pk_mul_f32 v[228:229], v[128:129], v[128:129]
    v_pk_mul_f32 v[230:231], v[130:131], v[130:131]
    v_pk_mul_f32 v[232:233], v[132:133], v[132:133]
    v_pk_mul_f32 v[234:235], v[134:135], v[134:135]
    v_pk_fma_f32 v[228:229], v[228:229], s[20:21], v[254:255]
    v_pk_fma_f32 v[230:231], v[230:231], s[20:21], v[254:255]
    v_pk_fma_f32 v[232:233], v[232:233], s[20:21], v[254:255]
    v_pk_fma_f32 v[234:235], v[234:235], s[20:21], v[254:255]
    v_pk_mul_f32 v[220:221], v[220:221], v[128:129]
    v_pk_mul_f32 v[222:223], v[222:223], v[130:131]
    v_pk_mul_f32 v[224:225], v[224:225], v[132:133]
    v_pk_mul_f32 v[226:227], v[226:227], v[134:135]
    v_pk_mul_f32 v[128:129], v[228:229], v[128:129]
    v_pk_mul_f32 v[130:131], v[230:231], v[130:131]
    v_pk_mul_f32 v[132:133], v[232:233], v[132:133]
    v_pk_mul_f32 v[134:135], v[234:235], v[134:135]
    v_pk_add_f32 v[120:121], v[120:121], s[22:23]
    v_pk_add_f32 v[122:123], v[122:123], s[22:23]
    v_pk_add_f32 v[124:125], v[124:125], s[22:23]
    v_pk_add_f32 v[126:127], v[126:127], s[22:23]
    v_pk_mul_f32 v[192:193], v[192:193], v[88:89]
    v_pk_mul_f32 v[194:195], v[194:195], v[90:91]
    v_pk_mul_f32 v[196:197], v[196:197], v[92:93]
    v_pk_mul_f32 v[198:199], v[198:199], v[94:95]
    buffer_load_dwordx4 a[132:135], v31, s[24:27], s30 offen offset:1024
    s_add_u32 s30, s30, 0x40000
    v_cvt_pk_bf16_f32 v248, v192, v193
    v_cvt_pk_bf16_f32 v249, v194, v195
    v_cvt_pk_bf16_f32 v250, v196, v197
    v_cvt_pk_bf16_f32 v251, v198, v199
    v_exp_f32 v128, v128
    v_accvgpr_read_b32 v192, a224
    v_exp_f32 v129, v129
    v_accvgpr_read_b32 v193, a225
    v_exp_f32 v130, v130
    v_accvgpr_read_b32 v194, a226
    v_permlane16_swap_b32 v248, v250
    v_permlane16_swap_b32 v249, v251
    v_exp_f32 v131, v131
    v_accvgpr_read_b32 v195, a227
    v_exp_f32 v132, v132
    v_accvgpr_read_b32 v196, a228
    buffer_load_dwordx4 a[32:35], v1, s[24:27], s70 offen offset:0
    buffer_store_dwordx4 v[248:251], v2, s[16:19], s57 offen offset:2048 sc1
    v_exp_f32 v133, v133
    v_accvgpr_read_b32 v197, a229
    v_exp_f32 v134, v134
    v_accvgpr_read_b32 v198, a230
    v_exp_f32 v135, v135
    v_accvgpr_read_b32 v199, a231
    v_rcp_f32 v120, v120
    v_rcp_f32 v121, v121
    v_rcp_f32 v122, v122
    v_rcp_f32 v123, v123
    v_rcp_f32 v124, v124
    v_rcp_f32 v125, v125
    v_rcp_f32 v126, v126
    v_rcp_f32 v127, v127
    v_pk_mul_f32 v[228:229], v[160:161], v[160:161]
    v_pk_mul_f32 v[230:231], v[162:163], v[162:163]
    v_pk_mul_f32 v[232:233], v[164:165], v[164:165]
    v_pk_mul_f32 v[234:235], v[166:167], v[166:167]
    v_pk_fma_f32 v[228:229], v[228:229], s[20:21], v[254:255]
    v_pk_fma_f32 v[230:231], v[230:231], s[20:21], v[254:255]
    v_pk_fma_f32 v[232:233], v[232:233], s[20:21], v[254:255]
    v_pk_fma_f32 v[234:235], v[234:235], s[20:21], v[254:255]
    v_pk_mul_f32 v[192:193], v[192:193], v[160:161]
    v_pk_mul_f32 v[194:195], v[194:195], v[162:163]
    v_pk_mul_f32 v[196:197], v[196:197], v[164:165]
    v_pk_mul_f32 v[198:199], v[198:199], v[166:167]
    v_pk_mul_f32 v[160:161], v[228:229], v[160:161]
    v_pk_mul_f32 v[162:163], v[230:231], v[162:163]
    v_pk_mul_f32 v[164:165], v[232:233], v[164:165]
    v_pk_mul_f32 v[166:167], v[234:235], v[166:167]
    v_pk_add_f32 v[128:129], v[128:129], s[22:23]
    v_pk_add_f32 v[130:131], v[130:131], s[22:23]
    v_pk_add_f32 v[132:133], v[132:133], s[22:23]
    v_pk_add_f32 v[134:135], v[134:135], s[22:23]
    v_pk_mul_f32 v[212:213], v[212:213], v[120:121]
    v_pk_mul_f32 v[214:215], v[214:215], v[122:123]
    v_pk_mul_f32 v[216:217], v[216:217], v[124:125]
    v_pk_mul_f32 v[218:219], v[218:219], v[126:127]
    buffer_load_dwordx4 a[36:39], v29, s[24:27], s70 offen offset:1024
    v_cvt_pk_bf16_f32 v236, v212, v213
    v_cvt_pk_bf16_f32 v237, v214, v215
    v_cvt_pk_bf16_f32 v238, v216, v217
    v_cvt_pk_bf16_f32 v239, v218, v219
    v_exp_f32 v160, v160
    v_accvgpr_read_b32 v212, a200
    v_exp_f32 v161, v161
    v_accvgpr_read_b32 v213, a201
    v_exp_f32 v162, v162
    v_accvgpr_read_b32 v214, a202
    v_permlane16_swap_b32 v236, v238
    v_permlane16_swap_b32 v237, v239
    v_exp_f32 v163, v163
    v_accvgpr_read_b32 v215, a203
    v_exp_f32 v164, v164
    v_accvgpr_read_b32 v216, a204
    buffer_load_dwordx4 a[160:163], v30, s[24:27], s70 offen offset:0
    buffer_store_dwordx4 v[236:239], v2, s[16:19], s57 offen offset:2560 sc1
    v_exp_f32 v165, v165
    v_accvgpr_read_b32 v217, a205
    v_exp_f32 v166, v166
    v_accvgpr_read_b32 v218, a206
    v_exp_f32 v167, v167
    v_accvgpr_read_b32 v219, a207
    v_rcp_f32 v128, v128
    v_rcp_f32 v129, v129
    v_rcp_f32 v130, v130
    v_rcp_f32 v131, v131
    v_rcp_f32 v132, v132
    v_rcp_f32 v133, v133
    v_rcp_f32 v134, v134
    v_rcp_f32 v135, v135
    v_pk_mul_f32 v[228:229], v[136:137], v[136:137]
    v_pk_mul_f32 v[230:231], v[138:139], v[138:139]
    v_pk_mul_f32 v[232:233], v[140:141], v[140:141]
    v_pk_mul_f32 v[234:235], v[142:143], v[142:143]
    v_pk_fma_f32 v[228:229], v[228:229], s[20:21], v[254:255]
    v_pk_fma_f32 v[230:231], v[230:231], s[20:21], v[254:255]
    v_pk_fma_f32 v[232:233], v[232:233], s[20:21], v[254:255]
    v_pk_fma_f32 v[234:235], v[234:235], s[20:21], v[254:255]
    v_pk_mul_f32 v[212:213], v[212:213], v[136:137]
    v_pk_mul_f32 v[214:215], v[214:215], v[138:139]
    v_pk_mul_f32 v[216:217], v[216:217], v[140:141]
    v_pk_mul_f32 v[218:219], v[218:219], v[142:143]
    v_pk_mul_f32 v[136:137], v[228:229], v[136:137]
    v_pk_mul_f32 v[138:139], v[230:231], v[138:139]
    v_pk_mul_f32 v[140:141], v[232:233], v[140:141]
    v_pk_mul_f32 v[142:143], v[234:235], v[142:143]
    v_pk_add_f32 v[160:161], v[160:161], s[22:23]
    v_pk_add_f32 v[162:163], v[162:163], s[22:23]
    v_pk_add_f32 v[164:165], v[164:165], s[22:23]
    v_pk_add_f32 v[166:167], v[166:167], s[22:23]
    v_pk_mul_f32 v[220:221], v[220:221], v[128:129]
    v_pk_mul_f32 v[222:223], v[222:223], v[130:131]
    v_pk_mul_f32 v[224:225], v[224:225], v[132:133]
    v_pk_mul_f32 v[226:227], v[226:227], v[134:135]
    buffer_load_dwordx4 a[164:167], v31, s[24:27], s70 offen offset:1024
    s_add_u32 s70, s70, 0x40000
    v_cvt_pk_bf16_f32 v240, v220, v221
    v_cvt_pk_bf16_f32 v241, v222, v223
    v_cvt_pk_bf16_f32 v242, v224, v225
    v_cvt_pk_bf16_f32 v243, v226, v227
    v_exp_f32 v136, v136
    v_accvgpr_read_b32 v220, a232
    v_exp_f32 v137, v137
    v_accvgpr_read_b32 v221, a233
    v_exp_f32 v138, v138
    v_accvgpr_read_b32 v222, a234
    v_permlane16_swap_b32 v240, v242
    v_permlane16_swap_b32 v241, v243
    v_exp_f32 v139, v139
    v_accvgpr_read_b32 v223, a235
    v_exp_f32 v140, v140
    v_accvgpr_read_b32 v224, a236
    buffer_load_dwordx4 a[8:11], v1, s[24:27], s28 offen offset:0
    buffer_store_dwordx4 v[240:243], v2, s[16:19], s58 offen offset:0 sc1
    v_exp_f32 v141, v141
    v_accvgpr_read_b32 v225, a237
    v_exp_f32 v142, v142
    v_accvgpr_read_b32 v226, a238
    v_exp_f32 v143, v143
    v_accvgpr_read_b32 v227, a239
    v_rcp_f32 v160, v160
    v_rcp_f32 v161, v161
    v_rcp_f32 v162, v162
    v_rcp_f32 v163, v163
    v_rcp_f32 v164, v164
    v_rcp_f32 v165, v165
    v_rcp_f32 v166, v166
    v_rcp_f32 v167, v167
    v_pk_mul_f32 v[228:229], v[168:169], v[168:169]
    v_pk_mul_f32 v[230:231], v[170:171], v[170:171]
    v_pk_mul_f32 v[232:233], v[172:173], v[172:173]
    v_pk_mul_f32 v[234:235], v[174:175], v[174:175]
    v_pk_fma_f32 v[228:229], v[228:229], s[20:21], v[254:255]
    v_pk_fma_f32 v[230:231], v[230:231], s[20:21], v[254:255]
    v_pk_fma_f32 v[232:233], v[232:233], s[20:21], v[254:255]
    v_pk_fma_f32 v[234:235], v[234:235], s[20:21], v[254:255]
    v_pk_mul_f32 v[220:221], v[220:221], v[168:169]
    v_pk_mul_f32 v[222:223], v[222:223], v[170:171]
    v_pk_mul_f32 v[224:225], v[224:225], v[172:173]
    v_pk_mul_f32 v[226:227], v[226:227], v[174:175]
    v_pk_mul_f32 v[168:169], v[228:229], v[168:169]
    v_pk_mul_f32 v[170:171], v[230:231], v[170:171]
    v_pk_mul_f32 v[172:173], v[232:233], v[172:173]
    v_pk_mul_f32 v[174:175], v[234:235], v[174:175]
    v_pk_add_f32 v[136:137], v[136:137], s[22:23]
    v_pk_add_f32 v[138:139], v[138:139], s[22:23]
    v_pk_add_f32 v[140:141], v[140:141], s[22:23]
    v_pk_add_f32 v[142:143], v[142:143], s[22:23]
    v_pk_mul_f32 v[192:193], v[192:193], v[160:161]
    v_pk_mul_f32 v[194:195], v[194:195], v[162:163]
    v_pk_mul_f32 v[196:197], v[196:197], v[164:165]
    v_pk_mul_f32 v[198:199], v[198:199], v[166:167]
    buffer_load_dwordx4 a[12:15], v29, s[24:27], s28 offen offset:1024
    v_cvt_pk_bf16_f32 v244, v192, v193
    v_cvt_pk_bf16_f32 v245, v194, v195
    v_cvt_pk_bf16_f32 v246, v196, v197
    v_cvt_pk_bf16_f32 v247, v198, v199
    v_exp_f32 v168, v168
    v_accvgpr_read_b32 v192, a208
    v_exp_f32 v169, v169
    v_accvgpr_read_b32 v193, a209
    v_exp_f32 v170, v170
    v_accvgpr_read_b32 v194, a210
    v_permlane16_swap_b32 v244, v246
    v_permlane16_swap_b32 v245, v247
    v_exp_f32 v171, v171
    v_accvgpr_read_b32 v195, a211
    v_exp_f32 v172, v172
    v_accvgpr_read_b32 v196, a212
    buffer_load_dwordx4 a[136:139], v30, s[24:27], s28 offen offset:0
    buffer_store_dwordx4 v[244:247], v2, s[16:19], s58 offen offset:512 sc1
    v_exp_f32 v173, v173
    v_accvgpr_read_b32 v197, a213
    v_exp_f32 v174, v174
    v_accvgpr_read_b32 v198, a214
    v_exp_f32 v175, v175
    v_accvgpr_read_b32 v199, a215
    v_rcp_f32 v136, v136
    v_rcp_f32 v137, v137
    v_rcp_f32 v138, v138
    v_rcp_f32 v139, v139
    v_rcp_f32 v140, v140
    v_rcp_f32 v141, v141
    v_rcp_f32 v142, v142
    v_rcp_f32 v143, v143
    v_pk_mul_f32 v[228:229], v[144:145], v[144:145]
    v_pk_mul_f32 v[230:231], v[146:147], v[146:147]
    v_pk_mul_f32 v[232:233], v[148:149], v[148:149]
    v_pk_mul_f32 v[234:235], v[150:151], v[150:151]
    v_pk_fma_f32 v[228:229], v[228:229], s[20:21], v[254:255]
    v_pk_fma_f32 v[230:231], v[230:231], s[20:21], v[254:255]
    v_pk_fma_f32 v[232:233], v[232:233], s[20:21], v[254:255]
    v_pk_fma_f32 v[234:235], v[234:235], s[20:21], v[254:255]
    v_pk_mul_f32 v[192:193], v[192:193], v[144:145]
    v_pk_mul_f32 v[194:195], v[194:195], v[146:147]
    v_pk_mul_f32 v[196:197], v[196:197], v[148:149]
    v_pk_mul_f32 v[198:199], v[198:199], v[150:151]
    v_pk_mul_f32 v[144:145], v[228:229], v[144:145]
    v_pk_mul_f32 v[146:147], v[230:231], v[146:147]
IW_P6:
    s_cbranch_execz IW_P10
    v_pk_mul_f32 v[148:149], v[232:233], v[148:149]
    v_pk_mul_f32 v[150:151], v[234:235], v[150:151]
    v_pk_add_f32 v[168:169], v[168:169], s[22:23]
    v_pk_add_f32 v[170:171], v[170:171], s[22:23]
    v_pk_add_f32 v[172:173], v[172:173], s[22:23]
    v_pk_add_f32 v[174:175], v[174:175], s[22:23]
    v_pk_mul_f32 v[212:213], v[212:213], v[136:137]
    v_pk_mul_f32 v[214:215], v[214:215], v[138:139]
    v_pk_mul_f32 v[216:217], v[216:217], v[140:141]
    v_pk_mul_f32 v[218:219], v[218:219], v[142:143]
    buffer_load_dwordx4 a[140:143], v31, s[24:27], s28 offen offset:1024
    s_add_u32 s28, s28, 0x40000
    v_cvt_pk_bf16_f32 v248, v212, v213
    v_cvt_pk_bf16_f32 v249, v214, v215
    v_cvt_pk_bf16_f32 v250, v216, v217
    v_cvt_pk_bf16_f32 v251, v218, v219
    v_exp_f32 v144, v144
    v_accvgpr_read_b32 v212, a240
    v_exp_f32 v145, v145
    v_accvgpr_read_b32 v213, a241
    v_exp_f32 v146, v146
    v_accvgpr_read_b32 v214, a242
    v_permlane16_swap_b32 v248, v250
    v_permlane16_swap_b32 v249, v251
    v_exp_f32 v147, v147
    v_accvgpr_read_b32 v215, a243
    v_exp_f32 v148, v148
    v_accvgpr_read_b32 v216, a244
    buffer_load_dwordx4 a[40:43], v1, s[24:27], s29 offen offset:0
    buffer_store_dwordx4 v[248:251], v2, s[16:19], s58 offen offset:2048 sc1
    v_exp_f32 v149, v149
    v_accvgpr_read_b32 v217, a245
    v_exp_f32 v150, v150
    v_accvgpr_read_b32 v218, a246
    v_exp_f32 v151, v151
    v_accvgpr_read_b32 v219, a247
    v_rcp_f32 v168, v168
    v_rcp_f32 v169, v169
    v_rcp_f32 v170, v170
    v_rcp_f32 v171, v171
    v_rcp_f32 v172, v172
    v_rcp_f32 v173, v173
    v_rcp_f32 v174, v174
    v_rcp_f32 v175, v175
    v_pk_mul_f32 v[228:229], v[176:177], v[176:177]
    v_pk_mul_f32 v[230:231], v[178:179], v[178:179]
    v_pk_mul_f32 v[232:233], v[180:181], v[180:181]
    v_pk_mul_f32 v[234:235], v[182:183], v[182:183]
    v_pk_fma_f32 v[228:229], v[228:229], s[20:21], v[254:255]
    v_pk_fma_f32 v[230:231], v[230:231], s[20:21], v[254:255]
    v_pk_fma_f32 v[232:233], v[232:233], s[20:21], v[254:255]
    v_pk_fma_f32 v[234:235], v[234:235], s[20:21], v[254:255]
    v_pk_mul_f32 v[212:213], v[212:213], v[176:177]
    v_pk_mul_f32 v[214:215], v[214:215], v[178:179]
    v_pk_mul_f32 v[216:217], v[216:217], v[180:181]
    v_pk_mul_f32 v[218:219], v[218:219], v[182:183]
    v_pk_mul_f32 v[176:177], v[228:229], v[176:177]
    v_pk_mul_f32 v[178:179], v[230:231], v[178:179]
    v_pk_mul_f32 v[180:181], v[232:233], v[180:181]
    v_pk_mul_f32 v[182:183], v[234:235], v[182:183]
    v_pk_add_f32 v[144:145], v[144:145], s[22:23]
    v_pk_add_f32 v[146:147], v[146:147], s[22:23]
    v_pk_add_f32 v[148:149], v[148:149], s[22:23]
    v_pk_add_f32 v[150:151], v[150:151], s[22:23]
    v_pk_mul_f32 v[220:221], v[220:221], v[168:169]
    v_pk_mul_f32 v[222:223], v[222:223], v[170:171]
    v_pk_mul_f32 v[224:225], v[224:225], v[172:173]
    v_pk_mul_f32 v[226:227], v[226:227], v[174:175]
    buffer_load_dwordx4 a[44:47], v29, s[24:27], s29 offen offset:1024
    v_cvt_pk_bf16_f32 v236, v220, v221
    v_cvt_pk_bf16_f32 v237, v222, v223
    v_cvt_pk_bf16_f32 v238, v224, v225
    v_cvt_pk_bf16_f32 v239, v226, v227
    v_exp_f32 v176, v176
    v_accvgpr_read_b32 v220, a216
    v_exp_f32 v177, v177
    v_accvgpr_read_b32 v221, a217
    v_exp_f32 v178, v178
    v_accvgpr_read_b32 v222, a218
    v_permlane16_swap_b32 v236, v238
    v_permlane16_swap_b32 v237, v239
    v_exp_f32 v179, v179
    v_accvgpr_read_b32 v223, a219
    v_exp_f32 v180, v180
    v_accvgpr_read_b32 v224, a220
    buffer_load_dwordx4 a[168:171], v30, s[24:27], s29 offen offset:0
    buffer_store_dwordx4 v[236:239], v2, s[16:19], s58 offen offset:2560 sc1
    v_exp_f32 v181, v181
    v_accvgpr_read_b32 v225, a221
    v_exp_f32 v182, v182
    v_accvgpr_read_b32 v226, a222
    v_exp_f32 v183, v183
    v_accvgpr_read_b32 v227, a223
    v_rcp_f32 v144, v144
    v_rcp_f32 v145, v145
    v_rcp_f32 v146, v146
    v_rcp_f32 v147, v147
    v_rcp_f32 v148, v148
    v_rcp_f32 v149, v149
    v_rcp_f32 v150, v150
    v_rcp_f32 v151, v151
    v_pk_mul_f32 v[228:229], v[152:153], v[152:153]
    v_pk_mul_f32 v[230:231], v[154:155], v[154:155]
    v_pk_mul_f32 v[232:233], v[156:157], v[156:157]
    v_pk_mul_f32 v[234:235], v[158:159], v[158:159]
    v_pk_fma_f32 v[228:229], v[228:229], s[20:21], v[254:255]
    v_pk_fma_f32 v[230:231], v[230:231], s[20:21], v[254:255]
    v_pk_fma_f32 v[232:233], v[232:233], s[20:21], v[254:255]
    v_pk_fma_f32 v[234:235], v[234:235], s[20:21], v[254:255]
    v_pk_mul_f32 v[220:221], v[220:221], v[152:153]
    v_pk_mul_f32 v[222:223], v[222:223], v[154:155]
    v_pk_mul_f32 v[224:225], v[224:225], v[156:157]
    v_pk_mul_f32 v[226:227], v[226:227], v[158:159]
    v_pk_mul_f32 v[152:153], v[228:229], v[152:153]
    v_pk_mul_f32 v[154:155], v[230:231], v[154:155]
    v_pk_mul_f32 v[156:157], v[232:233], v[156:157]
    v_pk_mul_f32 v[158:159], v[234:235], v[158:159]
    v_pk_add_f32 v[176:177], v[176:177], s[22:23]
    v_pk_add_f32 v[178:179], v[178:179], s[22:23]
    v_pk_add_f32 v[180:181], v[180:181], s[22:23]
    v_pk_add_f32 v[182:183], v[182:183], s[22:23]
    v_pk_mul_f32 v[192:193], v[192:193], v[144:145]
    v_pk_mul_f32 v[194:195], v[194:195], v[146:147]
    v_pk_mul_f32 v[196:197], v[196:197], v[148:149]
    v_pk_mul_f32 v[198:199], v[198:199], v[150:151]
    buffer_load_dwordx4 a[172:175], v31, s[24:27], s29 offen offset:1024
    s_add_u32 s29, s29, 0x40000
    s_mov_b64 exec, 0xffff
    ds_write_b128 v211, v[204:207]
    s_mov_b64 exec, 0x7fffff
    ds_write_b128 v211, v[204:207] offset:4352
    s_mov_b64 exec, 0xff
    ds_write_b128 v211, v[204:207] offset:8832
    s_mov_b64 exec, 1
    ds_write_b64 v211, v[204:205] offset:4720
    ds_write_b64 v211, v[204:205] offset:8824
    s_mov_b64 exec, -1
    v_cvt_pk_bf16_f32 v240, v192, v193
    v_cvt_pk_bf16_f32 v241, v194, v195
    v_cvt_pk_bf16_f32 v242, v196, v197
    v_cvt_pk_bf16_f32 v243, v198, v199
    v_exp_f32 v152, v152
    v_accvgpr_read_b32 v192, a248
    v_exp_f32 v153, v153
    v_accvgpr_read_b32 v193, a249
    v_exp_f32 v154, v154
    v_accvgpr_read_b32 v194, a250
    v_permlane16_swap_b32 v240, v242
    v_permlane16_swap_b32 v241, v243
    v_exp_f32 v155, v155
    v_accvgpr_read_b32 v195, a251
    v_exp_f32 v156, v156
    v_accvgpr_read_b32 v196, a252
    buffer_store_dwordx4 v[240:243], v2, s[16:19], s59 offen offset:0 sc1
    v_exp_f32 v157, v157
    v_accvgpr_read_b32 v197, a253
    v_exp_f32 v158, v158
    v_accvgpr_read_b32 v198, a254
    v_exp_f32 v159, v159
    v_accvgpr_read_b32 v199, a255
    v_rcp_f32 v176, v176
    v_rcp_f32 v177, v177
    v_rcp_f32 v178, v178
    v_rcp_f32 v179, v179
    v_rcp_f32 v180, v180
    v_rcp_f32 v181, v181
    v_rcp_f32 v182, v182
    v_rcp_f32 v183, v183
    v_pk_mul_f32 v[228:229], v[184:185], v[184:185]
    v_pk_mul_f32 v[230:231], v[186:187], v[186:187]
    v_pk_mul_f32 v[232:233], v[188:189], v[188:189]
    v_pk_mul_f32 v[234:235], v[190:191], v[190:191]
    v_pk_fma_f32 v[228:229], v[228:229], s[20:21], v[254:255]
    v_pk_fma_f32 v[230:231], v[230:231], s[20:21], v[254:255]
    v_pk_fma_f32 v[232:233], v[232:233], s[20:21], v[254:255]
    v_pk_fma_f32 v[234:235], v[234:235], s[20:21], v[254:255]
    v_pk_mul_f32 v[192:193], v[192:193], v[184:185]
    v_pk_mul_f32 v[194:195], v[194:195], v[186:187]
    v_pk_mul_f32 v[196:197], v[196:197], v[188:189]
    v_pk_mul_f32 v[198:199], v[198:199], v[190:191]
    v_pk_mul_f32 v[184:185], v[228:229], v[184:185]
    v_pk_mul_f32 v[186:187], v[230:231], v[186:187]
    v_pk_mul_f32 v[188:189], v[232:233], v[188:189]
    v_pk_mul_f32 v[190:191], v[234:235], v[190:191]
    v_pk_add_f32 v[152:153], v[152:153], s[22:23]
    v_pk_add_f32 v[154:155], v[154:155], s[22:23]
    v_pk_add_f32 v[156:157], v[156:157], s[22:23]
    v_pk_add_f32 v[158:159], v[158:159], s[22:23]
    v_pk_mul_f32 v[212:213], v[212:213], v[176:177]
    v_pk_mul_f32 v[214:215], v[214:215], v[178:179]
    v_pk_mul_f32 v[216:217], v[216:217], v[180:181]
    v_pk_mul_f32 v[218:219], v[218:219], v[182:183]
    v_cvt_pk_bf16_f32 v244, v212, v213
    v_cvt_pk_bf16_f32 v245, v214, v215
    v_cvt_pk_bf16_f32 v246, v216, v217
    v_cvt_pk_bf16_f32 v247, v218, v219
    v_exp_f32 v184, v184
    v_exp_f32 v185, v185
    v_exp_f32 v186, v186
    v_exp_f32 v187, v187
    v_exp_f32 v188, v188
    v_exp_f32 v189, v189
    v_permlane16_swap_b32 v244, v246
    v_permlane16_swap_b32 v245, v247
    v_exp_f32 v190, v190
    v_exp_f32 v191, v191
    v_rcp_f32 v152, v152
    v_rcp_f32 v153, v153
    s_waitcnt vmcnt(34)
    s_mov_b64 exec, 1
    ds_write_b16 v203, v202 offset:256
    ds_write_b16 v203, v202 offset:4728
    s_mov_b64 exec, -1
    ds_read_b128 v[64:67], v13 offset:0
    ds_read_b128 v[68:71], v13 offset:4480
    ds_read_b128 v[112:115], v14 offset:3072
    ds_read_b128 v[116:119], v14 offset:2048
    ds_read_b128 v[120:123], v14 offset:1024
    ds_read_b128 v[124:127], v14 offset:0
    ds_read_b128 v[80:83], v13 offset:64
    ds_read_b128 v[84:87], v13 offset:4544
    ds_read_b128 v[128:131], v14 offset:3136
    ds_read_b128 v[132:135], v14 offset:2112
    ds_read_b128 v[136:139], v14 offset:1088
    ds_read_b128 v[140:143], v14 offset:64
    ds_read_b128 v[88:91], v13 offset:3136
    ds_read_b128 v[92:95], v13 offset:7616
    buffer_store_dwordx4 v[244:247], v2, s[16:19], s59 offen offset:512 sc1
    v_rcp_f32 v154, v154
    v_rcp_f32 v155, v155
    v_rcp_f32 v156, v156
    v_rcp_f32 v157, v157
    v_rcp_f32 v158, v158
    v_rcp_f32 v159, v159
    v_pk_add_f32 v[184:185], v[184:185], s[22:23]
    v_pk_add_f32 v[186:187], v[186:187], s[22:23]
    v_pk_add_f32 v[188:189], v[188:189], s[22:23]
    v_pk_add_f32 v[190:191], v[190:191], s[22:23]
    v_pk_mul_f32 v[220:221], v[220:221], v[152:153]
    v_pk_mul_f32 v[222:223], v[222:223], v[154:155]
    v_pk_mul_f32 v[224:225], v[224:225], v[156:157]
    v_pk_mul_f32 v[226:227], v[226:227], v[158:159]
    v_cvt_pk_bf16_f32 v248, v220, v221
    v_cvt_pk_bf16_f32 v249, v222, v223
    v_cvt_pk_bf16_f32 v250, v224, v225
    v_cvt_pk_bf16_f32 v251, v226, v227
    v_rcp_f32 v184, v184
    v_rcp_f32 v185, v185
    v_rcp_f32 v186, v186
    v_rcp_f32 v187, v187
    v_rcp_f32 v188, v188
    v_rcp_f32 v189, v189
    v_permlane16_swap_b32 v248, v250
    v_permlane16_swap_b32 v249, v251
    v_rcp_f32 v190, v190
    v_rcp_f32 v191, v191
    buffer_store_dwordx4 v[248:251], v2, s[16:19], s59 offen offset:2048 sc1
    s_nop 0
    v_pk_mul_f32 v[192:193], v[192:193], v[184:185]
    v_pk_mul_f32 v[194:195], v[194:195], v[186:187]
    v_pk_mul_f32 v[196:197], v[196:197], v[188:189]
    v_pk_mul_f32 v[198:199], v[198:199], v[190:191]
    v_cvt_pk_bf16_f32 v236, v192, v193
    v_cvt_pk_bf16_f32 v237, v194, v195
    v_cvt_pk_bf16_f32 v238, v196, v197
    v_cvt_pk_bf16_f32 v239, v198, v199
    s_nop 1
    v_permlane16_swap_b32 v236, v238
    v_permlane16_swap_b32 v237, v239
    s_nop 0
    buffer_store_dwordx4 v[236:239], v2, s[16:19], s59 offen offset:2560 sc1
CV_COMMON:
    s_waitcnt lgkmcnt(8)
    v_mfma_f32_16x16x32_bf16 v[32:35], v[112:115], v[64:67], 0
    ds_read_b128 v[96:99], v13 offset:1088
    s_add_u32 s32, s72, 0x2300000
    s_addc_u32 s33, s73, 0
    s_mov_b32 s34, 0x30000
    v_mfma_f32_16x16x32_bf16 v[36:39], v[112:115], v[68:71], 0
    ds_read_b128 v[100:103], v13 offset:5568
    s_mov_b32 s35, 0x00020000
    v_mfma_f32_16x16x32_bf16 v[40:43], v[116:119], v[64:67], 0
    ds_read_b128 v[104:107], v13 offset:2112
    s_lshl_b32 s50, s2, 8
    v_mfma_f32_16x16x32_bf16 v[44:47], v[116:119], v[68:71], 0
    s_add_u32 s51, s50, 0x20000
    v_mfma_f32_16x16x32_bf16 v[48:51], v[120:123], v[64:67], 0
    ds_read_b128 v[108:111], v13 offset:6592
    v_mov_b32 v7, s51
    v_mfma_f32_16x16x32_bf16 v[52:55], v[120:123], v[68:71], 0
    ds_read_b128 v[184:187], v14 offset:1152
    s_add_u32 s51, s50, 0x10000
    v_mfma_f32_16x16x32_bf16 v[56:59], v[124:127], v[64:67], 0
    ds_read_b128 v[188:191], v14 offset:128
    v_writelane_b32 v7, s51, 1
    v_mfma_f32_16x16x32_bf16 v[60:63], v[124:127], v[68:71], 0
    s_lshr_b32 s51, s2, 3
    s_waitcnt lgkmcnt(6)
    v_mfma_f32_16x16x32_bf16 v[32:35], v[128:131], v[80:83], v[32:35]
    ds_read_b128 v[64:67], v13 offset:128
    s_sub_u32 s51, s51, 4
    v_mfma_f32_16x16x32_bf16 v[36:39], v[128:131], v[84:87], v[36:39]
    ds_read_b128 v[68:71], v13 offset:4608
    s_and_b32 s50, s51, 3
    s_and_b32 s3, s2, 7
    v_mfma_f32_16x16x32_bf16 v[40:43], v[132:135], v[80:83], v[40:43]
    s_lshl_b32 s3, s3, 2
    v_mfma_f32_16x16x32_bf16 v[44:47], v[132:135], v[84:87], v[44:47]
    ds_read_b128 v[176:179], v14 offset:3200
    s_add_u32 s50, s50, s3
    v_mfma_f32_16x16x32_bf16 v[48:51], v[136:139], v[80:83], v[48:51]
    s_lshl_b32 s50, s50, 3
    v_mfma_f32_16x16x32_bf16 v[52:55], v[136:139], v[84:87], v[52:55]
    ds_read_b128 v[180:183], v14 offset:2176
    s_lshr_b32 s51, s51, 2
    v_mfma_f32_16x16x32_bf16 v[56:59], v[140:143], v[80:83], v[56:59]
    ds_read_b128 v[72:75], v13 offset:3200
    s_and_b32 s51, s51, 7
    v_mfma_f32_16x16x32_bf16 v[60:63], v[140:143], v[84:87], v[60:63]
    s_add_u32 s50, s50, s51
    v_mfma_f32_16x16x32_bf16 v[56:59], v[128:131], v[88:91], v[56:59]
    ds_read_b128 v[76:79], v13 offset:7680
    s_lshl_b32 s50, s50, 8
    v_mfma_f32_16x16x32_bf16 v[60:63], v[128:131], v[92:95], v[60:63]
    v_writelane_b32 v7, s50, 0
    s_waitcnt lgkmcnt(8)
    v_mfma_f32_16x16x32_bf16 v[40:43], v[128:131], v[96:99], v[40:43]
    ds_read_b128 v[80:83], v13 offset:1152
    s_and_b32 s46, s2, 7
    s_lshr_b32 s47, s2, 3
    s_lshr_b32 s66, s46, 2
    v_mfma_f32_16x16x32_bf16 v[44:47], v[128:131], v[100:103], v[44:47]
    ds_read_b128 v[84:87], v13 offset:5632
    s_and_b32 s48, s46, 1
    s_lshl_b32 s48, s48, 3
    s_and_b32 s51, s47, 7
    v_mfma_f32_16x16x32_bf16 v[48:51], v[132:135], v[96:99], v[48:51]
    s_add_u32 s48, s48, s51
    s_and_b32 s49, s46, 2
    s_lshl_b32 s49, s49, 1
    v_mfma_f32_16x16x32_bf16 v[52:55], v[132:135], v[100:103], v[52:55]
    ds_read_b128 v[88:91], v13 offset:2176
    s_lshr_b32 s50, s47, 3
    s_add_u32 s49, s49, s50
    v_mfma_f32_16x16x32_bf16 v[56:59], v[136:139], v[96:99], v[56:59]
    v_lshlrev_b32 v2, 4, v0
    v_lshrrev_b32 v3, 4, v0
    s_and_b32 s64, s40, 1
    v_mfma_f32_16x16x32_bf16 v[60:63], v[136:139], v[100:103], v[60:63]
    ds_read_b128 v[92:95], v13 offset:6656
    s_lshr_b32 s65, s40, 1
    s_mul_i32 s52, s66, 56
    s_mul_i32 s53, s65, 28
    v_mfma_f32_16x16x32_bf16 v[48:51], v[128:131], v[104:107], v[48:51]
    ds_read_b128 v[120:123], v14 offset:1216
    s_add_u32 s52, s52, s53
    s_mul_i32 s53, s48, 112
    v_mfma_f32_16x16x32_bf16 v[52:55], v[128:131], v[108:111], v[52:55]
    s_add_u32 s53, s53, s52
    s_add_u32 s50, s50, s51
    s_add_u32 s41, s50, 0
    v_mfma_f32_16x16x32_bf16 v[56:59], v[132:135], v[104:107], v[56:59]
    ds_read_b128 v[124:127], v14 offset:192
    s_and_b32 s41, s41, 3
    s_add_u32 s41, s41, s53
    s_lshl_b32 s41, s41, 13
    v_mfma_f32_16x16x32_bf16 v[60:63], v[132:135], v[108:111], v[60:63]
    s_add_u32 s42, s50, 1
    s_and_b32 s42, s42, 3
    s_waitcnt lgkmcnt(6)
    v_mfma_f32_16x16x32_bf16 v[32:35], v[176:179], v[64:67], v[32:35]
    ds_read_b128 v[96:99], v13 offset:192
    s_add_u32 s42, s42, s53
    s_lshl_b32 s42, s42, 13
    s_add_u32 s43, s50, 2
    v_mfma_f32_16x16x32_bf16 v[36:39], v[176:179], v[68:71], v[36:39]
    ds_read_b128 v[100:103], v13 offset:4672
    s_and_b32 s43, s43, 3
    s_add_u32 s43, s43, s53
    s_lshl_b32 s43, s43, 13
    v_mfma_f32_16x16x32_bf16 v[40:43], v[180:183], v[64:67], v[40:43]
    s_add_u32 s71, s50, 3
    s_and_b32 s71, s71, 3
    s_add_u32 s71, s71, s53
    v_mfma_f32_16x16x32_bf16 v[44:47], v[180:183], v[68:71], v[44:47]
    ds_read_b128 v[112:115], v14 offset:3264
    s_lshl_b32 s71, s71, 13
    s_mul_i32 s67, s65, 98304
    v_mfma_f32_16x16x32_bf16 v[48:51], v[184:187], v[64:67], v[48:51]
    s_lshl_b32 s50, s64, 12
    s_lshl_b32 s51, s65, 11
    s_add_u32 s51, s51, s50
    v_mfma_f32_16x16x32_bf16 v[52:55], v[184:187], v[68:71], v[52:55]
    ds_read_b128 v[116:119], v14 offset:2240
    v_add_u32 v16, s51, v2
    v_xor_b32 v17, 0x800, v16
    s_lshl_b32 s50, s66, 1
    v_mfma_f32_16x16x32_bf16 v[56:59], v[188:191], v[64:67], v[56:59]
    ds_read_b128 v[104:107], v13 offset:3264
    s_add_u32 s50, s50, s65
    s_lshl_b32 s50, s50, 3
    v_mfma_f32_16x16x32_bf16 v[60:63], v[188:191], v[68:71], v[60:63]
    s_lshr_b32 s51, s48, 1
    s_add_u32 s50, s50, s51
    s_lshl_b32 s50, s50, 11
    v_mfma_f32_16x16x32_bf16 v[56:59], v[176:179], v[72:75], v[56:59]
    ds_read_b128 v[108:111], v13 offset:7744
    v_and_b32 v4, 7, v0
    v_lshlrev_b32 v4, 8, v4
    v_add_u32 v4, s50, v4
    v_mfma_f32_16x16x32_bf16 v[60:63], v[176:179], v[76:79], v[60:63]
    s_lshl_b32 s49, s49, 7
    s_lshl_b32 s48, s48, 7
    s_waitcnt lgkmcnt(8)
    v_mfma_f32_16x16x32_bf16 v[40:43], v[176:179], v[80:83], v[40:43]
    ds_read_b128 v[64:67], v13 offset:1216
    s_lshl_b32 s50, s64, 6
    v_mfma_f32_16x16x32_bf16 v[44:47], v[176:179], v[84:87], v[44:47]
    ds_read_b128 v[68:71], v13 offset:5696
    s_add_u32 s44, s48, s50
    v_mfma_f32_16x16x32_bf16 v[48:51], v[180:183], v[80:83], v[48:51]
    s_lshl_b32 s50, s65, 5
    v_mfma_f32_16x16x32_bf16 v[52:55], v[180:183], v[84:87], v[52:55]
    ds_read_b128 v[72:75], v13 offset:2240
    s_add_u32 s44, s44, s50
    v_mfma_f32_16x16x32_bf16 v[56:59], v[184:187], v[80:83], v[56:59]
    s_lshl_b32 s50, s66, 6
    v_mfma_f32_16x16x32_bf16 v[60:63], v[184:187], v[84:87], v[60:63]
    ds_read_b128 v[76:79], v13 offset:6720
    s_add_u32 s45, s49, s50
    v_mfma_f32_16x16x32_bf16 v[48:51], v[176:179], v[88:91], v[48:51]
    ds_read_b128 v[136:139], v15 offset:1280
    s_mov_b32 s20, s68
    v_mfma_f32_16x16x32_bf16 v[52:55], v[176:179], v[92:95], v[52:55]
    s_mov_b32 s21, s69
    v_mfma_f32_16x16x32_bf16 v[56:59], v[180:183], v[88:91], v[56:59]
    ds_read_b128 v[140:143], v15 offset:256
    s_mov_b32 s22, 0x400000
    v_mfma_f32_16x16x32_bf16 v[60:63], v[180:183], v[92:95], v[60:63]
    s_waitcnt lgkmcnt(6)
    v_mfma_f32_16x16x32_bf16 v[32:35], v[112:115], v[96:99], v[32:35]
    ds_read_b128 v[80:83], v13 offset:256
    s_mov_b32 s23, 0x00020000
    v_mfma_f32_16x16x32_bf16 v[36:39], v[112:115], v[100:103], v[36:39]
    ds_read_b128 v[84:87], v13 offset:4736
    s_add_u32 s36, s72, 0x2400000
    s_addc_u32 s37, s73, 0
    v_mfma_f32_16x16x32_bf16 v[40:43], v[116:119], v[96:99], v[40:43]
    s_mov_b32 s38, 0x800000
    v_mfma_f32_16x16x32_bf16 v[44:47], v[116:119], v[100:103], v[44:47]
    ds_read_b128 v[128:131], v15 offset:3328
    s_mov_b32 s39, 0x00020000
    v_mfma_f32_16x16x32_bf16 v[48:51], v[120:123], v[96:99], v[48:51]
    s_lshl_b32 s50, s2, 2
    v_mfma_f32_16x16x32_bf16 v[52:55], v[120:123], v[100:103], v[52:55]
    ds_read_b128 v[132:135], v15 offset:2304
    s_add_u32 s50, s50, s40
    v_mfma_f32_16x16x32_bf16 v[56:59], v[124:127], v[96:99], v[56:59]
    ds_read_b128 v[88:91], v13 offset:3328
    s_lshl_b32 s68, s50, 13
    v_mfma_f32_16x16x32_bf16 v[60:63], v[124:127], v[100:103], v[60:63]
    v_and_b32 v11, 1, v0
    v_mfma_f32_16x16x32_bf16 v[56:59], v[112:115], v[104:107], v[56:59]
    ds_read_b128 v[92:95], v13 offset:7808
    v_lshlrev_b32 v11, 17, v11
    v_mfma_f32_16x16x32_bf16 v[60:63], v[112:115], v[108:111], v[60:63]
    s_waitcnt vmcnt(0)
    s_barrier
    s_waitcnt lgkmcnt(8)
    v_mfma_f32_16x16x32_bf16 v[40:43], v[112:115], v[64:67], v[40:43]
    ds_read_b128 v[96:99], v13 offset:1280
    v_xor_b32 v11, s68, v11
    s_cmp_lg_u32 s40, 0
    s_cbranch_scc1 CV_HF
    v_mov_b32 v159, 1
    s_mov_b64 exec, 1
     buffer_store_dword v159, v7, s[32:35], 0 offen sc1
    s_mov_b64 exec, -1
CV_HF:
    v_mfma_f32_16x16x32_bf16 v[44:47], v[112:115], v[68:71], v[44:47]
    ds_read_b128 v[100:103], v13 offset:5760
    buffer_load_dwordx2 v[26:27], v11, s[36:39], 0 offen sc1
    v_mfma_f32_16x16x32_bf16 v[48:51], v[116:119], v[64:67], v[48:51]
    s_mov_b32 s4, s74
    v_mfma_f32_16x16x32_bf16 v[52:55], v[116:119], v[68:71], v[52:55]
    ds_read_b128 v[104:107], v13 offset:2304
    s_mov_b32 s5, s75
    v_mfma_f32_16x16x32_bf16 v[56:59], v[120:123], v[64:67], v[56:59]
    s_mov_b32 s6, 0x400000
    v_mfma_f32_16x16x32_bf16 v[60:63], v[120:123], v[68:71], v[60:63]
    ds_read_b128 v[108:111], v13 offset:6784
    s_mov_b32 s7, 0x00020000
    v_mfma_f32_16x16x32_bf16 v[48:51], v[112:115], v[72:75], v[48:51]
    ds_read_b128 v[184:187], v15 offset:1344
    v_and_b32 v8, 31, v0
    v_mfma_f32_16x16x32_bf16 v[52:55], v[112:115], v[76:79], v[52:55]
    v_add_lshl_u32 v8, v8, s44, 11
    v_mfma_f32_16x16x32_bf16 v[56:59], v[116:119], v[72:75], v[56:59]
    ds_read_b128 v[188:191], v15 offset:320
    s_lshl_b32 s50, s45, 1
    v_mfma_f32_16x16x32_bf16 v[60:63], v[116:119], v[76:79], v[60:63]
    s_waitcnt lgkmcnt(6)
    v_mfma_f32_16x16x32_bf16 v[32:35], v[128:131], v[80:83], v[32:35]
    ds_read_b128 v[64:67], v13 offset:320
    buffer_load_dword v25, v8, s[4:7], s50 offen
    v_mfma_f32_16x16x32_bf16 v[36:39], v[128:131], v[84:87], v[36:39]
    ds_read_b128 v[68:71], v13 offset:4800
    s_add_u32 s16, s72, 0x0
    s_addc_u32 s17, s73, 0
    v_mfma_f32_16x16x32_bf16 v[40:43], v[132:135], v[80:83], v[40:43]
    s_mov_b32 s18, 0xe00000
    v_mfma_f32_16x16x32_bf16 v[44:47], v[132:135], v[84:87], v[44:47]
    ds_read_b128 v[176:179], v15 offset:3392
    s_mov_b32 s19, 0x00020000
    v_mfma_f32_16x16x32_bf16 v[48:51], v[136:139], v[80:83], v[48:51]
    v_lshrrev_b32 v8, 2, v0
    v_mfma_f32_16x16x32_bf16 v[52:55], v[136:139], v[84:87], v[52:55]
    ds_read_b128 v[180:183], v15 offset:2368
    v_and_b32 v8, 3, v8
    v_mfma_f32_16x16x32_bf16 v[56:59], v[140:143], v[80:83], v[56:59]
    ds_read_b128 v[72:75], v13 offset:3392
    v_lshlrev_b32 v9, 7, v8
    v_mfma_f32_16x16x32_bf16 v[60:63], v[140:143], v[84:87], v[60:63]
    v_lshrrev_b32 v10, 1, v3
    v_mfma_f32_16x16x32_bf16 v[56:59], v[128:131], v[88:91], v[56:59]
    ds_read_b128 v[76:79], v13 offset:7872
    v_lshlrev_b32 v10, 12, v10
    v_mfma_f32_16x16x32_bf16 v[60:63], v[128:131], v[92:95], v[60:63]
    s_waitcnt lgkmcnt(8)
    v_mfma_f32_16x16x32_bf16 v[40:43], v[128:131], v[96:99], v[40:43]
    ds_read_b128 v[80:83], v13 offset:1344
    v_add_u32 v9, v9, v10
    v_mfma_f32_16x16x32_bf16 v[44:47], v[128:131], v[100:103], v[44:47]
    ds_read_b128 v[84:87], v13 offset:5824
    v_and_b32 v11, 1, v3
    v_mfma_f32_16x16x32_bf16 v[48:51], v[132:135], v[96:99], v[48:51]
    v_lshlrev_b32 v10, 10, v11
    v_mfma_f32_16x16x32_bf16 v[52:55], v[132:135], v[100:103], v[52:55]
    ds_read_b128 v[88:91], v13 offset:2368
    v_add_u32 v9, v9, v10
    v_mfma_f32_16x16x32_bf16 v[56:59], v[136:139], v[96:99], v[56:59]
    v_and_b32 v10, 3, v0
    v_mfma_f32_16x16x32_bf16 v[60:63], v[136:139], v[100:103], v[60:63]
    ds_read_b128 v[92:95], v13 offset:6848
    v_lshlrev_b32 v10, 3, v10
    v_mfma_f32_16x16x32_bf16 v[48:51], v[128:131], v[104:107], v[48:51]
    ds_read_b128 v[120:123], v15 offset:1408
    v_add3_u32 v9, v9, v10, s67
    v_mfma_f32_16x16x32_bf16 v[52:55], v[128:131], v[108:111], v[52:55]
    v_lshrrev_b32 v10, 1, v8
    v_mfma_f32_16x16x32_bf16 v[56:59], v[132:135], v[104:107], v[56:59]
    ds_read_b128 v[124:127], v15 offset:384
    v_lshlrev_b32 v11, 1, v11
    v_mfma_f32_16x16x32_bf16 v[60:63], v[132:135], v[108:111], v[60:63]
    s_waitcnt lgkmcnt(6)
    v_mfma_f32_16x16x32_bf16 v[32:35], v[176:179], v[64:67], v[32:35]
    ds_read_b128 v[96:99], v13 offset:384
    v_or_b32 v10, v10, v11
    v_mfma_f32_16x16x32_bf16 v[36:39], v[176:179], v[68:71], v[36:39]
    ds_read_b128 v[100:103], v13 offset:4864
    v_lshl_add_u32 v20, v10, 5, v9
    v_mfma_f32_16x16x32_bf16 v[40:43], v[180:183], v[64:67], v[40:43]
    v_xor_b32 v21, 32, v20
    v_mfma_f32_16x16x32_bf16 v[44:47], v[180:183], v[68:71], v[44:47]
    ds_read_b128 v[112:115], v15 offset:3456
    v_xor_b32 v22, 64, v20
    v_mfma_f32_16x16x32_bf16 v[48:51], v[184:187], v[64:67], v[48:51]
    v_xor_b32 v23, 96, v20
    v_mfma_f32_16x16x32_bf16 v[52:55], v[184:187], v[68:71], v[52:55]
    ds_read_b128 v[116:119], v15 offset:2432
    v_add_u32 v18, s31, v2
    v_mfma_f32_16x16x32_bf16 v[56:59], v[188:191], v[64:67], v[56:59]
    ds_read_b128 v[104:107], v13 offset:3456
    s_mov_b32 s46, 0
    v_mfma_f32_16x16x32_bf16 v[60:63], v[188:191], v[68:71], v[60:63]
    s_mov_b32 s47, 0
    v_mfma_f32_16x16x32_bf16 v[56:59], v[176:179], v[72:75], v[56:59]
    ds_read_b128 v[108:111], v13 offset:7936
    s_mov_b32 s59, 0x8000
    v_mfma_f32_16x16x32_bf16 v[60:63], v[176:179], v[76:79], v[60:63]
    s_waitcnt lgkmcnt(8)
    v_mfma_f32_16x16x32_bf16 v[40:43], v[176:179], v[80:83], v[40:43]
    ds_read_b128 v[64:67], v13 offset:1408
    s_mul_i32 s62, s60, 4096
    v_mfma_f32_16x16x32_bf16 v[44:47], v[176:179], v[84:87], v[44:47]
    ds_read_b128 v[68:71], v13 offset:5888
    v_mfma_f32_16x16x32_bf16 v[48:51], v[180:183], v[80:83], v[48:51]
    v_mfma_f32_16x16x32_bf16 v[52:55], v[180:183], v[84:87], v[52:55]
    ds_read_b128 v[72:75], v13 offset:2432
    v_mfma_f32_16x16x32_bf16 v[56:59], v[184:187], v[80:83], v[56:59]
    v_mfma_f32_16x16x32_bf16 v[60:63], v[184:187], v[84:87], v[60:63]
    ds_read_b128 v[76:79], v13 offset:6912
    v_mfma_f32_16x16x32_bf16 v[48:51], v[176:179], v[88:91], v[48:51]
    ds_read_b128 v[136:139], v15 offset:1472
    v_mfma_f32_16x16x32_bf16 v[52:55], v[176:179], v[92:95], v[52:55]
    v_mfma_f32_16x16x32_bf16 v[56:59], v[180:183], v[88:91], v[56:59]
    ds_read_b128 v[140:143], v15 offset:448
    v_mfma_f32_16x16x32_bf16 v[60:63], v[180:183], v[92:95], v[60:63]
    s_waitcnt lgkmcnt(6)
    v_mfma_f32_16x16x32_bf16 v[32:35], v[112:115], v[96:99], v[32:35]
    ds_read_b128 v[80:83], v13 offset:448
    v_mfma_f32_16x16x32_bf16 v[36:39], v[112:115], v[100:103], v[36:39]
    ds_read_b128 v[84:87], v13 offset:4928
    v_mfma_f32_16x16x32_bf16 v[40:43], v[116:119], v[96:99], v[40:43]
    v_mfma_f32_16x16x32_bf16 v[44:47], v[116:119], v[100:103], v[44:47]
    ds_read_b128 v[128:131], v15 offset:3520
    v_mfma_f32_16x16x32_bf16 v[48:51], v[120:123], v[96:99], v[48:51]
    v_mfma_f32_16x16x32_bf16 v[52:55], v[120:123], v[100:103], v[52:55]
    ds_read_b128 v[132:135], v15 offset:2496
    v_mfma_f32_16x16x32_bf16 v[56:59], v[124:127], v[96:99], v[56:59]
    ds_read_b128 v[88:91], v13 offset:3520
    v_mfma_f32_16x16x32_bf16 v[60:63], v[124:127], v[100:103], v[60:63]
    v_mfma_f32_16x16x32_bf16 v[56:59], v[112:115], v[104:107], v[56:59]
    ds_read_b128 v[92:95], v13 offset:8000
    v_mfma_f32_16x16x32_bf16 v[60:63], v[112:115], v[108:111], v[60:63]
    s_waitcnt lgkmcnt(8)
    v_mfma_f32_16x16x32_bf16 v[40:43], v[112:115], v[64:67], v[40:43]
    ds_read_b128 v[96:99], v13 offset:1472
    v_mfma_f32_16x16x32_bf16 v[44:47], v[112:115], v[68:71], v[44:47]
    ds_read_b128 v[100:103], v13 offset:5952
    v_mfma_f32_16x16x32_bf16 v[48:51], v[116:119], v[64:67], v[48:51]
    v_mfma_f32_16x16x32_bf16 v[52:55], v[116:119], v[68:71], v[52:55]
IW_P7:
    s_cbranch_execz IW_P11
    ds_read_b128 v[104:107], v13 offset:2496
    v_mfma_f32_16x16x32_bf16 v[56:59], v[120:123], v[64:67], v[56:59]
    v_mfma_f32_16x16x32_bf16 v[60:63], v[120:123], v[68:71], v[60:63]
    ds_read_b128 v[108:111], v13 offset:6976
    v_mfma_f32_16x16x32_bf16 v[48:51], v[112:115], v[72:75], v[48:51]
    ds_read_b128 v[184:187], v14 offset:1536
    v_mfma_f32_16x16x32_bf16 v[52:55], v[112:115], v[76:79], v[52:55]
    v_mfma_f32_16x16x32_bf16 v[56:59], v[116:119], v[72:75], v[56:59]
    ds_read_b128 v[188:191], v14 offset:512
    v_mfma_f32_16x16x32_bf16 v[60:63], v[116:119], v[76:79], v[60:63]
    s_waitcnt lgkmcnt(6)
    v_mfma_f32_16x16x32_bf16 v[32:35], v[128:131], v[80:83], v[32:35]
    ds_read_b128 v[64:67], v13 offset:512
    v_mfma_f32_16x16x32_bf16 v[36:39], v[128:131], v[84:87], v[36:39]
    ds_read_b128 v[68:71], v13 offset:4992
    v_mfma_f32_16x16x32_bf16 v[40:43], v[132:135], v[80:83], v[40:43]
    v_mfma_f32_16x16x32_bf16 v[44:47], v[132:135], v[84:87], v[44:47]
    ds_read_b128 v[176:179], v14 offset:3584
    v_mfma_f32_16x16x32_bf16 v[48:51], v[136:139], v[80:83], v[48:51]
    v_mfma_f32_16x16x32_bf16 v[52:55], v[136:139], v[84:87], v[52:55]
    ds_read_b128 v[180:183], v14 offset:2560
    v_mfma_f32_16x16x32_bf16 v[56:59], v[140:143], v[80:83], v[56:59]
    ds_read_b128 v[72:75], v13 offset:3584
    v_mfma_f32_16x16x32_bf16 v[60:63], v[140:143], v[84:87], v[60:63]
    v_mfma_f32_16x16x32_bf16 v[56:59], v[128:131], v[88:91], v[56:59]
    ds_read_b128 v[76:79], v13 offset:8064
    v_mfma_f32_16x16x32_bf16 v[60:63], v[128:131], v[92:95], v[60:63]
    buffer_load_dword v157, v4, s[32:35], 0 offen sc1
    s_waitcnt lgkmcnt(8)
    v_mfma_f32_16x16x32_bf16 v[40:43], v[128:131], v[96:99], v[40:43]
    ds_read_b128 v[80:83], v13 offset:1536
    v_mfma_f32_16x16x32_bf16 v[44:47], v[128:131], v[100:103], v[44:47]
    ds_read_b128 v[84:87], v13 offset:6016
    v_mfma_f32_16x16x32_bf16 v[48:51], v[132:135], v[96:99], v[48:51]
    v_mfma_f32_16x16x32_bf16 v[52:55], v[132:135], v[100:103], v[52:55]
    ds_read_b128 v[88:91], v13 offset:2560
    v_mfma_f32_16x16x32_bf16 v[56:59], v[136:139], v[96:99], v[56:59]
    v_mfma_f32_16x16x32_bf16 v[60:63], v[136:139], v[100:103], v[60:63]
    ds_read_b128 v[92:95], v13 offset:7040
    v_mfma_f32_16x16x32_bf16 v[48:51], v[128:131], v[104:107], v[48:51]
    ds_read_b128 v[120:123], v14 offset:1600
    v_mfma_f32_16x16x32_bf16 v[52:55], v[128:131], v[108:111], v[52:55]
    v_mfma_f32_16x16x32_bf16 v[56:59], v[132:135], v[104:107], v[56:59]
    ds_read_b128 v[124:127], v14 offset:576
    v_mfma_f32_16x16x32_bf16 v[60:63], v[132:135], v[108:111], v[60:63]
    s_waitcnt lgkmcnt(6)
    v_mfma_f32_16x16x32_bf16 v[32:35], v[176:179], v[64:67], v[32:35]
    ds_read_b128 v[96:99], v13 offset:576
    v_mfma_f32_16x16x32_bf16 v[36:39], v[176:179], v[68:71], v[36:39]
    ds_read_b128 v[100:103], v13 offset:5056
    v_mfma_f32_16x16x32_bf16 v[40:43], v[180:183], v[64:67], v[40:43]
    v_mfma_f32_16x16x32_bf16 v[44:47], v[180:183], v[68:71], v[44:47]
    ds_read_b128 v[112:115], v14 offset:3648
    v_mfma_f32_16x16x32_bf16 v[48:51], v[184:187], v[64:67], v[48:51]
    v_mfma_f32_16x16x32_bf16 v[52:55], v[184:187], v[68:71], v[52:55]
    ds_read_b128 v[116:119], v14 offset:2624
    v_mfma_f32_16x16x32_bf16 v[56:59], v[188:191], v[64:67], v[56:59]
    ds_read_b128 v[104:107], v13 offset:3648
    v_mfma_f32_16x16x32_bf16 v[60:63], v[188:191], v[68:71], v[60:63]
    v_mfma_f32_16x16x32_bf16 v[56:59], v[176:179], v[72:75], v[56:59]
    ds_read_b128 v[108:111], v13 offset:8128
    v_mfma_f32_16x16x32_bf16 v[60:63], v[176:179], v[76:79], v[60:63]
    buffer_load_dword v158, v4, s[32:35], 0 offen sc1
    s_waitcnt lgkmcnt(8)
    v_mfma_f32_16x16x32_bf16 v[40:43], v[176:179], v[80:83], v[40:43]
    ds_read_b128 v[64:67], v13 offset:1600
    v_mfma_f32_16x16x32_bf16 v[44:47], v[176:179], v[84:87], v[44:47]
    ds_read_b128 v[68:71], v13 offset:6080
    v_mfma_f32_16x16x32_bf16 v[48:51], v[180:183], v[80:83], v[48:51]
    v_mfma_f32_16x16x32_bf16 v[52:55], v[180:183], v[84:87], v[52:55]
    ds_read_b128 v[72:75], v13 offset:2624
    v_mfma_f32_16x16x32_bf16 v[56:59], v[184:187], v[80:83], v[56:59]
    v_mfma_f32_16x16x32_bf16 v[60:63], v[184:187], v[84:87], v[60:63]
    ds_read_b128 v[76:79], v13 offset:7104
    v_mfma_f32_16x16x32_bf16 v[48:51], v[176:179], v[88:91], v[48:51]
    ds_read_b128 v[136:139], v14 offset:1664
    v_mfma_f32_16x16x32_bf16 v[52:55], v[176:179], v[92:95], v[52:55]
    v_mfma_f32_16x16x32_bf16 v[56:59], v[180:183], v[88:91], v[56:59]
    ds_read_b128 v[140:143], v14 offset:640
    v_mfma_f32_16x16x32_bf16 v[60:63], v[180:183], v[92:95], v[60:63]
    s_waitcnt lgkmcnt(6)
    v_mfma_f32_16x16x32_bf16 v[32:35], v[112:115], v[96:99], v[32:35]
    ds_read_b128 v[80:83], v13 offset:640
    v_mfma_f32_16x16x32_bf16 v[36:39], v[112:115], v[100:103], v[36:39]
    ds_read_b128 v[84:87], v13 offset:5120
    v_mfma_f32_16x16x32_bf16 v[40:43], v[116:119], v[96:99], v[40:43]
    v_mfma_f32_16x16x32_bf16 v[44:47], v[116:119], v[100:103], v[44:47]
    ds_read_b128 v[128:131], v14 offset:3712
    v_mfma_f32_16x16x32_bf16 v[48:51], v[120:123], v[96:99], v[48:51]
    v_mfma_f32_16x16x32_bf16 v[52:55], v[120:123], v[100:103], v[52:55]
    ds_read_b128 v[132:135], v14 offset:2688
    v_mfma_f32_16x16x32_bf16 v[56:59], v[124:127], v[96:99], v[56:59]
    ds_read_b128 v[88:91], v13 offset:3712
    v_mfma_f32_16x16x32_bf16 v[60:63], v[124:127], v[100:103], v[60:63]
    v_mfma_f32_16x16x32_bf16 v[56:59], v[112:115], v[104:107], v[56:59]
    ds_read_b128 v[92:95], v13 offset:8192
    v_mfma_f32_16x16x32_bf16 v[60:63], v[112:115], v[108:111], v[60:63]
    buffer_load_dword v156, v4, s[32:35], 0 offen sc1
    s_waitcnt lgkmcnt(8)
    v_mfma_f32_16x16x32_bf16 v[40:43], v[112:115], v[64:67], v[40:43]
    ds_read_b128 v[96:99], v13 offset:1664
    v_mfma_f32_16x16x32_bf16 v[44:47], v[112:115], v[68:71], v[44:47]
    ds_read_b128 v[100:103], v13 offset:6144
    v_mfma_f32_16x16x32_bf16 v[48:51], v[116:119], v[64:67], v[48:51]
    v_mfma_f32_16x16x32_bf16 v[52:55], v[116:119], v[68:71], v[52:55]
    ds_read_b128 v[104:107], v13 offset:2688
    v_mfma_f32_16x16x32_bf16 v[56:59], v[120:123], v[64:67], v[56:59]
    v_mfma_f32_16x16x32_bf16 v[60:63], v[120:123], v[68:71], v[60:63]
    ds_read_b128 v[108:111], v13 offset:7168
    v_mfma_f32_16x16x32_bf16 v[48:51], v[112:115], v[72:75], v[48:51]
    ds_read_b128 v[184:187], v14 offset:1728
    v_mfma_f32_16x16x32_bf16 v[52:55], v[112:115], v[76:79], v[52:55]
    v_mfma_f32_16x16x32_bf16 v[56:59], v[116:119], v[72:75], v[56:59]
    ds_read_b128 v[188:191], v14 offset:704
    v_mfma_f32_16x16x32_bf16 v[60:63], v[116:119], v[76:79], v[60:63]
    s_waitcnt lgkmcnt(6)
    v_mfma_f32_16x16x32_bf16 v[32:35], v[128:131], v[80:83], v[32:35]
    ds_read_b128 v[64:67], v13 offset:704
    v_mfma_f32_16x16x32_bf16 v[36:39], v[128:131], v[84:87], v[36:39]
    ds_read_b128 v[68:71], v13 offset:5184
    v_mfma_f32_16x16x32_bf16 v[40:43], v[132:135], v[80:83], v[40:43]
    v_mfma_f32_16x16x32_bf16 v[44:47], v[132:135], v[84:87], v[44:47]
    ds_read_b128 v[176:179], v14 offset:3776
    v_mfma_f32_16x16x32_bf16 v[48:51], v[136:139], v[80:83], v[48:51]
    v_mfma_f32_16x16x32_bf16 v[52:55], v[136:139], v[84:87], v[52:55]
    ds_read_b128 v[180:183], v14 offset:2752
    v_mfma_f32_16x16x32_bf16 v[56:59], v[140:143], v[80:83], v[56:59]
    ds_read_b128 v[72:75], v13 offset:3776
    v_mfma_f32_16x16x32_bf16 v[60:63], v[140:143], v[84:87], v[60:63]
    v_mfma_f32_16x16x32_bf16 v[56:59], v[128:131], v[88:91], v[56:59]
    ds_read_b128 v[76:79], v13 offset:8256
    v_mfma_f32_16x16x32_bf16 v[60:63], v[128:131], v[92:95], v[60:63]
    s_waitcnt lgkmcnt(8)
    v_mfma_f32_16x16x32_bf16 v[40:43], v[128:131], v[96:99], v[40:43]
    ds_read_b128 v[80:83], v13 offset:1728
    v_mfma_f32_16x16x32_bf16 v[44:47], v[128:131], v[100:103], v[44:47]
    ds_read_b128 v[84:87], v13 offset:6208
    v_mfma_f32_16x16x32_bf16 v[48:51], v[132:135], v[96:99], v[48:51]
    v_mfma_f32_16x16x32_bf16 v[52:55], v[132:135], v[100:103], v[52:55]
    ds_read_b128 v[88:91], v13 offset:2752
    v_mfma_f32_16x16x32_bf16 v[56:59], v[136:139], v[96:99], v[56:59]
    v_mfma_f32_16x16x32_bf16 v[60:63], v[136:139], v[100:103], v[60:63]
    ds_read_b128 v[92:95], v13 offset:7232
    v_mfma_f32_16x16x32_bf16 v[48:51], v[128:131], v[104:107], v[48:51]
    ds_read_b128 v[120:123], v15 offset:1792
    v_mfma_f32_16x16x32_bf16 v[52:55], v[128:131], v[108:111], v[52:55]
    v_mfma_f32_16x16x32_bf16 v[56:59], v[132:135], v[104:107], v[56:59]
    ds_read_b128 v[124:127], v15 offset:768
    v_mfma_f32_16x16x32_bf16 v[60:63], v[132:135], v[108:111], v[60:63]
    s_waitcnt vmcnt(2)
    v_cmp_ne_u32 vcc, 0, v157
    s_nop 0
    s_or_b32 s47, s47, vcc_lo
    s_and_b32 s63, s47, 3
    s_cmp_eq_u32 s63, 3
    s_cbranch_scc0 CV_S3
CV_F3:
    s_mov_b32 s46, 2
    s_waitcnt lgkmcnt(6)
    v_mfma_f32_16x16x32_bf16 v[32:35], v[176:179], v[64:67], v[32:35]
    ds_read_b128 v[96:99], v13 offset:768
    buffer_load_dwordx4 a[64:67], v16, s[16:19], s41 offen offset:0 sc1
    v_mfma_f32_16x16x32_bf16 v[36:39], v[176:179], v[68:71], v[36:39]
    ds_read_b128 v[100:103], v13 offset:5248
    v_mfma_f32_16x16x32_bf16 v[40:43], v[180:183], v[64:67], v[40:43]
    v_mfma_f32_16x16x32_bf16 v[44:47], v[180:183], v[68:71], v[44:47]
    ds_read_b128 v[112:115], v15 offset:3840
    buffer_load_dwordx4 a[68:71], v16, s[16:19], s41 offen offset:1024 sc1
    v_mfma_f32_16x16x32_bf16 v[48:51], v[184:187], v[64:67], v[48:51]
    v_mfma_f32_16x16x32_bf16 v[52:55], v[184:187], v[68:71], v[52:55]
    ds_read_b128 v[116:119], v15 offset:2816
    v_mfma_f32_16x16x32_bf16 v[56:59], v[188:191], v[64:67], v[56:59]
    ds_read_b128 v[104:107], v13 offset:3840
    v_mfma_f32_16x16x32_bf16 v[60:63], v[188:191], v[68:71], v[60:63]
    buffer_load_dwordx4 a[192:195], v17, s[16:19], s41 offen offset:0 sc1
    v_mfma_f32_16x16x32_bf16 v[56:59], v[176:179], v[72:75], v[56:59]
    ds_read_b128 v[108:111], v13 offset:8320
    v_mfma_f32_16x16x32_bf16 v[60:63], v[176:179], v[76:79], v[60:63]
    s_waitcnt lgkmcnt(8)
    v_mfma_f32_16x16x32_bf16 v[40:43], v[176:179], v[80:83], v[40:43]
    ds_read_b128 v[64:67], v13 offset:1792
    v_mfma_f32_16x16x32_bf16 v[44:47], v[176:179], v[84:87], v[44:47]
    ds_read_b128 v[68:71], v13 offset:6272
    buffer_load_dwordx4 a[196:199], v17, s[16:19], s41 offen offset:1024 sc1
    s_add_u32 s41, s41, 0x8000
    v_mfma_f32_16x16x32_bf16 v[48:51], v[180:183], v[80:83], v[48:51]
    v_mfma_f32_16x16x32_bf16 v[52:55], v[180:183], v[84:87], v[52:55]
    ds_read_b128 v[72:75], v13 offset:2816
    v_mfma_f32_16x16x32_bf16 v[56:59], v[184:187], v[80:83], v[56:59]
    v_mfma_f32_16x16x32_bf16 v[60:63], v[184:187], v[84:87], v[60:63]
    ds_read_b128 v[76:79], v13 offset:7296
    buffer_load_dwordx4 a[96:99], v16, s[16:19], s42 offen offset:0 sc1
    v_mfma_f32_16x16x32_bf16 v[48:51], v[176:179], v[88:91], v[48:51]
    ds_read_b128 v[136:139], v15 offset:1856
    v_mfma_f32_16x16x32_bf16 v[52:55], v[176:179], v[92:95], v[52:55]
    v_mfma_f32_16x16x32_bf16 v[56:59], v[180:183], v[88:91], v[56:59]
    ds_read_b128 v[140:143], v15 offset:832
    buffer_load_dwordx4 a[100:103], v16, s[16:19], s42 offen offset:1024 sc1
    v_mfma_f32_16x16x32_bf16 v[60:63], v[180:183], v[92:95], v[60:63]
    s_waitcnt lgkmcnt(6)
    v_mfma_f32_16x16x32_bf16 v[32:35], v[112:115], v[96:99], v[32:35]
    ds_read_b128 v[80:83], v13 offset:832
    v_mfma_f32_16x16x32_bf16 v[36:39], v[112:115], v[100:103], v[36:39]
    v_mfma_f32_16x16x32_bf16 v[40:43], v[116:119], v[96:99], v[40:43]
    ds_read_b128 v[84:87], v13 offset:5312
    buffer_load_dwordx4 a[224:227], v17, s[16:19], s42 offen offset:0 sc1
    v_mfma_f32_16x16x32_bf16 v[44:47], v[116:119], v[100:103], v[44:47]
    v_mfma_f32_16x16x32_bf16 v[48:51], v[120:123], v[96:99], v[48:51]
    v_mfma_f32_16x16x32_bf16 v[52:55], v[120:123], v[100:103], v[52:55]
    ds_read_b128 v[128:131], v15 offset:3904
    v_mfma_f32_16x16x32_bf16 v[56:59], v[124:127], v[96:99], v[56:59]
    buffer_load_dwordx4 a[228:231], v17, s[16:19], s42 offen offset:1024 sc1
    s_add_u32 s42, s42, 0x8000
    v_mfma_f32_16x16x32_bf16 v[60:63], v[124:127], v[100:103], v[60:63]
    ds_read_b128 v[132:135], v15 offset:2880
    v_mfma_f32_16x16x32_bf16 v[56:59], v[112:115], v[104:107], v[56:59]
    v_mfma_f32_16x16x32_bf16 v[60:63], v[112:115], v[108:111], v[60:63]
    s_waitcnt lgkmcnt(6)
    v_mfma_f32_16x16x32_bf16 v[40:43], v[112:115], v[64:67], v[40:43]
    ds_read_b128 v[96:99], v13 offset:1856
    buffer_load_dwordx4 a[72:75], v16, s[16:19], s43 offen offset:0 sc1
    v_mfma_f32_16x16x32_bf16 v[44:47], v[112:115], v[68:71], v[44:47]
    ds_read_b128 v[100:103], v13 offset:6336
    v_mfma_f32_16x16x32_bf16 v[48:51], v[116:119], v[64:67], v[48:51]
    v_mfma_f32_16x16x32_bf16 v[52:55], v[116:119], v[68:71], v[52:55]
    ds_read_b128 v[104:107], v13 offset:2880
    buffer_load_dwordx4 a[76:79], v16, s[16:19], s43 offen offset:1024 sc1
    v_mfma_f32_16x16x32_bf16 v[56:59], v[120:123], v[64:67], v[56:59]
    v_mfma_f32_16x16x32_bf16 v[60:63], v[120:123], v[68:71], v[60:63]
    ds_read_b128 v[108:111], v13 offset:7360
    v_mfma_f32_16x16x32_bf16 v[48:51], v[112:115], v[72:75], v[48:51]
    ds_read_b128 v[184:187], v15 offset:1920
    v_mfma_f32_16x16x32_bf16 v[52:55], v[112:115], v[76:79], v[52:55]
    buffer_load_dwordx4 a[200:203], v17, s[16:19], s43 offen offset:0 sc1
    v_mfma_f32_16x16x32_bf16 v[56:59], v[116:119], v[72:75], v[56:59]
    ds_read_b128 v[188:191], v15 offset:896
    v_mfma_f32_16x16x32_bf16 v[60:63], v[116:119], v[76:79], v[60:63]
    s_waitcnt lgkmcnt(6)
    v_mfma_f32_16x16x32_bf16 v[32:35], v[128:131], v[80:83], v[32:35]
    ds_read_b128 v[64:67], v13 offset:896
    v_mfma_f32_16x16x32_bf16 v[36:39], v[128:131], v[84:87], v[36:39]
    buffer_load_dwordx4 a[204:207], v17, s[16:19], s43 offen offset:1024 sc1
    s_add_u32 s43, s43, 0x8000
    v_mfma_f32_16x16x32_bf16 v[40:43], v[132:135], v[80:83], v[40:43]
    ds_read_b128 v[68:71], v13 offset:5376
    v_mfma_f32_16x16x32_bf16 v[44:47], v[132:135], v[84:87], v[44:47]
    v_mfma_f32_16x16x32_bf16 v[48:51], v[136:139], v[80:83], v[48:51]
    ds_read_b128 v[176:179], v15 offset:3968
    v_mfma_f32_16x16x32_bf16 v[52:55], v[136:139], v[84:87], v[52:55]
    buffer_load_dwordx4 a[104:107], v16, s[16:19], s71 offen offset:0 sc1
    v_mfma_f32_16x16x32_bf16 v[56:59], v[140:143], v[80:83], v[56:59]
    ds_read_b128 v[180:183], v15 offset:2944
    v_mfma_f32_16x16x32_bf16 v[60:63], v[140:143], v[84:87], v[60:63]
    s_waitcnt lgkmcnt(6)
    v_mfma_f32_16x16x32_bf16 v[40:43], v[128:131], v[96:99], v[40:43]
    ds_read_b128 v[80:83], v13 offset:1920
    buffer_load_dwordx4 a[108:111], v16, s[16:19], s71 offen offset:1024 sc1
    v_mfma_f32_16x16x32_bf16 v[44:47], v[128:131], v[100:103], v[44:47]
    ds_read_b128 v[84:87], v13 offset:6400
    v_mfma_f32_16x16x32_bf16 v[48:51], v[132:135], v[96:99], v[48:51]
    v_mfma_f32_16x16x32_bf16 v[52:55], v[132:135], v[100:103], v[52:55]
    ds_read_b128 v[88:91], v13 offset:2944
    v_mfma_f32_16x16x32_bf16 v[56:59], v[136:139], v[96:99], v[56:59]
    buffer_load_dwordx4 a[232:235], v17, s[16:19], s71 offen offset:0 sc1
    v_mfma_f32_16x16x32_bf16 v[60:63], v[136:139], v[100:103], v[60:63]
    ds_read_b128 v[92:95], v13 offset:7424
    v_mfma_f32_16x16x32_bf16 v[48:51], v[128:131], v[104:107], v[48:51]
    ds_read_b128 v[120:123], v15 offset:1984
    v_mfma_f32_16x16x32_bf16 v[52:55], v[128:131], v[108:111], v[52:55]
    v_mfma_f32_16x16x32_bf16 v[56:59], v[132:135], v[104:107], v[56:59]
    ds_read_b128 v[124:127], v15 offset:960
    buffer_load_dwordx4 a[236:239], v17, s[16:19], s71 offen offset:1024 sc1
    s_add_u32 s71, s71, 0x8000
    v_mfma_f32_16x16x32_bf16 v[60:63], v[132:135], v[108:111], v[60:63]
    s_waitcnt lgkmcnt(6)
    v_mfma_f32_16x16x32_bf16 v[32:35], v[176:179], v[64:67], v[32:35]
    ds_read_b128 v[96:99], v13 offset:960
    v_mfma_f32_16x16x32_bf16 v[36:39], v[176:179], v[68:71], v[36:39]
    v_mfma_f32_16x16x32_bf16 v[40:43], v[180:183], v[64:67], v[40:43]
    ds_read_b128 v[100:103], v13 offset:5440
    buffer_load_dwordx4 a[80:83], v16, s[16:19], s41 offen offset:0 sc1
    v_mfma_f32_16x16x32_bf16 v[44:47], v[180:183], v[68:71], v[44:47]
    v_mfma_f32_16x16x32_bf16 v[48:51], v[184:187], v[64:67], v[48:51]
    ds_read_b128 v[112:115], v15 offset:4032
    v_mfma_f32_16x16x32_bf16 v[52:55], v[184:187], v[68:71], v[52:55]
    buffer_load_dwordx4 a[84:87], v16, s[16:19], s41 offen offset:1024 sc1
    v_mfma_f32_16x16x32_bf16 v[56:59], v[188:191], v[64:67], v[56:59]
    ds_read_b128 v[116:119], v15 offset:3008
    v_mfma_f32_16x16x32_bf16 v[60:63], v[188:191], v[68:71], v[60:63]
    s_waitcnt lgkmcnt(6)
    v_mfma_f32_16x16x32_bf16 v[40:43], v[176:179], v[80:83], v[40:43]
    ds_read_b128 v[64:67], v13 offset:1984
    v_mfma_f32_16x16x32_bf16 v[44:47], v[176:179], v[84:87], v[44:47]
    ds_read_b128 v[68:71], v13 offset:6464
    buffer_load_dwordx4 a[208:211], v17, s[16:19], s41 offen offset:0 sc1
    v_mfma_f32_16x16x32_bf16 v[48:51], v[180:183], v[80:83], v[48:51]
    v_mfma_f32_16x16x32_bf16 v[52:55], v[180:183], v[84:87], v[52:55]
    ds_read_b128 v[72:75], v13 offset:3008
    v_mfma_f32_16x16x32_bf16 v[56:59], v[184:187], v[80:83], v[56:59]
    v_mfma_f32_16x16x32_bf16 v[60:63], v[184:187], v[84:87], v[60:63]
    ds_read_b128 v[76:79], v13 offset:7488
    buffer_load_dwordx4 a[212:215], v17, s[16:19], s41 offen offset:1024 sc1
    s_add_u32 s41, s41, 0x8000
    v_mfma_f32_16x16x32_bf16 v[48:51], v[176:179], v[88:91], v[48:51]
    ds_read_b128 v[136:139], v14 offset:2048
    v_mfma_f32_16x16x32_bf16 v[52:55], v[176:179], v[92:95], v[52:55]
    v_mfma_f32_16x16x32_bf16 v[56:59], v[180:183], v[88:91], v[56:59]
    ds_read_b128 v[140:143], v14 offset:1024
    v_mfma_f32_16x16x32_bf16 v[60:63], v[180:183], v[92:95], v[60:63]
    buffer_load_dwordx4 a[112:115], v16, s[16:19], s42 offen offset:0 sc1
    s_waitcnt lgkmcnt(6)
    v_mfma_f32_16x16x32_bf16 v[32:35], v[112:115], v[96:99], v[32:35]
    ds_read_b128 v[80:83], v13 offset:1024
    v_mfma_f32_16x16x32_bf16 v[36:39], v[112:115], v[100:103], v[36:39]
    v_mfma_f32_16x16x32_bf16 v[40:43], v[116:119], v[96:99], v[40:43]
    ds_read_b128 v[84:87], v13 offset:5504
    buffer_load_dwordx4 a[116:119], v16, s[16:19], s42 offen offset:1024 sc1
    v_mfma_f32_16x16x32_bf16 v[44:47], v[116:119], v[100:103], v[44:47]
    v_mfma_f32_16x16x32_bf16 v[48:51], v[120:123], v[96:99], v[48:51]
    ds_read_b128 v[128:131], v14 offset:4096
    v_mfma_f32_16x16x32_bf16 v[52:55], v[120:123], v[100:103], v[52:55]
    v_mfma_f32_16x16x32_bf16 v[56:59], v[124:127], v[96:99], v[56:59]
    ds_read_b128 v[132:135], v14 offset:3072
    buffer_load_dwordx4 a[240:243], v17, s[16:19], s42 offen offset:0 sc1
    v_mfma_f32_16x16x32_bf16 v[60:63], v[124:127], v[100:103], v[60:63]
    s_waitcnt lgkmcnt(6)
    v_mfma_f32_16x16x32_bf16 v[40:43], v[112:115], v[64:67], v[40:43]
    ds_read_b128 v[96:99], v13 offset:2048
    v_mfma_f32_16x16x32_bf16 v[44:47], v[112:115], v[68:71], v[44:47]
    ds_read_b128 v[100:103], v13 offset:6528
    v_mfma_f32_16x16x32_bf16 v[48:51], v[116:119], v[64:67], v[48:51]
    buffer_load_dwordx4 a[244:247], v17, s[16:19], s42 offen offset:1024 sc1
    s_add_u32 s42, s42, 0x8000
    v_mfma_f32_16x16x32_bf16 v[52:55], v[116:119], v[68:71], v[52:55]
    ds_read_b128 v[104:107], v13 offset:3072
    v_mfma_f32_16x16x32_bf16 v[56:59], v[120:123], v[64:67], v[56:59]
    v_mfma_f32_16x16x32_bf16 v[60:63], v[120:123], v[68:71], v[60:63]
    ds_read_b128 v[108:111], v13 offset:7552
    v_mfma_f32_16x16x32_bf16 v[48:51], v[112:115], v[72:75], v[48:51]
    ds_read_b128 v[224:227], v15 offset:3904
    buffer_load_dwordx4 a[88:91], v16, s[16:19], s43 offen offset:0 sc1
    v_mfma_f32_16x16x32_bf16 v[52:55], v[112:115], v[76:79], v[52:55]
    v_mfma_f32_16x16x32_bf16 v[56:59], v[116:119], v[72:75], v[56:59]
    ds_read_b128 v[228:231], v15 offset:3968
    v_mfma_f32_16x16x32_bf16 v[60:63], v[116:119], v[76:79], v[60:63]
    buffer_load_dwordx4 a[92:95], v16, s[16:19], s43 offen offset:1024 sc1
    s_waitcnt lgkmcnt(6)
    v_mfma_f32_16x16x32_bf16 v[32:35], v[128:131], v[80:83], v[32:35]
    ds_read_b128 v[64:67], v13 offset:3904
    v_mfma_f32_16x16x32_bf16 v[36:39], v[128:131], v[84:87], v[36:39]
    ds_read_b128 v[68:71], v13 offset:8384
    v_mfma_f32_16x16x32_bf16 v[40:43], v[132:135], v[80:83], v[40:43]
    ds_read_b128 v[72:75], v13 offset:3968
    v_mfma_f32_16x16x32_bf16 v[44:47], v[132:135], v[84:87], v[44:47]
    buffer_load_dwordx4 a[216:219], v17, s[16:19], s43 offen offset:0 sc1
    v_mfma_f32_16x16x32_bf16 v[48:51], v[136:139], v[80:83], v[48:51]
    ds_read_b128 v[76:79], v13 offset:8448
    v_mfma_f32_16x16x32_bf16 v[52:55], v[136:139], v[84:87], v[52:55]
    ds_read_b128 v[232:235], v15 offset:4032
    v_mfma_f32_16x16x32_bf16 v[56:59], v[140:143], v[80:83], v[56:59]
    ds_read_b128 v[236:239], v14 offset:4096
    v_mfma_f32_16x16x32_bf16 v[60:63], v[140:143], v[84:87], v[60:63]
    buffer_load_dwordx4 a[220:223], v17, s[16:19], s43 offen offset:1024 sc1
    s_add_u32 s43, s43, 0x8000
    s_waitcnt lgkmcnt(8)
    v_mfma_f32_16x16x32_bf16 v[40:43], v[128:131], v[96:99], v[40:43]
    ds_read_b128 v[80:83], v13 offset:4032
    v_cvt_pk_bf16_f32 v240, v32, v33
    v_mfma_f32_16x16x32_bf16 v[44:47], v[128:131], v[100:103], v[44:47]
    v_mfma_f32_16x16x32_bf16 v[48:51], v[132:135], v[96:99], v[48:51]
    ds_read_b128 v[84:87], v13 offset:8512
    v_cvt_pk_bf16_f32 v241, v34, v35
    v_mfma_f32_16x16x32_bf16 v[52:55], v[132:135], v[100:103], v[52:55]
    buffer_load_dwordx4 a[120:123], v16, s[16:19], s71 offen offset:0 sc1
    v_mfma_f32_16x16x32_bf16 v[56:59], v[136:139], v[96:99], v[56:59]
    v_cvt_pk_bf16_f32 v242, v36, v37
    v_mfma_f32_16x16x32_bf16 v[60:63], v[136:139], v[100:103], v[60:63]
    ds_read_b128 v[88:91], v13 offset:4096
    v_mfma_f32_16x16x32_bf16 v[48:51], v[128:131], v[104:107], v[48:51]
    v_cvt_pk_bf16_f32 v243, v38, v39
    buffer_load_dwordx4 a[124:127], v16, s[16:19], s71 offen offset:1024 sc1
    v_mfma_f32_16x16x32_bf16 v[52:55], v[128:131], v[108:111], v[52:55]
    ds_read_b128 v[92:95], v13 offset:8576
    v_mfma_f32_16x16x32_bf16 v[56:59], v[132:135], v[104:107], v[56:59]
    buffer_store_dwordx4 v[240:243], v12, s[12:15], s62 offen offset:0 sc1
    v_mfma_f32_16x16x32_bf16 v[60:63], v[132:135], v[108:111], v[60:63]
    s_waitcnt lgkmcnt(6)
    v_mfma_f32_16x16x32_bf16 v[56:59], v[224:227], v[64:67], v[56:59]
    buffer_load_dwordx4 a[248:251], v17, s[16:19], s71 offen offset:0 sc1
    v_mfma_f32_16x16x32_bf16 v[60:63], v[224:227], v[68:71], v[60:63]
    v_cvt_pk_bf16_f32 v244, v40, v41
    v_cvt_pk_bf16_f32 v245, v42, v43
    v_mfma_f32_16x16x32_bf16 v[56:59], v[228:231], v[72:75], v[56:59]
    v_cvt_pk_bf16_f32 v246, v44, v45
    v_mfma_f32_16x16x32_bf16 v[60:63], v[228:231], v[76:79], v[60:63]
    v_cvt_pk_bf16_f32 v247, v46, v47
    buffer_store_dwordx4 v[244:247], v12, s[12:15], s62 offen offset:1024 sc1
    s_waitcnt lgkmcnt(0)
    v_mfma_f32_16x16x32_bf16 v[56:59], v[232:235], v[80:83], v[56:59]
    v_cvt_pk_bf16_f32 v248, v48, v49
    buffer_load_dwordx4 a[252:255], v17, s[16:19], s71 offen offset:1024 sc1
    s_add_u32 s71, s71, 0x8000
    v_mfma_f32_16x16x32_bf16 v[60:63], v[232:235], v[84:87], v[60:63]
    v_cvt_pk_bf16_f32 v249, v50, v51
    v_cvt_pk_bf16_f32 v250, v52, v53
    v_mfma_f32_16x16x32_bf16 v[56:59], v[236:239], v[88:91], v[56:59]
    v_cvt_pk_bf16_f32 v251, v54, v55
    v_mfma_f32_16x16x32_bf16 v[60:63], v[236:239], v[92:95], v[60:63]
    buffer_store_dwordx4 v[248:251], v12, s[12:15], s62 offen offset:2048 sc1
CV_CK:
    s_barrier
    buffer_load_dword v3, v4, s[32:35], 0 offen sc1
    ds_write_b128 v18, a[0:3] offset:0
    ds_write_b128 v18, a[4:7] offset:1024
    ds_write_b128 v18, a[128:131] offset:2048
    ds_write_b128 v18, a[132:135] offset:3072
    ds_write_b128 v18, a[32:35] offset:8192
    ds_write_b128 v18, a[36:39] offset:9216
    ds_write_b128 v18, a[160:163] offset:10240
    ds_write_b128 v18, a[164:167] offset:11264
    v_cvt_pk_bf16_f32 v252, v56, v57
    v_cvt_pk_bf16_f32 v253, v58, v59
    v_cvt_pk_bf16_f32 v254, v60, v61
    v_cvt_pk_bf16_f32 v255, v62, v63
    buffer_store_dwordx4 v[252:255], v12, s[12:15], s62 offen offset:3072 sc1
    ds_write_b128 v18, a[8:11] offset:16384
    ds_write_b128 v18, a[12:15] offset:17408
    ds_write_b128 v18, a[136:139] offset:18432
    ds_write_b128 v18, a[140:143] offset:19456
    ds_write_b128 v18, a[40:43] offset:24576
    ds_write_b128 v18, a[44:47] offset:25600
    ds_write_b128 v18, a[168:171] offset:26624
    ds_write_b128 v18, a[172:175] offset:27648
    s_cmp_eq_u32 s46, 2
    s_cbranch_scc0 CV_NI
CV_B:
g2_code:
    ds_read_b64_tr_b16 a[0:1], v20 offset:49152
    ds_read_b64_tr_b16 a[2:3], v20 offset:49664
    ds_read_b64_tr_b16 a[4:5], v21 offset:49152
    ds_read_b64_tr_b16 a[6:7], v21 offset:49664
    ds_read_b64_tr_b16 a[128:129], v22 offset:49152
    ds_read_b64_tr_b16 a[130:131], v22 offset:49664
    ds_read_b64_tr_b16 a[132:133], v23 offset:49152
    ds_read_b64_tr_b16 a[134:135], v23 offset:49664
    ds_read_b64_tr_b16 a[32:33], v20 offset:51200
    ds_read_b64_tr_b16 a[34:35], v20 offset:51712
    ds_read_b64_tr_b16 a[36:37], v21 offset:51200
    ds_read_b64_tr_b16 a[38:39], v21 offset:51712
    ds_read_b64_tr_b16 a[160:161], v22 offset:51200
    ds_read_b64_tr_b16 a[162:163], v22 offset:51712
    ds_read_b64_tr_b16 a[164:165], v23 offset:51200
    ds_read_b64_tr_b16 a[166:167], v23 offset:51712
    s_waitcnt vmcnt(28) lgkmcnt(0)
    s_barrier
    v_mfma_f32_16x16x32_bf16 v[160:163], a[0:3], a[192:195], 0
    ds_read_b64_tr_b16 a[8:9], v20 offset:57344
    ds_read_b64_tr_b16 a[10:11], v20 offset:57856
    v_mfma_f32_16x16x32_bf16 v[164:167], a[4:7], a[192:195], 0
    s_add_u32 m0, s31, 32768
    v_mfma_f32_16x16x32_bf16 v[168:171], a[128:131], a[192:195], 0
    buffer_load_dwordx4 v1, s[24:27], s30 offen offset:0 lds
    v_mfma_f32_16x16x32_bf16 v[172:175], a[132:135], a[192:195], 0
    ds_read_b64_tr_b16 a[12:13], v21 offset:57344
    v_mfma_f32_16x16x32_bf16 v[176:179], a[0:3], a[196:199], 0
    ds_read_b64_tr_b16 a[14:15], v21 offset:57856
    ds_read_b64_tr_b16 a[136:137], v22 offset:57344
    v_mfma_f32_16x16x32_bf16 v[180:183], a[4:7], a[196:199], 0
    ds_read_b64_tr_b16 a[138:139], v22 offset:57856
    v_mfma_f32_16x16x32_bf16 v[184:187], a[128:131], a[196:199], 0
    buffer_load_dwordx4 v29, s[24:27], s30 offen offset:1024 lds
    v_mfma_f32_16x16x32_bf16 v[188:191], a[132:135], a[196:199], 0
    ds_read_b64_tr_b16 a[140:141], v23 offset:57344
    v_mfma_f32_16x16x32_bf16 v[128:131], a[0:3], a[64:67], 0
    ds_read_b64_tr_b16 a[142:143], v23 offset:57856
    ds_read_b64_tr_b16 a[40:41], v20 offset:59392
    v_mfma_f32_16x16x32_bf16 v[132:135], a[4:7], a[64:67], 0
    s_add_u32 m0, s31, 34816
    v_mfma_f32_16x16x32_bf16 v[136:139], a[128:131], a[64:67], 0
    buffer_load_dwordx4 v30, s[24:27], s30 offen offset:0 lds
    v_mfma_f32_16x16x32_bf16 v[140:143], a[132:135], a[64:67], 0
    ds_read_b64_tr_b16 a[42:43], v20 offset:59904
    v_mfma_f32_16x16x32_bf16 v[144:147], a[0:3], a[68:71], 0
    ds_read_b64_tr_b16 a[44:45], v21 offset:59392
    ds_read_b64_tr_b16 a[46:47], v21 offset:59904
    v_mfma_f32_16x16x32_bf16 v[148:151], a[4:7], a[68:71], 0
    ds_read_b64_tr_b16 a[168:169], v22 offset:59392
    v_mfma_f32_16x16x32_bf16 v[152:155], a[128:131], a[68:71], 0
    buffer_load_dwordx4 v31, s[24:27], s30 offen offset:1024 lds
    v_mfma_f32_16x16x32_bf16 v[156:159], a[132:135], a[68:71], 0
    ds_read_b64_tr_b16 a[170:171], v22 offset:59904
    v_mfma_f32_16x16x32_bf16 v[224:227], a[32:35], a[192:195], 0
    s_add_u32 s30, s30, 0x40000
    ds_read_b64_tr_b16 a[172:173], v23 offset:59392
    v_mfma_f32_16x16x32_bf16 v[228:231], a[36:39], a[192:195], 0
    s_add_u32 m0, s31, 40960
    v_mfma_f32_16x16x32_bf16 v[232:235], a[160:163], a[192:195], 0
    buffer_load_dwordx4 v1, s[24:27], s70 offen offset:0 lds
    v_mfma_f32_16x16x32_bf16 v[236:239], a[164:167], a[192:195], 0
    ds_read_b64_tr_b16 a[174:175], v23 offset:59904
    v_mfma_f32_16x16x32_bf16 v[240:243], a[32:35], a[196:199], 0
    v_mfma_f32_16x16x32_bf16 v[244:247], a[36:39], a[196:199], 0
    v_mfma_f32_16x16x32_bf16 v[248:251], a[160:163], a[196:199], 0
    buffer_load_dwordx4 v29, s[24:27], s70 offen offset:1024 lds
    v_mfma_f32_16x16x32_bf16 v[252:255], a[164:167], a[196:199], 0
    v_mfma_f32_16x16x32_bf16 v[192:195], a[32:35], a[64:67], 0
    v_mfma_f32_16x16x32_bf16 v[196:199], a[36:39], a[64:67], 0
    s_add_u32 m0, s31, 43008
    v_mfma_f32_16x16x32_bf16 v[200:203], a[160:163], a[64:67], 0
    buffer_load_dwordx4 v30, s[24:27], s70 offen offset:0 lds
    v_mfma_f32_16x16x32_bf16 v[204:207], a[164:167], a[64:67], 0
    v_mfma_f32_16x16x32_bf16 v[208:211], a[32:35], a[68:71], 0
    v_mfma_f32_16x16x32_bf16 v[212:215], a[36:39], a[68:71], 0
    v_mfma_f32_16x16x32_bf16 v[216:219], a[160:163], a[68:71], 0
    buffer_load_dwordx4 v31, s[24:27], s70 offen offset:1024 lds
    v_mfma_f32_16x16x32_bf16 v[220:223], a[164:167], a[68:71], 0
    s_add_u32 s70, s70, 0x40000
    s_waitcnt vmcnt(32) lgkmcnt(0)
    v_mfma_f32_16x16x32_bf16 v[160:163], a[8:11], a[224:227], v[160:163]
    ds_read_b64_tr_b16 a[0:1], v20 offset:0
    ds_read_b64_tr_b16 a[2:3], v20 offset:512
    v_mfma_f32_16x16x32_bf16 v[164:167], a[12:15], a[224:227], v[164:167]
    s_add_u32 m0, s31, 49152
    v_mfma_f32_16x16x32_bf16 v[168:171], a[136:139], a[224:227], v[168:171]
    buffer_load_dwordx4 v1, s[24:27], s28 offen offset:0 lds
    v_mfma_f32_16x16x32_bf16 v[172:175], a[140:143], a[224:227], v[172:175]
    ds_read_b64_tr_b16 a[4:5], v21 offset:0
    v_mfma_f32_16x16x32_bf16 v[176:179], a[8:11], a[228:231], v[176:179]
    ds_read_b64_tr_b16 a[6:7], v21 offset:512
    ds_read_b64_tr_b16 a[128:129], v22 offset:0
    v_mfma_f32_16x16x32_bf16 v[180:183], a[12:15], a[228:231], v[180:183]
    ds_read_b64_tr_b16 a[130:131], v22 offset:512
    v_mfma_f32_16x16x32_bf16 v[184:187], a[136:139], a[228:231], v[184:187]
    buffer_load_dwordx4 v29, s[24:27], s28 offen offset:1024 lds
IW_P8:
    s_cbranch_execz IW_P12
    v_mfma_f32_16x16x32_bf16 v[188:191], a[140:143], a[228:231], v[188:191]
    ds_read_b64_tr_b16 a[132:133], v23 offset:0
    v_mfma_f32_16x16x32_bf16 v[128:131], a[8:11], a[96:99], v[128:131]
    ds_read_b64_tr_b16 a[134:135], v23 offset:512
    v_mfma_f32_16x16x32_bf16 v[132:135], a[12:15], a[96:99], v[132:135]
    s_add_u32 m0, s31, 51200
    ds_read_b64_tr_b16 a[32:33], v20 offset:2048
    v_mfma_f32_16x16x32_bf16 v[136:139], a[136:139], a[96:99], v[136:139]
    buffer_load_dwordx4 v30, s[24:27], s28 offen offset:0 lds
    v_mfma_f32_16x16x32_bf16 v[140:143], a[140:143], a[96:99], v[140:143]
    ds_read_b64_tr_b16 a[34:35], v20 offset:2560
    v_mfma_f32_16x16x32_bf16 v[144:147], a[8:11], a[100:103], v[144:147]
    ds_read_b64_tr_b16 a[36:37], v21 offset:2048
    v_mfma_f32_16x16x32_bf16 v[148:151], a[12:15], a[100:103], v[148:151]
    ds_read_b64_tr_b16 a[38:39], v21 offset:2560
    v_mfma_f32_16x16x32_bf16 v[152:155], a[136:139], a[100:103], v[152:155]
    buffer_load_dwordx4 v31, s[24:27], s28 offen offset:1024 lds
    v_mfma_f32_16x16x32_bf16 v[156:159], a[140:143], a[100:103], v[156:159]
    ds_read_b64_tr_b16 a[160:161], v22 offset:2048
    ds_read_b64_tr_b16 a[162:163], v22 offset:2560
    v_mfma_f32_16x16x32_bf16 v[224:227], a[40:43], a[224:227], v[224:227]
    s_add_u32 s28, s28, 0x40000
    v_mfma_f32_16x16x32_bf16 v[228:231], a[44:47], a[224:227], v[228:231]
    ds_read_b64_tr_b16 a[164:165], v23 offset:2048
    v_mfma_f32_16x16x32_bf16 v[232:235], a[168:171], a[224:227], v[232:235]
    s_andn2_b32 s50, 0x4, s47
    s_cbranch_scc1 G2_SP2
G2_OK2:
    buffer_load_dwordx4 a[16:19], v16, s[16:19], s41 offen offset:0 sc1
    v_mfma_f32_16x16x32_bf16 v[236:239], a[172:175], a[224:227], v[236:239]
    ds_read_b64_tr_b16 a[166:167], v23 offset:2560
    v_mfma_f32_16x16x32_bf16 v[240:243], a[40:43], a[228:231], v[240:243]
    v_mfma_f32_16x16x32_bf16 v[244:247], a[44:47], a[228:231], v[244:247]
    v_mfma_f32_16x16x32_bf16 v[248:251], a[168:171], a[228:231], v[248:251]
    buffer_load_dwordx4 a[20:23], v16, s[16:19], s41 offen offset:1024 sc1
    v_mfma_f32_16x16x32_bf16 v[252:255], a[172:175], a[228:231], v[252:255]
    v_mfma_f32_16x16x32_bf16 v[192:195], a[40:43], a[96:99], v[192:195]
    v_mfma_f32_16x16x32_bf16 v[196:199], a[44:47], a[96:99], v[196:199]
    v_mfma_f32_16x16x32_bf16 v[200:203], a[168:171], a[96:99], v[200:203]
    buffer_load_dwordx4 a[144:147], v17, s[16:19], s41 offen offset:0 sc1
    v_mfma_f32_16x16x32_bf16 v[204:207], a[172:175], a[96:99], v[204:207]
    v_mfma_f32_16x16x32_bf16 v[208:211], a[40:43], a[100:103], v[208:211]
    v_mfma_f32_16x16x32_bf16 v[212:215], a[44:47], a[100:103], v[212:215]
    v_mfma_f32_16x16x32_bf16 v[216:219], a[168:171], a[100:103], v[216:219]
    buffer_load_dwordx4 a[148:151], v17, s[16:19], s41 offen offset:1024 sc1
    v_mfma_f32_16x16x32_bf16 v[220:223], a[172:175], a[100:103], v[220:223]
    s_add_u32 s41, s41, 0x8000
    s_waitcnt vmcnt(36) lgkmcnt(0)
    s_barrier
    v_mfma_f32_16x16x32_bf16 v[160:163], a[0:3], a[200:203], v[160:163]
    ds_read_b64_tr_b16 a[8:9], v20 offset:8192
    ds_read_b64_tr_b16 a[10:11], v20 offset:8704
    v_mfma_f32_16x16x32_bf16 v[164:167], a[4:7], a[200:203], v[164:167]
    s_add_u32 m0, s31, 57344
    v_lshrrev_b32 v120, 3, v0
    v_mfma_f32_16x16x32_bf16 v[168:171], a[128:131], a[200:203], v[168:171]
    buffer_load_dwordx4 v1, s[24:27], s29 offen offset:0 lds
    v_mfma_f32_16x16x32_bf16 v[172:175], a[132:135], a[200:203], v[172:175]
    ds_read_b64_tr_b16 a[12:13], v21 offset:8192
    v_add_lshl_u32 v120, v120, s44, 11
    v_mfma_f32_16x16x32_bf16 v[176:179], a[0:3], a[204:207], v[176:179]
    ds_read_b64_tr_b16 a[14:15], v21 offset:8704
    ds_read_b64_tr_b16 a[136:137], v22 offset:8192
    v_mfma_f32_16x16x32_bf16 v[180:183], a[4:7], a[204:207], v[180:183]
    ds_read_b64_tr_b16 a[138:139], v22 offset:8704
    v_mfma_f32_16x16x32_bf16 v[184:187], a[128:131], a[204:207], v[184:187]
    buffer_load_dwordx4 v29, s[24:27], s29 offen offset:1024 lds
    v_mfma_f32_16x16x32_bf16 v[188:191], a[132:135], a[204:207], v[188:191]
    ds_read_b64_tr_b16 a[140:141], v23 offset:8192
    v_lshrrev_b32 v121, 4, v0
    v_mfma_f32_16x16x32_bf16 v[128:131], a[0:3], a[72:75], v[128:131]
    ds_read_b64_tr_b16 a[142:143], v23 offset:8704
    v_mfma_f32_16x16x32_bf16 v[132:135], a[4:7], a[72:75], v[132:135]
    s_add_u32 m0, s31, 59392
    ds_read_b64_tr_b16 a[40:41], v20 offset:10240
    v_mfma_f32_16x16x32_bf16 v[136:139], a[128:131], a[72:75], v[136:139]
    buffer_load_dwordx4 v30, s[24:27], s29 offen offset:0 lds
    v_mfma_f32_16x16x32_bf16 v[140:143], a[132:135], a[72:75], v[140:143]
    ds_read_b64_tr_b16 a[42:43], v20 offset:10752
    v_and_b32 v122, 7, v0
    v_mfma_f32_16x16x32_bf16 v[144:147], a[0:3], a[76:79], v[144:147]
    ds_read_b64_tr_b16 a[44:45], v21 offset:10240
    v_mfma_f32_16x16x32_bf16 v[148:151], a[4:7], a[76:79], v[148:151]
    ds_read_b64_tr_b16 a[46:47], v21 offset:10752
    v_xor_b32 v121, v121, v122
    v_mfma_f32_16x16x32_bf16 v[152:155], a[128:131], a[76:79], v[152:155]
    buffer_load_dwordx4 v31, s[24:27], s29 offen offset:1024 lds
    v_mfma_f32_16x16x32_bf16 v[156:159], a[132:135], a[76:79], v[156:159]
    ds_read_b64_tr_b16 a[168:169], v22 offset:10240
    ds_read_b64_tr_b16 a[170:171], v22 offset:10752
    v_mfma_f32_16x16x32_bf16 v[224:227], a[32:35], a[200:203], v[224:227]
    s_add_u32 s29, s29, 0x40000
    v_lshlrev_b32 v121, 4, v121
    v_mfma_f32_16x16x32_bf16 v[228:231], a[36:39], a[200:203], v[228:231]
    ds_read_b64_tr_b16 a[172:173], v23 offset:10240
    v_mfma_f32_16x16x32_bf16 v[232:235], a[160:163], a[200:203], v[232:235]
    buffer_load_dwordx4 a[48:51], v16, s[16:19], s42 offen offset:0 sc1
    v_mfma_f32_16x16x32_bf16 v[236:239], a[164:167], a[200:203], v[236:239]
    ds_read_b64_tr_b16 a[174:175], v23 offset:10752
    s_lshl_b32 s51, s45, 1
    v_mfma_f32_16x16x32_bf16 v[240:243], a[32:35], a[204:207], v[240:243]
    v_add3_u32 v24, v120, v121, s51
    v_mfma_f32_16x16x32_bf16 v[244:247], a[36:39], a[204:207], v[244:247]
    v_xor_b32 v5, 64, v24
    v_mfma_f32_16x16x32_bf16 v[248:251], a[160:163], a[204:207], v[248:251]
    buffer_load_dwordx4 a[52:55], v16, s[16:19], s42 offen offset:1024 sc1
    v_mfma_f32_16x16x32_bf16 v[252:255], a[164:167], a[204:207], v[252:255]
    v_add_u32 v5, 0x3c00, v5
    v_mfma_f32_16x16x32_bf16 v[192:195], a[32:35], a[72:75], v[192:195]
    s_movk_i32 s53, 30720
    v_mfma_f32_16x16x32_bf16 v[196:199], a[36:39], a[72:75], v[196:199]
    s_lshl_b32 s62, s40, 12
    v_mfma_f32_16x16x32_bf16 v[200:203], a[160:163], a[72:75], v[200:203]
    buffer_load_dwordx4 a[176:179], v17, s[16:19], s42 offen offset:0 sc1
    v_mfma_f32_16x16x32_bf16 v[204:207], a[164:167], a[72:75], v[204:207]
    s_add_u32 s62, s62, 81920
    v_add_u32 v26, 1, v26
    v_mfma_f32_16x16x32_bf16 v[208:211], a[32:35], a[76:79], v[208:211]
    v_add_u32 v27, 1, v27
    v_mfma_f32_16x16x32_bf16 v[212:215], a[36:39], a[76:79], v[212:215]
    v_and_b32 v26, 0xff, v26
    v_mfma_f32_16x16x32_bf16 v[216:219], a[160:163], a[76:79], v[216:219]
    buffer_load_dwordx4 a[180:183], v17, s[16:19], s42 offen offset:1024 sc1
    v_mfma_f32_16x16x32_bf16 v[220:223], a[164:167], a[76:79], v[220:223]
    s_add_u32 s42, s42, 0x8000
    s_waitcnt vmcnt(40) lgkmcnt(0)
    v_mfma_f32_16x16x32_bf16 v[160:163], a[8:11], a[232:235], v[160:163]
    ds_read_b64_tr_b16 a[0:1], v20 offset:16384
    ds_read_b64_tr_b16 a[2:3], v20 offset:16896
    v_mfma_f32_16x16x32_bf16 v[164:167], a[12:15], a[232:235], v[164:167]
    s_add_u32 m0, s31, 0
    v_and_b32 v27, 0xff, v27
    v_mfma_f32_16x16x32_bf16 v[168:171], a[136:139], a[232:235], v[168:171]
    buffer_load_dwordx4 v1, s[24:27], s30 offen offset:0 lds
    v_mfma_f32_16x16x32_bf16 v[172:175], a[140:143], a[232:235], v[172:175]
    ds_read_b64_tr_b16 a[4:5], v21 offset:16384
    v_max_u32 v26, 1, v26
    v_mfma_f32_16x16x32_bf16 v[176:179], a[8:11], a[236:239], v[176:179]
    ds_read_b64_tr_b16 a[6:7], v21 offset:16896
    ds_read_b64_tr_b16 a[128:129], v22 offset:16384
    v_mfma_f32_16x16x32_bf16 v[180:183], a[12:15], a[236:239], v[180:183]
    ds_read_b64_tr_b16 a[130:131], v22 offset:16896
    v_mfma_f32_16x16x32_bf16 v[184:187], a[136:139], a[236:239], v[184:187]
    buffer_load_dwordx4 v29, s[24:27], s30 offen offset:1024 lds
    v_mfma_f32_16x16x32_bf16 v[188:191], a[140:143], a[236:239], v[188:191]
    ds_read_b64_tr_b16 a[132:133], v23 offset:16384
    v_max_u32 v27, 1, v27
    v_mfma_f32_16x16x32_bf16 v[128:131], a[8:11], a[104:107], v[128:131]
    ds_read_b64_tr_b16 a[134:135], v23 offset:16896
    v_mfma_f32_16x16x32_bf16 v[132:135], a[12:15], a[104:107], v[132:135]
    s_add_u32 m0, s31, 2048
    ds_read_b64_tr_b16 a[32:33], v20 offset:18432
    v_mfma_f32_16x16x32_bf16 v[136:139], a[136:139], a[104:107], v[136:139]
    buffer_load_dwordx4 v30, s[24:27], s30 offen offset:0 lds
    v_mfma_f32_16x16x32_bf16 v[140:143], a[140:143], a[104:107], v[140:143]
    ds_read_b64_tr_b16 a[34:35], v20 offset:18944
    v_readlane_b32 s80, v26, 0
    v_mfma_f32_16x16x32_bf16 v[144:147], a[8:11], a[108:111], v[144:147]
    ds_read_b64_tr_b16 a[36:37], v21 offset:18432
    v_mfma_f32_16x16x32_bf16 v[148:151], a[12:15], a[108:111], v[148:151]
    ds_read_b64_tr_b16 a[38:39], v21 offset:18944
    v_readlane_b32 s81, v27, 0
    v_mfma_f32_16x16x32_bf16 v[152:155], a[136:139], a[108:111], v[152:155]
    buffer_load_dwordx4 v31, s[24:27], s30 offen offset:1024 lds
    v_mfma_f32_16x16x32_bf16 v[156:159], a[140:143], a[108:111], v[156:159]
    ds_read_b64_tr_b16 a[160:161], v22 offset:18432
    ds_read_b64_tr_b16 a[162:163], v22 offset:18944
    v_mfma_f32_16x16x32_bf16 v[224:227], a[40:43], a[232:235], v[224:227]
    s_add_u32 s30, s30, 0x40000
    v_readlane_b32 s60, v26, 1
    v_mfma_f32_16x16x32_bf16 v[228:231], a[44:47], a[232:235], v[228:231]
    ds_read_b64_tr_b16 a[164:165], v23 offset:18432
    v_mfma_f32_16x16x32_bf16 v[232:235], a[168:171], a[232:235], v[232:235]
    buffer_load_dwordx4 a[24:27], v16, s[16:19], s43 offen offset:0 sc1
    v_mfma_f32_16x16x32_bf16 v[236:239], a[172:175], a[232:235], v[236:239]
    ds_read_b64_tr_b16 a[166:167], v23 offset:18944
    v_readlane_b32 s61, v27, 1
    v_mfma_f32_16x16x32_bf16 v[240:243], a[40:43], a[236:239], v[240:243]
    s_lshr_b32 s51, s45, 6
    v_mfma_f32_16x16x32_bf16 v[244:247], a[44:47], a[236:239], v[244:247]
    s_lshr_b32 s52, s48, 7
    v_mfma_f32_16x16x32_bf16 v[248:251], a[168:171], a[236:239], v[248:251]
    buffer_load_dwordx4 a[28:31], v16, s[16:19], s43 offen offset:1024 sc1
    v_mfma_f32_16x16x32_bf16 v[252:255], a[172:175], a[236:239], v[252:255]
    s_cmp_lt_u32 s40, 2
    s_cselect_b32 s51, s51, s52
    v_mfma_f32_16x16x32_bf16 v[192:195], a[40:43], a[104:107], v[192:195]
    v_mfma_f32_16x16x32_bf16 v[196:199], a[44:47], a[104:107], v[196:199]
    s_lshl_b32 s51, s51, 1
    v_mfma_f32_16x16x32_bf16 v[200:203], a[168:171], a[104:107], v[200:203]
    buffer_load_dwordx4 a[152:155], v17, s[16:19], s43 offen offset:0 sc1
    v_mfma_f32_16x16x32_bf16 v[204:207], a[172:175], a[104:107], v[204:207]
    s_add_u32 s51, s51, s64
    s_lshl_b32 s51, s51, 11
    v_mfma_f32_16x16x32_bf16 v[208:211], a[40:43], a[108:111], v[208:211]
    s_add_u32 s51, s51, 0x10000
    v_mfma_f32_16x16x32_bf16 v[212:215], a[44:47], a[108:111], v[212:215]
    v_and_b32 v120, 7, v0
    v_mfma_f32_16x16x32_bf16 v[216:219], a[168:171], a[108:111], v[216:219]
    buffer_load_dwordx4 a[156:159], v17, s[16:19], s43 offen offset:1024 sc1
    v_mfma_f32_16x16x32_bf16 v[220:223], a[172:175], a[108:111], v[220:223]
    s_add_u32 s43, s43, 0x8000
    s_waitcnt vmcnt(28) lgkmcnt(0)
    s_barrier
    v_mfma_f32_16x16x32_bf16 v[160:163], a[0:3], a[208:211], v[160:163]
    v_cmp_ne_u32 vcc, 0, v3
    s_nop 0
    s_or_b32 s47, s47, vcc_lo
    s_andn2_b32 s50, 0x7f, s47
    s_cselect_b32 s50, 0, 0x40000000
    v_or_b32 v4, s50, v4
    v_mfma_f32_16x16x32_bf16 v[164:167], a[4:7], a[208:211], v[164:167]
    s_cmp_lg_u32 s40, 0
    s_cbranch_scc1 G2_ZF
    v_mov_b32 v10, 1
    s_mov_b64 exec, 2
     buffer_store_dword v10, v7, s[32:35], 0 offen sc1
    s_mov_b64 exec, -1
G2_ZF:
    buffer_load_dword v3, v4, s[32:35], 0 offen sc1
    s_add_u32 m0, s31, 8192
    v_mfma_f32_16x16x32_bf16 v[168:171], a[128:131], a[208:211], v[168:171]
    buffer_load_dwordx4 v1, s[24:27], s70 offen offset:0 lds
    v_mfma_f32_16x16x32_bf16 v[172:175], a[132:135], a[208:211], v[172:175]
    ds_read_b64_tr_b16 a[8:9], v20 offset:24576
    ds_read_b64_tr_b16 a[10:11], v20 offset:25088
    v_mfma_f32_16x16x32_bf16 v[176:179], a[0:3], a[212:215], v[176:179]
    ds_read_b64_tr_b16 a[12:13], v21 offset:24576
    v_lshl_add_u32 v28, v120, 8, s51
    v_mfma_f32_16x16x32_bf16 v[180:183], a[4:7], a[212:215], v[180:183]
    ds_read_b64_tr_b16 a[14:15], v21 offset:25088
    ds_read_b64_tr_b16 a[136:137], v22 offset:24576
    v_mfma_f32_16x16x32_bf16 v[184:187], a[128:131], a[212:215], v[184:187]
    buffer_load_dwordx4 v29, s[24:27], s70 offen offset:1024 lds
    v_mfma_f32_16x16x32_bf16 v[188:191], a[132:135], a[212:215], v[188:191]
    ds_read_b64_tr_b16 a[138:139], v22 offset:25088
    s_xor_b32 s52, s2, 4
    v_mfma_f32_16x16x32_bf16 v[128:131], a[0:3], a[80:83], v[128:131]
    ds_read_b64_tr_b16 a[140:141], v23 offset:24576
    v_mfma_f32_16x16x32_bf16 v[132:135], a[4:7], a[80:83], v[132:135]
    s_add_u32 m0, s31, 10240
    ds_read_b64_tr_b16 a[142:143], v23 offset:25088
    v_mfma_f32_16x16x32_bf16 v[136:139], a[128:131], a[80:83], v[136:139]
    buffer_load_dwordx4 v30, s[24:27], s70 offen offset:0 lds
    v_mfma_f32_16x16x32_bf16 v[140:143], a[132:135], a[80:83], v[140:143]
    ds_read_b64_tr_b16 a[40:41], v20 offset:26624
    s_lshl_b32 s52, s52, 8
    v_mfma_f32_16x16x32_bf16 v[144:147], a[0:3], a[84:87], v[144:147]
    ds_read_b64_tr_b16 a[42:43], v20 offset:27136
    ds_read_b64_tr_b16 a[44:45], v21 offset:26624
    v_mfma_f32_16x16x32_bf16 v[148:151], a[4:7], a[84:87], v[148:151]
    ds_read_b64_tr_b16 a[46:47], v21 offset:27136
    s_add_u32 s52, s52, 0x10000
    v_mfma_f32_16x16x32_bf16 v[152:155], a[128:131], a[84:87], v[152:155]
    buffer_load_dwordx4 v31, s[24:27], s70 offen offset:1024 lds
    v_mfma_f32_16x16x32_bf16 v[156:159], a[132:135], a[84:87], v[156:159]
    ds_read_b64_tr_b16 a[168:169], v22 offset:26624
    v_mfma_f32_16x16x32_bf16 v[224:227], a[32:35], a[208:211], v[224:227]
    s_add_u32 s70, s70, 0x40000
    ds_read_b64_tr_b16 a[170:171], v22 offset:27136
    v_mfma_f32_16x16x32_bf16 v[228:231], a[36:39], a[208:211], v[228:231]
    ds_read_b64_tr_b16 a[172:173], v23 offset:26624
    v_writelane_b32 v28, s52, 63
    v_mfma_f32_16x16x32_bf16 v[232:235], a[160:163], a[208:211], v[232:235]
    buffer_load_dwordx4 a[56:59], v16, s[16:19], s71 offen offset:0 sc1
    v_mfma_f32_16x16x32_bf16 v[236:239], a[164:167], a[208:211], v[236:239]
    ds_read_b64_tr_b16 a[174:175], v23 offset:27136
    s_add_u32 s8, s72, 0x2100000
    s_addc_u32 s9, s73, 0
    v_mfma_f32_16x16x32_bf16 v[240:243], a[32:35], a[212:215], v[240:243]
    v_mfma_f32_16x16x32_bf16 v[244:247], a[36:39], a[212:215], v[244:247]
    s_mov_b32 s10, 0x2000
    v_mfma_f32_16x16x32_bf16 v[248:251], a[160:163], a[212:215], v[248:251]
    buffer_load_dwordx4 a[60:63], v16, s[16:19], s71 offen offset:1024 sc1
    v_mfma_f32_16x16x32_bf16 v[252:255], a[164:167], a[212:215], v[252:255]
    s_mov_b32 s11, 0x00020000
    v_mfma_f32_16x16x32_bf16 v[192:195], a[32:35], a[80:83], v[192:195]
    v_and_b32 v120, 15, v0
    v_add_lshl_u32 v25, v120, s44, 2
    v_mfma_f32_16x16x32_bf16 v[196:199], a[36:39], a[80:83], v[196:199]
    s_lshl_b32 s51, s65, 5
    v_mfma_f32_16x16x32_bf16 v[200:203], a[160:163], a[80:83], v[200:203]
    buffer_load_dwordx4 a[184:187], v17, s[16:19], s71 offen offset:0 sc1
    v_mfma_f32_16x16x32_bf16 v[204:207], a[164:167], a[80:83], v[204:207]
    s_add_u32 s51, s51, s45
    v_mfma_f32_16x16x32_bf16 v[208:211], a[32:35], a[84:87], v[208:211]
    v_lshrrev_b32 v120, 3, v0
    v_add_u32 v120, s51, v120
    v_mfma_f32_16x16x32_bf16 v[212:215], a[36:39], a[84:87], v[212:215]
    s_mov_b32 m0, s62
    v_mfma_f32_16x16x32_bf16 v[216:219], a[160:163], a[84:87], v[216:219]
    buffer_load_dwordx4 v24, s[4:7], 0 offen offset:0 lds
    v_mfma_f32_16x16x32_bf16 v[220:223], a[164:167], a[84:87], v[220:223]
    v_mul_u32_u24 v120, 0x1000, v120
    s_waitcnt vmcnt(49) lgkmcnt(0)
    v_mfma_f32_16x16x32_bf16 v[160:163], a[8:11], a[240:243], v[160:163]
    ds_read_b64_tr_b16 a[0:1], v20 offset:32768
    ds_read_b64_tr_b16 a[2:3], v20 offset:33280
    v_mfma_f32_16x16x32_bf16 v[164:167], a[12:15], a[240:243], v[164:167]
    s_add_u32 m0, s31, 16384
    v_lshrrev_b32 v121, 4, v0
    v_mfma_f32_16x16x32_bf16 v[168:171], a[136:139], a[240:243], v[168:171]
    buffer_load_dwordx4 v1, s[24:27], s28 offen offset:0 lds
    v_mfma_f32_16x16x32_bf16 v[172:175], a[140:143], a[240:243], v[172:175]
    ds_read_b64_tr_b16 a[4:5], v21 offset:32768
    v_lshlrev_b32 v121, 1, v121
    v_mfma_f32_16x16x32_bf16 v[176:179], a[8:11], a[244:247], v[176:179]
    ds_read_b64_tr_b16 a[6:7], v21 offset:33280
    ds_read_b64_tr_b16 a[128:129], v22 offset:32768
    v_mfma_f32_16x16x32_bf16 v[180:183], a[12:15], a[244:247], v[180:183]
    ds_read_b64_tr_b16 a[130:131], v22 offset:33280
    v_mfma_f32_16x16x32_bf16 v[184:187], a[136:139], a[244:247], v[184:187]
    buffer_load_dwordx4 v29, s[24:27], s28 offen offset:1024 lds
    v_mfma_f32_16x16x32_bf16 v[188:191], a[140:143], a[244:247], v[188:191]
    ds_read_b64_tr_b16 a[132:133], v23 offset:32768
    v_and_b32 v122, 7, v0
    v_mfma_f32_16x16x32_bf16 v[128:131], a[8:11], a[112:115], v[128:131]
    ds_read_b64_tr_b16 a[134:135], v23 offset:33280
    v_mfma_f32_16x16x32_bf16 v[132:135], a[12:15], a[112:115], v[132:135]
    s_add_u32 m0, s31, 18432
    ds_read_b64_tr_b16 a[32:33], v20 offset:34816
    v_mfma_f32_16x16x32_bf16 v[136:139], a[136:139], a[112:115], v[136:139]
    buffer_load_dwordx4 v30, s[24:27], s28 offen offset:0 lds
    v_mfma_f32_16x16x32_bf16 v[140:143], a[140:143], a[112:115], v[140:143]
    ds_read_b64_tr_b16 a[34:35], v20 offset:35328
    v_xor_b32 v121, v121, v122
    v_mfma_f32_16x16x32_bf16 v[144:147], a[8:11], a[116:119], v[144:147]
    ds_read_b64_tr_b16 a[36:37], v21 offset:34816
    v_mfma_f32_16x16x32_bf16 v[148:151], a[12:15], a[116:119], v[148:151]
    ds_read_b64_tr_b16 a[38:39], v21 offset:35328
    v_lshl_add_u32 v26, v121, 4, v120
    v_mfma_f32_16x16x32_bf16 v[152:155], a[136:139], a[116:119], v[152:155]
    buffer_load_dwordx4 v31, s[24:27], s28 offen offset:1024 lds
    v_mfma_f32_16x16x32_bf16 v[156:159], a[140:143], a[116:119], v[156:159]
    ds_read_b64_tr_b16 a[160:161], v22 offset:34816
    ds_read_b64_tr_b16 a[162:163], v22 offset:35328
    v_mfma_f32_16x16x32_bf16 v[224:227], a[40:43], a[240:243], v[224:227]
    s_add_u32 s28, s28, 0x40000
    s_lshl_b32 s51, s64, 6
    v_mfma_f32_16x16x32_bf16 v[228:231], a[44:47], a[240:243], v[228:231]
    ds_read_b64_tr_b16 a[164:165], v23 offset:34816
    v_mfma_f32_16x16x32_bf16 v[232:235], a[168:171], a[240:243], v[232:235]
    buffer_load_dwordx4 a[188:191], v17, s[16:19], s71 offen offset:1024 sc1
    v_mfma_f32_16x16x32_bf16 v[236:239], a[172:175], a[240:243], v[236:239]
    ds_read_b64_tr_b16 a[166:167], v23 offset:35328
    s_add_u32 s51, s51, s48
    v_mfma_f32_16x16x32_bf16 v[240:243], a[40:43], a[244:247], v[240:243]
    s_add_u32 s71, s71, 0x8000
    v_mfma_f32_16x16x32_bf16 v[244:247], a[44:47], a[244:247], v[244:247]
    s_lshl_b32 s56, s51, 1
    v_mfma_f32_16x16x32_bf16 v[248:251], a[168:171], a[244:247], v[248:251]
    s_andn2_b32 s50, 0x8, s47
    s_cbranch_scc1 G2_SP3
G2_OK3:
    buffer_load_dwordx4 a[64:67], v16, s[16:19], s41 offen offset:0 sc1
    v_mfma_f32_16x16x32_bf16 v[252:255], a[172:175], a[244:247], v[252:255]
    s_lshl_b32 s52, s64, 13
    s_add_u32 s52, s52, 65536
    v_mfma_f32_16x16x32_bf16 v[192:195], a[40:43], a[112:115], v[192:195]
    s_lshl_b32 s57, s65, 12
    v_mfma_f32_16x16x32_bf16 v[196:199], a[44:47], a[112:115], v[196:199]
    s_add_u32 s57, s57, s52
    v_mfma_f32_16x16x32_bf16 v[200:203], a[168:171], a[112:115], v[200:203]
    buffer_load_dwordx4 a[68:71], v16, s[16:19], s41 offen offset:1024 sc1
    v_mfma_f32_16x16x32_bf16 v[204:207], a[172:175], a[112:115], v[204:207]
    v_lshrrev_b32 v120, 2, v0
    v_mfma_f32_16x16x32_bf16 v[208:211], a[40:43], a[116:119], v[208:211]
    v_lshlrev_b32 v120, 7, v120
    v_mfma_f32_16x16x32_bf16 v[212:215], a[44:47], a[116:119], v[212:215]
    v_lshrrev_b32 v121, 3, v0
    v_mfma_f32_16x16x32_bf16 v[216:219], a[168:171], a[116:119], v[216:219]
    buffer_load_dwordx4 a[192:195], v17, s[16:19], s41 offen offset:0 sc1
    v_mfma_f32_16x16x32_bf16 v[220:223], a[172:175], a[116:119], v[220:223]
    v_and_b32 v121, 3, v121
    s_waitcnt vmcnt(37) lgkmcnt(0)
    s_barrier
    v_mfma_f32_16x16x32_bf16 v[160:163], a[0:3], a[216:219], v[160:163]
    ds_read_b64_tr_b16 a[8:9], v20 offset:40960
    ds_read_b64_tr_b16 a[10:11], v20 offset:41472
    v_mfma_f32_16x16x32_bf16 v[164:167], a[4:7], a[216:219], v[164:167]
    s_add_u32 m0, s31, 24576
    v_lshlrev_b32 v121, 5, v121
    v_mfma_f32_16x16x32_bf16 v[168:171], a[128:131], a[216:219], v[168:171]
    buffer_load_dwordx4 v1, s[24:27], s29 offen offset:0 lds
    v_mfma_f32_16x16x32_bf16 v[172:175], a[132:135], a[216:219], v[172:175]
    ds_read_b64_tr_b16 a[12:13], v21 offset:40960
    s_lshl_b32 s51, s65, 6
    v_mfma_f32_16x16x32_bf16 v[176:179], a[0:3], a[220:223], v[176:179]
    ds_read_b64_tr_b16 a[14:15], v21 offset:41472
    ds_read_b64_tr_b16 a[136:137], v22 offset:40960
    v_mfma_f32_16x16x32_bf16 v[180:183], a[4:7], a[220:223], v[180:183]
    ds_read_b64_tr_b16 a[138:139], v22 offset:41472
    v_mfma_f32_16x16x32_bf16 v[184:187], a[128:131], a[220:223], v[184:187]
    buffer_load_dwordx4 v29, s[24:27], s29 offen offset:1024 lds
    v_mfma_f32_16x16x32_bf16 v[188:191], a[132:135], a[220:223], v[188:191]
    ds_read_b64_tr_b16 a[140:141], v23 offset:40960
    v_xor_b32 v121, s51, v121
    v_mfma_f32_16x16x32_bf16 v[128:131], a[0:3], a[88:91], v[128:131]
    ds_read_b64_tr_b16 a[142:143], v23 offset:41472
    v_mfma_f32_16x16x32_bf16 v[132:135], a[4:7], a[88:91], v[132:135]
    s_add_u32 m0, s31, 26624
    ds_read_b64_tr_b16 a[40:41], v20 offset:43008
    v_mfma_f32_16x16x32_bf16 v[136:139], a[128:131], a[88:91], v[136:139]
    buffer_load_dwordx4 v30, s[24:27], s29 offen offset:0 lds
    v_mfma_f32_16x16x32_bf16 v[140:143], a[132:135], a[88:91], v[140:143]
    ds_read_b64_tr_b16 a[42:43], v20 offset:43520
    v_and_b32 v122, 3, v0
    v_mfma_f32_16x16x32_bf16 v[144:147], a[0:3], a[92:95], v[144:147]
    ds_read_b64_tr_b16 a[44:45], v21 offset:43008
    v_lshlrev_b32 v122, 3, v122
    v_mfma_f32_16x16x32_bf16 v[148:151], a[4:7], a[92:95], v[148:151]
    ds_read_b64_tr_b16 a[46:47], v21 offset:43520
    v_mfma_f32_16x16x32_bf16 v[152:155], a[128:131], a[92:95], v[152:155]
    buffer_load_dwordx4 v31, s[24:27], s29 offen offset:1024 lds
    v_mfma_f32_16x16x32_bf16 v[156:159], a[132:135], a[92:95], v[156:159]
    ds_read_b64_tr_b16 a[168:169], v22 offset:43008
    ds_read_b64_tr_b16 a[170:171], v22 offset:43520
    v_mfma_f32_16x16x32_bf16 v[224:227], a[32:35], a[216:219], v[224:227]
    s_add_u32 s29, s29, 0x40000
    v_add3_u32 v6, v120, v121, v122
    v_mfma_f32_16x16x32_bf16 v[228:231], a[36:39], a[216:219], v[228:231]
    ds_read_b64_tr_b16 a[172:173], v23 offset:43008
    v_mfma_f32_16x16x32_bf16 v[232:235], a[160:163], a[216:219], v[232:235]
    buffer_load_dwordx4 a[196:199], v17, s[16:19], s41 offen offset:1024 sc1
    v_mfma_f32_16x16x32_bf16 v[236:239], a[164:167], a[216:219], v[236:239]
    ds_read_b64_tr_b16 a[174:175], v23 offset:43520
    v_add_u32 v6, s52, v6
    v_mfma_f32_16x16x32_bf16 v[240:243], a[32:35], a[220:223], v[240:243]
    s_add_u32 s41, s41, 0x8000
    v_and_b32 v120, 15, v0
    v_mfma_f32_16x16x32_bf16 v[244:247], a[36:39], a[220:223], v[244:247]
    v_lshrrev_b32 v121, 1, v120
    v_mfma_f32_16x16x32_bf16 v[248:251], a[160:163], a[220:223], v[248:251]
    buffer_load_dwordx4 a[96:99], v16, s[16:19], s42 offen offset:0 sc1
    v_mfma_f32_16x16x32_bf16 v[252:255], a[164:167], a[220:223], v[252:255]
    v_lshrrev_b32 v122, 5, v0
    v_mfma_f32_16x16x32_bf16 v[192:195], a[32:35], a[88:91], v[192:195]
    v_xor_b32 v121, v121, v122
    v_mfma_f32_16x16x32_bf16 v[196:199], a[36:39], a[88:91], v[196:199]
    v_lshlrev_b32 v121, 4, v121
    v_mfma_f32_16x16x32_bf16 v[200:203], a[160:163], a[88:91], v[200:203]
    buffer_load_dwordx4 a[100:103], v16, s[16:19], s42 offen offset:1024 sc1
    v_mfma_f32_16x16x32_bf16 v[204:207], a[164:167], a[88:91], v[204:207]
    v_lshl_add_u32 v120, v120, 7, v121
    v_lshrrev_b32 v122, 1, v0
    v_mfma_f32_16x16x32_bf16 v[208:211], a[32:35], a[92:95], v[208:211]
    v_and_b32 v122, 8, v122
    v_mfma_f32_16x16x32_bf16 v[212:215], a[36:39], a[92:95], v[212:215]
    s_mov_b32 m0, s62
    v_mfma_f32_16x16x32_bf16 v[216:219], a[160:163], a[92:95], v[216:219]
    buffer_load_dwordx4 v5, s[4:7], 0 offen offset:1024 lds
    v_mfma_f32_16x16x32_bf16 v[220:223], a[164:167], a[92:95], v[220:223]
    v_add3_u32 v116, v120, v122, s62
    s_waitcnt vmcnt(57) lgkmcnt(0)
    v_mfma_f32_16x16x32_bf16 v[160:163], a[8:11], a[248:251], v[160:163]
    ds_read_b64_tr_b16 a[0:1], v20 offset:49152
    ds_read_b64_tr_b16 a[2:3], v20 offset:49664
    v_mfma_f32_16x16x32_bf16 v[164:167], a[12:15], a[248:251], v[164:167]
    s_add_u32 m0, s31, 32768
    v_xor_b32 v117, 32, v116
    v_mfma_f32_16x16x32_bf16 v[168:171], a[136:139], a[248:251], v[168:171]
    buffer_load_dwordx4 v1, s[24:27], s30 offen offset:0 lds
    v_mfma_f32_16x16x32_bf16 v[172:175], a[140:143], a[248:251], v[172:175]
    ds_read_b64_tr_b16 a[4:5], v21 offset:49152
    v_xor_b32 v118, 64, v116
    v_mfma_f32_16x16x32_bf16 v[176:179], a[8:11], a[252:255], v[176:179]
    ds_read_b64_tr_b16 a[6:7], v21 offset:49664
    ds_read_b64_tr_b16 a[128:129], v22 offset:49152
    v_mfma_f32_16x16x32_bf16 v[180:183], a[12:15], a[252:255], v[180:183]
    ds_read_b64_tr_b16 a[130:131], v22 offset:49664
    v_mfma_f32_16x16x32_bf16 v[184:187], a[136:139], a[252:255], v[184:187]
    buffer_load_dwordx4 v29, s[24:27], s30 offen offset:1024 lds
    v_mfma_f32_16x16x32_bf16 v[188:191], a[140:143], a[252:255], v[188:191]
    ds_read_b64_tr_b16 a[132:133], v23 offset:49152
    v_xor_b32 v119, 96, v116
    v_mfma_f32_16x16x32_bf16 v[128:131], a[8:11], a[120:123], v[128:131]
    ds_read_b64_tr_b16 a[134:135], v23 offset:49664
    v_mfma_f32_16x16x32_bf16 v[132:135], a[12:15], a[120:123], v[132:135]
    s_add_u32 m0, s31, 34816
    ds_read_b64_tr_b16 a[32:33], v20 offset:51200
    v_mfma_f32_16x16x32_bf16 v[136:139], a[136:139], a[120:123], v[136:139]
    buffer_load_dwordx4 v30, s[24:27], s30 offen offset:0 lds
    v_mfma_f32_16x16x32_bf16 v[140:143], a[140:143], a[120:123], v[140:143]
    ds_read_b64_tr_b16 a[34:35], v20 offset:51712
    s_mov_b32 s58, 0xffff0000
    v_mfma_f32_16x16x32_bf16 v[144:147], a[8:11], a[124:127], v[144:147]
    ds_read_b64_tr_b16 a[36:37], v21 offset:51200
    v_mfma_f32_16x16x32_bf16 v[148:151], a[12:15], a[124:127], v[148:151]
    ds_read_b64_tr_b16 a[38:39], v21 offset:51712
    v_and_b32 v120, 31, v0
    v_mfma_f32_16x16x32_bf16 v[152:155], a[136:139], a[124:127], v[152:155]
    buffer_load_dwordx4 v31, s[24:27], s30 offen offset:1024 lds
    v_mfma_f32_16x16x32_bf16 v[156:159], a[140:143], a[124:127], v[156:159]
    ds_read_b64_tr_b16 a[160:161], v22 offset:51200
    ds_read_b64_tr_b16 a[162:163], v22 offset:51712
    v_mfma_f32_16x16x32_bf16 v[224:227], a[40:43], a[248:251], v[224:227]
    s_add_u32 s30, s30, 0x40000
    v_add_lshl_u32 v120, v120, s44, 11
    v_mfma_f32_16x16x32_bf16 v[228:231], a[44:47], a[248:251], v[228:231]
    ds_read_b64_tr_b16 a[164:165], v23 offset:51200
    v_mfma_f32_16x16x32_bf16 v[232:235], a[168:171], a[248:251], v[232:235]
    buffer_load_dwordx4 a[224:227], v17, s[16:19], s42 offen offset:0 sc1
    v_mfma_f32_16x16x32_bf16 v[236:239], a[172:175], a[248:251], v[236:239]
    ds_read_b64_tr_b16 a[166:167], v23 offset:51712
    v_lshrrev_b32 v121, 5, v0
    v_mfma_f32_16x16x32_bf16 v[240:243], a[40:43], a[252:255], v[240:243]
    v_lshlrev_b32 v121, 4, v121
    v_mfma_f32_16x16x32_bf16 v[244:247], a[44:47], a[252:255], v[244:247]
    s_lshl_b32 s51, s45, 1
    v_mfma_f32_16x16x32_bf16 v[248:251], a[168:171], a[252:255], v[248:251]
    buffer_load_dwordx4 a[228:231], v17, s[16:19], s42 offen offset:1024 sc1
    v_mfma_f32_16x16x32_bf16 v[252:255], a[172:175], a[252:255], v[252:255]
    v_add3_u32 v27, v120, v121, s51
    v_mfma_f32_16x16x32_bf16 v[192:195], a[40:43], a[120:123], v[192:195]
    s_add_u32 s42, s42, 0x8000
    s_sub_u32 s51, 98304, s67
    v_mfma_f32_16x16x32_bf16 v[196:199], a[44:47], a[120:123], v[196:199]
    s_lshl_b32 s52, s64, 12
    v_mfma_f32_16x16x32_bf16 v[200:203], a[168:171], a[120:123], v[200:203]
    buffer_load_dwordx4 a[72:75], v16, s[16:19], s43 offen offset:0 sc1
    v_mfma_f32_16x16x32_bf16 v[204:207], a[172:175], a[120:123], v[204:207]
    s_add_u32 s51, s51, s52
    v_mfma_f32_16x16x32_bf16 v[208:211], a[40:43], a[124:127], v[208:211]
    v_add_u32 v19, s51, v2
    v_mfma_f32_16x16x32_bf16 v[212:215], a[44:47], a[124:127], v[212:215]
    s_add_u32 s69, s68, 4096
    v_mfma_f32_16x16x32_bf16 v[216:219], a[168:171], a[124:127], v[216:219]
    buffer_load_dwordx4 a[76:79], v16, s[16:19], s43 offen offset:1024 sc1
    v_mfma_f32_16x16x32_bf16 v[220:223], a[172:175], a[124:127], v[220:223]
    s_xor_b32 s54, s68, 0x20000
    s_waitcnt vmcnt(37) lgkmcnt(0)
    s_barrier
    v_mfma_f32_16x16x32_bf16 v[160:163], a[0:3], a[144:147], v[160:163]
    ds_read_b64_tr_b16 a[8:9], v20 offset:57344
    ds_read_b64_tr_b16 a[10:11], v20 offset:57856
    v_mfma_f32_16x16x32_bf16 v[164:167], a[4:7], a[144:147], v[164:167]
    s_add_u32 m0, s31, 40960
    s_add_u32 s55, s54, 4096
    v_mfma_f32_16x16x32_bf16 v[168:171], a[128:131], a[144:147], v[168:171]
    buffer_load_dwordx4 v1, s[24:27], s70 offen offset:0 lds
    v_mfma_f32_16x16x32_bf16 v[172:175], a[132:135], a[144:147], v[172:175]
    ds_read_b64_tr_b16 a[12:13], v21 offset:57344
    v_mfma_f32_16x16x32_bf16 v[176:179], a[0:3], a[148:151], v[176:179]
    ds_read_b64_tr_b16 a[14:15], v21 offset:57856
    ds_read_b64_tr_b16 a[136:137], v22 offset:57344
    v_mfma_f32_16x16x32_bf16 v[180:183], a[4:7], a[148:151], v[180:183]
    ds_read_b64_tr_b16 a[138:139], v22 offset:57856
    v_mfma_f32_16x16x32_bf16 v[184:187], a[128:131], a[148:151], v[184:187]
    buffer_load_dwordx4 v29, s[24:27], s70 offen offset:1024 lds
    v_mfma_f32_16x16x32_bf16 v[188:191], a[132:135], a[148:151], v[188:191]
    ds_read_b64_tr_b16 a[140:141], v23 offset:57344
    v_mfma_f32_16x16x32_bf16 v[128:131], a[0:3], a[16:19], v[128:131]
    ds_read_b64_tr_b16 a[142:143], v23 offset:57856
    v_mfma_f32_16x16x32_bf16 v[132:135], a[4:7], a[16:19], v[132:135]
    s_add_u32 m0, s31, 43008
    ds_read_b64_tr_b16 a[40:41], v20 offset:59392
    v_mfma_f32_16x16x32_bf16 v[136:139], a[128:131], a[16:19], v[136:139]
    buffer_load_dwordx4 v30, s[24:27], s70 offen offset:0 lds
    v_mfma_f32_16x16x32_bf16 v[140:143], a[132:135], a[16:19], v[140:143]
    ds_read_b64_tr_b16 a[42:43], v20 offset:59904
    v_mfma_f32_16x16x32_bf16 v[144:147], a[0:3], a[20:23], v[144:147]
IW_P9:
    s_cbranch_execz IW_R1
    ds_read_b64_tr_b16 a[44:45], v21 offset:59392
    v_mfma_f32_16x16x32_bf16 v[148:151], a[4:7], a[20:23], v[148:151]
    ds_read_b64_tr_b16 a[46:47], v21 offset:59904
    v_mfma_f32_16x16x32_bf16 v[152:155], a[128:131], a[20:23], v[152:155]
    buffer_load_dwordx4 v31, s[24:27], s70 offen offset:1024 lds
    v_mfma_f32_16x16x32_bf16 v[156:159], a[132:135], a[20:23], v[156:159]
    ds_read_b64_tr_b16 a[168:169], v22 offset:59392
    ds_read_b64_tr_b16 a[170:171], v22 offset:59904
    v_mfma_f32_16x16x32_bf16 v[224:227], a[32:35], a[144:147], v[224:227]
    s_add_u32 s70, s70, 0x40000
    v_mfma_f32_16x16x32_bf16 v[228:231], a[36:39], a[144:147], v[228:231]
    ds_read_b64_tr_b16 a[172:173], v23 offset:59392
    v_mfma_f32_16x16x32_bf16 v[232:235], a[160:163], a[144:147], v[232:235]
    buffer_load_dwordx4 a[200:203], v17, s[16:19], s43 offen offset:0 sc1
    v_mfma_f32_16x16x32_bf16 v[236:239], a[164:167], a[144:147], v[236:239]
    ds_read_b64_tr_b16 a[174:175], v23 offset:59904
    v_mfma_f32_16x16x32_bf16 v[240:243], a[32:35], a[148:151], v[240:243]
    v_mfma_f32_16x16x32_bf16 v[244:247], a[36:39], a[148:151], v[244:247]
    v_mov_b32 v8, 0x03020104
    v_mfma_f32_16x16x32_bf16 v[248:251], a[160:163], a[148:151], v[248:251]
    buffer_load_dwordx4 a[204:207], v17, s[16:19], s43 offen offset:1024 sc1
    v_mfma_f32_16x16x32_bf16 v[252:255], a[164:167], a[148:151], v[252:255]
    v_mfma_f32_16x16x32_bf16 v[192:195], a[32:35], a[16:19], v[192:195]
    s_add_u32 s43, s43, 0x8000
    v_mfma_f32_16x16x32_bf16 v[196:199], a[36:39], a[16:19], v[196:199]
    v_mfma_f32_16x16x32_bf16 v[200:203], a[160:163], a[16:19], v[200:203]
    buffer_load_dwordx4 a[104:107], v16, s[16:19], s71 offen offset:0 sc1
    v_mfma_f32_16x16x32_bf16 v[204:207], a[164:167], a[16:19], v[204:207]
    v_mfma_f32_16x16x32_bf16 v[208:211], a[32:35], a[20:23], v[208:211]
    v_mfma_f32_16x16x32_bf16 v[212:215], a[36:39], a[20:23], v[212:215]
    s_mov_b32 m0, s62
    v_mfma_f32_16x16x32_bf16 v[216:219], a[160:163], a[20:23], v[216:219]
    buffer_load_dwordx4 v24, s[4:7], s53 offen offset:2048 lds
    v_mfma_f32_16x16x32_bf16 v[220:223], a[164:167], a[20:23], v[220:223]
    s_waitcnt vmcnt(49) lgkmcnt(0)
    v_mfma_f32_16x16x32_bf16 v[160:163], a[8:11], a[176:179], v[160:163]
    ds_read_b64_tr_b16 a[0:1], v20 offset:0
    ds_read_b64_tr_b16 a[2:3], v20 offset:512
    v_mfma_f32_16x16x32_bf16 v[164:167], a[12:15], a[176:179], v[164:167]
    s_add_u32 m0, s31, 49152
    v_mfma_f32_16x16x32_bf16 v[168:171], a[136:139], a[176:179], v[168:171]
    buffer_load_dwordx4 v1, s[24:27], s28 offen offset:0 lds
    v_mfma_f32_16x16x32_bf16 v[172:175], a[140:143], a[176:179], v[172:175]
    ds_read_b64_tr_b16 a[4:5], v21 offset:0
    v_mfma_f32_16x16x32_bf16 v[176:179], a[8:11], a[180:183], v[176:179]
    ds_read_b64_tr_b16 a[6:7], v21 offset:512
    ds_read_b64_tr_b16 a[128:129], v22 offset:0
    v_mfma_f32_16x16x32_bf16 v[180:183], a[12:15], a[180:183], v[180:183]
    ds_read_b64_tr_b16 a[130:131], v22 offset:512
    v_mfma_f32_16x16x32_bf16 v[184:187], a[136:139], a[180:183], v[184:187]
    buffer_load_dwordx4 v29, s[24:27], s28 offen offset:1024 lds
    v_mfma_f32_16x16x32_bf16 v[188:191], a[140:143], a[180:183], v[188:191]
    ds_read_b64_tr_b16 a[132:133], v23 offset:0
    v_mfma_f32_16x16x32_bf16 v[128:131], a[8:11], a[48:51], v[128:131]
    ds_read_b64_tr_b16 a[134:135], v23 offset:512
    v_mfma_f32_16x16x32_bf16 v[132:135], a[12:15], a[48:51], v[132:135]
    s_add_u32 m0, s31, 51200
    ds_read_b64_tr_b16 a[32:33], v20 offset:2048
    v_mfma_f32_16x16x32_bf16 v[136:139], a[136:139], a[48:51], v[136:139]
    buffer_load_dwordx4 v30, s[24:27], s28 offen offset:0 lds
    v_mfma_f32_16x16x32_bf16 v[140:143], a[140:143], a[48:51], v[140:143]
    ds_read_b64_tr_b16 a[34:35], v20 offset:2560
    v_mfma_f32_16x16x32_bf16 v[144:147], a[8:11], a[52:55], v[144:147]
    ds_read_b64_tr_b16 a[36:37], v21 offset:2048
    v_mfma_f32_16x16x32_bf16 v[148:151], a[12:15], a[52:55], v[148:151]
    ds_read_b64_tr_b16 a[38:39], v21 offset:2560
    v_mfma_f32_16x16x32_bf16 v[152:155], a[136:139], a[52:55], v[152:155]
    buffer_load_dwordx4 v31, s[24:27], s28 offen offset:1024 lds
    v_mfma_f32_16x16x32_bf16 v[156:159], a[140:143], a[52:55], v[156:159]
    ds_read_b64_tr_b16 a[160:161], v22 offset:2048
    ds_read_b64_tr_b16 a[162:163], v22 offset:2560
    v_mfma_f32_16x16x32_bf16 v[224:227], a[40:43], a[176:179], v[224:227]
    s_add_u32 s28, s28, 0x40000
    v_mfma_f32_16x16x32_bf16 v[228:231], a[44:47], a[176:179], v[228:231]
    ds_read_b64_tr_b16 a[164:165], v23 offset:2048
    v_mfma_f32_16x16x32_bf16 v[232:235], a[168:171], a[176:179], v[232:235]
    buffer_load_dwordx4 a[108:111], v16, s[16:19], s71 offen offset:1024 sc1
    v_mfma_f32_16x16x32_bf16 v[236:239], a[172:175], a[176:179], v[236:239]
    ds_read_b64_tr_b16 a[166:167], v23 offset:2560
    v_mfma_f32_16x16x32_bf16 v[240:243], a[40:43], a[180:183], v[240:243]
    v_mfma_f32_16x16x32_bf16 v[244:247], a[44:47], a[180:183], v[244:247]
    v_mfma_f32_16x16x32_bf16 v[248:251], a[168:171], a[180:183], v[248:251]
    buffer_load_dwordx4 a[232:235], v17, s[16:19], s71 offen offset:0 sc1
    v_mfma_f32_16x16x32_bf16 v[252:255], a[172:175], a[180:183], v[252:255]
    v_mfma_f32_16x16x32_bf16 v[192:195], a[40:43], a[48:51], v[192:195]
    v_mfma_f32_16x16x32_bf16 v[196:199], a[44:47], a[48:51], v[196:199]
    v_mfma_f32_16x16x32_bf16 v[200:203], a[168:171], a[48:51], v[200:203]
    buffer_load_dwordx4 a[236:239], v17, s[16:19], s71 offen offset:1024 sc1
    v_mfma_f32_16x16x32_bf16 v[204:207], a[172:175], a[48:51], v[204:207]
    v_mfma_f32_16x16x32_bf16 v[208:211], a[40:43], a[52:55], v[208:211]
    s_add_u32 s71, s71, 0x8000
    v_mfma_f32_16x16x32_bf16 v[212:215], a[44:47], a[52:55], v[212:215]
    v_mfma_f32_16x16x32_bf16 v[216:219], a[168:171], a[52:55], v[216:219]
    s_andn2_b32 s50, 0x10, s47
    s_cbranch_scc1 G2_SP4
G2_OK4:
    buffer_load_dwordx4 a[80:83], v16, s[16:19], s41 offen offset:0 sc1
    v_mfma_f32_16x16x32_bf16 v[220:223], a[172:175], a[52:55], v[220:223]
    s_waitcnt vmcnt(36) lgkmcnt(0)
    s_barrier
    v_mfma_f32_16x16x32_bf16 v[160:163], a[0:3], a[152:155], v[160:163]
    v_cmp_ne_u32 vcc, 0, v3
    s_nop 0
    s_or_b32 s47, s47, vcc_lo
    s_andn2_b32 s50, 0x7f, s47
    s_cselect_b32 s50, 0, 0x40000000
    v_or_b32 v4, s50, v4
    v_mfma_f32_16x16x32_bf16 v[164:167], a[4:7], a[152:155], v[164:167]
    buffer_load_dword v3, v4, s[32:35], 0 offen sc1
    s_add_u32 m0, s31, 57344
    v_mfma_f32_16x16x32_bf16 v[168:171], a[128:131], a[152:155], v[168:171]
    buffer_load_dwordx4 v1, s[24:27], s29 offen offset:0 lds
    v_mfma_f32_16x16x32_bf16 v[172:175], a[132:135], a[152:155], v[172:175]
    ds_read_b64_tr_b16 a[8:9], v20 offset:8192
    ds_read_b64_tr_b16 a[10:11], v20 offset:8704
    v_mfma_f32_16x16x32_bf16 v[176:179], a[0:3], a[156:159], v[176:179]
    ds_read_b64_tr_b16 a[12:13], v21 offset:8192
    v_mfma_f32_16x16x32_bf16 v[180:183], a[4:7], a[156:159], v[180:183]
    ds_read_b64_tr_b16 a[14:15], v21 offset:8704
    ds_read_b64_tr_b16 a[136:137], v22 offset:8192
    v_mfma_f32_16x16x32_bf16 v[184:187], a[128:131], a[156:159], v[184:187]
    buffer_load_dwordx4 v29, s[24:27], s29 offen offset:1024 lds
    v_mfma_f32_16x16x32_bf16 v[188:191], a[132:135], a[156:159], v[188:191]
    ds_read_b64_tr_b16 a[138:139], v22 offset:8704
    v_mfma_f32_16x16x32_bf16 v[128:131], a[0:3], a[24:27], v[128:131]
    ds_read_b64_tr_b16 a[140:141], v23 offset:8192
    v_mfma_f32_16x16x32_bf16 v[132:135], a[4:7], a[24:27], v[132:135]
    s_add_u32 m0, s31, 59392
    ds_read_b64_tr_b16 a[142:143], v23 offset:8704
    v_mfma_f32_16x16x32_bf16 v[136:139], a[128:131], a[24:27], v[136:139]
    buffer_load_dwordx4 v30, s[24:27], s29 offen offset:0 lds
    v_mfma_f32_16x16x32_bf16 v[140:143], a[132:135], a[24:27], v[140:143]
    ds_read_b64_tr_b16 a[40:41], v20 offset:10240
    v_mfma_f32_16x16x32_bf16 v[144:147], a[0:3], a[28:31], v[144:147]
    ds_read_b64_tr_b16 a[42:43], v20 offset:10752
    ds_read_b64_tr_b16 a[44:45], v21 offset:10240
    v_mfma_f32_16x16x32_bf16 v[148:151], a[4:7], a[28:31], v[148:151]
    ds_read_b64_tr_b16 a[46:47], v21 offset:10752
    v_mfma_f32_16x16x32_bf16 v[152:155], a[128:131], a[28:31], v[152:155]
    buffer_load_dwordx4 v31, s[24:27], s29 offen offset:1024 lds
    v_mfma_f32_16x16x32_bf16 v[156:159], a[132:135], a[28:31], v[156:159]
    ds_read_b64_tr_b16 a[168:169], v22 offset:10240
    v_mfma_f32_16x16x32_bf16 v[224:227], a[32:35], a[152:155], v[224:227]
    s_add_u32 s29, s29, 0x40000
    ds_read_b64_tr_b16 a[170:171], v22 offset:10752
    v_mfma_f32_16x16x32_bf16 v[228:231], a[36:39], a[152:155], v[228:231]
    ds_read_b64_tr_b16 a[172:173], v23 offset:10240
    v_mfma_f32_16x16x32_bf16 v[232:235], a[160:163], a[152:155], v[232:235]
    buffer_load_dwordx4 a[84:87], v16, s[16:19], s41 offen offset:1024 sc1
    v_mfma_f32_16x16x32_bf16 v[236:239], a[164:167], a[152:155], v[236:239]
    ds_read_b64_tr_b16 a[174:175], v23 offset:10752
    v_mfma_f32_16x16x32_bf16 v[240:243], a[32:35], a[156:159], v[240:243]
    v_mfma_f32_16x16x32_bf16 v[244:247], a[36:39], a[156:159], v[244:247]
    v_mfma_f32_16x16x32_bf16 v[248:251], a[160:163], a[156:159], v[248:251]
    buffer_load_dwordx4 a[208:211], v17, s[16:19], s41 offen offset:0 sc1
    v_mfma_f32_16x16x32_bf16 v[252:255], a[164:167], a[156:159], v[252:255]
    v_mfma_f32_16x16x32_bf16 v[192:195], a[32:35], a[24:27], v[192:195]
    v_mfma_f32_16x16x32_bf16 v[196:199], a[36:39], a[24:27], v[196:199]
    v_mfma_f32_16x16x32_bf16 v[200:203], a[160:163], a[24:27], v[200:203]
    buffer_load_dwordx4 a[212:215], v17, s[16:19], s41 offen offset:1024 sc1
    v_mfma_f32_16x16x32_bf16 v[204:207], a[164:167], a[24:27], v[204:207]
    v_mfma_f32_16x16x32_bf16 v[208:211], a[32:35], a[28:31], v[208:211]
    s_add_u32 s41, s41, 0x8000
    v_mfma_f32_16x16x32_bf16 v[212:215], a[36:39], a[28:31], v[212:215]
    s_mov_b32 m0, s62
    v_mfma_f32_16x16x32_bf16 v[216:219], a[160:163], a[28:31], v[216:219]
    buffer_load_dwordx4 v5, s[4:7], s53 offen offset:3072 lds
    v_mfma_f32_16x16x32_bf16 v[220:223], a[164:167], a[28:31], v[220:223]
    s_waitcnt vmcnt(44) lgkmcnt(0)
    v_mfma_f32_16x16x32_bf16 v[160:163], a[8:11], a[184:187], v[160:163]
    ds_read_b64_tr_b16 a[0:1], v20 offset:16384
    ds_read_b64_tr_b16 a[2:3], v20 offset:16896
    v_mfma_f32_16x16x32_bf16 v[164:167], a[12:15], a[184:187], v[164:167]
    s_add_u32 m0, s31, 0
    v_mfma_f32_16x16x32_bf16 v[168:171], a[136:139], a[184:187], v[168:171]
    buffer_load_dwordx4 v1, s[24:27], s30 offen offset:0 lds
    v_mfma_f32_16x16x32_bf16 v[172:175], a[140:143], a[184:187], v[172:175]
    ds_read_b64_tr_b16 a[4:5], v21 offset:16384
    v_mfma_f32_16x16x32_bf16 v[176:179], a[8:11], a[188:191], v[176:179]
    ds_read_b64_tr_b16 a[6:7], v21 offset:16896
    v_mfma_f32_16x16x32_bf16 v[180:183], a[12:15], a[188:191], v[180:183]
    ds_read_b64_tr_b16 a[128:129], v22 offset:16384
    v_mfma_f32_16x16x32_bf16 v[184:187], a[136:139], a[188:191], v[184:187]
    buffer_load_dwordx4 v29, s[24:27], s30 offen offset:1024 lds
    v_mfma_f32_16x16x32_bf16 v[188:191], a[140:143], a[188:191], v[188:191]
    ds_read_b64_tr_b16 a[130:131], v22 offset:16896
    ds_read_b64_tr_b16 a[132:133], v23 offset:16384
    v_mfma_f32_16x16x32_bf16 v[128:131], a[8:11], a[56:59], v[128:131]
    s_add_u32 s85, s30, 0x40000
    v_mfma_f32_16x16x32_bf16 v[132:135], a[12:15], a[56:59], v[132:135]
    ds_read_b64_tr_b16 a[134:135], v23 offset:16896
    v_mfma_f32_16x16x32_bf16 v[136:139], a[136:139], a[56:59], v[136:139]
    buffer_load_dwordx4 a[112:115], v16, s[16:19], s42 offen offset:0 sc1
    v_mfma_f32_16x16x32_bf16 v[140:143], a[140:143], a[56:59], v[140:143]
    ds_read_b64_tr_b16 a[32:33], v20 offset:18432
    v_mfma_f32_16x16x32_bf16 v[144:147], a[8:11], a[60:63], v[144:147]
    ds_read_b64_tr_b16 a[34:35], v20 offset:18944
    v_mfma_f32_16x16x32_bf16 v[148:151], a[12:15], a[60:63], v[148:151]
    ds_read_b64_tr_b16 a[36:37], v21 offset:18432
    ds_read_b64_tr_b16 a[38:39], v21 offset:18944
    v_mfma_f32_16x16x32_bf16 v[152:155], a[136:139], a[60:63], v[152:155]
    buffer_load_dwordx4 a[116:119], v16, s[16:19], s42 offen offset:1024 sc1
    v_mfma_f32_16x16x32_bf16 v[156:159], a[140:143], a[60:63], v[156:159]
    ds_read_b64_tr_b16 a[160:161], v22 offset:18432
    v_mfma_f32_16x16x32_bf16 v[224:227], a[40:43], a[184:187], v[224:227]
    ds_read_b64_tr_b16 a[162:163], v22 offset:18944
    v_mfma_f32_16x16x32_bf16 v[228:231], a[44:47], a[184:187], v[228:231]
    ds_read_b64_tr_b16 a[164:165], v23 offset:18432
    v_mfma_f32_16x16x32_bf16 v[232:235], a[168:171], a[184:187], v[232:235]
    buffer_load_dwordx4 a[240:243], v17, s[16:19], s42 offen offset:0 sc1
    v_mfma_f32_16x16x32_bf16 v[236:239], a[172:175], a[184:187], v[236:239]
    ds_read_b64_tr_b16 a[166:167], v23 offset:18944
    v_mfma_f32_16x16x32_bf16 v[240:243], a[40:43], a[188:191], v[240:243]
    v_mfma_f32_16x16x32_bf16 v[244:247], a[44:47], a[188:191], v[244:247]
    v_mfma_f32_16x16x32_bf16 v[248:251], a[168:171], a[188:191], v[248:251]
    buffer_load_dwordx4 a[244:247], v17, s[16:19], s42 offen offset:1024 sc1
    v_mfma_f32_16x16x32_bf16 v[252:255], a[172:175], a[188:191], v[252:255]
    v_mfma_f32_16x16x32_bf16 v[192:195], a[40:43], a[56:59], v[192:195]
    s_add_u32 s42, s42, 0x8000
    v_mfma_f32_16x16x32_bf16 v[196:199], a[44:47], a[56:59], v[196:199]
    v_mfma_f32_16x16x32_bf16 v[200:203], a[168:171], a[56:59], v[200:203]
    buffer_load_dwordx4 a[88:91], v16, s[16:19], s43 offen offset:0 sc1
    v_mfma_f32_16x16x32_bf16 v[204:207], a[172:175], a[56:59], v[204:207]
    v_mfma_f32_16x16x32_bf16 v[208:211], a[40:43], a[60:63], v[208:211]
    v_mfma_f32_16x16x32_bf16 v[212:215], a[44:47], a[60:63], v[212:215]
    v_mfma_f32_16x16x32_bf16 v[216:219], a[168:171], a[60:63], v[216:219]
    buffer_load_dwordx4 a[92:95], v16, s[16:19], s43 offen offset:1024 sc1
    v_mfma_f32_16x16x32_bf16 v[220:223], a[172:175], a[60:63], v[220:223]
    s_waitcnt vmcnt(37) lgkmcnt(0)
    s_barrier
    v_mfma_f32_16x16x32_bf16 v[160:163], a[0:3], a[192:195], v[160:163]
    ds_read_b64_tr_b16 a[8:9], v20 offset:24576
    ds_read_b64_tr_b16 a[10:11], v20 offset:25088
    v_mfma_f32_16x16x32_bf16 v[164:167], a[4:7], a[192:195], v[164:167]
    ds_read_b64_tr_b16 a[12:13], v21 offset:24576
    v_mfma_f32_16x16x32_bf16 v[168:171], a[128:131], a[192:195], v[168:171]
    buffer_load_dword v40, v28, s[32:35], 0 offen sc1
    v_mfma_f32_16x16x32_bf16 v[172:175], a[132:135], a[192:195], v[172:175]
    ds_read_b64_tr_b16 a[14:15], v21 offset:25088
    ds_read_b64_tr_b16 a[136:137], v22 offset:24576
    v_mfma_f32_16x16x32_bf16 v[176:179], a[0:3], a[196:199], v[176:179]
    s_add_u32 m0, s31, 8192
    v_mfma_f32_16x16x32_bf16 v[180:183], a[4:7], a[196:199], v[180:183]
    buffer_load_dwordx4 v1, s[24:27], s70 offen offset:0 lds
    v_mfma_f32_16x16x32_bf16 v[184:187], a[128:131], a[196:199], v[184:187]
    ds_read_b64_tr_b16 a[138:139], v22 offset:25088
    v_mfma_f32_16x16x32_bf16 v[188:191], a[132:135], a[196:199], v[188:191]
    ds_read_b64_tr_b16 a[140:141], v23 offset:24576
    ds_read_b64_tr_b16 a[142:143], v23 offset:25088
    v_mfma_f32_16x16x32_bf16 v[128:131], a[0:3], a[64:67], v[128:131]
    ds_read_b64_tr_b16 a[40:41], v20 offset:26624
    v_mfma_f32_16x16x32_bf16 v[132:135], a[4:7], a[64:67], v[132:135]
    buffer_load_dwordx4 v29, s[24:27], s70 offen offset:1024 lds
    v_mfma_f32_16x16x32_bf16 v[136:139], a[128:131], a[64:67], v[136:139]
    ds_read_b64_tr_b16 a[42:43], v20 offset:27136
    v_mfma_f32_16x16x32_bf16 v[140:143], a[132:135], a[64:67], v[140:143]
    s_add_u32 s76, s70, 0x40000
    ds_read_b64_tr_b16 a[44:45], v21 offset:26624
    v_mfma_f32_16x16x32_bf16 v[144:147], a[0:3], a[68:71], v[144:147]
    buffer_load_dwordx4 a[216:219], v17, s[16:19], s43 offen offset:0 sc1
    v_mfma_f32_16x16x32_bf16 v[148:151], a[4:7], a[68:71], v[148:151]
    ds_read_b64_tr_b16 a[46:47], v21 offset:27136
    v_mfma_f32_16x16x32_bf16 v[152:155], a[128:131], a[68:71], v[152:155]
    ds_read_b64_tr_b16 a[168:169], v22 offset:26624
    v_mfma_f32_16x16x32_bf16 v[156:159], a[132:135], a[68:71], v[156:159]
    ds_read_b64_tr_b16 a[170:171], v22 offset:27136
    ds_read_b64_tr_b16 a[172:173], v23 offset:26624
    v_mfma_f32_16x16x32_bf16 v[224:227], a[32:35], a[192:195], v[224:227]
    buffer_load_dwordx4 a[220:223], v17, s[16:19], s43 offen offset:1024 sc1
    v_mfma_f32_16x16x32_bf16 v[228:231], a[36:39], a[192:195], v[228:231]
    ds_read_b64_tr_b16 a[174:175], v23 offset:27136
    v_mfma_f32_16x16x32_bf16 v[232:235], a[160:163], a[192:195], v[232:235]
    s_add_u32 s43, s43, 0x8000
    v_mfma_f32_16x16x32_bf16 v[236:239], a[164:167], a[192:195], v[236:239]
    buffer_load_dwordx4 a[120:123], v16, s[16:19], s71 offen offset:0 sc1
    v_mfma_f32_16x16x32_bf16 v[240:243], a[32:35], a[196:199], v[240:243]
    v_mfma_f32_16x16x32_bf16 v[244:247], a[36:39], a[196:199], v[244:247]
    v_mfma_f32_16x16x32_bf16 v[248:251], a[160:163], a[196:199], v[248:251]
    v_mfma_f32_16x16x32_bf16 v[252:255], a[164:167], a[196:199], v[252:255]
    buffer_load_dwordx4 a[124:127], v16, s[16:19], s71 offen offset:1024 sc1
    v_mfma_f32_16x16x32_bf16 v[192:195], a[32:35], a[64:67], v[192:195]
    v_mfma_f32_16x16x32_bf16 v[196:199], a[36:39], a[64:67], v[196:199]
    v_mfma_f32_16x16x32_bf16 v[200:203], a[160:163], a[64:67], v[200:203]
    buffer_load_dwordx4 a[248:251], v17, s[16:19], s71 offen offset:0 sc1
    v_mfma_f32_16x16x32_bf16 v[204:207], a[164:167], a[64:67], v[204:207]
    v_mfma_f32_16x16x32_bf16 v[208:211], a[32:35], a[68:71], v[208:211]
    v_mfma_f32_16x16x32_bf16 v[212:215], a[36:39], a[68:71], v[212:215]
    v_mfma_f32_16x16x32_bf16 v[216:219], a[160:163], a[68:71], v[216:219]
    buffer_load_dwordx4 a[252:255], v17, s[16:19], s71 offen offset:1024 sc1
    v_mfma_f32_16x16x32_bf16 v[220:223], a[164:167], a[68:71], v[220:223]
    s_add_u32 s71, s71, 0x8000
    s_waitcnt vmcnt(44) lgkmcnt(0)
    v_mfma_f32_16x16x32_bf16 v[160:163], a[8:11], a[224:227], v[160:163]
    ds_read_b64_tr_b16 a[0:1], v20 offset:32768
    ds_read_b64_tr_b16 a[2:3], v20 offset:33280
    v_mfma_f32_16x16x32_bf16 v[164:167], a[12:15], a[224:227], v[164:167]
    s_add_u32 m0, s31, 16384
    v_mfma_f32_16x16x32_bf16 v[168:171], a[136:139], a[224:227], v[168:171]
    buffer_load_dwordx4 v1, s[24:27], s28 offen offset:0 lds
    v_mfma_f32_16x16x32_bf16 v[172:175], a[140:143], a[224:227], v[172:175]
    ds_read_b64_tr_b16 a[4:5], v21 offset:32768
    v_mfma_f32_16x16x32_bf16 v[176:179], a[8:11], a[228:231], v[176:179]
    ds_read_b64_tr_b16 a[6:7], v21 offset:33280
    v_mfma_f32_16x16x32_bf16 v[180:183], a[12:15], a[228:231], v[180:183]
    ds_read_b64_tr_b16 a[128:129], v22 offset:32768
    v_mfma_f32_16x16x32_bf16 v[184:187], a[136:139], a[228:231], v[184:187]
    buffer_load_dwordx4 v29, s[24:27], s28 offen offset:1024 lds
    v_mfma_f32_16x16x32_bf16 v[188:191], a[140:143], a[228:231], v[188:191]
    ds_read_b64_tr_b16 a[130:131], v22 offset:33280
    ds_read_b64_tr_b16 a[132:133], v23 offset:32768
    v_mfma_f32_16x16x32_bf16 v[128:131], a[8:11], a[96:99], v[128:131]
    s_add_u32 s77, s28, 0x40000
    v_mfma_f32_16x16x32_bf16 v[132:135], a[12:15], a[96:99], v[132:135]
    ds_read_b64_tr_b16 a[134:135], v23 offset:33280
    v_mfma_f32_16x16x32_bf16 v[136:139], a[136:139], a[96:99], v[136:139]
    s_andn2_b32 s50, 0x20, s47
    s_cbranch_scc1 G2_SP5
G2_OK5:
    buffer_load_dwordx4 a[16:19], v16, s[16:19], s41 offen offset:0 sc1
    v_mfma_f32_16x16x32_bf16 v[140:143], a[140:143], a[96:99], v[140:143]
    ds_read_b64_tr_b16 a[32:33], v20 offset:34816
    v_mfma_f32_16x16x32_bf16 v[144:147], a[8:11], a[100:103], v[144:147]
    ds_read_b64_tr_b16 a[34:35], v20 offset:35328
    v_mfma_f32_16x16x32_bf16 v[148:151], a[12:15], a[100:103], v[148:151]
    ds_read_b64_tr_b16 a[36:37], v21 offset:34816
    ds_read_b64_tr_b16 a[38:39], v21 offset:35328
    v_mfma_f32_16x16x32_bf16 v[152:155], a[136:139], a[100:103], v[152:155]
    buffer_load_dwordx4 a[20:23], v16, s[16:19], s41 offen offset:1024 sc1
    v_mfma_f32_16x16x32_bf16 v[156:159], a[140:143], a[100:103], v[156:159]
    ds_read_b64_tr_b16 a[160:161], v22 offset:34816
    v_mfma_f32_16x16x32_bf16 v[224:227], a[40:43], a[224:227], v[224:227]
    ds_read_b64_tr_b16 a[162:163], v22 offset:35328
    v_mfma_f32_16x16x32_bf16 v[228:231], a[44:47], a[224:227], v[228:231]
    ds_read_b64_tr_b16 a[164:165], v23 offset:34816
    v_mfma_f32_16x16x32_bf16 v[232:235], a[168:171], a[224:227], v[232:235]
    buffer_load_dwordx4 a[144:147], v17, s[16:19], s41 offen offset:0 sc1
    v_mfma_f32_16x16x32_bf16 v[236:239], a[172:175], a[224:227], v[236:239]
    ds_read_b64_tr_b16 a[166:167], v23 offset:35328
    v_mfma_f32_16x16x32_bf16 v[240:243], a[40:43], a[228:231], v[240:243]
    v_mfma_f32_16x16x32_bf16 v[244:247], a[44:47], a[228:231], v[244:247]
    v_mfma_f32_16x16x32_bf16 v[248:251], a[168:171], a[228:231], v[248:251]
    buffer_load_dwordx4 a[148:151], v17, s[16:19], s41 offen offset:1024 sc1
    v_mfma_f32_16x16x32_bf16 v[252:255], a[172:175], a[228:231], v[252:255]
    v_mfma_f32_16x16x32_bf16 v[192:195], a[40:43], a[96:99], v[192:195]
    s_add_u32 s41, s41, 0x8000
    v_mfma_f32_16x16x32_bf16 v[196:199], a[44:47], a[96:99], v[196:199]
    v_mfma_f32_16x16x32_bf16 v[200:203], a[168:171], a[96:99], v[200:203]
    buffer_load_dwordx4 a[48:51], v16, s[16:19], s42 offen offset:0 sc1
    v_mfma_f32_16x16x32_bf16 v[204:207], a[172:175], a[96:99], v[204:207]
    v_mfma_f32_16x16x32_bf16 v[208:211], a[40:43], a[100:103], v[208:211]
    v_mfma_f32_16x16x32_bf16 v[212:215], a[44:47], a[100:103], v[212:215]
    v_mfma_f32_16x16x32_bf16 v[216:219], a[168:171], a[100:103], v[216:219]
    buffer_load_dwordx4 a[52:55], v16, s[16:19], s42 offen offset:1024 sc1
    v_mfma_f32_16x16x32_bf16 v[220:223], a[172:175], a[100:103], v[220:223]
    s_waitcnt vmcnt(38) lgkmcnt(0)
    s_barrier
    v_mfma_f32_16x16x32_bf16 v[160:163], a[0:3], a[200:203], v[160:163]
    ds_read_b64_tr_b16 a[8:9], v20 offset:40960
    ds_read_b64_tr_b16 a[10:11], v20 offset:41472
    v_mfma_f32_16x16x32_bf16 v[164:167], a[4:7], a[200:203], v[164:167]
    s_add_u32 m0, s31, 24576
    v_mfma_f32_16x16x32_bf16 v[168:171], a[128:131], a[200:203], v[168:171]
    buffer_load_dwordx4 v1, s[24:27], s29 offen offset:0 lds
    v_mfma_f32_16x16x32_bf16 v[172:175], a[132:135], a[200:203], v[172:175]
    ds_read_b64_tr_b16 a[12:13], v21 offset:40960
    v_mfma_f32_16x16x32_bf16 v[176:179], a[0:3], a[204:207], v[176:179]
    ds_read_b64_tr_b16 a[14:15], v21 offset:41472
    ds_read_b64_tr_b16 a[136:137], v22 offset:40960
    v_mfma_f32_16x16x32_bf16 v[180:183], a[4:7], a[204:207], v[180:183]
    ds_read_b64_tr_b16 a[138:139], v22 offset:41472
    v_mfma_f32_16x16x32_bf16 v[184:187], a[128:131], a[204:207], v[184:187]
    buffer_load_dwordx4 v29, s[24:27], s29 offen offset:1024 lds
    v_mfma_f32_16x16x32_bf16 v[188:191], a[132:135], a[204:207], v[188:191]
    ds_read_b64_tr_b16 a[140:141], v23 offset:40960
    v_mfma_f32_16x16x32_bf16 v[128:131], a[0:3], a[72:75], v[128:131]
    s_add_u32 s84, s29, 0x40000
    v_mfma_f32_16x16x32_bf16 v[132:135], a[4:7], a[72:75], v[132:135]
    ds_read_b64_tr_b16 a[142:143], v23 offset:41472
    ds_read_b64_tr_b16 a[40:41], v20 offset:43008
    v_mfma_f32_16x16x32_bf16 v[136:139], a[128:131], a[72:75], v[136:139]
    buffer_load_dwordx4 a[176:179], v17, s[16:19], s42 offen offset:0 sc1
    v_mfma_f32_16x16x32_bf16 v[140:143], a[132:135], a[72:75], v[140:143]
    ds_read_b64_tr_b16 a[42:43], v20 offset:43520
    v_mfma_f32_16x16x32_bf16 v[144:147], a[0:3], a[76:79], v[144:147]
    ds_read_b64_tr_b16 a[44:45], v21 offset:43008
    v_mfma_f32_16x16x32_bf16 v[148:151], a[4:7], a[76:79], v[148:151]
    ds_read_b64_tr_b16 a[46:47], v21 offset:43520
    v_mfma_f32_16x16x32_bf16 v[152:155], a[128:131], a[76:79], v[152:155]
    buffer_load_dwordx4 a[180:183], v17, s[16:19], s42 offen offset:1024 sc1
    v_mfma_f32_16x16x32_bf16 v[156:159], a[132:135], a[76:79], v[156:159]
    ds_read_b64_tr_b16 a[168:169], v22 offset:43008
    ds_read_b64_tr_b16 a[170:171], v22 offset:43520
    v_mfma_f32_16x16x32_bf16 v[224:227], a[32:35], a[200:203], v[224:227]
    s_add_u32 s42, s42, 0x8000
    v_mfma_f32_16x16x32_bf16 v[228:231], a[36:39], a[200:203], v[228:231]
    ds_read_b64_tr_b16 a[172:173], v23 offset:43008
    v_mfma_f32_16x16x32_bf16 v[232:235], a[160:163], a[200:203], v[232:235]
    buffer_load_dwordx4 a[24:27], v16, s[16:19], s43 offen offset:0 sc1
    v_mfma_f32_16x16x32_bf16 v[236:239], a[164:167], a[200:203], v[236:239]
    ds_read_b64_tr_b16 a[174:175], v23 offset:43520
    v_mfma_f32_16x16x32_bf16 v[240:243], a[32:35], a[204:207], v[240:243]
    v_mfma_f32_16x16x32_bf16 v[244:247], a[36:39], a[204:207], v[244:247]
    v_mfma_f32_16x16x32_bf16 v[248:251], a[160:163], a[204:207], v[248:251]
    buffer_load_dwordx4 a[28:31], v16, s[16:19], s43 offen offset:1024 sc1
    v_mfma_f32_16x16x32_bf16 v[252:255], a[164:167], a[204:207], v[252:255]
    v_mfma_f32_16x16x32_bf16 v[192:195], a[32:35], a[72:75], v[192:195]
    v_mfma_f32_16x16x32_bf16 v[196:199], a[36:39], a[72:75], v[196:199]
    v_mfma_f32_16x16x32_bf16 v[200:203], a[160:163], a[72:75], v[200:203]
    buffer_load_dwordx4 a[152:155], v17, s[16:19], s43 offen offset:0 sc1
    v_mfma_f32_16x16x32_bf16 v[204:207], a[164:167], a[72:75], v[204:207]
    v_mfma_f32_16x16x32_bf16 v[208:211], a[32:35], a[76:79], v[208:211]
    v_mfma_f32_16x16x32_bf16 v[212:215], a[36:39], a[76:79], v[212:215]
    v_mfma_f32_16x16x32_bf16 v[216:219], a[160:163], a[76:79], v[216:219]
    buffer_load_dwordx4 a[156:159], v17, s[16:19], s43 offen offset:1024 sc1
    v_mfma_f32_16x16x32_bf16 v[220:223], a[164:167], a[76:79], v[220:223]
    s_add_u32 s43, s43, 0x8000
    s_waitcnt vmcnt(43) lgkmcnt(0)
    v_mfma_f32_16x16x32_bf16 v[160:163], a[8:11], a[232:235], v[160:163]
    ds_read_b64_tr_b16 a[0:1], v20 offset:49152
    ds_read_b64_tr_b16 a[2:3], v20 offset:49664
    v_mfma_f32_16x16x32_bf16 v[164:167], a[12:15], a[232:235], v[164:167]
    s_add_u32 m0, s31, 32768
    v_mfma_f32_16x16x32_bf16 v[168:171], a[136:139], a[232:235], v[168:171]
    buffer_load_dwordx4 v1, s[24:27], s85 offen offset:0 lds
    v_mfma_f32_16x16x32_bf16 v[172:175], a[140:143], a[232:235], v[172:175]
    ds_read_b64_tr_b16 a[4:5], v21 offset:49152
    v_mfma_f32_16x16x32_bf16 v[176:179], a[8:11], a[236:239], v[176:179]
    ds_read_b64_tr_b16 a[6:7], v21 offset:49664
    v_mfma_f32_16x16x32_bf16 v[180:183], a[12:15], a[236:239], v[180:183]
    ds_read_b64_tr_b16 a[128:129], v22 offset:49152
    v_mfma_f32_16x16x32_bf16 v[184:187], a[136:139], a[236:239], v[184:187]
    buffer_load_dwordx4 v29, s[24:27], s85 offen offset:1024 lds
    v_mfma_f32_16x16x32_bf16 v[188:191], a[140:143], a[236:239], v[188:191]
    ds_read_b64_tr_b16 a[130:131], v22 offset:49664
    ds_read_b64_tr_b16 a[132:133], v23 offset:49152
    v_mfma_f32_16x16x32_bf16 v[128:131], a[8:11], a[104:107], v[128:131]
    s_add_u32 s85, s85, 0x40000
    v_mfma_f32_16x16x32_bf16 v[132:135], a[12:15], a[104:107], v[132:135]
    ds_read_b64_tr_b16 a[134:135], v23 offset:49664
    v_mfma_f32_16x16x32_bf16 v[136:139], a[136:139], a[104:107], v[136:139]
    buffer_load_dwordx4 a[56:59], v16, s[16:19], s71 offen offset:0 sc1
    v_mfma_f32_16x16x32_bf16 v[140:143], a[140:143], a[104:107], v[140:143]
    ds_read_b64_tr_b16 a[32:33], v20 offset:51200
    v_mfma_f32_16x16x32_bf16 v[144:147], a[8:11], a[108:111], v[144:147]
    ds_read_b64_tr_b16 a[34:35], v20 offset:51712
    v_mfma_f32_16x16x32_bf16 v[148:151], a[12:15], a[108:111], v[148:151]
    ds_read_b64_tr_b16 a[36:37], v21 offset:51200
    ds_read_b64_tr_b16 a[38:39], v21 offset:51712
    v_mfma_f32_16x16x32_bf16 v[152:155], a[136:139], a[108:111], v[152:155]
    buffer_load_dwordx4 a[60:63], v16, s[16:19], s71 offen offset:1024 sc1
    v_mfma_f32_16x16x32_bf16 v[156:159], a[140:143], a[108:111], v[156:159]
    ds_read_b64_tr_b16 a[160:161], v22 offset:51200
    v_mfma_f32_16x16x32_bf16 v[224:227], a[40:43], a[232:235], v[224:227]
    ds_read_b64_tr_b16 a[162:163], v22 offset:51712
    v_mfma_f32_16x16x32_bf16 v[228:231], a[44:47], a[232:235], v[228:231]
    ds_read_b64_tr_b16 a[164:165], v23 offset:51200
    v_mfma_f32_16x16x32_bf16 v[232:235], a[168:171], a[232:235], v[232:235]
    buffer_load_dwordx4 a[184:187], v17, s[16:19], s71 offen offset:0 sc1
    v_mfma_f32_16x16x32_bf16 v[236:239], a[172:175], a[232:235], v[236:239]
    ds_read_b64_tr_b16 a[166:167], v23 offset:51712
    v_mfma_f32_16x16x32_bf16 v[240:243], a[40:43], a[236:239], v[240:243]
    v_mfma_f32_16x16x32_bf16 v[244:247], a[44:47], a[236:239], v[244:247]
    v_mfma_f32_16x16x32_bf16 v[248:251], a[168:171], a[236:239], v[248:251]
    buffer_load_dwordx4 a[188:191], v17, s[16:19], s71 offen offset:1024 sc1
    v_mfma_f32_16x16x32_bf16 v[252:255], a[172:175], a[236:239], v[252:255]
    v_mfma_f32_16x16x32_bf16 v[192:195], a[40:43], a[104:107], v[192:195]
    s_add_u32 s71, s71, 0x8000
    v_mfma_f32_16x16x32_bf16 v[196:199], a[44:47], a[104:107], v[196:199]
    v_mfma_f32_16x16x32_bf16 v[200:203], a[168:171], a[104:107], v[200:203]
    s_andn2_b32 s50, 0x40, s47
    s_cbranch_scc1 G2_SP6
G2_OK6:
    buffer_load_dwordx4 a[64:67], v16, s[16:19], s41 offen offset:0 sc1
    v_mfma_f32_16x16x32_bf16 v[204:207], a[172:175], a[104:107], v[204:207]
    v_mfma_f32_16x16x32_bf16 v[208:211], a[40:43], a[108:111], v[208:211]
    v_mfma_f32_16x16x32_bf16 v[212:215], a[44:47], a[108:111], v[212:215]
    v_mfma_f32_16x16x32_bf16 v[216:219], a[168:171], a[108:111], v[216:219]
    buffer_load_dwordx4 a[68:71], v16, s[16:19], s41 offen offset:1024 sc1
    v_mfma_f32_16x16x32_bf16 v[220:223], a[172:175], a[108:111], v[220:223]
    s_waitcnt vmcnt(39) lgkmcnt(0)
    s_barrier
    v_mfma_f32_16x16x32_bf16 v[160:163], a[0:3], a[208:211], v[160:163]
    v_cmp_ne_u32 vcc, 0, v3
    s_nop 0
    s_or_b32 s47, s47, vcc_lo
    v_mfma_f32_16x16x32_bf16 v[164:167], a[4:7], a[208:211], v[164:167]
    s_add_u32 m0, s31, 40960
    ds_read_b64_tr_b16 a[8:9], v20 offset:57344
    v_mfma_f32_16x16x32_bf16 v[168:171], a[128:131], a[208:211], v[168:171]
    buffer_load_dwordx4 v1, s[24:27], s76 offen offset:0 lds
    v_mfma_f32_16x16x32_bf16 v[172:175], a[132:135], a[208:211], v[172:175]
    ds_read_b64_tr_b16 a[10:11], v20 offset:57856
    ds_read_b64 v[96:97], v116 offset:0
    v_mfma_f32_16x16x32_bf16 v[176:179], a[0:3], a[212:215], v[176:179]
    ds_read_b64_tr_b16 a[12:13], v21 offset:57344
    v_mfma_f32_16x16x32_bf16 v[180:183], a[4:7], a[212:215], v[180:183]
    ds_read_b64_tr_b16 a[14:15], v21 offset:57856
    ds_read_b64_tr_b16 a[136:137], v22 offset:57344
    v_mfma_f32_16x16x32_bf16 v[184:187], a[128:131], a[212:215], v[184:187]
    buffer_load_dwordx4 v29, s[24:27], s76 offen offset:1024 lds
    v_mfma_f32_16x16x32_bf16 v[188:191], a[132:135], a[212:215], v[188:191]
    ds_read_b64_tr_b16 a[138:139], v22 offset:57856
    v_mfma_f32_16x16x32_bf16 v[128:131], a[0:3], a[80:83], v[128:131]
    s_add_u32 s76, s76, 0x40000
    ds_read_b64 v[98:99], v117 offset:0
    v_mfma_f32_16x16x32_bf16 v[132:135], a[4:7], a[80:83], v[132:135]
    ds_read_b64_tr_b16 a[140:141], v23 offset:57344
    v_mfma_f32_16x16x32_bf16 v[136:139], a[128:131], a[80:83], v[136:139]
    buffer_load_dwordx4 a[192:195], v17, s[16:19], s41 offen offset:0 sc1
    v_mfma_f32_16x16x32_bf16 v[140:143], a[132:135], a[80:83], v[140:143]
    ds_read_b64_tr_b16 a[142:143], v23 offset:57856
    ds_read_b64_tr_b16 a[40:41], v20 offset:59392
    v_mfma_f32_16x16x32_bf16 v[144:147], a[0:3], a[84:87], v[144:147]
    ds_read_b64_tr_b16 a[42:43], v20 offset:59904
    v_mfma_f32_16x16x32_bf16 v[148:151], a[4:7], a[84:87], v[148:151]
    ds_read_b64_tr_b16 a[44:45], v21 offset:59392
    v_mfma_f32_16x16x32_bf16 v[152:155], a[128:131], a[84:87], v[152:155]
    buffer_load_dwordx4 a[196:199], v17, s[16:19], s41 offen offset:1024 sc1
    v_mfma_f32_16x16x32_bf16 v[156:159], a[132:135], a[84:87], v[156:159]
    ds_read_b64_tr_b16 a[46:47], v21 offset:59904
    ds_read_b64_tr_b16 a[168:169], v22 offset:59392
    v_mfma_f32_16x16x32_bf16 v[224:227], a[32:35], a[208:211], v[224:227]
    ds_read_b64_tr_b16 a[170:171], v22 offset:59904
    ds_read_b64 v[100:101], v118 offset:0
    v_mfma_f32_16x16x32_bf16 v[228:231], a[36:39], a[208:211], v[228:231]
    ds_read_b64_tr_b16 a[172:173], v23 offset:59392
    v_mfma_f32_16x16x32_bf16 v[232:235], a[160:163], a[208:211], v[232:235]
    buffer_load_dwordx4 a[96:99], v16, s[16:19], s42 offen offset:0 sc1
    v_mfma_f32_16x16x32_bf16 v[236:239], a[164:167], a[208:211], v[236:239]
IW_P10:
    s_cbranch_execz IW_R1
    ds_read_b64_tr_b16 a[174:175], v23 offset:59904
    v_mfma_f32_16x16x32_bf16 v[240:243], a[32:35], a[212:215], v[240:243]
    ds_read_b64 v[102:103], v119 offset:0
    ds_read_b64 v[104:105], v116 offset:2048
    ds_read_b64 v[106:107], v117 offset:2048
    ds_read_b64 v[108:109], v118 offset:2048
    ds_read_b64 v[110:111], v119 offset:2048
    v_mfma_f32_16x16x32_bf16 v[244:247], a[36:39], a[212:215], v[244:247]
    v_mfma_f32_16x16x32_bf16 v[248:251], a[160:163], a[212:215], v[248:251]
    buffer_load_dwordx4 a[100:103], v16, s[16:19], s42 offen offset:1024 sc1
    v_mfma_f32_16x16x32_bf16 v[252:255], a[164:167], a[212:215], v[252:255]
    v_mfma_f32_16x16x32_bf16 v[192:195], a[32:35], a[80:83], v[192:195]
    v_mfma_f32_16x16x32_bf16 v[196:199], a[36:39], a[80:83], v[196:199]
    v_mfma_f32_16x16x32_bf16 v[200:203], a[160:163], a[80:83], v[200:203]
    buffer_load_dwordx4 a[224:227], v17, s[16:19], s42 offen offset:0 sc1
    v_mfma_f32_16x16x32_bf16 v[204:207], a[164:167], a[80:83], v[204:207]
    v_mfma_f32_16x16x32_bf16 v[208:211], a[32:35], a[84:87], v[208:211]
    v_mfma_f32_16x16x32_bf16 v[212:215], a[36:39], a[84:87], v[212:215]
    v_mfma_f32_16x16x32_bf16 v[216:219], a[160:163], a[84:87], v[216:219]
    buffer_load_dwordx4 a[228:231], v17, s[16:19], s42 offen offset:1024 sc1
    v_mfma_f32_16x16x32_bf16 v[220:223], a[164:167], a[84:87], v[220:223]
    s_waitcnt vmcnt(43) lgkmcnt(0)
    v_mfma_f32_16x16x32_bf16 v[160:163], a[8:11], a[240:243], v[160:163]
    ds_read_b64_tr_b16 a[32:33], v20 offset:0
    v_lshlrev_b32 v64, 16, v96
    v_mfma_f32_16x16x32_bf16 v[164:167], a[12:15], a[240:243], v[164:167]
    s_add_u32 m0, s31, 49152
    v_mfma_f32_16x16x32_bf16 v[168:171], a[136:139], a[240:243], v[168:171]
    buffer_load_dwordx4 v1, s[24:27], s77 offen offset:0 lds
    v_mfma_f32_16x16x32_bf16 v[172:175], a[140:143], a[240:243], v[172:175]
    ds_read_b64_tr_b16 a[34:35], v20 offset:512
    v_and_b32 v65, s58, v96
    v_mfma_f32_16x16x32_bf16 v[176:179], a[8:11], a[244:247], v[176:179]
    v_lshlrev_b32 v66, 16, v97
    v_mfma_f32_16x16x32_bf16 v[180:183], a[12:15], a[244:247], v[180:183]
    ds_read_b64_tr_b16 a[36:37], v21 offset:0
    v_mfma_f32_16x16x32_bf16 v[184:187], a[136:139], a[244:247], v[184:187]
    buffer_load_dwordx4 v29, s[24:27], s77 offen offset:1024 lds
    v_mfma_f32_16x16x32_bf16 v[188:191], a[140:143], a[244:247], v[188:191]
    v_and_b32 v67, s58, v97
    v_mfma_f32_16x16x32_bf16 v[128:131], a[8:11], a[112:115], v[128:131]
    ds_read_b64_tr_b16 a[38:39], v21 offset:512
    v_mfma_f32_16x16x32_bf16 v[132:135], a[12:15], a[112:115], v[132:135]
    v_lshlrev_b32 v68, 16, v98
    v_mfma_f32_16x16x32_bf16 v[136:139], a[136:139], a[112:115], v[136:139]
    buffer_load_dwordx4 a[72:75], v16, s[16:19], s43 offen offset:0 sc1
    v_mfma_f32_16x16x32_bf16 v[140:143], a[140:143], a[112:115], v[140:143]
    ds_read_b64_tr_b16 a[160:161], v22 offset:0
    v_mfma_f32_16x16x32_bf16 v[144:147], a[8:11], a[116:119], v[144:147]
    ds_read_b64_tr_b16 a[162:163], v22 offset:512
    v_and_b32 v69, s58, v98
    v_mfma_f32_16x16x32_bf16 v[148:151], a[12:15], a[116:119], v[148:151]
    v_lshlrev_b32 v70, 16, v99
    v_mfma_f32_16x16x32_bf16 v[152:155], a[136:139], a[116:119], v[152:155]
    buffer_load_dwordx4 a[76:79], v16, s[16:19], s43 offen offset:1024 sc1
    v_mfma_f32_16x16x32_bf16 v[156:159], a[140:143], a[116:119], v[156:159]
    ds_read_b64_tr_b16 a[164:165], v23 offset:0
    v_mfma_f32_16x16x32_bf16 v[224:227], a[40:43], a[240:243], v[224:227]
    v_and_b32 v71, s58, v99
    v_mfma_f32_16x16x32_bf16 v[228:231], a[44:47], a[240:243], v[228:231]
    ds_read_b64_tr_b16 a[166:167], v23 offset:512
    v_mfma_f32_16x16x32_bf16 v[232:235], a[168:171], a[240:243], v[232:235]
    buffer_load_dwordx4 a[200:203], v17, s[16:19], s43 offen offset:0 sc1
    v_mfma_f32_16x16x32_bf16 v[236:239], a[172:175], a[240:243], v[236:239]
    v_lshlrev_b32 v72, 16, v100
    v_mfma_f32_16x16x32_bf16 v[240:243], a[40:43], a[244:247], v[240:243]
    v_and_b32 v73, s58, v100
    v_mfma_f32_16x16x32_bf16 v[244:247], a[44:47], a[244:247], v[244:247]
    v_lshlrev_b32 v74, 16, v101
    v_mfma_f32_16x16x32_bf16 v[248:251], a[168:171], a[244:247], v[248:251]
    buffer_load_dwordx4 a[204:207], v17, s[16:19], s43 offen offset:1024 sc1
    v_mfma_f32_16x16x32_bf16 v[252:255], a[172:175], a[244:247], v[252:255]
    v_and_b32 v75, s58, v101
    v_mfma_f32_16x16x32_bf16 v[192:195], a[40:43], a[112:115], v[192:195]
    v_mfma_f32_16x16x32_bf16 v[196:199], a[44:47], a[112:115], v[196:199]
    v_lshlrev_b32 v76, 16, v102
    v_mfma_f32_16x16x32_bf16 v[200:203], a[168:171], a[112:115], v[200:203]
    buffer_load_dwordx4 a[104:107], v16, s[16:19], s71 offen offset:0 sc1
    v_mfma_f32_16x16x32_bf16 v[204:207], a[172:175], a[112:115], v[204:207]
    v_and_b32 v77, s58, v102
    v_mfma_f32_16x16x32_bf16 v[208:211], a[40:43], a[116:119], v[208:211]
    v_lshlrev_b32 v78, 16, v103
    v_mfma_f32_16x16x32_bf16 v[212:215], a[44:47], a[116:119], v[212:215]
    v_and_b32 v79, s58, v103
    v_mfma_f32_16x16x32_bf16 v[216:219], a[168:171], a[116:119], v[216:219]
    buffer_load_dwordx4 a[108:111], v16, s[16:19], s71 offen offset:1024 sc1
    v_mfma_f32_16x16x32_bf16 v[220:223], a[172:175], a[116:119], v[220:223]
    s_waitcnt vmcnt(38) lgkmcnt(0)
    s_barrier
    v_mfma_f32_16x16x32_bf16 v[160:163], a[32:35], a[216:219], v[160:163]
    ds_read_b64_tr_b16 a[40:41], v20 offset:8192
    ds_read_b64_tr_b16 a[42:43], v20 offset:8704
    v_mfma_f32_16x16x32_bf16 v[164:167], a[36:39], a[216:219], v[164:167]
    s_add_u32 m0, s31, 57344
    v_lshlrev_b32 v80, 16, v104
    v_mfma_f32_16x16x32_bf16 v[168:171], a[160:163], a[216:219], v[168:171]
    buffer_load_dwordx4 v1, s[24:27], s84 offen offset:0 lds
    v_mfma_f32_16x16x32_bf16 v[172:175], a[164:167], a[216:219], v[172:175]
    ds_read_b64_tr_b16 a[44:45], v21 offset:8192
    v_and_b32 v81, s58, v104
    v_mfma_f32_16x16x32_bf16 v[176:179], a[32:35], a[220:223], v[176:179]
    ds_read_b64_tr_b16 a[46:47], v21 offset:8704
    v_lshlrev_b32 v82, 16, v105
    v_mfma_f32_16x16x32_bf16 v[180:183], a[36:39], a[220:223], v[180:183]
    ds_read_b64_tr_b16 a[168:169], v22 offset:8192
    v_and_b32 v83, s58, v105
    v_mfma_f32_16x16x32_bf16 v[184:187], a[160:163], a[220:223], v[184:187]
    buffer_load_dwordx4 v29, s[24:27], s84 offen offset:1024 lds
    v_mfma_f32_16x16x32_bf16 v[188:191], a[164:167], a[220:223], v[188:191]
    ds_read_b64_tr_b16 a[170:171], v22 offset:8704
    v_lshlrev_b32 v84, 16, v106
    v_mfma_f32_16x16x32_bf16 v[128:131], a[32:35], a[88:91], v[128:131]
    ds_read_b64_tr_b16 a[172:173], v23 offset:8192
    v_and_b32 v85, s58, v106
    v_mfma_f32_16x16x32_bf16 v[132:135], a[36:39], a[88:91], v[132:135]
    ds_read_b64_tr_b16 a[174:175], v23 offset:8704
    v_lshlrev_b32 v86, 16, v107
    v_mfma_f32_16x16x32_bf16 v[136:139], a[160:163], a[88:91], v[136:139]
    buffer_load_dwordx4 a[232:235], v17, s[16:19], s71 offen offset:0 sc1
    v_mfma_f32_16x16x32_bf16 v[140:143], a[164:167], a[88:91], v[140:143]
    v_and_b32 v87, s58, v107
    v_lshlrev_b32 v88, 16, v108
    v_mfma_f32_16x16x32_bf16 v[144:147], a[32:35], a[92:95], v[144:147]
    v_and_b32 v89, s58, v108
    v_lshlrev_b32 v90, 16, v109
    v_mfma_f32_16x16x32_bf16 v[148:151], a[36:39], a[92:95], v[148:151]
    v_and_b32 v91, s58, v109
    v_lshlrev_b32 v92, 16, v110
    v_mfma_f32_16x16x32_bf16 v[152:155], a[160:163], a[92:95], v[152:155]
    buffer_load_dwordx4 a[236:239], v17, s[16:19], s71 offen offset:1024 sc1
    v_mfma_f32_16x16x32_bf16 v[156:159], a[164:167], a[92:95], v[156:159]
    v_and_b32 v93, s58, v110
    v_lshlrev_b32 v94, 16, v111
    s_waitcnt vmcnt(44) lgkmcnt(0)
    v_mfma_f32_16x16x32_bf16 v[160:163], a[40:43], a[248:251], v[160:163]
    ds_read_b64_tr_b16 a[0:1], v20 offset:16384
    ds_read_b64_tr_b16 a[2:3], v20 offset:16896
    v_mfma_f32_16x16x32_bf16 v[164:167], a[44:47], a[248:251], v[164:167]
    s_add_u32 m0, s31, 0
    v_and_b32 v95, s58, v111
    v_mfma_f32_16x16x32_bf16 v[168:171], a[168:171], a[248:251], v[168:171]
    buffer_load_dwordx4 v1, s[24:27], s85 offen offset:0 lds
    v_mfma_f32_16x16x32_bf16 v[172:175], a[172:175], a[248:251], v[172:175]
    ds_read_b64_tr_b16 a[4:5], v21 offset:16384
    v_mfma_f32_16x16x32_bf16 v[176:179], a[40:43], a[252:255], v[176:179]
    ds_read_b64_tr_b16 a[6:7], v21 offset:16896
    v_mfma_f32_16x16x32_bf16 v[180:183], a[44:47], a[252:255], v[180:183]
    ds_read_b64_tr_b16 a[128:129], v22 offset:16384
    ds_read_b64_tr_b16 a[130:131], v22 offset:16896
    v_mfma_f32_16x16x32_bf16 v[184:187], a[168:171], a[252:255], v[184:187]
    buffer_load_dwordx4 v29, s[24:27], s85 offen offset:1024 lds
    v_mfma_f32_16x16x32_bf16 v[188:191], a[172:175], a[252:255], v[188:191]
    ds_read_b64_tr_b16 a[132:133], v23 offset:16384
    v_mfma_f32_16x16x32_bf16 v[128:131], a[40:43], a[120:123], v[128:131]
    ds_read_b64_tr_b16 a[134:135], v23 offset:16896
    v_mfma_f32_16x16x32_bf16 v[132:135], a[44:47], a[120:123], v[132:135]
    s_add_u32 m0, s31, 2048
    v_mfma_f32_16x16x32_bf16 v[136:139], a[168:171], a[120:123], v[136:139]
    buffer_load_dwordx4 v30, s[24:27], s30 offen offset:0 lds
    v_mfma_f32_16x16x32_bf16 v[140:143], a[172:175], a[120:123], v[140:143]
    v_xor_b32 v116, 32, v6
    v_mfma_f32_16x16x32_bf16 v[144:147], a[40:43], a[124:127], v[144:147]
    v_mfma_f32_16x16x32_bf16 v[148:151], a[44:47], a[124:127], v[148:151]
    s_waitcnt vmcnt(55)
G2_ZC:
    v_cmp_eq_u32 vcc, 0, v40
    s_nop 1
    s_cbranch_vccnz G2_ZSP
G2_ZOK:
    v_mfma_f32_16x16x32_bf16 v[152:155], a[168:171], a[124:127], v[152:155]
    buffer_load_dwordx4 v31, s[24:27], s30 offen offset:1024 lds
    v_mfma_f32_16x16x32_bf16 v[156:159], a[172:175], a[124:127], v[156:159]
    s_add_u32 s30, s30, 0x40000
    s_waitcnt vmcnt(22) lgkmcnt(0)
    s_barrier
    v_mfma_f32_16x16x32_bf16 v[160:163], a[0:3], a[144:147], v[160:163]
    ds_read_b64_tr_b16 a[8:9], v20 offset:24576
    ds_read_b64_tr_b16 a[10:11], v20 offset:25088
    v_mfma_f32_16x16x32_bf16 v[164:167], a[4:7], a[144:147], v[164:167]
    s_add_u32 m0, s31, 8192
    ds_read_b64_tr_b16 a[12:13], v21 offset:24576
    v_mfma_f32_16x16x32_bf16 v[168:171], a[128:131], a[144:147], v[168:171]
    buffer_load_dwordx4 v1, s[24:27], s76 offen offset:0 lds
    v_mfma_f32_16x16x32_bf16 v[172:175], a[132:135], a[144:147], v[172:175]
    ds_read_b64_tr_b16 a[14:15], v21 offset:25088
    v_mfma_f32_16x16x32_bf16 v[176:179], a[0:3], a[148:151], v[176:179]
    buffer_load_dwordx4 v29, s[24:27], s76 offen offset:1024 lds
    v_mfma_f32_16x16x32_bf16 v[180:183], a[4:7], a[148:151], v[180:183]
    ds_read_b64_tr_b16 a[136:137], v22 offset:24576
    ds_read_b64_tr_b16 a[138:139], v22 offset:25088
    v_mfma_f32_16x16x32_bf16 v[184:187], a[128:131], a[148:151], v[184:187]
    s_mov_b32 m0, s57
    v_mfma_f32_16x16x32_bf16 v[188:191], a[132:135], a[148:151], v[188:191]
    buffer_load_dwordx4 v26, s[12:15], s56 offen offset:0 sc1 lds
    v_add_u32 v26, 0x7c00, v26
    v_mfma_f32_16x16x32_bf16 v[128:131], a[0:3], a[16:19], v[128:131]
    ds_read_b64_tr_b16 a[140:141], v23 offset:24576
    ds_read_b64_tr_b16 a[142:143], v23 offset:25088
    v_mfma_f32_16x16x32_bf16 v[132:135], a[4:7], a[16:19], v[132:135]
    s_mov_b32 m0, s57
    v_mfma_f32_16x16x32_bf16 v[136:139], a[128:131], a[16:19], v[136:139]
    buffer_load_dwordx4 v26, s[12:15], s56 offen offset:1024 sc1 lds
    v_add_u32 v26, 0x7c00, v26
    v_mfma_f32_16x16x32_bf16 v[140:143], a[132:135], a[16:19], v[140:143]
    v_mfma_f32_16x16x32_bf16 v[144:147], a[0:3], a[20:23], v[144:147]
    buffer_load_dword v112, v25, s[8:11], 0 offen offset:0 sc1
    v_mfma_f32_16x16x32_bf16 v[148:151], a[4:7], a[20:23], v[148:151]
    v_mfma_f32_16x16x32_bf16 v[152:155], a[128:131], a[20:23], v[152:155]
    v_mfma_f32_16x16x32_bf16 v[156:159], a[132:135], a[20:23], v[156:159]
    buffer_load_dword v113, v25, s[8:11], 0 offen offset:64 sc1
    s_waitcnt vmcnt(42) lgkmcnt(0)
    v_mfma_f32_16x16x32_bf16 v[160:163], a[8:11], a[176:179], v[160:163]
    ds_read_b64_tr_b16 a[32:33], v20 offset:32768
    ds_read_b64_tr_b16 a[34:35], v20 offset:33280
    v_mfma_f32_16x16x32_bf16 v[164:167], a[12:15], a[176:179], v[164:167]
    s_add_u32 m0, s31, 10240
    v_mfma_f32_16x16x32_bf16 v[168:171], a[136:139], a[176:179], v[168:171]
    buffer_load_dwordx4 v30, s[24:27], s70 offen offset:0 lds
    v_mfma_f32_16x16x32_bf16 v[172:175], a[140:143], a[176:179], v[172:175]
    ds_read_b64_tr_b16 a[36:37], v21 offset:32768
    ds_read_b64_tr_b16 a[38:39], v21 offset:33280
    v_mfma_f32_16x16x32_bf16 v[176:179], a[8:11], a[180:183], v[176:179]
    ds_read_b64_tr_b16 a[160:161], v22 offset:32768
    v_mfma_f32_16x16x32_bf16 v[180:183], a[12:15], a[180:183], v[180:183]
    ds_read_b64_tr_b16 a[162:163], v22 offset:33280
    v_mfma_f32_16x16x32_bf16 v[184:187], a[136:139], a[180:183], v[184:187]
    buffer_load_dwordx4 v31, s[24:27], s70 offen offset:1024 lds
    v_mfma_f32_16x16x32_bf16 v[188:191], a[140:143], a[180:183], v[188:191]
    ds_read_b64_tr_b16 a[164:165], v23 offset:32768
    ds_read_b64_tr_b16 a[166:167], v23 offset:33280
    v_mfma_f32_16x16x32_bf16 v[128:131], a[8:11], a[48:51], v[128:131]
    s_add_u32 s70, s70, 0x40000
    v_mfma_f32_16x16x32_bf16 v[132:135], a[12:15], a[48:51], v[132:135]
    s_mov_b32 m0, s57
    v_mfma_f32_16x16x32_bf16 v[136:139], a[136:139], a[48:51], v[136:139]
    buffer_load_dwordx4 v26, s[12:15], s56 offen offset:2048 sc1 lds
    v_add_u32 v26, 0x7c00, v26
    v_mfma_f32_16x16x32_bf16 v[140:143], a[140:143], a[48:51], v[140:143]
    v_mfma_f32_16x16x32_bf16 v[144:147], a[8:11], a[52:55], v[144:147]
    v_mfma_f32_16x16x32_bf16 v[148:151], a[12:15], a[52:55], v[148:151]
    s_mov_b32 m0, s57
    v_mfma_f32_16x16x32_bf16 v[152:155], a[136:139], a[52:55], v[152:155]
    buffer_load_dwordx4 v26, s[12:15], s56 offen offset:3072 sc1 lds
    v_mfma_f32_16x16x32_bf16 v[156:159], a[140:143], a[52:55], v[156:159]
    s_waitcnt vmcnt(42) lgkmcnt(0)
    v_mfma_f32_16x16x32_bf16 v[160:163], a[32:35], a[152:155], v[160:163]
    ds_read_b64_tr_b16 a[40:41], v20 offset:40960
    ds_read_b64_tr_b16 a[42:43], v20 offset:41472
    v_mfma_f32_16x16x32_bf16 v[164:167], a[36:39], a[152:155], v[164:167]
    s_add_u32 m0, s31, 18432
    v_mfma_f32_16x16x32_bf16 v[168:171], a[160:163], a[152:155], v[168:171]
    buffer_load_dwordx4 v30, s[24:27], s28 offen offset:0 lds
    v_mfma_f32_16x16x32_bf16 v[172:175], a[164:167], a[152:155], v[172:175]
    ds_read_b64_tr_b16 a[44:45], v21 offset:40960
    ds_read_b64_tr_b16 a[46:47], v21 offset:41472
    v_mfma_f32_16x16x32_bf16 v[176:179], a[32:35], a[156:159], v[176:179]
    ds_read_b64_tr_b16 a[168:169], v22 offset:40960
    v_mfma_f32_16x16x32_bf16 v[180:183], a[36:39], a[156:159], v[180:183]
    ds_read_b64_tr_b16 a[170:171], v22 offset:41472
    v_mfma_f32_16x16x32_bf16 v[184:187], a[160:163], a[156:159], v[184:187]
    buffer_load_dwordx4 v31, s[24:27], s28 offen offset:1024 lds
    v_mfma_f32_16x16x32_bf16 v[188:191], a[164:167], a[156:159], v[188:191]
    ds_read_b64_tr_b16 a[172:173], v23 offset:40960
    ds_read_b64_tr_b16 a[174:175], v23 offset:41472
    v_mfma_f32_16x16x32_bf16 v[128:131], a[32:35], a[24:27], v[128:131]
    s_add_u32 s28, s28, 0x40000
    v_mfma_f32_16x16x32_bf16 v[132:135], a[36:39], a[24:27], v[132:135]
    s_add_u32 m0, s31, 26624
    v_mfma_f32_16x16x32_bf16 v[136:139], a[160:163], a[24:27], v[136:139]
    buffer_load_dwordx4 v30, s[24:27], s29 offen offset:0 lds
    v_mfma_f32_16x16x32_bf16 v[140:143], a[164:167], a[24:27], v[140:143]
    v_mfma_f32_16x16x32_bf16 v[144:147], a[32:35], a[28:31], v[144:147]
    v_mfma_f32_16x16x32_bf16 v[148:151], a[36:39], a[28:31], v[148:151]
    v_mfma_f32_16x16x32_bf16 v[152:155], a[160:163], a[28:31], v[152:155]
    buffer_load_dwordx4 v31, s[24:27], s29 offen offset:1024 lds
    v_mfma_f32_16x16x32_bf16 v[156:159], a[164:167], a[28:31], v[156:159]
    s_add_u32 s29, s29, 0x40000
    s_waitcnt vmcnt(12) lgkmcnt(0)
    s_barrier
    v_mfma_f32_16x16x32_bf16 v[160:163], a[40:43], a[184:187], v[160:163]
    ds_read_b64_tr_b16 a[0:1], v20 offset:49152
    ds_read_b64_tr_b16 a[2:3], v20 offset:49664
    ds_read_b64_tr_b16 a[4:5], v21 offset:49152
    v_mfma_f32_16x16x32_bf16 v[164:167], a[44:47], a[184:187], v[164:167]
    s_add_u32 m0, s31, 34816
    ds_read_b64_tr_b16 a[6:7], v21 offset:49664
    v_mfma_f32_16x16x32_bf16 v[168:171], a[168:171], a[184:187], v[168:171]
    buffer_load_dwordx4 v30, s[24:27], s30 offen offset:0 lds
    v_mfma_f32_16x16x32_bf16 v[172:175], a[172:175], a[184:187], v[172:175]
    ds_read_b64_tr_b16 a[128:129], v22 offset:49152
    ds_read_b64_tr_b16 a[130:131], v22 offset:49664
    v_mfma_f32_16x16x32_bf16 v[176:179], a[40:43], a[188:191], v[176:179]
    ds_read_b64_tr_b16 a[132:133], v23 offset:49152
    ds_read_b64_tr_b16 a[134:135], v23 offset:49664
    v_mfma_f32_16x16x32_bf16 v[180:183], a[44:47], a[188:191], v[180:183]
    ds_read_b64_tr_b16 a[8:9], v20 offset:57344
    ds_read_b64_tr_b16 a[10:11], v20 offset:57856
    v_mfma_f32_16x16x32_bf16 v[184:187], a[168:171], a[188:191], v[184:187]
    buffer_load_dwordx4 v31, s[24:27], s30 offen offset:1024 lds
    v_mfma_f32_16x16x32_bf16 v[188:191], a[172:175], a[188:191], v[188:191]
    ds_read_b64_tr_b16 a[12:13], v21 offset:57344
    ds_read_b64_tr_b16 a[14:15], v21 offset:57856
    v_mfma_f32_16x16x32_bf16 v[128:131], a[40:43], a[56:59], v[128:131]
    s_add_u32 s30, s30, 0x40000
    ds_read_b64_tr_b16 a[136:137], v22 offset:57344
    v_mfma_f32_16x16x32_bf16 v[132:135], a[44:47], a[56:59], v[132:135]
    s_add_u32 m0, s31, 43008
    ds_read_b64_tr_b16 a[138:139], v22 offset:57856
    v_mfma_f32_16x16x32_bf16 v[136:139], a[168:171], a[56:59], v[136:139]
    buffer_load_dwordx4 v30, s[24:27], s70 offen offset:0 lds
    v_mfma_f32_16x16x32_bf16 v[140:143], a[172:175], a[56:59], v[140:143]
    ds_read_b64_tr_b16 a[140:141], v23 offset:57344
    ds_read_b64_tr_b16 a[142:143], v23 offset:57856
    v_mfma_f32_16x16x32_bf16 v[144:147], a[40:43], a[60:63], v[144:147]
    v_mfma_f32_16x16x32_bf16 v[148:151], a[44:47], a[60:63], v[148:151]
    v_mfma_f32_16x16x32_bf16 v[152:155], a[168:171], a[60:63], v[152:155]
    buffer_load_dwordx4 v31, s[24:27], s70 offen offset:1024 lds
    v_mfma_f32_16x16x32_bf16 v[156:159], a[172:175], a[60:63], v[156:159]
    s_add_u32 s70, s70, 0x40000
    s_waitcnt vmcnt(34) lgkmcnt(0)
    v_mfma_f32_16x16x32_bf16 v[160:163], a[0:3], a[192:195], v[160:163]
    ds_read_b64_tr_b16 a[32:33], v20 offset:0
    ds_read_b64_tr_b16 a[34:35], v20 offset:512
    v_mfma_f32_16x16x32_bf16 v[164:167], a[4:7], a[192:195], v[164:167]
    s_add_u32 m0, s31, 51200
    ds_read_b64_tr_b16 a[36:37], v21 offset:0
    v_mfma_f32_16x16x32_bf16 v[168:171], a[128:131], a[192:195], v[168:171]
    buffer_load_dwordx4 v30, s[24:27], s28 offen offset:0 lds
    v_mfma_f32_16x16x32_bf16 v[172:175], a[132:135], a[192:195], v[172:175]
    ds_read_b64_tr_b16 a[38:39], v21 offset:512
    ds_read_b64_tr_b16 a[160:161], v22 offset:0
    v_mfma_f32_16x16x32_bf16 v[176:179], a[0:3], a[196:199], v[176:179]
    ds_read_b64_tr_b16 a[162:163], v22 offset:512
    ds_read_b64_tr_b16 a[164:165], v23 offset:0
    v_mfma_f32_16x16x32_bf16 v[180:183], a[4:7], a[196:199], v[180:183]
    ds_read_b64_tr_b16 a[166:167], v23 offset:512
    ds_read_b64_tr_b16 a[40:41], v20 offset:8192
    v_mfma_f32_16x16x32_bf16 v[184:187], a[128:131], a[196:199], v[184:187]
    buffer_load_dwordx4 v31, s[24:27], s28 offen offset:1024 lds
    v_mfma_f32_16x16x32_bf16 v[188:191], a[132:135], a[196:199], v[188:191]
    ds_read_b64_tr_b16 a[42:43], v20 offset:8704
    ds_read_b64_tr_b16 a[44:45], v21 offset:8192
    v_mfma_f32_16x16x32_bf16 v[160:163], a[8:11], a[224:227], v[160:163]
    ds_read_b64_tr_b16 a[46:47], v21 offset:8704
    ds_read_b64_tr_b16 a[168:169], v22 offset:8192
    v_mfma_f32_16x16x32_bf16 v[164:167], a[12:15], a[224:227], v[164:167]
    s_add_u32 m0, s31, 59392
    ds_read_b64_tr_b16 a[170:171], v22 offset:8704
    v_mfma_f32_16x16x32_bf16 v[168:171], a[136:139], a[224:227], v[168:171]
    buffer_load_dwordx4 v30, s[24:27], s29 offen offset:0 lds
    v_mfma_f32_16x16x32_bf16 v[172:175], a[140:143], a[224:227], v[172:175]
    ds_read_b64_tr_b16 a[172:173], v23 offset:8192
    ds_read_b64_tr_b16 a[174:175], v23 offset:8704
    v_mfma_f32_16x16x32_bf16 v[176:179], a[8:11], a[228:231], v[176:179]
    v_mfma_f32_16x16x32_bf16 v[180:183], a[12:15], a[228:231], v[180:183]
    v_mfma_f32_16x16x32_bf16 v[184:187], a[136:139], a[228:231], v[184:187]
    buffer_load_dwordx4 v31, s[24:27], s29 offen offset:1024 lds
    v_mfma_f32_16x16x32_bf16 v[188:191], a[140:143], a[228:231], v[188:191]
    s_waitcnt vmcnt(16) lgkmcnt(0)
    v_mfma_f32_16x16x32_bf16 v[160:163], a[32:35], a[200:203], v[160:163]
    v_mul_f32 v64, v64, v112
    v_mul_f32 v65, v65, v112
    v_mfma_f32_16x16x32_bf16 v[164:167], a[36:39], a[200:203], v[164:167]
    v_mul_f32 v66, v66, v112
    v_mul_f32 v67, v67, v112
    v_mfma_f32_16x16x32_bf16 v[168:171], a[160:163], a[200:203], v[168:171]
    v_mul_f32 v68, v68, v112
    v_mul_f32 v69, v69, v112
    v_mfma_f32_16x16x32_bf16 v[172:175], a[164:167], a[200:203], v[172:175]
    v_mul_f32 v70, v70, v112
    v_mul_f32 v71, v71, v112
    v_mfma_f32_16x16x32_bf16 v[176:179], a[32:35], a[204:207], v[176:179]
    v_mul_f32 v72, v72, v112
    v_mul_f32 v73, v73, v112
    v_mfma_f32_16x16x32_bf16 v[180:183], a[36:39], a[204:207], v[180:183]
    v_mul_f32 v74, v74, v112
    v_mul_f32 v75, v75, v112
    v_mfma_f32_16x16x32_bf16 v[184:187], a[160:163], a[204:207], v[184:187]
    v_mul_f32 v76, v76, v112
    v_mul_f32 v77, v77, v112
    v_mfma_f32_16x16x32_bf16 v[188:191], a[164:167], a[204:207], v[188:191]
    v_mul_f32 v78, v78, v112
    v_mul_f32 v79, v79, v112
    v_mfma_f32_16x16x32_bf16 v[160:163], a[40:43], a[232:235], v[160:163]
    v_mul_f32 v80, v80, v113
    v_mul_f32 v81, v81, v113
    v_mfma_f32_16x16x32_bf16 v[164:167], a[44:47], a[232:235], v[164:167]
    v_mul_f32 v82, v82, v113
    v_mul_f32 v83, v83, v113
    v_mfma_f32_16x16x32_bf16 v[168:171], a[168:171], a[232:235], v[168:171]
    v_mul_f32 v84, v84, v113
    v_mul_f32 v85, v85, v113
    v_mfma_f32_16x16x32_bf16 v[172:175], a[172:175], a[232:235], v[172:175]
    v_mul_f32 v86, v86, v113
    v_mul_f32 v87, v87, v113
    v_mfma_f32_16x16x32_bf16 v[176:179], a[40:43], a[236:239], v[176:179]
    v_mul_f32 v88, v88, v113
    v_mul_f32 v89, v89, v113
    v_mfma_f32_16x16x32_bf16 v[180:183], a[44:47], a[236:239], v[180:183]
    v_mul_f32 v90, v90, v113
    v_mul_f32 v91, v91, v113
    v_mfma_f32_16x16x32_bf16 v[184:187], a[168:171], a[236:239], v[184:187]
    v_mul_f32 v92, v92, v113
    v_mul_f32 v93, v93, v113
    v_mfma_f32_16x16x32_bf16 v[188:191], a[172:175], a[236:239], v[188:191]
    v_mul_f32 v94, v94, v113
    v_mul_f32 v95, v95, v113
    s_waitcnt lgkmcnt(0)
    v_mfma_f32_16x16x32_bf16 v[128:131], a[0:3], a[64:67], v[128:131]
    ds_write_b128 v18, v[160:163] offset:16384
    v_sub_f32 v114, 1.0, v112
    v_mfma_f32_16x16x32_bf16 v[132:135], a[4:7], a[64:67], v[132:135]
    ds_write_b128 v18, v[164:167] offset:17408
    v_mfma_f32_16x16x32_bf16 v[136:139], a[128:131], a[64:67], v[136:139]
    v_mfma_f32_16x16x32_bf16 v[140:143], a[132:135], a[64:67], v[140:143]
    ds_write_b128 v18, v[168:171] offset:24576
    v_sub_f32 v115, 1.0, v113
    v_mfma_f32_16x16x32_bf16 v[144:147], a[0:3], a[68:71], v[144:147]
    v_mfma_f32_16x16x32_bf16 v[148:151], a[4:7], a[68:71], v[148:151]
    ds_write_b128 v18, v[172:175] offset:25600
    v_mfma_f32_16x16x32_bf16 v[152:155], a[128:131], a[68:71], v[152:155]
    v_cvt_pk_bf16_f32 v114, v114, v114
    v_mfma_f32_16x16x32_bf16 v[156:159], a[132:135], a[68:71], v[156:159]
    ds_write_b128 v18, v[176:179] offset:32768
    v_mfma_f32_16x16x32_bf16 v[128:131], a[8:11], a[96:99], v[128:131]
    ds_write_b128 v18, v[180:183] offset:33792
    v_mfma_f32_16x16x32_bf16 v[132:135], a[12:15], a[96:99], v[132:135]
    v_cvt_pk_bf16_f32 v115, v115, v115
    v_mfma_f32_16x16x32_bf16 v[136:139], a[136:139], a[96:99], v[136:139]
    ds_write_b128 v18, v[184:187] offset:40960
    v_mfma_f32_16x16x32_bf16 v[140:143], a[140:143], a[96:99], v[140:143]
    v_and_b32 v114, s58, v114
    v_mfma_f32_16x16x32_bf16 v[144:147], a[8:11], a[100:103], v[144:147]
    ds_write_b128 v18, v[188:191] offset:41984
    v_mfma_f32_16x16x32_bf16 v[148:151], a[12:15], a[100:103], v[148:151]
    v_mfma_f32_16x16x32_bf16 v[152:155], a[136:139], a[100:103], v[152:155]
    v_and_b32 v115, s58, v115
    v_mfma_f32_16x16x32_bf16 v[156:159], a[140:143], a[100:103], v[156:159]
    s_waitcnt vmcnt(6) lgkmcnt(0)
    s_barrier
    v_mfma_f32_16x16x32_bf16 v[128:131], a[32:35], a[72:75], v[128:131]
    ds_read_b128 v[160:163], v19 offset:16384
    ds_read_b128 v[164:167], v19 offset:17408
    v_mfma_f32_16x16x32_bf16 v[132:135], a[36:39], a[72:75], v[132:135]
    s_add_u32 m0, s31, 0
    ds_read_b128 v[168:171], v19 offset:24576
    v_mfma_f32_16x16x32_bf16 v[136:139], a[160:163], a[72:75], v[136:139]
    buffer_load_dwordx4 v30, s[24:27], s30 offen offset:0 lds
    v_mfma_f32_16x16x32_bf16 v[140:143], a[164:167], a[72:75], v[140:143]
    ds_read_b128 v[172:175], v19 offset:25600
    ds_read_b128 v[176:179], v19 offset:32768
    v_mfma_f32_16x16x32_bf16 v[144:147], a[32:35], a[76:79], v[144:147]
    ds_read_b128 v[180:183], v19 offset:33792
    ds_read_b128 v[184:187], v19 offset:40960
    v_mfma_f32_16x16x32_bf16 v[148:151], a[36:39], a[76:79], v[148:151]
    ds_read_b128 v[188:191], v19 offset:41984
    ds_read_b64_tr_b16 a[0:1], v20 offset:2048
    v_mfma_f32_16x16x32_bf16 v[152:155], a[160:163], a[76:79], v[152:155]
    buffer_load_dwordx4 v31, s[24:27], s30 offen offset:1024 lds
    v_mfma_f32_16x16x32_bf16 v[156:159], a[164:167], a[76:79], v[156:159]
    ds_read_b64_tr_b16 a[2:3], v20 offset:2560
    ds_read_b64_tr_b16 a[4:5], v21 offset:2048
    v_mfma_f32_16x16x32_bf16 v[128:131], a[40:43], a[104:107], v[128:131]
    ds_read_b64_tr_b16 a[6:7], v21 offset:2560
    ds_read_b64_tr_b16 a[128:129], v22 offset:2048
    v_mfma_f32_16x16x32_bf16 v[132:135], a[44:47], a[104:107], v[132:135]
    s_add_u32 m0, s31, 8192
    ds_read_b64_tr_b16 a[130:131], v22 offset:2560
    v_mfma_f32_16x16x32_bf16 v[136:139], a[168:171], a[104:107], v[136:139]
    buffer_load_dwordx4 v30, s[24:27], s70 offen offset:0 lds
    v_mfma_f32_16x16x32_bf16 v[140:143], a[172:175], a[104:107], v[140:143]
    ds_read_b64_tr_b16 a[132:133], v23 offset:2048
    ds_read_b64_tr_b16 a[134:135], v23 offset:2560
    v_mfma_f32_16x16x32_bf16 v[144:147], a[40:43], a[108:111], v[144:147]
    ds_read_b64_tr_b16 v[96:97], v6 offset:0
    ds_read_b64_tr_b16 v[98:99], v6 offset:2048
    ds_read_b64_tr_b16 v[100:101], v6 offset:4096
    ds_read_b64_tr_b16 v[102:103], v6 offset:6144
    ds_read_b64_tr_b16 v[104:105], v116 offset:0
    ds_read_b64_tr_b16 v[106:107], v116 offset:2048
    v_mfma_f32_16x16x32_bf16 v[148:151], a[44:47], a[108:111], v[148:151]
    v_mfma_f32_16x16x32_bf16 v[152:155], a[168:171], a[108:111], v[152:155]
    buffer_load_dwordx4 v31, s[24:27], s70 offen offset:1024 lds
    v_mfma_f32_16x16x32_bf16 v[156:159], a[172:175], a[108:111], v[156:159]
    s_waitcnt lgkmcnt(0)
    v_mfma_f32_16x16x32_bf16 v[224:227], a[0:3], a[216:219], v[224:227]
    ds_read_b64_tr_b16 a[8:9], v20 offset:10240
    ds_read_b64_tr_b16 v[108:109], v116 offset:4096
    v_mfma_f32_16x16x32_bf16 v[228:231], a[4:7], a[216:219], v[228:231]
    v_add_f32 v128, v128, v160
    ds_read_b64_tr_b16 a[10:11], v20 offset:10752
    v_mfma_f32_16x16x32_bf16 v[232:235], a[128:131], a[216:219], v[232:235]
    v_add_f32 v129, v129, v161
    ds_read_b64_tr_b16 a[12:13], v21 offset:10240
    v_mfma_f32_16x16x32_bf16 v[236:239], a[132:135], a[216:219], v[236:239]
    v_add_f32 v130, v130, v162
    ds_read_b64_tr_b16 a[14:15], v21 offset:10752
    v_mfma_f32_16x16x32_bf16 v[240:243], a[0:3], a[220:223], v[240:243]
    v_add_f32 v131, v131, v163
    ds_read_b64_tr_b16 a[136:137], v22 offset:10240
    v_mfma_f32_16x16x32_bf16 v[244:247], a[4:7], a[220:223], v[244:247]
    v_perm_b32 v128, s80, v128, v8
    ds_read_b64_tr_b16 a[138:139], v22 offset:10752
    v_mfma_f32_16x16x32_bf16 v[248:251], a[128:131], a[220:223], v[248:251]
    v_perm_b32 v129, s81, v129, v8
    ds_read_b64_tr_b16 a[140:141], v23 offset:10240
    v_mfma_f32_16x16x32_bf16 v[252:255], a[132:135], a[220:223], v[252:255]
    buffer_store_dwordx4 v[128:131], v2, s[36:39], s68 offen offset:0 sc1
    ds_read_b64_tr_b16 a[142:143], v23 offset:10752
    v_mfma_f32_16x16x32_bf16 v[192:195], a[0:3], a[88:91], v[192:195]
    v_add_f32 v132, v132, v164
    v_add_f32 v133, v133, v165
    v_mfma_f32_16x16x32_bf16 v[196:199], a[4:7], a[88:91], v[196:199]
    v_add_f32 v134, v134, v166
    v_add_f32 v135, v135, v167
    v_mfma_f32_16x16x32_bf16 v[200:203], a[128:131], a[88:91], v[200:203]
    v_perm_b32 v132, s80, v132, v8
    v_perm_b32 v133, s81, v133, v8
    v_mfma_f32_16x16x32_bf16 v[204:207], a[132:135], a[88:91], v[204:207]
    buffer_store_dwordx4 v[132:135], v2, s[36:39], s68 offen offset:1024 sc1
    v_add_f32 v136, v136, v168
    v_mfma_f32_16x16x32_bf16 v[208:211], a[0:3], a[92:95], v[208:211]
    v_add_f32 v137, v137, v169
    v_add_f32 v138, v138, v170
    v_mfma_f32_16x16x32_bf16 v[212:215], a[4:7], a[92:95], v[212:215]
    v_add_f32 v139, v139, v171
    v_perm_b32 v136, s80, v136, v8
    v_mfma_f32_16x16x32_bf16 v[216:219], a[128:131], a[92:95], v[216:219]
    v_perm_b32 v137, s81, v137, v8
    buffer_store_dwordx4 v[136:139], v2, s[36:39], s68 offen offset:2048 sc1
    v_mfma_f32_16x16x32_bf16 v[220:223], a[132:135], a[92:95], v[220:223]
    v_add_f32 v140, v140, v172
    v_add_f32 v141, v141, v173
    s_waitcnt lgkmcnt(0)
    v_mfma_f32_16x16x32_bf16 v[224:227], a[8:11], a[248:251], v[224:227]
    v_add_f32 v142, v142, v174
    ds_read_b64_tr_b16 a[32:33], v20 offset:18432
    v_mfma_f32_16x16x32_bf16 v[228:231], a[12:15], a[248:251], v[228:231]
    v_add_f32 v143, v143, v175
    ds_read_b64_tr_b16 a[34:35], v20 offset:18944
    v_mfma_f32_16x16x32_bf16 v[232:235], a[136:139], a[248:251], v[232:235]
    v_perm_b32 v140, s80, v140, v8
    ds_read_b64_tr_b16 a[36:37], v21 offset:18432
    v_mfma_f32_16x16x32_bf16 v[236:239], a[140:143], a[248:251], v[236:239]
    v_perm_b32 v141, s81, v141, v8
    ds_read_b64_tr_b16 a[38:39], v21 offset:18944
    v_mfma_f32_16x16x32_bf16 v[240:243], a[8:11], a[252:255], v[240:243]
    buffer_store_dwordx4 v[140:143], v2, s[36:39], s68 offen offset:3072 sc1
    ds_read_b64_tr_b16 a[160:161], v22 offset:18432
    v_mfma_f32_16x16x32_bf16 v[244:247], a[12:15], a[252:255], v[244:247]
    v_add_f32 v144, v144, v176
    ds_read_b64_tr_b16 a[162:163], v22 offset:18944
    v_mfma_f32_16x16x32_bf16 v[248:251], a[136:139], a[252:255], v[248:251]
    v_add_f32 v145, v145, v177
    ds_read_b64_tr_b16 a[164:165], v23 offset:18432
    v_mfma_f32_16x16x32_bf16 v[252:255], a[140:143], a[252:255], v[252:255]
    v_add_f32 v146, v146, v178
    ds_read_b64_tr_b16 a[166:167], v23 offset:18944
    v_mfma_f32_16x16x32_bf16 v[192:195], a[8:11], a[120:123], v[192:195]
    v_add_f32 v147, v147, v179
    v_perm_b32 v144, s80, v144, v8
    v_mfma_f32_16x16x32_bf16 v[196:199], a[12:15], a[120:123], v[196:199]
    v_perm_b32 v145, s81, v145, v8
    buffer_store_dwordx4 v[144:147], v2, s[36:39], s69 offen offset:0 sc1
    v_mfma_f32_16x16x32_bf16 v[200:203], a[136:139], a[120:123], v[200:203]
    v_add_f32 v148, v148, v180
    v_add_f32 v149, v149, v181
    v_mfma_f32_16x16x32_bf16 v[204:207], a[140:143], a[120:123], v[204:207]
    v_add_f32 v150, v150, v182
    v_add_f32 v151, v151, v183
    v_mfma_f32_16x16x32_bf16 v[208:211], a[8:11], a[124:127], v[208:211]
    v_perm_b32 v148, s80, v148, v8
    v_perm_b32 v149, s81, v149, v8
IW_P11:
    s_cbranch_execz IW_R1
    v_mfma_f32_16x16x32_bf16 v[212:215], a[12:15], a[124:127], v[212:215]
    buffer_store_dwordx4 v[148:151], v2, s[36:39], s69 offen offset:1024 sc1
    v_add_f32 v152, v152, v184
    v_mfma_f32_16x16x32_bf16 v[216:219], a[136:139], a[124:127], v[216:219]
    v_add_f32 v153, v153, v185
    v_add_f32 v154, v154, v186
    v_mfma_f32_16x16x32_bf16 v[220:223], a[140:143], a[124:127], v[220:223]
    v_add_f32 v155, v155, v187
    v_perm_b32 v152, s80, v152, v8
    s_waitcnt lgkmcnt(0)
    v_mfma_f32_16x16x32_bf16 v[224:227], a[32:35], a[144:147], v[224:227]
    v_perm_b32 v153, s81, v153, v8
    ds_read_b64_tr_b16 a[40:41], v20 offset:26624
    v_mfma_f32_16x16x32_bf16 v[228:231], a[36:39], a[144:147], v[228:231]
    buffer_store_dwordx4 v[152:155], v2, s[36:39], s69 offen offset:2048 sc1
    ds_read_b64_tr_b16 a[42:43], v20 offset:27136
    v_mfma_f32_16x16x32_bf16 v[232:235], a[160:163], a[144:147], v[232:235]
    v_add_f32 v156, v156, v188
    ds_read_b64_tr_b16 a[44:45], v21 offset:26624
    v_mfma_f32_16x16x32_bf16 v[236:239], a[164:167], a[144:147], v[236:239]
    v_add_f32 v157, v157, v189
    ds_read_b64_tr_b16 a[46:47], v21 offset:27136
    v_mfma_f32_16x16x32_bf16 v[240:243], a[32:35], a[148:151], v[240:243]
    v_add_f32 v158, v158, v190
    ds_read_b64_tr_b16 a[168:169], v22 offset:26624
    v_mfma_f32_16x16x32_bf16 v[244:247], a[36:39], a[148:151], v[244:247]
    v_add_f32 v159, v159, v191
    ds_read_b64_tr_b16 a[170:171], v22 offset:27136
    v_mfma_f32_16x16x32_bf16 v[248:251], a[160:163], a[148:151], v[248:251]
    v_perm_b32 v156, s80, v156, v8
    ds_read_b64_tr_b16 a[172:173], v23 offset:26624
    v_mfma_f32_16x16x32_bf16 v[252:255], a[164:167], a[148:151], v[252:255]
    v_perm_b32 v157, s81, v157, v8
    ds_read_b64_tr_b16 a[174:175], v23 offset:27136
    v_mfma_f32_16x16x32_bf16 v[192:195], a[32:35], a[16:19], v[192:195]
    buffer_store_dwordx4 v[156:159], v2, s[36:39], s69 offen offset:3072 sc1
    v_mfma_f32_16x16x32_bf16 v[196:199], a[36:39], a[16:19], v[196:199]
    ds_read_b64_tr_b16 v[110:111], v116 offset:6144
    v_mfma_f32_16x16x32_bf16 v[200:203], a[160:163], a[16:19], v[200:203]
    v_mfma_f32_16x16x32_bf16 v[204:207], a[164:167], a[16:19], v[204:207]
    v_mfma_f32_16x16x32_bf16 v[208:211], a[32:35], a[20:23], v[208:211]
    v_mfma_f32_16x16x32_bf16 v[212:215], a[36:39], a[20:23], v[212:215]
    v_mfma_f32_16x16x32_bf16 v[216:219], a[160:163], a[20:23], v[216:219]
    v_mfma_f32_16x16x32_bf16 v[220:223], a[164:167], a[20:23], v[220:223]
    s_waitcnt lgkmcnt(0)
    v_mfma_f32_16x16x32_bf16 v[224:227], a[40:43], a[176:179], v[224:227]
    ds_read_b64_tr_b16 a[0:1], v20 offset:34816
    v_lshlrev_b32 v120, 16, v96
    v_mfma_f32_16x16x32_bf16 v[228:231], a[44:47], a[176:179], v[228:231]
    ds_read_b64_tr_b16 a[2:3], v20 offset:35328
    v_and_b32 v121, s58, v96
    v_mfma_f32_16x16x32_bf16 v[232:235], a[168:171], a[176:179], v[232:235]
    ds_read_b64_tr_b16 a[4:5], v21 offset:34816
    v_lshlrev_b32 v122, 16, v97
    v_mfma_f32_16x16x32_bf16 v[236:239], a[172:175], a[176:179], v[236:239]
    ds_read_b64_tr_b16 a[6:7], v21 offset:35328
    v_and_b32 v123, s58, v97
    v_mfma_f32_16x16x32_bf16 v[240:243], a[40:43], a[180:183], v[240:243]
    v_mul_f32 v64, v64, v120
    v_mul_f32 v65, v65, v121
    v_mfma_f32_16x16x32_bf16 v[244:247], a[44:47], a[180:183], v[244:247]
    ds_read_b64_tr_b16 a[128:129], v22 offset:34816
    v_mul_f32 v66, v66, v122
    v_mfma_f32_16x16x32_bf16 v[248:251], a[168:171], a[180:183], v[248:251]
    ds_read_b64_tr_b16 a[130:131], v22 offset:35328
    v_mul_f32 v67, v67, v123
    v_mfma_f32_16x16x32_bf16 v[252:255], a[172:175], a[180:183], v[252:255]
    ds_read_b64_tr_b16 a[132:133], v23 offset:34816
    v_lshlrev_b32 v124, 16, v98
    v_mfma_f32_16x16x32_bf16 v[192:195], a[40:43], a[48:51], v[192:195]
    ds_read_b64_tr_b16 a[134:135], v23 offset:35328
    v_and_b32 v125, s58, v98
    v_mfma_f32_16x16x32_bf16 v[196:199], a[44:47], a[48:51], v[196:199]
    v_lshlrev_b32 v126, 16, v99
    v_and_b32 v127, s58, v99
    v_mfma_f32_16x16x32_bf16 v[200:203], a[168:171], a[48:51], v[200:203]
    v_mul_f32 v68, v68, v124
    v_mul_f32 v69, v69, v125
    v_mfma_f32_16x16x32_bf16 v[204:207], a[172:175], a[48:51], v[204:207]
    v_mul_f32 v70, v70, v126
    v_mul_f32 v71, v71, v127
    v_mfma_f32_16x16x32_bf16 v[208:211], a[40:43], a[52:55], v[208:211]
    v_lshlrev_b32 v120, 16, v100
    v_and_b32 v121, s58, v100
    v_mfma_f32_16x16x32_bf16 v[212:215], a[44:47], a[52:55], v[212:215]
    v_lshlrev_b32 v122, 16, v101
    v_and_b32 v123, s58, v101
    v_mfma_f32_16x16x32_bf16 v[216:219], a[168:171], a[52:55], v[216:219]
    v_mul_f32 v72, v72, v120
    v_mul_f32 v73, v73, v121
    v_mfma_f32_16x16x32_bf16 v[220:223], a[172:175], a[52:55], v[220:223]
    v_mul_f32 v74, v74, v122
    v_mul_f32 v75, v75, v123
    s_waitcnt vmcnt(8) lgkmcnt(0)
    s_barrier
    v_mfma_f32_16x16x32_bf16 v[224:227], a[0:3], a[152:155], v[224:227]
    ds_read_b64_tr_b16 a[8:9], v20 offset:43008
    v_lshlrev_b32 v124, 16, v102
    v_mfma_f32_16x16x32_bf16 v[228:231], a[4:7], a[152:155], v[228:231]
    ds_read_b64_tr_b16 a[10:11], v20 offset:43520
    v_and_b32 v125, s58, v102
    v_mfma_f32_16x16x32_bf16 v[232:235], a[128:131], a[152:155], v[232:235]
    ds_read_b64_tr_b16 a[12:13], v21 offset:43008
    v_lshlrev_b32 v126, 16, v103
    v_mfma_f32_16x16x32_bf16 v[236:239], a[132:135], a[152:155], v[236:239]
    ds_read_b64_tr_b16 a[14:15], v21 offset:43520
    v_and_b32 v127, s58, v103
    v_mfma_f32_16x16x32_bf16 v[240:243], a[0:3], a[156:159], v[240:243]
    v_mul_f32 v76, v76, v124
    v_mul_f32 v77, v77, v125
    v_mfma_f32_16x16x32_bf16 v[244:247], a[4:7], a[156:159], v[244:247]
    ds_read_b64_tr_b16 a[136:137], v22 offset:43008
    v_mul_f32 v78, v78, v126
    v_mfma_f32_16x16x32_bf16 v[248:251], a[128:131], a[156:159], v[248:251]
    ds_read_b64_tr_b16 a[138:139], v22 offset:43520
    v_mul_f32 v79, v79, v127
    v_mfma_f32_16x16x32_bf16 v[252:255], a[132:135], a[156:159], v[252:255]
    ds_read_b64_tr_b16 a[140:141], v23 offset:43008
    v_lshlrev_b32 v120, 16, v104
    v_mfma_f32_16x16x32_bf16 v[192:195], a[0:3], a[24:27], v[192:195]
    ds_read_b64_tr_b16 a[142:143], v23 offset:43520
    v_and_b32 v121, s58, v104
    v_mfma_f32_16x16x32_bf16 v[196:199], a[4:7], a[24:27], v[196:199]
    v_lshlrev_b32 v122, 16, v105
    v_and_b32 v123, s58, v105
    v_mfma_f32_16x16x32_bf16 v[200:203], a[128:131], a[24:27], v[200:203]
    v_mul_f32 v80, v80, v120
    v_mul_f32 v81, v81, v121
    v_mfma_f32_16x16x32_bf16 v[204:207], a[132:135], a[24:27], v[204:207]
    v_mul_f32 v82, v82, v122
    v_mul_f32 v83, v83, v123
    v_mfma_f32_16x16x32_bf16 v[208:211], a[0:3], a[28:31], v[208:211]
    v_lshlrev_b32 v124, 16, v106
    v_and_b32 v125, s58, v106
    v_mfma_f32_16x16x32_bf16 v[212:215], a[4:7], a[28:31], v[212:215]
    v_lshlrev_b32 v126, 16, v107
    v_and_b32 v127, s58, v107
    v_mfma_f32_16x16x32_bf16 v[216:219], a[128:131], a[28:31], v[216:219]
    v_mul_f32 v84, v84, v124
    v_mul_f32 v85, v85, v125
    v_mfma_f32_16x16x32_bf16 v[220:223], a[132:135], a[28:31], v[220:223]
    v_mul_f32 v86, v86, v126
    v_mul_f32 v87, v87, v127
    s_waitcnt lgkmcnt(0)
    v_mfma_f32_16x16x32_bf16 v[224:227], a[8:11], a[184:187], v[224:227]
    ds_read_b64_tr_b16 a[32:33], v20 offset:51200
    ds_read_b64_tr_b16 a[34:35], v20 offset:51712
    v_mfma_f32_16x16x32_bf16 v[228:231], a[12:15], a[184:187], v[228:231]
    ds_read_b64_tr_b16 a[36:37], v21 offset:51200
    ds_read_b64_tr_b16 a[38:39], v21 offset:51712
    v_mfma_f32_16x16x32_bf16 v[232:235], a[136:139], a[184:187], v[232:235]
    ds_read_b64_tr_b16 a[160:161], v22 offset:51200
    ds_read_b64_tr_b16 a[162:163], v22 offset:51712
    v_mfma_f32_16x16x32_bf16 v[236:239], a[140:143], a[184:187], v[236:239]
    ds_read_b64_tr_b16 a[164:165], v23 offset:51200
    ds_read_b64_tr_b16 a[166:167], v23 offset:51712
    v_mfma_f32_16x16x32_bf16 v[240:243], a[8:11], a[188:191], v[240:243]
    ds_read_b64_tr_b16 a[40:41], v20 offset:59392
    ds_read_b64_tr_b16 a[42:43], v20 offset:59904
    v_mfma_f32_16x16x32_bf16 v[244:247], a[12:15], a[188:191], v[244:247]
    ds_read_b64_tr_b16 a[44:45], v21 offset:59392
    ds_read_b64_tr_b16 a[46:47], v21 offset:59904
    v_mfma_f32_16x16x32_bf16 v[248:251], a[136:139], a[188:191], v[248:251]
    ds_read_b64_tr_b16 a[168:169], v22 offset:59392
    ds_read_b64_tr_b16 a[170:171], v22 offset:59904
    v_mfma_f32_16x16x32_bf16 v[252:255], a[140:143], a[188:191], v[252:255]
    ds_read_b64_tr_b16 a[172:173], v23 offset:59392
    ds_read_b64_tr_b16 a[174:175], v23 offset:59904
    v_mfma_f32_16x16x32_bf16 v[192:195], a[8:11], a[56:59], v[192:195]
    ds_read_b64_tr_b16 a[0:1], v20 offset:0
    ds_read_b64_tr_b16 a[2:3], v20 offset:512
    v_mfma_f32_16x16x32_bf16 v[196:199], a[12:15], a[56:59], v[196:199]
    ds_read_b64_tr_b16 a[4:5], v21 offset:0
    ds_read_b64_tr_b16 a[6:7], v21 offset:512
    v_mfma_f32_16x16x32_bf16 v[200:203], a[136:139], a[56:59], v[200:203]
    ds_read_b64_tr_b16 a[128:129], v22 offset:0
    ds_read_b64_tr_b16 a[130:131], v22 offset:512
    v_mfma_f32_16x16x32_bf16 v[204:207], a[140:143], a[56:59], v[204:207]
    ds_read_b64_tr_b16 a[132:133], v23 offset:0
    ds_read_b64_tr_b16 a[134:135], v23 offset:512
    v_mfma_f32_16x16x32_bf16 v[208:211], a[8:11], a[60:63], v[208:211]
    v_lshlrev_b32 v120, 16, v108
    v_and_b32 v121, s58, v108
    v_mfma_f32_16x16x32_bf16 v[212:215], a[12:15], a[60:63], v[212:215]
    v_lshlrev_b32 v122, 16, v109
    v_and_b32 v123, s58, v109
    v_mfma_f32_16x16x32_bf16 v[216:219], a[136:139], a[60:63], v[216:219]
    v_mul_f32 v88, v88, v120
    v_mul_f32 v89, v89, v121
    v_mfma_f32_16x16x32_bf16 v[220:223], a[140:143], a[60:63], v[220:223]
    v_mul_f32 v90, v90, v122
    v_mul_f32 v91, v91, v123
    s_waitcnt lgkmcnt(0)
    v_mfma_f32_16x16x32_bf16 v[224:227], a[32:35], a[192:195], v[224:227]
    ds_read_b64_tr_b16 a[8:9], v20 offset:8192
    ds_read_b64_tr_b16 a[10:11], v20 offset:8704
    ds_read_b64_tr_b16 a[12:13], v21 offset:8192
    v_mfma_f32_16x16x32_bf16 v[228:231], a[36:39], a[192:195], v[228:231]
    ds_read_b64_tr_b16 a[14:15], v21 offset:8704
    ds_read_b64_tr_b16 a[136:137], v22 offset:8192
    ds_read_b64_tr_b16 a[138:139], v22 offset:8704
    v_mfma_f32_16x16x32_bf16 v[232:235], a[160:163], a[192:195], v[232:235]
    ds_read_b64_tr_b16 a[140:141], v23 offset:8192
    ds_read_b64_tr_b16 a[142:143], v23 offset:8704
    buffer_load_dwordx4 v[32:35], v2, s[36:39], s54 offen offset:0 sc1
    v_mfma_f32_16x16x32_bf16 v[236:239], a[164:167], a[192:195], v[236:239]
    v_lshlrev_b32 v124, 16, v110
    v_and_b32 v125, s58, v110
    v_mfma_f32_16x16x32_bf16 v[224:227], a[40:43], a[224:227], v[224:227]
    buffer_load_dwordx4 v[36:39], v2, s[36:39], s54 offen offset:1024 sc1
    v_mfma_f32_16x16x32_bf16 v[228:231], a[44:47], a[224:227], v[228:231]
    v_lshlrev_b32 v126, 16, v111
    v_mfma_f32_16x16x32_bf16 v[232:235], a[168:171], a[224:227], v[232:235]
    buffer_load_dwordx4 v[40:43], v2, s[36:39], s54 offen offset:2048 sc1
    v_mfma_f32_16x16x32_bf16 v[236:239], a[172:175], a[224:227], v[236:239]
    v_and_b32 v127, s58, v111
    v_mul_f32 v92, v92, v124
    v_mfma_f32_16x16x32_bf16 v[224:227], a[0:3], a[200:203], v[224:227]
    buffer_load_dwordx4 v[44:47], v2, s[36:39], s54 offen offset:3072 sc1
    v_mfma_f32_16x16x32_bf16 v[228:231], a[4:7], a[200:203], v[228:231]
    v_mul_f32 v93, v93, v125
    v_mfma_f32_16x16x32_bf16 v[232:235], a[128:131], a[200:203], v[232:235]
    buffer_load_dwordx4 v[48:51], v2, s[36:39], s55 offen offset:0 sc1
    v_mfma_f32_16x16x32_bf16 v[236:239], a[132:135], a[200:203], v[236:239]
    s_waitcnt lgkmcnt(0)
    v_mul_f32 v94, v94, v126
    v_mfma_f32_16x16x32_bf16 v[224:227], a[8:11], a[232:235], v[224:227]
    buffer_load_dwordx4 v[52:55], v2, s[36:39], s55 offen offset:1024 sc1
    v_mfma_f32_16x16x32_bf16 v[228:231], a[12:15], a[232:235], v[228:231]
    v_mul_f32 v95, v95, v127
    v_mfma_f32_16x16x32_bf16 v[232:235], a[136:139], a[232:235], v[232:235]
    buffer_load_dwordx4 v[56:59], v2, s[36:39], s55 offen offset:2048 sc1
    v_mfma_f32_16x16x32_bf16 v[236:239], a[140:143], a[232:235], v[236:239]
    buffer_load_dwordx4 v[60:63], v2, s[36:39], s55 offen offset:3072 sc1
    s_waitcnt lgkmcnt(0)
    v_mfma_f32_16x16x32_bf16 v[240:243], a[32:35], a[196:199], v[240:243]
    v_mfma_f32_16x16x32_bf16 v[244:247], a[36:39], a[196:199], v[244:247]
    v_mfma_f32_16x16x32_bf16 v[248:251], a[160:163], a[196:199], v[248:251]
    ds_write_b128 v18, v[224:227] offset:16384
    v_mfma_f32_16x16x32_bf16 v[252:255], a[164:167], a[196:199], v[252:255]
    v_mfma_f32_16x16x32_bf16 v[240:243], a[40:43], a[228:231], v[240:243]
    v_mfma_f32_16x16x32_bf16 v[244:247], a[44:47], a[228:231], v[244:247]
    ds_write_b128 v18, v[228:231] offset:17408
    v_mfma_f32_16x16x32_bf16 v[248:251], a[168:171], a[228:231], v[248:251]
    v_mfma_f32_16x16x32_bf16 v[252:255], a[172:175], a[228:231], v[252:255]
    v_mfma_f32_16x16x32_bf16 v[240:243], a[0:3], a[204:207], v[240:243]
    v_mfma_f32_16x16x32_bf16 v[244:247], a[4:7], a[204:207], v[244:247]
    ds_write_b128 v18, v[232:235] offset:24576
    v_mfma_f32_16x16x32_bf16 v[248:251], a[128:131], a[204:207], v[248:251]
    v_mfma_f32_16x16x32_bf16 v[252:255], a[132:135], a[204:207], v[252:255]
    v_mfma_f32_16x16x32_bf16 v[240:243], a[8:11], a[236:239], v[240:243]
    ds_write_b128 v18, v[236:239] offset:25600
    v_mfma_f32_16x16x32_bf16 v[244:247], a[12:15], a[236:239], v[244:247]
    v_mfma_f32_16x16x32_bf16 v[248:251], a[136:139], a[236:239], v[248:251]
    v_mfma_f32_16x16x32_bf16 v[252:255], a[140:143], a[236:239], v[252:255]
    v_mfma_f32_16x16x32_bf16 v[192:195], a[32:35], a[64:67], v[192:195]
    ds_write_b128 v18, v[240:243] offset:32768
    v_mfma_f32_16x16x32_bf16 v[196:199], a[36:39], a[64:67], v[196:199]
    v_mfma_f32_16x16x32_bf16 v[200:203], a[160:163], a[64:67], v[200:203]
    v_mfma_f32_16x16x32_bf16 v[204:207], a[164:167], a[64:67], v[204:207]
    ds_write_b128 v18, v[244:247] offset:33792
    v_mfma_f32_16x16x32_bf16 v[208:211], a[32:35], a[68:71], v[208:211]
    v_mfma_f32_16x16x32_bf16 v[212:215], a[36:39], a[68:71], v[212:215]
    v_mfma_f32_16x16x32_bf16 v[216:219], a[160:163], a[68:71], v[216:219]
    v_mfma_f32_16x16x32_bf16 v[220:223], a[164:167], a[68:71], v[220:223]
    ds_write_b128 v18, v[248:251] offset:40960
    v_mfma_f32_16x16x32_bf16 v[192:195], a[40:43], a[96:99], v[192:195]
    v_mfma_f32_16x16x32_bf16 v[196:199], a[44:47], a[96:99], v[196:199]
    v_mfma_f32_16x16x32_bf16 v[200:203], a[168:171], a[96:99], v[200:203]
    ds_write_b128 v18, v[252:255] offset:41984
    v_mfma_f32_16x16x32_bf16 v[204:207], a[172:175], a[96:99], v[204:207]
    v_mfma_f32_16x16x32_bf16 v[208:211], a[40:43], a[100:103], v[208:211]
    v_mfma_f32_16x16x32_bf16 v[212:215], a[44:47], a[100:103], v[212:215]
    v_mfma_f32_16x16x32_bf16 v[216:219], a[168:171], a[100:103], v[216:219]
    v_mfma_f32_16x16x32_bf16 v[220:223], a[172:175], a[100:103], v[220:223]
    s_waitcnt lgkmcnt(0)
    s_barrier
    v_mfma_f32_16x16x32_bf16 v[192:195], a[0:3], a[72:75], v[192:195]
    ds_read_b128 v[224:227], v19 offset:16384
    v_mfma_f32_16x16x32_bf16 v[196:199], a[4:7], a[72:75], v[196:199]
    ds_read_b128 v[228:231], v19 offset:17408
    v_mfma_f32_16x16x32_bf16 v[200:203], a[128:131], a[72:75], v[200:203]
    ds_read_b128 v[232:235], v19 offset:24576
    v_mfma_f32_16x16x32_bf16 v[204:207], a[132:135], a[72:75], v[204:207]
    ds_read_b128 v[236:239], v19 offset:25600
    v_mfma_f32_16x16x32_bf16 v[208:211], a[0:3], a[76:79], v[208:211]
    v_mfma_f32_16x16x32_bf16 v[212:215], a[4:7], a[76:79], v[212:215]
    ds_read_b128 v[240:243], v19 offset:32768
    v_mfma_f32_16x16x32_bf16 v[216:219], a[128:131], a[76:79], v[216:219]
    ds_read_b128 v[244:247], v19 offset:33792
    v_mfma_f32_16x16x32_bf16 v[220:223], a[132:135], a[76:79], v[220:223]
    ds_read_b128 v[248:251], v19 offset:40960
    v_mfma_f32_16x16x32_bf16 v[192:195], a[8:11], a[104:107], v[192:195]
    ds_read_b128 v[252:255], v19 offset:41984
    v_mfma_f32_16x16x32_bf16 v[196:199], a[12:15], a[104:107], v[196:199]
    v_mfma_f32_16x16x32_bf16 v[200:203], a[136:139], a[104:107], v[200:203]
    v_mfma_f32_16x16x32_bf16 v[204:207], a[140:143], a[104:107], v[204:207]
    v_mfma_f32_16x16x32_bf16 v[208:211], a[8:11], a[108:111], v[208:211]
    v_mfma_f32_16x16x32_bf16 v[212:215], a[12:15], a[108:111], v[212:215]
    v_mfma_f32_16x16x32_bf16 v[216:219], a[136:139], a[108:111], v[216:219]
    v_mfma_f32_16x16x32_bf16 v[220:223], a[140:143], a[108:111], v[220:223]
    s_mov_b32 s59, 0x8000
    s_waitcnt lgkmcnt(0)
    v_pk_fma_f32 v[64:65], v[224:225], v[114:115], v[64:65] op_sel:[0,0,0] op_sel_hi:[1,0,1]
    v_pk_fma_f32 v[66:67], v[226:227], v[114:115], v[66:67] op_sel:[0,0,0] op_sel_hi:[1,0,1]
    v_pk_fma_f32 v[68:69], v[228:229], v[114:115], v[68:69] op_sel:[0,0,0] op_sel_hi:[1,0,1]
    v_pk_fma_f32 v[70:71], v[230:231], v[114:115], v[70:71] op_sel:[0,0,0] op_sel_hi:[1,0,1]
    v_pk_fma_f32 v[72:73], v[232:233], v[114:115], v[72:73] op_sel:[0,0,0] op_sel_hi:[1,0,1]
    v_pk_fma_f32 v[74:75], v[234:235], v[114:115], v[74:75] op_sel:[0,0,0] op_sel_hi:[1,0,1]
    v_pk_fma_f32 v[76:77], v[236:237], v[114:115], v[76:77] op_sel:[0,0,0] op_sel_hi:[1,0,1]
    v_pk_fma_f32 v[78:79], v[238:239], v[114:115], v[78:79] op_sel:[0,0,0] op_sel_hi:[1,0,1]
    v_pk_fma_f32 v[80:81], v[240:241], v[114:115], v[80:81] op_sel:[0,1,0] op_sel_hi:[1,1,1]
    v_pk_fma_f32 v[82:83], v[242:243], v[114:115], v[82:83] op_sel:[0,1,0] op_sel_hi:[1,1,1]
    v_pk_fma_f32 v[84:85], v[244:245], v[114:115], v[84:85] op_sel:[0,1,0] op_sel_hi:[1,1,1]
    v_pk_fma_f32 v[86:87], v[246:247], v[114:115], v[86:87] op_sel:[0,1,0] op_sel_hi:[1,1,1]
    v_pk_fma_f32 v[88:89], v[248:249], v[114:115], v[88:89] op_sel:[0,1,0] op_sel_hi:[1,1,1]
    v_pk_fma_f32 v[90:91], v[250:251], v[114:115], v[90:91] op_sel:[0,1,0] op_sel_hi:[1,1,1]
    v_pk_fma_f32 v[92:93], v[252:253], v[114:115], v[92:93] op_sel:[0,1,0] op_sel_hi:[1,1,1]
    v_pk_fma_f32 v[94:95], v[254:255], v[114:115], v[94:95] op_sel:[0,1,0] op_sel_hi:[1,1,1]
    v_pk_fma_f32 v[64:65], v[192:193], v[114:115], v[64:65] op_sel:[0,0,0] op_sel_hi:[1,0,1]
    v_pk_fma_f32 v[66:67], v[194:195], v[114:115], v[66:67] op_sel:[0,0,0] op_sel_hi:[1,0,1]
    v_pk_fma_f32 v[68:69], v[196:197], v[114:115], v[68:69] op_sel:[0,0,0] op_sel_hi:[1,0,1]
    v_pk_fma_f32 v[70:71], v[198:199], v[114:115], v[70:71] op_sel:[0,0,0] op_sel_hi:[1,0,1]
    v_pk_fma_f32 v[72:73], v[200:201], v[114:115], v[72:73] op_sel:[0,0,0] op_sel_hi:[1,0,1]
    v_pk_fma_f32 v[74:75], v[202:203], v[114:115], v[74:75] op_sel:[0,0,0] op_sel_hi:[1,0,1]
    v_pk_fma_f32 v[76:77], v[204:205], v[114:115], v[76:77] op_sel:[0,0,0] op_sel_hi:[1,0,1]
    v_pk_fma_f32 v[78:79], v[206:207], v[114:115], v[78:79] op_sel:[0,0,0] op_sel_hi:[1,0,1]
    v_pk_fma_f32 v[80:81], v[208:209], v[114:115], v[80:81] op_sel:[0,1,0] op_sel_hi:[1,1,1]
    v_pk_fma_f32 v[82:83], v[210:211], v[114:115], v[82:83] op_sel:[0,1,0] op_sel_hi:[1,1,1]
    v_pk_fma_f32 v[84:85], v[212:213], v[114:115], v[84:85] op_sel:[0,1,0] op_sel_hi:[1,1,1]
    v_pk_fma_f32 v[86:87], v[214:215], v[114:115], v[86:87] op_sel:[0,1,0] op_sel_hi:[1,1,1]
    v_pk_fma_f32 v[88:89], v[216:217], v[114:115], v[88:89] op_sel:[0,1,0] op_sel_hi:[1,1,1]
    v_pk_fma_f32 v[90:91], v[218:219], v[114:115], v[90:91] op_sel:[0,1,0] op_sel_hi:[1,1,1]
    v_pk_fma_f32 v[92:93], v[220:221], v[114:115], v[92:93] op_sel:[0,1,0] op_sel_hi:[1,1,1]
    v_pk_fma_f32 v[94:95], v[222:223], v[114:115], v[94:95] op_sel:[0,1,0] op_sel_hi:[1,1,1]
G2_CHK:
    s_waitcnt vmcnt(7)
    v_msad_u8 v120, v32, s60, 0
    v_msad_u8 v121, v33, s61, 0
    v_pk_fma_f32 v[32:33], v[32:33], v[114:115], v[64:65] op_sel:[0,0,0] op_sel_hi:[1,0,1]
    v_pk_fma_f32 v[34:35], v[34:35], v[114:115], v[66:67] op_sel:[0,0,0] op_sel_hi:[1,0,1]
    v_cvt_pk_bf16_f32 v96, v32, v33
    v_cvt_pk_bf16_f32 v97, v34, v35
    s_waitcnt vmcnt(6)
    v_msad_u8 v120, v36, s60, v120
    v_msad_u8 v121, v37, s61, v121
    v_pk_fma_f32 v[36:37], v[36:37], v[114:115], v[68:69] op_sel:[0,0,0] op_sel_hi:[1,0,1]
    v_pk_fma_f32 v[38:39], v[38:39], v[114:115], v[70:71] op_sel:[0,0,0] op_sel_hi:[1,0,1]
    v_cvt_pk_bf16_f32 v100, v36, v37
    v_cvt_pk_bf16_f32 v101, v38, v39
    s_waitcnt vmcnt(5)
    v_msad_u8 v120, v40, s60, v120
    v_msad_u8 v121, v41, s61, v121
    v_pk_fma_f32 v[40:41], v[40:41], v[114:115], v[72:73] op_sel:[0,0,0] op_sel_hi:[1,0,1]
    v_pk_fma_f32 v[42:43], v[42:43], v[114:115], v[74:75] op_sel:[0,0,0] op_sel_hi:[1,0,1]
    v_cvt_pk_bf16_f32 v104, v40, v41
    v_cvt_pk_bf16_f32 v105, v42, v43
    s_waitcnt vmcnt(4)
    v_msad_u8 v120, v44, s60, v120
    v_msad_u8 v121, v45, s61, v121
    v_pk_fma_f32 v[44:45], v[44:45], v[114:115], v[76:77] op_sel:[0,0,0] op_sel_hi:[1,0,1]
    v_pk_fma_f32 v[46:47], v[46:47], v[114:115], v[78:79] op_sel:[0,0,0] op_sel_hi:[1,0,1]
    v_cvt_pk_bf16_f32 v108, v44, v45
    v_cvt_pk_bf16_f32 v109, v46, v47
    s_waitcnt vmcnt(3)
    v_msad_u8 v120, v48, s60, v120
    v_msad_u8 v121, v49, s61, v121
    v_pk_fma_f32 v[48:49], v[48:49], v[114:115], v[80:81] op_sel:[0,1,0] op_sel_hi:[1,1,1]
    v_pk_fma_f32 v[50:51], v[50:51], v[114:115], v[82:83] op_sel:[0,1,0] op_sel_hi:[1,1,1]
    v_cvt_pk_bf16_f32 v98, v48, v49
    v_cvt_pk_bf16_f32 v99, v50, v51
    s_waitcnt vmcnt(2)
    v_msad_u8 v120, v52, s60, v120
    v_msad_u8 v121, v53, s61, v121
    v_pk_fma_f32 v[52:53], v[52:53], v[114:115], v[84:85] op_sel:[0,1,0] op_sel_hi:[1,1,1]
    v_pk_fma_f32 v[54:55], v[54:55], v[114:115], v[86:87] op_sel:[0,1,0] op_sel_hi:[1,1,1]
    v_permlane16_swap_b32 v96, v98
    v_permlane16_swap_b32 v97, v99
    v_cvt_pk_bf16_f32 v102, v52, v53
    v_cvt_pk_bf16_f32 v103, v54, v55
    s_waitcnt vmcnt(1)
    v_msad_u8 v120, v56, s60, v120
    v_msad_u8 v121, v57, s61, v121
    v_pk_fma_f32 v[56:57], v[56:57], v[114:115], v[88:89] op_sel:[0,1,0] op_sel_hi:[1,1,1]
    v_pk_fma_f32 v[58:59], v[58:59], v[114:115], v[90:91] op_sel:[0,1,0] op_sel_hi:[1,1,1]
    v_permlane16_swap_b32 v100, v102
    v_permlane16_swap_b32 v101, v103
    v_cvt_pk_bf16_f32 v106, v56, v57
    v_cvt_pk_bf16_f32 v107, v58, v59
    s_waitcnt vmcnt(0)
    v_msad_u8 v120, v60, s60, v120
    v_msad_u8 v121, v61, s61, v121
    v_pk_fma_f32 v[60:61], v[60:61], v[114:115], v[92:93] op_sel:[0,1,0] op_sel_hi:[1,1,1]
    v_pk_fma_f32 v[62:63], v[62:63], v[114:115], v[94:95] op_sel:[0,1,0] op_sel_hi:[1,1,1]
    v_permlane16_swap_b32 v104, v106
    v_permlane16_swap_b32 v105, v107
    v_cvt_pk_bf16_f32 v110, v60, v61
    v_cvt_pk_bf16_f32 v111, v62, v63
    v_or_b32 v120, v120, v121
    v_cmp_ne_u32 vcc, 0, v120
    v_permlane16_swap_b32 v108, v110
    v_permlane16_swap_b32 v109, v111
    s_cbranch_vccnz G2_POLL
G2_FIN:
    buffer_store_dwordx4 v[96:99], v27, s[20:23], 0 offen offset:0
    buffer_store_dwordx4 v[100:103], v27, s[20:23], 0 offen offset:32
    buffer_store_dwordx4 v[104:107], v27, s[20:23], 0 offen offset:64
    buffer_store_dwordx4 v[108:111], v27, s[20:23], 0 offen offset:96
G_END:
    s_endpgm
G2_POLL:
    s_sub_u32 s59, s59, 1
    s_cmp_lt_i32 s59, 1
    s_cbranch_scc1 G2_FIN
    buffer_load_dwordx4 v[32:35], v2, s[36:39], s54 offen offset:0 sc1
    buffer_load_dwordx4 v[36:39], v2, s[36:39], s54 offen offset:1024 sc1
    buffer_load_dwordx4 v[40:43], v2, s[36:39], s54 offen offset:2048 sc1
    buffer_load_dwordx4 v[44:47], v2, s[36:39], s54 offen offset:3072 sc1
    buffer_load_dwordx4 v[48:51], v2, s[36:39], s55 offen offset:0 sc1
    buffer_load_dwordx4 v[52:55], v2, s[36:39], s55 offen offset:1024 sc1
    buffer_load_dwordx4 v[56:59], v2, s[36:39], s55 offen offset:2048 sc1
    buffer_load_dwordx4 v[60:63], v2, s[36:39], s55 offen offset:3072 sc1
    s_branch G2_CHK
G2_SP2:
    buffer_load_dword v3, v4, s[32:35], 0 offen sc1
    s_waitcnt vmcnt(0)
    v_cmp_ne_u32 vcc, 0, v3
    s_nop 0
    s_or_b32 s47, s47, vcc_lo
    s_and_b32 s50, s47, 0x4
    s_cmp_eq_u32 s50, 0x4
    s_cbranch_scc1 G2_OK2
    s_sub_u32 s59, s59, 1
    s_cmp_lt_i32 s59, 1
    s_cbranch_scc1 G2_OK2
    s_sleep 2
    s_branch G2_SP2
G2_SP3:
    buffer_load_dword v3, v4, s[32:35], 0 offen sc1
    s_waitcnt vmcnt(0)
    v_cmp_ne_u32 vcc, 0, v3
    s_nop 0
    s_or_b32 s47, s47, vcc_lo
    s_and_b32 s50, s47, 0x8
    s_cmp_eq_u32 s50, 0x8
    s_cbranch_scc1 G2_OK3
    s_sub_u32 s59, s59, 1
    s_cmp_lt_i32 s59, 1
    s_cbranch_scc1 G2_OK3
    s_sleep 2
    s_branch G2_SP3
G2_SP4:
    buffer_load_dword v3, v4, s[32:35], 0 offen sc1
    s_waitcnt vmcnt(0)
    v_cmp_ne_u32 vcc, 0, v3
    s_nop 0
    s_or_b32 s47, s47, vcc_lo
    s_and_b32 s50, s47, 0x10
    s_cmp_eq_u32 s50, 0x10
    s_cbranch_scc1 G2_OK4
    s_sub_u32 s59, s59, 1
    s_cmp_lt_i32 s59, 1
    s_cbranch_scc1 G2_OK4
    s_sleep 2
    s_branch G2_SP4
G2_SP5:
    buffer_load_dword v3, v4, s[32:35], 0 offen sc1
    s_waitcnt vmcnt(0)
    v_cmp_ne_u32 vcc, 0, v3
    s_nop 0
    s_or_b32 s47, s47, vcc_lo
    s_and_b32 s50, s47, 0x20
    s_cmp_eq_u32 s50, 0x20
    s_cbranch_scc1 G2_OK5
    s_sub_u32 s59, s59, 1
    s_cmp_lt_i32 s59, 1
    s_cbranch_scc1 G2_OK5
    s_sleep 2
    s_branch G2_SP5
G2_SP6:
    buffer_load_dword v3, v4, s[32:35], 0 offen sc1
    s_waitcnt vmcnt(0)
    v_cmp_ne_u32 vcc, 0, v3
    s_nop 0
    s_or_b32 s47, s47, vcc_lo
    s_and_b32 s50, s47, 0x40
    s_cmp_eq_u32 s50, 0x40
    s_cbranch_scc1 G2_OK6
    s_sub_u32 s59, s59, 1
    s_cmp_lt_i32 s59, 1
    s_cbranch_scc1 G2_OK6
    s_sleep 2
    s_branch G2_SP6
G2_ZSP:
    s_sub_u32 s59, s59, 1
    s_cmp_lt_i32 s59, 1
    s_cbranch_scc1 G2_ZOK
    s_sleep 2
    buffer_load_dword v40, v28, s[32:35], 0 offen sc1
    s_waitcnt vmcnt(0)
    s_branch G2_ZC
CV_S3:
    buffer_load_dword v159, v4, s[32:35], 0 offen sc1
    s_waitcnt lgkmcnt(6)
    v_mfma_f32_16x16x32_bf16 v[32:35], v[176:179], v[64:67], v[32:35]
    ds_read_b128 v[96:99], v13 offset:768
    v_mfma_f32_16x16x32_bf16 v[36:39], v[176:179], v[68:71], v[36:39]
    ds_read_b128 v[100:103], v13 offset:5248
    v_mfma_f32_16x16x32_bf16 v[40:43], v[180:183], v[64:67], v[40:43]
    v_mfma_f32_16x16x32_bf16 v[44:47], v[180:183], v[68:71], v[44:47]
    ds_read_b128 v[112:115], v15 offset:3840
    v_mfma_f32_16x16x32_bf16 v[48:51], v[184:187], v[64:67], v[48:51]
    v_mfma_f32_16x16x32_bf16 v[52:55], v[184:187], v[68:71], v[52:55]
    ds_read_b128 v[116:119], v15 offset:2816
    v_mfma_f32_16x16x32_bf16 v[56:59], v[188:191], v[64:67], v[56:59]
    ds_read_b128 v[104:107], v13 offset:3840
    v_mfma_f32_16x16x32_bf16 v[60:63], v[188:191], v[68:71], v[60:63]
    v_mfma_f32_16x16x32_bf16 v[56:59], v[176:179], v[72:75], v[56:59]
    ds_read_b128 v[108:111], v13 offset:8320
    v_mfma_f32_16x16x32_bf16 v[60:63], v[176:179], v[76:79], v[60:63]
    s_waitcnt lgkmcnt(8)
    v_mfma_f32_16x16x32_bf16 v[40:43], v[176:179], v[80:83], v[40:43]
    ds_read_b128 v[64:67], v13 offset:1792
    v_mfma_f32_16x16x32_bf16 v[44:47], v[176:179], v[84:87], v[44:47]
    ds_read_b128 v[68:71], v13 offset:6272
    v_mfma_f32_16x16x32_bf16 v[48:51], v[180:183], v[80:83], v[48:51]
    v_mfma_f32_16x16x32_bf16 v[52:55], v[180:183], v[84:87], v[52:55]
    ds_read_b128 v[72:75], v13 offset:2816
    v_mfma_f32_16x16x32_bf16 v[56:59], v[184:187], v[80:83], v[56:59]
    v_mfma_f32_16x16x32_bf16 v[60:63], v[184:187], v[84:87], v[60:63]
    ds_read_b128 v[76:79], v13 offset:7296
    v_mfma_f32_16x16x32_bf16 v[48:51], v[176:179], v[88:91], v[48:51]
    ds_read_b128 v[136:139], v15 offset:1856
    v_mfma_f32_16x16x32_bf16 v[52:55], v[176:179], v[92:95], v[52:55]
    v_mfma_f32_16x16x32_bf16 v[56:59], v[180:183], v[88:91], v[56:59]
    ds_read_b128 v[140:143], v15 offset:832
    v_mfma_f32_16x16x32_bf16 v[60:63], v[180:183], v[92:95], v[60:63]
    s_waitcnt vmcnt(2)
    v_cmp_ne_u32 vcc, 0, v158
    s_nop 0
    s_or_b32 s47, s47, vcc_lo
    s_and_b32 s63, s47, 3
    s_cmp_eq_u32 s63, 3
    s_cbranch_scc0 CV_S4
CV_F4:
    s_mov_b32 s46, 2
    s_waitcnt lgkmcnt(6)
    v_mfma_f32_16x16x32_bf16 v[32:35], v[112:115], v[96:99], v[32:35]
    ds_read_b128 v[80:83], v13 offset:832
    buffer_load_dwordx4 a[64:67], v16, s[16:19], s41 offen offset:0 sc1
    v_mfma_f32_16x16x32_bf16 v[36:39], v[112:115], v[100:103], v[36:39]
    v_mfma_f32_16x16x32_bf16 v[40:43], v[116:119], v[96:99], v[40:43]
    ds_read_b128 v[84:87], v13 offset:5312
    v_mfma_f32_16x16x32_bf16 v[44:47], v[116:119], v[100:103], v[44:47]
    buffer_load_dwordx4 a[68:71], v16, s[16:19], s41 offen offset:1024 sc1
    v_mfma_f32_16x16x32_bf16 v[48:51], v[120:123], v[96:99], v[48:51]
    v_mfma_f32_16x16x32_bf16 v[52:55], v[120:123], v[100:103], v[52:55]
    ds_read_b128 v[128:131], v15 offset:3904
    v_mfma_f32_16x16x32_bf16 v[56:59], v[124:127], v[96:99], v[56:59]
    buffer_load_dwordx4 a[192:195], v17, s[16:19], s41 offen offset:0 sc1
    v_mfma_f32_16x16x32_bf16 v[60:63], v[124:127], v[100:103], v[60:63]
    ds_read_b128 v[132:135], v15 offset:2880
    v_mfma_f32_16x16x32_bf16 v[56:59], v[112:115], v[104:107], v[56:59]
    v_mfma_f32_16x16x32_bf16 v[60:63], v[112:115], v[108:111], v[60:63]
    buffer_load_dwordx4 a[196:199], v17, s[16:19], s41 offen offset:1024 sc1
    s_add_u32 s41, s41, 0x8000
    s_waitcnt lgkmcnt(6)
    v_mfma_f32_16x16x32_bf16 v[40:43], v[112:115], v[64:67], v[40:43]
    ds_read_b128 v[96:99], v13 offset:1856
    v_mfma_f32_16x16x32_bf16 v[44:47], v[112:115], v[68:71], v[44:47]
    ds_read_b128 v[100:103], v13 offset:6336
    v_mfma_f32_16x16x32_bf16 v[48:51], v[116:119], v[64:67], v[48:51]
    buffer_load_dwordx4 a[96:99], v16, s[16:19], s42 offen offset:0 sc1
    v_mfma_f32_16x16x32_bf16 v[52:55], v[116:119], v[68:71], v[52:55]
    ds_read_b128 v[104:107], v13 offset:2880
    v_mfma_f32_16x16x32_bf16 v[56:59], v[120:123], v[64:67], v[56:59]
    v_mfma_f32_16x16x32_bf16 v[60:63], v[120:123], v[68:71], v[60:63]
    ds_read_b128 v[108:111], v13 offset:7360
    buffer_load_dwordx4 a[100:103], v16, s[16:19], s42 offen offset:1024 sc1
    v_mfma_f32_16x16x32_bf16 v[48:51], v[112:115], v[72:75], v[48:51]
    ds_read_b128 v[184:187], v15 offset:1920
    v_mfma_f32_16x16x32_bf16 v[52:55], v[112:115], v[76:79], v[52:55]
    v_mfma_f32_16x16x32_bf16 v[56:59], v[116:119], v[72:75], v[56:59]
    ds_read_b128 v[188:191], v15 offset:896
    buffer_load_dwordx4 a[224:227], v17, s[16:19], s42 offen offset:0 sc1
    v_mfma_f32_16x16x32_bf16 v[60:63], v[116:119], v[76:79], v[60:63]
    s_waitcnt lgkmcnt(6)
    v_mfma_f32_16x16x32_bf16 v[32:35], v[128:131], v[80:83], v[32:35]
    ds_read_b128 v[64:67], v13 offset:896
    v_mfma_f32_16x16x32_bf16 v[36:39], v[128:131], v[84:87], v[36:39]
    buffer_load_dwordx4 a[228:231], v17, s[16:19], s42 offen offset:1024 sc1
    s_add_u32 s42, s42, 0x8000
    v_mfma_f32_16x16x32_bf16 v[40:43], v[132:135], v[80:83], v[40:43]
    ds_read_b128 v[68:71], v13 offset:5376
    v_mfma_f32_16x16x32_bf16 v[44:47], v[132:135], v[84:87], v[44:47]
    v_mfma_f32_16x16x32_bf16 v[48:51], v[136:139], v[80:83], v[48:51]
    ds_read_b128 v[176:179], v15 offset:3968
    v_mfma_f32_16x16x32_bf16 v[52:55], v[136:139], v[84:87], v[52:55]
    buffer_load_dwordx4 a[72:75], v16, s[16:19], s43 offen offset:0 sc1
    v_mfma_f32_16x16x32_bf16 v[56:59], v[140:143], v[80:83], v[56:59]
    ds_read_b128 v[180:183], v15 offset:2944
    v_mfma_f32_16x16x32_bf16 v[60:63], v[140:143], v[84:87], v[60:63]
    s_waitcnt lgkmcnt(6)
    v_mfma_f32_16x16x32_bf16 v[40:43], v[128:131], v[96:99], v[40:43]
    ds_read_b128 v[80:83], v13 offset:1920
    buffer_load_dwordx4 a[76:79], v16, s[16:19], s43 offen offset:1024 sc1
    v_mfma_f32_16x16x32_bf16 v[44:47], v[128:131], v[100:103], v[44:47]
    ds_read_b128 v[84:87], v13 offset:6400
    v_mfma_f32_16x16x32_bf16 v[48:51], v[132:135], v[96:99], v[48:51]
    v_mfma_f32_16x16x32_bf16 v[52:55], v[132:135], v[100:103], v[52:55]
    ds_read_b128 v[88:91], v13 offset:2944
    buffer_load_dwordx4 a[200:203], v17, s[16:19], s43 offen offset:0 sc1
    v_mfma_f32_16x16x32_bf16 v[56:59], v[136:139], v[96:99], v[56:59]
    v_mfma_f32_16x16x32_bf16 v[60:63], v[136:139], v[100:103], v[60:63]
    ds_read_b128 v[92:95], v13 offset:7424
    v_mfma_f32_16x16x32_bf16 v[48:51], v[128:131], v[104:107], v[48:51]
    ds_read_b128 v[120:123], v15 offset:1984
IW_P12:
    s_cbranch_execz IW_R1
    buffer_load_dwordx4 a[204:207], v17, s[16:19], s43 offen offset:1024 sc1
    s_add_u32 s43, s43, 0x8000
    v_mfma_f32_16x16x32_bf16 v[52:55], v[128:131], v[108:111], v[52:55]
    v_mfma_f32_16x16x32_bf16 v[56:59], v[132:135], v[104:107], v[56:59]
    ds_read_b128 v[124:127], v15 offset:960
    v_mfma_f32_16x16x32_bf16 v[60:63], v[132:135], v[108:111], v[60:63]
    buffer_load_dwordx4 a[104:107], v16, s[16:19], s71 offen offset:0 sc1
    s_waitcnt lgkmcnt(6)
    v_mfma_f32_16x16x32_bf16 v[32:35], v[176:179], v[64:67], v[32:35]
    ds_read_b128 v[96:99], v13 offset:960
    v_mfma_f32_16x16x32_bf16 v[36:39], v[176:179], v[68:71], v[36:39]
    v_mfma_f32_16x16x32_bf16 v[40:43], v[180:183], v[64:67], v[40:43]
    ds_read_b128 v[100:103], v13 offset:5440
    buffer_load_dwordx4 a[108:111], v16, s[16:19], s71 offen offset:1024 sc1
    v_mfma_f32_16x16x32_bf16 v[44:47], v[180:183], v[68:71], v[44:47]
    v_mfma_f32_16x16x32_bf16 v[48:51], v[184:187], v[64:67], v[48:51]
    ds_read_b128 v[112:115], v15 offset:4032
    v_mfma_f32_16x16x32_bf16 v[52:55], v[184:187], v[68:71], v[52:55]
    buffer_load_dwordx4 a[232:235], v17, s[16:19], s71 offen offset:0 sc1
    v_mfma_f32_16x16x32_bf16 v[56:59], v[188:191], v[64:67], v[56:59]
    ds_read_b128 v[116:119], v15 offset:3008
    v_mfma_f32_16x16x32_bf16 v[60:63], v[188:191], v[68:71], v[60:63]
    s_waitcnt lgkmcnt(6)
    v_mfma_f32_16x16x32_bf16 v[40:43], v[176:179], v[80:83], v[40:43]
    ds_read_b128 v[64:67], v13 offset:1984
    buffer_load_dwordx4 a[236:239], v17, s[16:19], s71 offen offset:1024 sc1
    s_add_u32 s71, s71, 0x8000
    v_mfma_f32_16x16x32_bf16 v[44:47], v[176:179], v[84:87], v[44:47]
    ds_read_b128 v[68:71], v13 offset:6464
    v_mfma_f32_16x16x32_bf16 v[48:51], v[180:183], v[80:83], v[48:51]
    v_mfma_f32_16x16x32_bf16 v[52:55], v[180:183], v[84:87], v[52:55]
    ds_read_b128 v[72:75], v13 offset:3008
    v_mfma_f32_16x16x32_bf16 v[56:59], v[184:187], v[80:83], v[56:59]
    buffer_load_dwordx4 a[80:83], v16, s[16:19], s41 offen offset:0 sc1
    v_mfma_f32_16x16x32_bf16 v[60:63], v[184:187], v[84:87], v[60:63]
    ds_read_b128 v[76:79], v13 offset:7488
    v_mfma_f32_16x16x32_bf16 v[48:51], v[176:179], v[88:91], v[48:51]
    ds_read_b128 v[136:139], v14 offset:2048
    v_mfma_f32_16x16x32_bf16 v[52:55], v[176:179], v[92:95], v[52:55]
    buffer_load_dwordx4 a[84:87], v16, s[16:19], s41 offen offset:1024 sc1
    v_mfma_f32_16x16x32_bf16 v[56:59], v[180:183], v[88:91], v[56:59]
    ds_read_b128 v[140:143], v14 offset:1024
    v_mfma_f32_16x16x32_bf16 v[60:63], v[180:183], v[92:95], v[60:63]
    s_waitcnt lgkmcnt(6)
    v_mfma_f32_16x16x32_bf16 v[32:35], v[112:115], v[96:99], v[32:35]
    ds_read_b128 v[80:83], v13 offset:1024
    buffer_load_dwordx4 a[208:211], v17, s[16:19], s41 offen offset:0 sc1
    v_mfma_f32_16x16x32_bf16 v[36:39], v[112:115], v[100:103], v[36:39]
    v_mfma_f32_16x16x32_bf16 v[40:43], v[116:119], v[96:99], v[40:43]
    ds_read_b128 v[84:87], v13 offset:5504
    v_mfma_f32_16x16x32_bf16 v[44:47], v[116:119], v[100:103], v[44:47]
    buffer_load_dwordx4 a[212:215], v17, s[16:19], s41 offen offset:1024 sc1
    s_add_u32 s41, s41, 0x8000
    v_mfma_f32_16x16x32_bf16 v[48:51], v[120:123], v[96:99], v[48:51]
    ds_read_b128 v[128:131], v14 offset:4096
    v_mfma_f32_16x16x32_bf16 v[52:55], v[120:123], v[100:103], v[52:55]
    v_mfma_f32_16x16x32_bf16 v[56:59], v[124:127], v[96:99], v[56:59]
    ds_read_b128 v[132:135], v14 offset:3072
    buffer_load_dwordx4 a[112:115], v16, s[16:19], s42 offen offset:0 sc1
    v_mfma_f32_16x16x32_bf16 v[60:63], v[124:127], v[100:103], v[60:63]
    s_waitcnt lgkmcnt(6)
    v_mfma_f32_16x16x32_bf16 v[40:43], v[112:115], v[64:67], v[40:43]
    ds_read_b128 v[96:99], v13 offset:2048
    v_mfma_f32_16x16x32_bf16 v[44:47], v[112:115], v[68:71], v[44:47]
    ds_read_b128 v[100:103], v13 offset:6528
    buffer_load_dwordx4 a[116:119], v16, s[16:19], s42 offen offset:1024 sc1
    v_mfma_f32_16x16x32_bf16 v[48:51], v[116:119], v[64:67], v[48:51]
    v_mfma_f32_16x16x32_bf16 v[52:55], v[116:119], v[68:71], v[52:55]
    ds_read_b128 v[104:107], v13 offset:3072
    v_mfma_f32_16x16x32_bf16 v[56:59], v[120:123], v[64:67], v[56:59]
    buffer_load_dwordx4 a[240:243], v17, s[16:19], s42 offen offset:0 sc1
    v_mfma_f32_16x16x32_bf16 v[60:63], v[120:123], v[68:71], v[60:63]
    ds_read_b128 v[108:111], v13 offset:7552
    v_mfma_f32_16x16x32_bf16 v[48:51], v[112:115], v[72:75], v[48:51]
    ds_read_b128 v[224:227], v15 offset:3904
    v_mfma_f32_16x16x32_bf16 v[52:55], v[112:115], v[76:79], v[52:55]
    buffer_load_dwordx4 a[244:247], v17, s[16:19], s42 offen offset:1024 sc1
    s_add_u32 s42, s42, 0x8000
    v_mfma_f32_16x16x32_bf16 v[56:59], v[116:119], v[72:75], v[56:59]
    ds_read_b128 v[228:231], v15 offset:3968
    v_mfma_f32_16x16x32_bf16 v[60:63], v[116:119], v[76:79], v[60:63]
    s_waitcnt lgkmcnt(6)
    v_mfma_f32_16x16x32_bf16 v[32:35], v[128:131], v[80:83], v[32:35]
    ds_read_b128 v[64:67], v13 offset:3904
    v_mfma_f32_16x16x32_bf16 v[36:39], v[128:131], v[84:87], v[36:39]
    ds_read_b128 v[68:71], v13 offset:8384
    buffer_load_dwordx4 a[88:91], v16, s[16:19], s43 offen offset:0 sc1
    v_mfma_f32_16x16x32_bf16 v[40:43], v[132:135], v[80:83], v[40:43]
    ds_read_b128 v[72:75], v13 offset:3968
    v_mfma_f32_16x16x32_bf16 v[44:47], v[132:135], v[84:87], v[44:47]
    v_mfma_f32_16x16x32_bf16 v[48:51], v[136:139], v[80:83], v[48:51]
    ds_read_b128 v[76:79], v13 offset:8448
    buffer_load_dwordx4 a[92:95], v16, s[16:19], s43 offen offset:1024 sc1
    v_mfma_f32_16x16x32_bf16 v[52:55], v[136:139], v[84:87], v[52:55]
    ds_read_b128 v[232:235], v15 offset:4032
    v_mfma_f32_16x16x32_bf16 v[56:59], v[140:143], v[80:83], v[56:59]
    ds_read_b128 v[236:239], v14 offset:4096
    v_mfma_f32_16x16x32_bf16 v[60:63], v[140:143], v[84:87], v[60:63]
    buffer_load_dwordx4 a[216:219], v17, s[16:19], s43 offen offset:0 sc1
    s_waitcnt lgkmcnt(8)
    v_mfma_f32_16x16x32_bf16 v[40:43], v[128:131], v[96:99], v[40:43]
    ds_read_b128 v[80:83], v13 offset:4032
    v_cvt_pk_bf16_f32 v240, v32, v33
    v_mfma_f32_16x16x32_bf16 v[44:47], v[128:131], v[100:103], v[44:47]
    v_mfma_f32_16x16x32_bf16 v[48:51], v[132:135], v[96:99], v[48:51]
    ds_read_b128 v[84:87], v13 offset:8512
    v_cvt_pk_bf16_f32 v241, v34, v35
    buffer_load_dwordx4 a[220:223], v17, s[16:19], s43 offen offset:1024 sc1
    s_add_u32 s43, s43, 0x8000
    v_mfma_f32_16x16x32_bf16 v[52:55], v[132:135], v[100:103], v[52:55]
    v_mfma_f32_16x16x32_bf16 v[56:59], v[136:139], v[96:99], v[56:59]
    v_cvt_pk_bf16_f32 v242, v36, v37
    v_mfma_f32_16x16x32_bf16 v[60:63], v[136:139], v[100:103], v[60:63]
    ds_read_b128 v[88:91], v13 offset:4096
    buffer_load_dwordx4 a[120:123], v16, s[16:19], s71 offen offset:0 sc1
    v_mfma_f32_16x16x32_bf16 v[48:51], v[128:131], v[104:107], v[48:51]
    v_cvt_pk_bf16_f32 v243, v38, v39
    v_mfma_f32_16x16x32_bf16 v[52:55], v[128:131], v[108:111], v[52:55]
    ds_read_b128 v[92:95], v13 offset:8576
    v_mfma_f32_16x16x32_bf16 v[56:59], v[132:135], v[104:107], v[56:59]
    buffer_store_dwordx4 v[240:243], v12, s[12:15], s62 offen offset:0 sc1
    buffer_load_dwordx4 a[124:127], v16, s[16:19], s71 offen offset:1024 sc1
    v_mfma_f32_16x16x32_bf16 v[60:63], v[132:135], v[108:111], v[60:63]
    s_waitcnt lgkmcnt(6)
    v_mfma_f32_16x16x32_bf16 v[56:59], v[224:227], v[64:67], v[56:59]
    v_mfma_f32_16x16x32_bf16 v[60:63], v[224:227], v[68:71], v[60:63]
    v_cvt_pk_bf16_f32 v244, v40, v41
    v_cvt_pk_bf16_f32 v245, v42, v43
    buffer_load_dwordx4 a[248:251], v17, s[16:19], s71 offen offset:0 sc1
    v_mfma_f32_16x16x32_bf16 v[56:59], v[228:231], v[72:75], v[56:59]
    v_cvt_pk_bf16_f32 v246, v44, v45
    v_mfma_f32_16x16x32_bf16 v[60:63], v[228:231], v[76:79], v[60:63]
    v_cvt_pk_bf16_f32 v247, v46, v47
    buffer_store_dwordx4 v[244:247], v12, s[12:15], s62 offen offset:1024 sc1
    s_waitcnt lgkmcnt(0)
    v_mfma_f32_16x16x32_bf16 v[56:59], v[232:235], v[80:83], v[56:59]
    v_cvt_pk_bf16_f32 v248, v48, v49
    buffer_load_dwordx4 a[252:255], v17, s[16:19], s71 offen offset:1024 sc1
    s_add_u32 s71, s71, 0x8000
    v_mfma_f32_16x16x32_bf16 v[60:63], v[232:235], v[84:87], v[60:63]
    v_cvt_pk_bf16_f32 v249, v50, v51
    v_cvt_pk_bf16_f32 v250, v52, v53
    v_mfma_f32_16x16x32_bf16 v[56:59], v[236:239], v[88:91], v[56:59]
    v_cvt_pk_bf16_f32 v251, v54, v55
    v_mfma_f32_16x16x32_bf16 v[60:63], v[236:239], v[92:95], v[60:63]
    buffer_store_dwordx4 v[248:251], v12, s[12:15], s62 offen offset:2048 sc1
    s_branch CV_CK
CV_S4:
    buffer_load_dword v157, v4, s[32:35], 0 offen sc1
    s_waitcnt lgkmcnt(6)
    v_mfma_f32_16x16x32_bf16 v[32:35], v[112:115], v[96:99], v[32:35]
    ds_read_b128 v[80:83], v13 offset:832
    v_mfma_f32_16x16x32_bf16 v[36:39], v[112:115], v[100:103], v[36:39]
    v_mfma_f32_16x16x32_bf16 v[40:43], v[116:119], v[96:99], v[40:43]
    ds_read_b128 v[84:87], v13 offset:5312
    v_mfma_f32_16x16x32_bf16 v[44:47], v[116:119], v[100:103], v[44:47]
    v_mfma_f32_16x16x32_bf16 v[48:51], v[120:123], v[96:99], v[48:51]
    v_mfma_f32_16x16x32_bf16 v[52:55], v[120:123], v[100:103], v[52:55]
    ds_read_b128 v[128:131], v15 offset:3904
    v_mfma_f32_16x16x32_bf16 v[56:59], v[124:127], v[96:99], v[56:59]
    v_mfma_f32_16x16x32_bf16 v[60:63], v[124:127], v[100:103], v[60:63]
    ds_read_b128 v[132:135], v15 offset:2880
    v_mfma_f32_16x16x32_bf16 v[56:59], v[112:115], v[104:107], v[56:59]
    v_mfma_f32_16x16x32_bf16 v[60:63], v[112:115], v[108:111], v[60:63]
    s_waitcnt lgkmcnt(6)
    v_mfma_f32_16x16x32_bf16 v[40:43], v[112:115], v[64:67], v[40:43]
    ds_read_b128 v[96:99], v13 offset:1856
    v_mfma_f32_16x16x32_bf16 v[44:47], v[112:115], v[68:71], v[44:47]
    ds_read_b128 v[100:103], v13 offset:6336
    v_mfma_f32_16x16x32_bf16 v[48:51], v[116:119], v[64:67], v[48:51]
    v_mfma_f32_16x16x32_bf16 v[52:55], v[116:119], v[68:71], v[52:55]
    ds_read_b128 v[104:107], v13 offset:2880
    v_mfma_f32_16x16x32_bf16 v[56:59], v[120:123], v[64:67], v[56:59]
    v_mfma_f32_16x16x32_bf16 v[60:63], v[120:123], v[68:71], v[60:63]
    ds_read_b128 v[108:111], v13 offset:7360
    v_mfma_f32_16x16x32_bf16 v[48:51], v[112:115], v[72:75], v[48:51]
    ds_read_b128 v[184:187], v15 offset:1920
    v_mfma_f32_16x16x32_bf16 v[52:55], v[112:115], v[76:79], v[52:55]
    v_mfma_f32_16x16x32_bf16 v[56:59], v[116:119], v[72:75], v[56:59]
    ds_read_b128 v[188:191], v15 offset:896
    v_mfma_f32_16x16x32_bf16 v[60:63], v[116:119], v[76:79], v[60:63]
    s_waitcnt vmcnt(2)
    v_cmp_ne_u32 vcc, 0, v156
    s_nop 0
    s_or_b32 s47, s47, vcc_lo
    s_and_b32 s63, s47, 3
    s_cmp_eq_u32 s63, 3
    s_cbranch_scc0 CV_S5
CV_F5:
    s_mov_b32 s46, 2
    s_waitcnt lgkmcnt(6)
    v_mfma_f32_16x16x32_bf16 v[32:35], v[128:131], v[80:83], v[32:35]
    ds_read_b128 v[64:67], v13 offset:896
    buffer_load_dwordx4 a[64:67], v16, s[16:19], s41 offen offset:0 sc1
    v_mfma_f32_16x16x32_bf16 v[36:39], v[128:131], v[84:87], v[36:39]
    v_mfma_f32_16x16x32_bf16 v[40:43], v[132:135], v[80:83], v[40:43]
    ds_read_b128 v[68:71], v13 offset:5376
    buffer_load_dwordx4 a[68:71], v16, s[16:19], s41 offen offset:1024 sc1
    v_mfma_f32_16x16x32_bf16 v[44:47], v[132:135], v[84:87], v[44:47]
    v_mfma_f32_16x16x32_bf16 v[48:51], v[136:139], v[80:83], v[48:51]
    ds_read_b128 v[176:179], v15 offset:3968
    v_mfma_f32_16x16x32_bf16 v[52:55], v[136:139], v[84:87], v[52:55]
    buffer_load_dwordx4 a[192:195], v17, s[16:19], s41 offen offset:0 sc1
    v_mfma_f32_16x16x32_bf16 v[56:59], v[140:143], v[80:83], v[56:59]
    ds_read_b128 v[180:183], v15 offset:2944
    v_mfma_f32_16x16x32_bf16 v[60:63], v[140:143], v[84:87], v[60:63]
    buffer_load_dwordx4 a[196:199], v17, s[16:19], s41 offen offset:1024 sc1
    s_add_u32 s41, s41, 0x8000
    s_waitcnt lgkmcnt(6)
    v_mfma_f32_16x16x32_bf16 v[40:43], v[128:131], v[96:99], v[40:43]
    ds_read_b128 v[80:83], v13 offset:1920
    v_mfma_f32_16x16x32_bf16 v[44:47], v[128:131], v[100:103], v[44:47]
    ds_read_b128 v[84:87], v13 offset:6400
    v_mfma_f32_16x16x32_bf16 v[48:51], v[132:135], v[96:99], v[48:51]
    buffer_load_dwordx4 a[96:99], v16, s[16:19], s42 offen offset:0 sc1
    v_mfma_f32_16x16x32_bf16 v[52:55], v[132:135], v[100:103], v[52:55]
    ds_read_b128 v[88:91], v13 offset:2944
    v_mfma_f32_16x16x32_bf16 v[56:59], v[136:139], v[96:99], v[56:59]
    buffer_load_dwordx4 a[100:103], v16, s[16:19], s42 offen offset:1024 sc1
    v_mfma_f32_16x16x32_bf16 v[60:63], v[136:139], v[100:103], v[60:63]
    ds_read_b128 v[92:95], v13 offset:7424
    v_mfma_f32_16x16x32_bf16 v[48:51], v[128:131], v[104:107], v[48:51]
    ds_read_b128 v[120:123], v15 offset:1984
    v_mfma_f32_16x16x32_bf16 v[52:55], v[128:131], v[108:111], v[52:55]
    buffer_load_dwordx4 a[224:227], v17, s[16:19], s42 offen offset:0 sc1
    v_mfma_f32_16x16x32_bf16 v[56:59], v[132:135], v[104:107], v[56:59]
    ds_read_b128 v[124:127], v15 offset:960
    v_mfma_f32_16x16x32_bf16 v[60:63], v[132:135], v[108:111], v[60:63]
    buffer_load_dwordx4 a[228:231], v17, s[16:19], s42 offen offset:1024 sc1
    s_add_u32 s42, s42, 0x8000
    s_waitcnt lgkmcnt(6)
    v_mfma_f32_16x16x32_bf16 v[32:35], v[176:179], v[64:67], v[32:35]
    ds_read_b128 v[96:99], v13 offset:960
    v_mfma_f32_16x16x32_bf16 v[36:39], v[176:179], v[68:71], v[36:39]
    v_mfma_f32_16x16x32_bf16 v[40:43], v[180:183], v[64:67], v[40:43]
    ds_read_b128 v[100:103], v13 offset:5440
    buffer_load_dwordx4 a[72:75], v16, s[16:19], s43 offen offset:0 sc1
    v_mfma_f32_16x16x32_bf16 v[44:47], v[180:183], v[68:71], v[44:47]
    v_mfma_f32_16x16x32_bf16 v[48:51], v[184:187], v[64:67], v[48:51]
    ds_read_b128 v[112:115], v15 offset:4032
    buffer_load_dwordx4 a[76:79], v16, s[16:19], s43 offen offset:1024 sc1
    v_mfma_f32_16x16x32_bf16 v[52:55], v[184:187], v[68:71], v[52:55]
    v_mfma_f32_16x16x32_bf16 v[56:59], v[188:191], v[64:67], v[56:59]
    ds_read_b128 v[116:119], v15 offset:3008
    v_mfma_f32_16x16x32_bf16 v[60:63], v[188:191], v[68:71], v[60:63]
    buffer_load_dwordx4 a[200:203], v17, s[16:19], s43 offen offset:0 sc1
    s_waitcnt lgkmcnt(6)
    v_mfma_f32_16x16x32_bf16 v[40:43], v[176:179], v[80:83], v[40:43]
    ds_read_b128 v[64:67], v13 offset:1984
    v_mfma_f32_16x16x32_bf16 v[44:47], v[176:179], v[84:87], v[44:47]
    ds_read_b128 v[68:71], v13 offset:6464
    buffer_load_dwordx4 a[204:207], v17, s[16:19], s43 offen offset:1024 sc1
    s_add_u32 s43, s43, 0x8000
    v_mfma_f32_16x16x32_bf16 v[48:51], v[180:183], v[80:83], v[48:51]
    v_mfma_f32_16x16x32_bf16 v[52:55], v[180:183], v[84:87], v[52:55]
    ds_read_b128 v[72:75], v13 offset:3008
    v_mfma_f32_16x16x32_bf16 v[56:59], v[184:187], v[80:83], v[56:59]
    buffer_load_dwordx4 a[104:107], v16, s[16:19], s71 offen offset:0 sc1
    v_mfma_f32_16x16x32_bf16 v[60:63], v[184:187], v[84:87], v[60:63]
    ds_read_b128 v[76:79], v13 offset:7488
    v_mfma_f32_16x16x32_bf16 v[48:51], v[176:179], v[88:91], v[48:51]
    ds_read_b128 v[136:139], v14 offset:2048
    buffer_load_dwordx4 a[108:111], v16, s[16:19], s71 offen offset:1024 sc1
    v_mfma_f32_16x16x32_bf16 v[52:55], v[176:179], v[92:95], v[52:55]
    v_mfma_f32_16x16x32_bf16 v[56:59], v[180:183], v[88:91], v[56:59]
    ds_read_b128 v[140:143], v14 offset:1024
    v_mfma_f32_16x16x32_bf16 v[60:63], v[180:183], v[92:95], v[60:63]
    buffer_load_dwordx4 a[232:235], v17, s[16:19], s71 offen offset:0 sc1
    s_waitcnt lgkmcnt(6)
    v_mfma_f32_16x16x32_bf16 v[32:35], v[112:115], v[96:99], v[32:35]
    ds_read_b128 v[80:83], v13 offset:1024
    v_mfma_f32_16x16x32_bf16 v[36:39], v[112:115], v[100:103], v[36:39]
    buffer_load_dwordx4 a[236:239], v17, s[16:19], s71 offen offset:1024 sc1
    s_add_u32 s71, s71, 0x8000
    v_mfma_f32_16x16x32_bf16 v[40:43], v[116:119], v[96:99], v[40:43]
    ds_read_b128 v[84:87], v13 offset:5504
    v_mfma_f32_16x16x32_bf16 v[44:47], v[116:119], v[100:103], v[44:47]
    v_mfma_f32_16x16x32_bf16 v[48:51], v[120:123], v[96:99], v[48:51]
    ds_read_b128 v[128:131], v14 offset:4096
    buffer_load_dwordx4 a[80:83], v16, s[16:19], s41 offen offset:0 sc1
    v_mfma_f32_16x16x32_bf16 v[52:55], v[120:123], v[100:103], v[52:55]
    v_mfma_f32_16x16x32_bf16 v[56:59], v[124:127], v[96:99], v[56:59]
    ds_read_b128 v[132:135], v14 offset:3072
    buffer_load_dwordx4 a[84:87], v16, s[16:19], s41 offen offset:1024 sc1
    v_mfma_f32_16x16x32_bf16 v[60:63], v[124:127], v[100:103], v[60:63]
    s_waitcnt lgkmcnt(6)
    v_mfma_f32_16x16x32_bf16 v[40:43], v[112:115], v[64:67], v[40:43]
    ds_read_b128 v[96:99], v13 offset:2048
    v_mfma_f32_16x16x32_bf16 v[44:47], v[112:115], v[68:71], v[44:47]
    ds_read_b128 v[100:103], v13 offset:6528
    buffer_load_dwordx4 a[208:211], v17, s[16:19], s41 offen offset:0 sc1
    v_mfma_f32_16x16x32_bf16 v[48:51], v[116:119], v[64:67], v[48:51]
    v_mfma_f32_16x16x32_bf16 v[52:55], v[116:119], v[68:71], v[52:55]
    ds_read_b128 v[104:107], v13 offset:3072
    buffer_load_dwordx4 a[212:215], v17, s[16:19], s41 offen offset:1024 sc1
    s_add_u32 s41, s41, 0x8000
    v_mfma_f32_16x16x32_bf16 v[56:59], v[120:123], v[64:67], v[56:59]
    v_mfma_f32_16x16x32_bf16 v[60:63], v[120:123], v[68:71], v[60:63]
    ds_read_b128 v[108:111], v13 offset:7552
    v_mfma_f32_16x16x32_bf16 v[48:51], v[112:115], v[72:75], v[48:51]
    ds_read_b128 v[224:227], v15 offset:3904
    buffer_load_dwordx4 a[112:115], v16, s[16:19], s42 offen offset:0 sc1
    v_mfma_f32_16x16x32_bf16 v[52:55], v[112:115], v[76:79], v[52:55]
    v_mfma_f32_16x16x32_bf16 v[56:59], v[116:119], v[72:75], v[56:59]
    ds_read_b128 v[228:231], v15 offset:3968
    buffer_load_dwordx4 a[116:119], v16, s[16:19], s42 offen offset:1024 sc1
    v_mfma_f32_16x16x32_bf16 v[60:63], v[116:119], v[76:79], v[60:63]
    s_waitcnt lgkmcnt(6)
    v_mfma_f32_16x16x32_bf16 v[32:35], v[128:131], v[80:83], v[32:35]
    ds_read_b128 v[64:67], v13 offset:3904
    v_mfma_f32_16x16x32_bf16 v[36:39], v[128:131], v[84:87], v[36:39]
    ds_read_b128 v[68:71], v13 offset:8384
    buffer_load_dwordx4 a[240:243], v17, s[16:19], s42 offen offset:0 sc1
    v_mfma_f32_16x16x32_bf16 v[40:43], v[132:135], v[80:83], v[40:43]
    ds_read_b128 v[72:75], v13 offset:3968
    v_mfma_f32_16x16x32_bf16 v[44:47], v[132:135], v[84:87], v[44:47]
    buffer_load_dwordx4 a[244:247], v17, s[16:19], s42 offen offset:1024 sc1
    s_add_u32 s42, s42, 0x8000
    v_mfma_f32_16x16x32_bf16 v[48:51], v[136:139], v[80:83], v[48:51]
    ds_read_b128 v[76:79], v13 offset:8448
    v_mfma_f32_16x16x32_bf16 v[52:55], v[136:139], v[84:87], v[52:55]
    ds_read_b128 v[232:235], v15 offset:4032
    v_mfma_f32_16x16x32_bf16 v[56:59], v[140:143], v[80:83], v[56:59]
    ds_read_b128 v[236:239], v14 offset:4096
    buffer_load_dwordx4 a[88:91], v16, s[16:19], s43 offen offset:0 sc1
    v_mfma_f32_16x16x32_bf16 v[60:63], v[140:143], v[84:87], v[60:63]
    s_waitcnt lgkmcnt(8)
    v_mfma_f32_16x16x32_bf16 v[40:43], v[128:131], v[96:99], v[40:43]
    ds_read_b128 v[80:83], v13 offset:4032
    v_cvt_pk_bf16_f32 v240, v32, v33
    buffer_load_dwordx4 a[92:95], v16, s[16:19], s43 offen offset:1024 sc1
    v_mfma_f32_16x16x32_bf16 v[44:47], v[128:131], v[100:103], v[44:47]
    v_mfma_f32_16x16x32_bf16 v[48:51], v[132:135], v[96:99], v[48:51]
    ds_read_b128 v[84:87], v13 offset:8512
    v_cvt_pk_bf16_f32 v241, v34, v35
    v_mfma_f32_16x16x32_bf16 v[52:55], v[132:135], v[100:103], v[52:55]
    buffer_load_dwordx4 a[216:219], v17, s[16:19], s43 offen offset:0 sc1
    v_mfma_f32_16x16x32_bf16 v[56:59], v[136:139], v[96:99], v[56:59]
    v_cvt_pk_bf16_f32 v242, v36, v37
    v_mfma_f32_16x16x32_bf16 v[60:63], v[136:139], v[100:103], v[60:63]
    ds_read_b128 v[88:91], v13 offset:4096
    buffer_load_dwordx4 a[220:223], v17, s[16:19], s43 offen offset:1024 sc1
    s_add_u32 s43, s43, 0x8000
    v_mfma_f32_16x16x32_bf16 v[48:51], v[128:131], v[104:107], v[48:51]
    v_cvt_pk_bf16_f32 v243, v38, v39
    v_mfma_f32_16x16x32_bf16 v[52:55], v[128:131], v[108:111], v[52:55]
    ds_read_b128 v[92:95], v13 offset:8576
    v_mfma_f32_16x16x32_bf16 v[56:59], v[132:135], v[104:107], v[56:59]
    buffer_store_dwordx4 v[240:243], v12, s[12:15], s62 offen offset:0 sc1
    buffer_load_dwordx4 a[120:123], v16, s[16:19], s71 offen offset:0 sc1
    v_mfma_f32_16x16x32_bf16 v[60:63], v[132:135], v[108:111], v[60:63]
    s_waitcnt lgkmcnt(6)
    v_mfma_f32_16x16x32_bf16 v[56:59], v[224:227], v[64:67], v[56:59]
    buffer_load_dwordx4 a[124:127], v16, s[16:19], s71 offen offset:1024 sc1
    v_mfma_f32_16x16x32_bf16 v[60:63], v[224:227], v[68:71], v[60:63]
    v_cvt_pk_bf16_f32 v244, v40, v41
    v_cvt_pk_bf16_f32 v245, v42, v43
    v_mfma_f32_16x16x32_bf16 v[56:59], v[228:231], v[72:75], v[56:59]
    v_cvt_pk_bf16_f32 v246, v44, v45
    v_mfma_f32_16x16x32_bf16 v[60:63], v[228:231], v[76:79], v[60:63]
    v_cvt_pk_bf16_f32 v247, v46, v47
    buffer_store_dwordx4 v[244:247], v12, s[12:15], s62 offen offset:1024 sc1
    buffer_load_dwordx4 a[248:251], v17, s[16:19], s71 offen offset:0 sc1
    s_waitcnt lgkmcnt(0)
    v_mfma_f32_16x16x32_bf16 v[56:59], v[232:235], v[80:83], v[56:59]
    v_cvt_pk_bf16_f32 v248, v48, v49
    v_mfma_f32_16x16x32_bf16 v[60:63], v[232:235], v[84:87], v[60:63]
    v_cvt_pk_bf16_f32 v249, v50, v51
    v_cvt_pk_bf16_f32 v250, v52, v53
    buffer_load_dwordx4 a[252:255], v17, s[16:19], s71 offen offset:1024 sc1
    s_add_u32 s71, s71, 0x8000
    v_mfma_f32_16x16x32_bf16 v[56:59], v[236:239], v[88:91], v[56:59]
    v_cvt_pk_bf16_f32 v251, v54, v55
    v_mfma_f32_16x16x32_bf16 v[60:63], v[236:239], v[92:95], v[60:63]
    buffer_store_dwordx4 v[248:251], v12, s[12:15], s62 offen offset:2048 sc1
    s_branch CV_CK
CV_S5:
    buffer_load_dword v158, v4, s[32:35], 0 offen sc1
    s_waitcnt lgkmcnt(6)
    v_mfma_f32_16x16x32_bf16 v[32:35], v[128:131], v[80:83], v[32:35]
    ds_read_b128 v[64:67], v13 offset:896
    v_mfma_f32_16x16x32_bf16 v[36:39], v[128:131], v[84:87], v[36:39]
    v_mfma_f32_16x16x32_bf16 v[40:43], v[132:135], v[80:83], v[40:43]
    ds_read_b128 v[68:71], v13 offset:5376
    v_mfma_f32_16x16x32_bf16 v[44:47], v[132:135], v[84:87], v[44:47]
    v_mfma_f32_16x16x32_bf16 v[48:51], v[136:139], v[80:83], v[48:51]
    ds_read_b128 v[176:179], v15 offset:3968
    v_mfma_f32_16x16x32_bf16 v[52:55], v[136:139], v[84:87], v[52:55]
    v_mfma_f32_16x16x32_bf16 v[56:59], v[140:143], v[80:83], v[56:59]
    ds_read_b128 v[180:183], v15 offset:2944
    v_mfma_f32_16x16x32_bf16 v[60:63], v[140:143], v[84:87], v[60:63]
    s_waitcnt lgkmcnt(6)
    v_mfma_f32_16x16x32_bf16 v[40:43], v[128:131], v[96:99], v[40:43]
    ds_read_b128 v[80:83], v13 offset:1920
    v_mfma_f32_16x16x32_bf16 v[44:47], v[128:131], v[100:103], v[44:47]
    ds_read_b128 v[84:87], v13 offset:6400
    v_mfma_f32_16x16x32_bf16 v[48:51], v[132:135], v[96:99], v[48:51]
    v_mfma_f32_16x16x32_bf16 v[52:55], v[132:135], v[100:103], v[52:55]
    ds_read_b128 v[88:91], v13 offset:2944
    v_mfma_f32_16x16x32_bf16 v[56:59], v[136:139], v[96:99], v[56:59]
    v_mfma_f32_16x16x32_bf16 v[60:63], v[136:139], v[100:103], v[60:63]
    ds_read_b128 v[92:95], v13 offset:7424
    v_mfma_f32_16x16x32_bf16 v[48:51], v[128:131], v[104:107], v[48:51]
    ds_read_b128 v[120:123], v15 offset:1984
    v_mfma_f32_16x16x32_bf16 v[52:55], v[128:131], v[108:111], v[52:55]
    v_mfma_f32_16x16x32_bf16 v[56:59], v[132:135], v[104:107], v[56:59]
    ds_read_b128 v[124:127], v15 offset:960
    v_mfma_f32_16x16x32_bf16 v[60:63], v[132:135], v[108:111], v[60:63]
    s_waitcnt vmcnt(2)
    v_cmp_ne_u32 vcc, 0, v159
    s_nop 0
    s_or_b32 s47, s47, vcc_lo
    s_and_b32 s63, s47, 3
    s_cmp_eq_u32 s63, 3
    s_cbranch_scc0 CV_S6
CV_F6:
    s_mov_b32 s46, 2
    s_waitcnt lgkmcnt(6)
    v_mfma_f32_16x16x32_bf16 v[32:35], v[176:179], v[64:67], v[32:35]
    ds_read_b128 v[96:99], v13 offset:960
    buffer_load_dwordx4 a[64:67], v16, s[16:19], s41 offen offset:0 sc1
    v_mfma_f32_16x16x32_bf16 v[36:39], v[176:179], v[68:71], v[36:39]
    buffer_load_dwordx4 a[68:71], v16, s[16:19], s41 offen offset:1024 sc1
    v_mfma_f32_16x16x32_bf16 v[40:43], v[180:183], v[64:67], v[40:43]
    ds_read_b128 v[100:103], v13 offset:5440
    v_mfma_f32_16x16x32_bf16 v[44:47], v[180:183], v[68:71], v[44:47]
    buffer_load_dwordx4 a[192:195], v17, s[16:19], s41 offen offset:0 sc1
    v_mfma_f32_16x16x32_bf16 v[48:51], v[184:187], v[64:67], v[48:51]
    ds_read_b128 v[112:115], v15 offset:4032
    v_mfma_f32_16x16x32_bf16 v[52:55], v[184:187], v[68:71], v[52:55]
    buffer_load_dwordx4 a[196:199], v17, s[16:19], s41 offen offset:1024 sc1
    s_add_u32 s41, s41, 0x8000
    v_mfma_f32_16x16x32_bf16 v[56:59], v[188:191], v[64:67], v[56:59]
    ds_read_b128 v[116:119], v15 offset:3008
    v_mfma_f32_16x16x32_bf16 v[60:63], v[188:191], v[68:71], v[60:63]
    buffer_load_dwordx4 a[96:99], v16, s[16:19], s42 offen offset:0 sc1
    s_waitcnt lgkmcnt(6)
    v_mfma_f32_16x16x32_bf16 v[40:43], v[176:179], v[80:83], v[40:43]
    ds_read_b128 v[64:67], v13 offset:1984
    v_mfma_f32_16x16x32_bf16 v[44:47], v[176:179], v[84:87], v[44:47]
    ds_read_b128 v[68:71], v13 offset:6464
    buffer_load_dwordx4 a[100:103], v16, s[16:19], s42 offen offset:1024 sc1
    v_mfma_f32_16x16x32_bf16 v[48:51], v[180:183], v[80:83], v[48:51]
    v_mfma_f32_16x16x32_bf16 v[52:55], v[180:183], v[84:87], v[52:55]
    ds_read_b128 v[72:75], v13 offset:3008
    buffer_load_dwordx4 a[224:227], v17, s[16:19], s42 offen offset:0 sc1
    v_mfma_f32_16x16x32_bf16 v[56:59], v[184:187], v[80:83], v[56:59]
    v_mfma_f32_16x16x32_bf16 v[60:63], v[184:187], v[84:87], v[60:63]
    ds_read_b128 v[76:79], v13 offset:7488
    buffer_load_dwordx4 a[228:231], v17, s[16:19], s42 offen offset:1024 sc1
    s_add_u32 s42, s42, 0x8000
    v_mfma_f32_16x16x32_bf16 v[48:51], v[176:179], v[88:91], v[48:51]
    ds_read_b128 v[136:139], v14 offset:2048
    v_mfma_f32_16x16x32_bf16 v[52:55], v[176:179], v[92:95], v[52:55]
    buffer_load_dwordx4 a[72:75], v16, s[16:19], s43 offen offset:0 sc1
    v_mfma_f32_16x16x32_bf16 v[56:59], v[180:183], v[88:91], v[56:59]
    ds_read_b128 v[140:143], v14 offset:1024
    v_mfma_f32_16x16x32_bf16 v[60:63], v[180:183], v[92:95], v[60:63]
    buffer_load_dwordx4 a[76:79], v16, s[16:19], s43 offen offset:1024 sc1
    s_waitcnt lgkmcnt(6)
    v_mfma_f32_16x16x32_bf16 v[32:35], v[112:115], v[96:99], v[32:35]
    ds_read_b128 v[80:83], v13 offset:1024
    v_mfma_f32_16x16x32_bf16 v[36:39], v[112:115], v[100:103], v[36:39]
    buffer_load_dwordx4 a[200:203], v17, s[16:19], s43 offen offset:0 sc1
    v_mfma_f32_16x16x32_bf16 v[40:43], v[116:119], v[96:99], v[40:43]
    ds_read_b128 v[84:87], v13 offset:5504
    v_mfma_f32_16x16x32_bf16 v[44:47], v[116:119], v[100:103], v[44:47]
    buffer_load_dwordx4 a[204:207], v17, s[16:19], s43 offen offset:1024 sc1
    s_add_u32 s43, s43, 0x8000
    v_mfma_f32_16x16x32_bf16 v[48:51], v[120:123], v[96:99], v[48:51]
    ds_read_b128 v[128:131], v14 offset:4096
    v_mfma_f32_16x16x32_bf16 v[52:55], v[120:123], v[100:103], v[52:55]
    buffer_load_dwordx4 a[104:107], v16, s[16:19], s71 offen offset:0 sc1
    v_mfma_f32_16x16x32_bf16 v[56:59], v[124:127], v[96:99], v[56:59]
    ds_read_b128 v[132:135], v14 offset:3072
    v_mfma_f32_16x16x32_bf16 v[60:63], v[124:127], v[100:103], v[60:63]
    buffer_load_dwordx4 a[108:111], v16, s[16:19], s71 offen offset:1024 sc1
    s_waitcnt lgkmcnt(6)
    v_mfma_f32_16x16x32_bf16 v[40:43], v[112:115], v[64:67], v[40:43]
    ds_read_b128 v[96:99], v13 offset:2048
    v_mfma_f32_16x16x32_bf16 v[44:47], v[112:115], v[68:71], v[44:47]
    ds_read_b128 v[100:103], v13 offset:6528
    buffer_load_dwordx4 a[232:235], v17, s[16:19], s71 offen offset:0 sc1
    v_mfma_f32_16x16x32_bf16 v[48:51], v[116:119], v[64:67], v[48:51]
    v_mfma_f32_16x16x32_bf16 v[52:55], v[116:119], v[68:71], v[52:55]
    ds_read_b128 v[104:107], v13 offset:3072
    buffer_load_dwordx4 a[236:239], v17, s[16:19], s71 offen offset:1024 sc1
    s_add_u32 s71, s71, 0x8000
    v_mfma_f32_16x16x32_bf16 v[56:59], v[120:123], v[64:67], v[56:59]
    v_mfma_f32_16x16x32_bf16 v[60:63], v[120:123], v[68:71], v[60:63]
    ds_read_b128 v[108:111], v13 offset:7552
    buffer_load_dwordx4 a[80:83], v16, s[16:19], s41 offen offset:0 sc1
    v_mfma_f32_16x16x32_bf16 v[48:51], v[112:115], v[72:75], v[48:51]
    ds_read_b128 v[224:227], v15 offset:3904
    buffer_load_dwordx4 a[84:87], v16, s[16:19], s41 offen offset:1024 sc1
    v_mfma_f32_16x16x32_bf16 v[52:55], v[112:115], v[76:79], v[52:55]
    v_mfma_f32_16x16x32_bf16 v[56:59], v[116:119], v[72:75], v[56:59]
    ds_read_b128 v[228:231], v15 offset:3968
    buffer_load_dwordx4 a[208:211], v17, s[16:19], s41 offen offset:0 sc1
    v_mfma_f32_16x16x32_bf16 v[60:63], v[116:119], v[76:79], v[60:63]
    s_waitcnt lgkmcnt(6)
    v_mfma_f32_16x16x32_bf16 v[32:35], v[128:131], v[80:83], v[32:35]
    ds_read_b128 v[64:67], v13 offset:3904
    buffer_load_dwordx4 a[212:215], v17, s[16:19], s41 offen offset:1024 sc1
    s_add_u32 s41, s41, 0x8000
    v_mfma_f32_16x16x32_bf16 v[36:39], v[128:131], v[84:87], v[36:39]
    ds_read_b128 v[68:71], v13 offset:8384
    v_mfma_f32_16x16x32_bf16 v[40:43], v[132:135], v[80:83], v[40:43]
    ds_read_b128 v[72:75], v13 offset:3968
    buffer_load_dwordx4 a[112:115], v16, s[16:19], s42 offen offset:0 sc1
    v_mfma_f32_16x16x32_bf16 v[44:47], v[132:135], v[84:87], v[44:47]
    v_mfma_f32_16x16x32_bf16 v[48:51], v[136:139], v[80:83], v[48:51]
    ds_read_b128 v[76:79], v13 offset:8448
    buffer_load_dwordx4 a[116:119], v16, s[16:19], s42 offen offset:1024 sc1
    v_mfma_f32_16x16x32_bf16 v[52:55], v[136:139], v[84:87], v[52:55]
    ds_read_b128 v[232:235], v15 offset:4032
    v_mfma_f32_16x16x32_bf16 v[56:59], v[140:143], v[80:83], v[56:59]
    ds_read_b128 v[236:239], v14 offset:4096
    buffer_load_dwordx4 a[240:243], v17, s[16:19], s42 offen offset:0 sc1
    v_mfma_f32_16x16x32_bf16 v[60:63], v[140:143], v[84:87], v[60:63]
    s_waitcnt lgkmcnt(8)
    v_mfma_f32_16x16x32_bf16 v[40:43], v[128:131], v[96:99], v[40:43]
    ds_read_b128 v[80:83], v13 offset:4032
    v_cvt_pk_bf16_f32 v240, v32, v33
    buffer_load_dwordx4 a[244:247], v17, s[16:19], s42 offen offset:1024 sc1
    s_add_u32 s42, s42, 0x8000
    v_mfma_f32_16x16x32_bf16 v[44:47], v[128:131], v[100:103], v[44:47]
    v_mfma_f32_16x16x32_bf16 v[48:51], v[132:135], v[96:99], v[48:51]
    ds_read_b128 v[84:87], v13 offset:8512
    v_cvt_pk_bf16_f32 v241, v34, v35
    buffer_load_dwordx4 a[88:91], v16, s[16:19], s43 offen offset:0 sc1
    v_mfma_f32_16x16x32_bf16 v[52:55], v[132:135], v[100:103], v[52:55]
    v_mfma_f32_16x16x32_bf16 v[56:59], v[136:139], v[96:99], v[56:59]
    v_cvt_pk_bf16_f32 v242, v36, v37
    buffer_load_dwordx4 a[92:95], v16, s[16:19], s43 offen offset:1024 sc1
    v_mfma_f32_16x16x32_bf16 v[60:63], v[136:139], v[100:103], v[60:63]
    ds_read_b128 v[88:91], v13 offset:4096
    v_mfma_f32_16x16x32_bf16 v[48:51], v[128:131], v[104:107], v[48:51]
    v_cvt_pk_bf16_f32 v243, v38, v39
    buffer_load_dwordx4 a[216:219], v17, s[16:19], s43 offen offset:0 sc1
    v_mfma_f32_16x16x32_bf16 v[52:55], v[128:131], v[108:111], v[52:55]
    ds_read_b128 v[92:95], v13 offset:8576
    v_mfma_f32_16x16x32_bf16 v[56:59], v[132:135], v[104:107], v[56:59]
    buffer_store_dwordx4 v[240:243], v12, s[12:15], s62 offen offset:0 sc1
    buffer_load_dwordx4 a[220:223], v17, s[16:19], s43 offen offset:1024 sc1
    s_add_u32 s43, s43, 0x8000
    v_mfma_f32_16x16x32_bf16 v[60:63], v[132:135], v[108:111], v[60:63]
    s_waitcnt lgkmcnt(6)
    v_mfma_f32_16x16x32_bf16 v[56:59], v[224:227], v[64:67], v[56:59]
    buffer_load_dwordx4 a[120:123], v16, s[16:19], s71 offen offset:0 sc1
    v_mfma_f32_16x16x32_bf16 v[60:63], v[224:227], v[68:71], v[60:63]
    v_cvt_pk_bf16_f32 v244, v40, v41
    v_cvt_pk_bf16_f32 v245, v42, v43
    v_mfma_f32_16x16x32_bf16 v[56:59], v[228:231], v[72:75], v[56:59]
    v_cvt_pk_bf16_f32 v246, v44, v45
    buffer_load_dwordx4 a[124:127], v16, s[16:19], s71 offen offset:1024 sc1
    v_mfma_f32_16x16x32_bf16 v[60:63], v[228:231], v[76:79], v[60:63]
    v_cvt_pk_bf16_f32 v247, v46, v47
    buffer_store_dwordx4 v[244:247], v12, s[12:15], s62 offen offset:1024 sc1
    s_waitcnt lgkmcnt(0)
    v_mfma_f32_16x16x32_bf16 v[56:59], v[232:235], v[80:83], v[56:59]
    v_cvt_pk_bf16_f32 v248, v48, v49
    buffer_load_dwordx4 a[248:251], v17, s[16:19], s71 offen offset:0 sc1
    v_mfma_f32_16x16x32_bf16 v[60:63], v[232:235], v[84:87], v[60:63]
    v_cvt_pk_bf16_f32 v249, v50, v51
    v_cvt_pk_bf16_f32 v250, v52, v53
    v_mfma_f32_16x16x32_bf16 v[56:59], v[236:239], v[88:91], v[56:59]
    v_cvt_pk_bf16_f32 v251, v54, v55
    buffer_load_dwordx4 a[252:255], v17, s[16:19], s71 offen offset:1024 sc1
    s_add_u32 s71, s71, 0x8000
    v_mfma_f32_16x16x32_bf16 v[60:63], v[236:239], v[92:95], v[60:63]
    buffer_store_dwordx4 v[248:251], v12, s[12:15], s62 offen offset:2048 sc1
    s_branch CV_CK
CV_S6:
    buffer_load_dword v156, v4, s[32:35], 0 offen sc1
    s_waitcnt lgkmcnt(6)
    v_mfma_f32_16x16x32_bf16 v[32:35], v[176:179], v[64:67], v[32:35]
    ds_read_b128 v[96:99], v13 offset:960
    v_mfma_f32_16x16x32_bf16 v[36:39], v[176:179], v[68:71], v[36:39]
    v_mfma_f32_16x16x32_bf16 v[40:43], v[180:183], v[64:67], v[40:43]
    ds_read_b128 v[100:103], v13 offset:5440
    v_mfma_f32_16x16x32_bf16 v[44:47], v[180:183], v[68:71], v[44:47]
    v_mfma_f32_16x16x32_bf16 v[48:51], v[184:187], v[64:67], v[48:51]
    ds_read_b128 v[112:115], v15 offset:4032
    v_mfma_f32_16x16x32_bf16 v[52:55], v[184:187], v[68:71], v[52:55]
    v_mfma_f32_16x16x32_bf16 v[56:59], v[188:191], v[64:67], v[56:59]
    ds_read_b128 v[116:119], v15 offset:3008
    v_mfma_f32_16x16x32_bf16 v[60:63], v[188:191], v[68:71], v[60:63]
    s_waitcnt lgkmcnt(6)
    v_mfma_f32_16x16x32_bf16 v[40:43], v[176:179], v[80:83], v[40:43]
    ds_read_b128 v[64:67], v13 offset:1984
    v_mfma_f32_16x16x32_bf16 v[44:47], v[176:179], v[84:87], v[44:47]
    ds_read_b128 v[68:71], v13 offset:6464
    v_mfma_f32_16x16x32_bf16 v[48:51], v[180:183], v[80:83], v[48:51]
    v_mfma_f32_16x16x32_bf16 v[52:55], v[180:183], v[84:87], v[52:55]
    ds_read_b128 v[72:75], v13 offset:3008
    v_mfma_f32_16x16x32_bf16 v[56:59], v[184:187], v[80:83], v[56:59]
    v_mfma_f32_16x16x32_bf16 v[60:63], v[184:187], v[84:87], v[60:63]
    ds_read_b128 v[76:79], v13 offset:7488
    v_mfma_f32_16x16x32_bf16 v[48:51], v[176:179], v[88:91], v[48:51]
    ds_read_b128 v[136:139], v14 offset:2048
    v_mfma_f32_16x16x32_bf16 v[52:55], v[176:179], v[92:95], v[52:55]
    v_mfma_f32_16x16x32_bf16 v[56:59], v[180:183], v[88:91], v[56:59]
    ds_read_b128 v[140:143], v14 offset:1024
    v_mfma_f32_16x16x32_bf16 v[60:63], v[180:183], v[92:95], v[60:63]
    s_waitcnt vmcnt(2)
    v_cmp_ne_u32 vcc, 0, v157
    s_nop 0
    s_or_b32 s47, s47, vcc_lo
    s_and_b32 s63, s47, 3
    s_cmp_eq_u32 s63, 3
    s_cbranch_scc0 CV_S7
CV_F7:
    s_mov_b32 s46, 2
    s_waitcnt lgkmcnt(6)
    v_mfma_f32_16x16x32_bf16 v[32:35], v[112:115], v[96:99], v[32:35]
    ds_read_b128 v[80:83], v13 offset:1024
    buffer_load_dwordx4 a[64:67], v16, s[16:19], s41 offen offset:0 sc1
    v_mfma_f32_16x16x32_bf16 v[36:39], v[112:115], v[100:103], v[36:39]
    buffer_load_dwordx4 a[68:71], v16, s[16:19], s41 offen offset:1024 sc1
    v_mfma_f32_16x16x32_bf16 v[40:43], v[116:119], v[96:99], v[40:43]
    ds_read_b128 v[84:87], v13 offset:5504
    buffer_load_dwordx4 a[192:195], v17, s[16:19], s41 offen offset:0 sc1
    v_mfma_f32_16x16x32_bf16 v[44:47], v[116:119], v[100:103], v[44:47]
    v_mfma_f32_16x16x32_bf16 v[48:51], v[120:123], v[96:99], v[48:51]
    ds_read_b128 v[128:131], v14 offset:4096
    buffer_load_dwordx4 a[196:199], v17, s[16:19], s41 offen offset:1024 sc1
    s_add_u32 s41, s41, 0x8000
    v_mfma_f32_16x16x32_bf16 v[52:55], v[120:123], v[100:103], v[52:55]
    buffer_load_dwordx4 a[96:99], v16, s[16:19], s42 offen offset:0 sc1
    v_mfma_f32_16x16x32_bf16 v[56:59], v[124:127], v[96:99], v[56:59]
    ds_read_b128 v[132:135], v14 offset:3072
    buffer_load_dwordx4 a[100:103], v16, s[16:19], s42 offen offset:1024 sc1
    v_mfma_f32_16x16x32_bf16 v[60:63], v[124:127], v[100:103], v[60:63]
    s_waitcnt lgkmcnt(6)
    v_mfma_f32_16x16x32_bf16 v[40:43], v[112:115], v[64:67], v[40:43]
    ds_read_b128 v[96:99], v13 offset:2048
    buffer_load_dwordx4 a[224:227], v17, s[16:19], s42 offen offset:0 sc1
    v_mfma_f32_16x16x32_bf16 v[44:47], v[112:115], v[68:71], v[44:47]
    ds_read_b128 v[100:103], v13 offset:6528
    buffer_load_dwordx4 a[228:231], v17, s[16:19], s42 offen offset:1024 sc1
    s_add_u32 s42, s42, 0x8000
    v_mfma_f32_16x16x32_bf16 v[48:51], v[116:119], v[64:67], v[48:51]
    v_mfma_f32_16x16x32_bf16 v[52:55], v[116:119], v[68:71], v[52:55]
    ds_read_b128 v[104:107], v13 offset:3072
    buffer_load_dwordx4 a[72:75], v16, s[16:19], s43 offen offset:0 sc1
    v_mfma_f32_16x16x32_bf16 v[56:59], v[120:123], v[64:67], v[56:59]
    buffer_load_dwordx4 a[76:79], v16, s[16:19], s43 offen offset:1024 sc1
    v_mfma_f32_16x16x32_bf16 v[60:63], v[120:123], v[68:71], v[60:63]
    ds_read_b128 v[108:111], v13 offset:7552
    buffer_load_dwordx4 a[200:203], v17, s[16:19], s43 offen offset:0 sc1
    v_mfma_f32_16x16x32_bf16 v[48:51], v[112:115], v[72:75], v[48:51]
    ds_read_b128 v[224:227], v15 offset:3904
    v_mfma_f32_16x16x32_bf16 v[52:55], v[112:115], v[76:79], v[52:55]
    buffer_load_dwordx4 a[204:207], v17, s[16:19], s43 offen offset:1024 sc1
    s_add_u32 s43, s43, 0x8000
    v_mfma_f32_16x16x32_bf16 v[56:59], v[116:119], v[72:75], v[56:59]
    ds_read_b128 v[228:231], v15 offset:3968
    buffer_load_dwordx4 a[104:107], v16, s[16:19], s71 offen offset:0 sc1
    v_mfma_f32_16x16x32_bf16 v[60:63], v[116:119], v[76:79], v[60:63]
    buffer_load_dwordx4 a[108:111], v16, s[16:19], s71 offen offset:1024 sc1
    s_waitcnt lgkmcnt(6)
    v_mfma_f32_16x16x32_bf16 v[32:35], v[128:131], v[80:83], v[32:35]
    ds_read_b128 v[64:67], v13 offset:3904
    v_mfma_f32_16x16x32_bf16 v[36:39], v[128:131], v[84:87], v[36:39]
    ds_read_b128 v[68:71], v13 offset:8384
    buffer_load_dwordx4 a[232:235], v17, s[16:19], s71 offen offset:0 sc1
    v_mfma_f32_16x16x32_bf16 v[40:43], v[132:135], v[80:83], v[40:43]
    ds_read_b128 v[72:75], v13 offset:3968
    buffer_load_dwordx4 a[236:239], v17, s[16:19], s71 offen offset:1024 sc1
    s_add_u32 s71, s71, 0x8000
    v_mfma_f32_16x16x32_bf16 v[44:47], v[132:135], v[84:87], v[44:47]
    v_mfma_f32_16x16x32_bf16 v[48:51], v[136:139], v[80:83], v[48:51]
    ds_read_b128 v[76:79], v13 offset:8448
    buffer_load_dwordx4 a[80:83], v16, s[16:19], s41 offen offset:0 sc1
    v_mfma_f32_16x16x32_bf16 v[52:55], v[136:139], v[84:87], v[52:55]
    ds_read_b128 v[232:235], v15 offset:4032
    buffer_load_dwordx4 a[84:87], v16, s[16:19], s41 offen offset:1024 sc1
    v_mfma_f32_16x16x32_bf16 v[56:59], v[140:143], v[80:83], v[56:59]
    ds_read_b128 v[236:239], v14 offset:4096
    buffer_load_dwordx4 a[208:211], v17, s[16:19], s41 offen offset:0 sc1
    v_mfma_f32_16x16x32_bf16 v[60:63], v[140:143], v[84:87], v[60:63]
    s_waitcnt lgkmcnt(8)
    v_mfma_f32_16x16x32_bf16 v[40:43], v[128:131], v[96:99], v[40:43]
    ds_read_b128 v[80:83], v13 offset:4032
    v_cvt_pk_bf16_f32 v240, v32, v33
    buffer_load_dwordx4 a[212:215], v17, s[16:19], s41 offen offset:1024 sc1
    s_add_u32 s41, s41, 0x8000
    v_mfma_f32_16x16x32_bf16 v[44:47], v[128:131], v[100:103], v[44:47]
    buffer_load_dwordx4 a[112:115], v16, s[16:19], s42 offen offset:0 sc1
    v_mfma_f32_16x16x32_bf16 v[48:51], v[132:135], v[96:99], v[48:51]
    ds_read_b128 v[84:87], v13 offset:8512
    v_cvt_pk_bf16_f32 v241, v34, v35
    buffer_load_dwordx4 a[116:119], v16, s[16:19], s42 offen offset:1024 sc1
    v_mfma_f32_16x16x32_bf16 v[52:55], v[132:135], v[100:103], v[52:55]
    v_mfma_f32_16x16x32_bf16 v[56:59], v[136:139], v[96:99], v[56:59]
    v_cvt_pk_bf16_f32 v242, v36, v37
    buffer_load_dwordx4 a[240:243], v17, s[16:19], s42 offen offset:0 sc1
    v_mfma_f32_16x16x32_bf16 v[60:63], v[136:139], v[100:103], v[60:63]
    ds_read_b128 v[88:91], v13 offset:4096
    buffer_load_dwordx4 a[244:247], v17, s[16:19], s42 offen offset:1024 sc1
    s_add_u32 s42, s42, 0x8000
    v_mfma_f32_16x16x32_bf16 v[48:51], v[128:131], v[104:107], v[48:51]
    v_cvt_pk_bf16_f32 v243, v38, v39
    v_mfma_f32_16x16x32_bf16 v[52:55], v[128:131], v[108:111], v[52:55]
    ds_read_b128 v[92:95], v13 offset:8576
    buffer_load_dwordx4 a[88:91], v16, s[16:19], s43 offen offset:0 sc1
    v_mfma_f32_16x16x32_bf16 v[56:59], v[132:135], v[104:107], v[56:59]
    buffer_store_dwordx4 v[240:243], v12, s[12:15], s62 offen offset:0 sc1
    buffer_load_dwordx4 a[92:95], v16, s[16:19], s43 offen offset:1024 sc1
    v_mfma_f32_16x16x32_bf16 v[60:63], v[132:135], v[108:111], v[60:63]
    buffer_load_dwordx4 a[216:219], v17, s[16:19], s43 offen offset:0 sc1
    s_waitcnt lgkmcnt(6)
    v_mfma_f32_16x16x32_bf16 v[56:59], v[224:227], v[64:67], v[56:59]
    v_mfma_f32_16x16x32_bf16 v[60:63], v[224:227], v[68:71], v[60:63]
    v_cvt_pk_bf16_f32 v244, v40, v41
    v_cvt_pk_bf16_f32 v245, v42, v43
    buffer_load_dwordx4 a[220:223], v17, s[16:19], s43 offen offset:1024 sc1
    s_add_u32 s43, s43, 0x8000
    v_mfma_f32_16x16x32_bf16 v[56:59], v[228:231], v[72:75], v[56:59]
    v_cvt_pk_bf16_f32 v246, v44, v45
    buffer_load_dwordx4 a[120:123], v16, s[16:19], s71 offen offset:0 sc1
    v_mfma_f32_16x16x32_bf16 v[60:63], v[228:231], v[76:79], v[60:63]
    v_cvt_pk_bf16_f32 v247, v46, v47
    buffer_store_dwordx4 v[244:247], v12, s[12:15], s62 offen offset:1024 sc1
    buffer_load_dwordx4 a[124:127], v16, s[16:19], s71 offen offset:1024 sc1
    s_waitcnt lgkmcnt(0)
    v_mfma_f32_16x16x32_bf16 v[56:59], v[232:235], v[80:83], v[56:59]
    v_cvt_pk_bf16_f32 v248, v48, v49
    v_mfma_f32_16x16x32_bf16 v[60:63], v[232:235], v[84:87], v[60:63]
    v_cvt_pk_bf16_f32 v249, v50, v51
    v_cvt_pk_bf16_f32 v250, v52, v53
    buffer_load_dwordx4 a[248:251], v17, s[16:19], s71 offen offset:0 sc1
    v_mfma_f32_16x16x32_bf16 v[56:59], v[236:239], v[88:91], v[56:59]
    v_cvt_pk_bf16_f32 v251, v54, v55
    buffer_load_dwordx4 a[252:255], v17, s[16:19], s71 offen offset:1024 sc1
    s_add_u32 s71, s71, 0x8000
    v_mfma_f32_16x16x32_bf16 v[60:63], v[236:239], v[92:95], v[60:63]
    buffer_store_dwordx4 v[248:251], v12, s[12:15], s62 offen offset:2048 sc1
    s_branch CV_CK
CV_S7:
    s_waitcnt lgkmcnt(6)
    v_mfma_f32_16x16x32_bf16 v[32:35], v[112:115], v[96:99], v[32:35]
    ds_read_b128 v[80:83], v13 offset:1024
    v_mfma_f32_16x16x32_bf16 v[36:39], v[112:115], v[100:103], v[36:39]
    v_mfma_f32_16x16x32_bf16 v[40:43], v[116:119], v[96:99], v[40:43]
    ds_read_b128 v[84:87], v13 offset:5504
    v_mfma_f32_16x16x32_bf16 v[44:47], v[116:119], v[100:103], v[44:47]
    v_mfma_f32_16x16x32_bf16 v[48:51], v[120:123], v[96:99], v[48:51]
    ds_read_b128 v[128:131], v14 offset:4096
    v_mfma_f32_16x16x32_bf16 v[52:55], v[120:123], v[100:103], v[52:55]
    v_mfma_f32_16x16x32_bf16 v[56:59], v[124:127], v[96:99], v[56:59]
    ds_read_b128 v[132:135], v14 offset:3072
    v_mfma_f32_16x16x32_bf16 v[60:63], v[124:127], v[100:103], v[60:63]
    s_waitcnt lgkmcnt(6)
    v_mfma_f32_16x16x32_bf16 v[40:43], v[112:115], v[64:67], v[40:43]
    ds_read_b128 v[96:99], v13 offset:2048
    v_mfma_f32_16x16x32_bf16 v[44:47], v[112:115], v[68:71], v[44:47]
    ds_read_b128 v[100:103], v13 offset:6528
    v_mfma_f32_16x16x32_bf16 v[48:51], v[116:119], v[64:67], v[48:51]
    v_mfma_f32_16x16x32_bf16 v[52:55], v[116:119], v[68:71], v[52:55]
    ds_read_b128 v[104:107], v13 offset:3072
    v_mfma_f32_16x16x32_bf16 v[56:59], v[120:123], v[64:67], v[56:59]
    v_mfma_f32_16x16x32_bf16 v[60:63], v[120:123], v[68:71], v[60:63]
    ds_read_b128 v[108:111], v13 offset:7552
    v_mfma_f32_16x16x32_bf16 v[48:51], v[112:115], v[72:75], v[48:51]
    ds_read_b128 v[224:227], v15 offset:3904
    v_mfma_f32_16x16x32_bf16 v[52:55], v[112:115], v[76:79], v[52:55]
    v_mfma_f32_16x16x32_bf16 v[56:59], v[116:119], v[72:75], v[56:59]
    ds_read_b128 v[228:231], v15 offset:3968
    v_mfma_f32_16x16x32_bf16 v[60:63], v[116:119], v[76:79], v[60:63]
    s_waitcnt vmcnt(1)
    v_cmp_ne_u32 vcc, 0, v158
    s_nop 0
    s_or_b32 s47, s47, vcc_lo
    s_and_b32 s63, s47, 3
    s_cmp_eq_u32 s63, 3
    s_cbranch_scc0 CV_S8
CV_F8:
    s_mov_b32 s46, 2
    s_waitcnt lgkmcnt(6)
    v_mfma_f32_16x16x32_bf16 v[32:35], v[128:131], v[80:83], v[32:35]
    ds_read_b128 v[64:67], v13 offset:3904
    buffer_load_dwordx4 a[64:67], v16, s[16:19], s41 offen offset:0 sc1
    buffer_load_dwordx4 a[68:71], v16, s[16:19], s41 offen offset:1024 sc1
    v_mfma_f32_16x16x32_bf16 v[36:39], v[128:131], v[84:87], v[36:39]
    ds_read_b128 v[68:71], v13 offset:8384
    buffer_load_dwordx4 a[192:195], v17, s[16:19], s41 offen offset:0 sc1
    v_mfma_f32_16x16x32_bf16 v[40:43], v[132:135], v[80:83], v[40:43]
    ds_read_b128 v[72:75], v13 offset:3968
    buffer_load_dwordx4 a[196:199], v17, s[16:19], s41 offen offset:1024 sc1
    s_add_u32 s41, s41, 0x8000
    v_mfma_f32_16x16x32_bf16 v[44:47], v[132:135], v[84:87], v[44:47]
    buffer_load_dwordx4 a[96:99], v16, s[16:19], s42 offen offset:0 sc1
    v_mfma_f32_16x16x32_bf16 v[48:51], v[136:139], v[80:83], v[48:51]
    ds_read_b128 v[76:79], v13 offset:8448
    buffer_load_dwordx4 a[100:103], v16, s[16:19], s42 offen offset:1024 sc1
    buffer_load_dwordx4 a[224:227], v17, s[16:19], s42 offen offset:0 sc1
    v_mfma_f32_16x16x32_bf16 v[52:55], v[136:139], v[84:87], v[52:55]
    ds_read_b128 v[232:235], v15 offset:4032
    buffer_load_dwordx4 a[228:231], v17, s[16:19], s42 offen offset:1024 sc1
    s_add_u32 s42, s42, 0x8000
    v_mfma_f32_16x16x32_bf16 v[56:59], v[140:143], v[80:83], v[56:59]
    ds_read_b128 v[236:239], v14 offset:4096
    buffer_load_dwordx4 a[72:75], v16, s[16:19], s43 offen offset:0 sc1
    v_mfma_f32_16x16x32_bf16 v[60:63], v[140:143], v[84:87], v[60:63]
    buffer_load_dwordx4 a[76:79], v16, s[16:19], s43 offen offset:1024 sc1
    s_waitcnt lgkmcnt(8)
    v_mfma_f32_16x16x32_bf16 v[40:43], v[128:131], v[96:99], v[40:43]
    ds_read_b128 v[80:83], v13 offset:4032
    v_cvt_pk_bf16_f32 v240, v32, v33
    buffer_load_dwordx4 a[200:203], v17, s[16:19], s43 offen offset:0 sc1
    buffer_load_dwordx4 a[204:207], v17, s[16:19], s43 offen offset:1024 sc1
    s_add_u32 s43, s43, 0x8000
    v_mfma_f32_16x16x32_bf16 v[44:47], v[128:131], v[100:103], v[44:47]
    buffer_load_dwordx4 a[104:107], v16, s[16:19], s71 offen offset:0 sc1
    v_mfma_f32_16x16x32_bf16 v[48:51], v[132:135], v[96:99], v[48:51]
    ds_read_b128 v[84:87], v13 offset:8512
    v_cvt_pk_bf16_f32 v241, v34, v35
    buffer_load_dwordx4 a[108:111], v16, s[16:19], s71 offen offset:1024 sc1
    v_mfma_f32_16x16x32_bf16 v[52:55], v[132:135], v[100:103], v[52:55]
    buffer_load_dwordx4 a[232:235], v17, s[16:19], s71 offen offset:0 sc1
    v_mfma_f32_16x16x32_bf16 v[56:59], v[136:139], v[96:99], v[56:59]
    v_cvt_pk_bf16_f32 v242, v36, v37
    buffer_load_dwordx4 a[236:239], v17, s[16:19], s71 offen offset:1024 sc1
    s_add_u32 s71, s71, 0x8000
    v_mfma_f32_16x16x32_bf16 v[60:63], v[136:139], v[100:103], v[60:63]
    ds_read_b128 v[88:91], v13 offset:4096
    buffer_load_dwordx4 a[80:83], v16, s[16:19], s41 offen offset:0 sc1
    buffer_load_dwordx4 a[84:87], v16, s[16:19], s41 offen offset:1024 sc1
    v_mfma_f32_16x16x32_bf16 v[48:51], v[128:131], v[104:107], v[48:51]
    v_cvt_pk_bf16_f32 v243, v38, v39
    buffer_load_dwordx4 a[208:211], v17, s[16:19], s41 offen offset:0 sc1
    v_mfma_f32_16x16x32_bf16 v[52:55], v[128:131], v[108:111], v[52:55]
    ds_read_b128 v[92:95], v13 offset:8576
    buffer_load_dwordx4 a[212:215], v17, s[16:19], s41 offen offset:1024 sc1
    s_add_u32 s41, s41, 0x8000
    v_mfma_f32_16x16x32_bf16 v[56:59], v[132:135], v[104:107], v[56:59]
    buffer_store_dwordx4 v[240:243], v12, s[12:15], s62 offen offset:0 sc1
    buffer_load_dwordx4 a[112:115], v16, s[16:19], s42 offen offset:0 sc1
    v_mfma_f32_16x16x32_bf16 v[60:63], v[132:135], v[108:111], v[60:63]
    buffer_load_dwordx4 a[116:119], v16, s[16:19], s42 offen offset:1024 sc1
    buffer_load_dwordx4 a[240:243], v17, s[16:19], s42 offen offset:0 sc1
    s_waitcnt lgkmcnt(6)
    v_mfma_f32_16x16x32_bf16 v[56:59], v[224:227], v[64:67], v[56:59]
    buffer_load_dwordx4 a[244:247], v17, s[16:19], s42 offen offset:1024 sc1
    s_add_u32 s42, s42, 0x8000
    v_mfma_f32_16x16x32_bf16 v[60:63], v[224:227], v[68:71], v[60:63]
    v_cvt_pk_bf16_f32 v244, v40, v41
    v_cvt_pk_bf16_f32 v245, v42, v43
    buffer_load_dwordx4 a[88:91], v16, s[16:19], s43 offen offset:0 sc1
    v_mfma_f32_16x16x32_bf16 v[56:59], v[228:231], v[72:75], v[56:59]
    v_cvt_pk_bf16_f32 v246, v44, v45
    buffer_load_dwordx4 a[92:95], v16, s[16:19], s43 offen offset:1024 sc1
    v_mfma_f32_16x16x32_bf16 v[60:63], v[228:231], v[76:79], v[60:63]
    v_cvt_pk_bf16_f32 v247, v46, v47
    buffer_store_dwordx4 v[244:247], v12, s[12:15], s62 offen offset:1024 sc1
    buffer_load_dwordx4 a[216:219], v17, s[16:19], s43 offen offset:0 sc1
    buffer_load_dwordx4 a[220:223], v17, s[16:19], s43 offen offset:1024 sc1
    s_add_u32 s43, s43, 0x8000
    s_waitcnt lgkmcnt(0)
    v_mfma_f32_16x16x32_bf16 v[56:59], v[232:235], v[80:83], v[56:59]
    v_cvt_pk_bf16_f32 v248, v48, v49
    buffer_load_dwordx4 a[120:123], v16, s[16:19], s71 offen offset:0 sc1
    v_mfma_f32_16x16x32_bf16 v[60:63], v[232:235], v[84:87], v[60:63]
    v_cvt_pk_bf16_f32 v249, v50, v51
    v_cvt_pk_bf16_f32 v250, v52, v53
    buffer_load_dwordx4 a[124:127], v16, s[16:19], s71 offen offset:1024 sc1
    v_mfma_f32_16x16x32_bf16 v[56:59], v[236:239], v[88:91], v[56:59]
    v_cvt_pk_bf16_f32 v251, v54, v55
    buffer_load_dwordx4 a[248:251], v17, s[16:19], s71 offen offset:0 sc1
    v_mfma_f32_16x16x32_bf16 v[60:63], v[236:239], v[92:95], v[60:63]
    buffer_store_dwordx4 v[248:251], v12, s[12:15], s62 offen offset:2048 sc1
    buffer_load_dwordx4 a[252:255], v17, s[16:19], s71 offen offset:1024 sc1
    s_add_u32 s71, s71, 0x8000
    s_branch CV_CK
CV_S8:
    s_waitcnt lgkmcnt(6)
    v_mfma_f32_16x16x32_bf16 v[32:35], v[128:131], v[80:83], v[32:35]
    ds_read_b128 v[64:67], v13 offset:3904
    v_mfma_f32_16x16x32_bf16 v[36:39], v[128:131], v[84:87], v[36:39]
    ds_read_b128 v[68:71], v13 offset:8384
    v_mfma_f32_16x16x32_bf16 v[40:43], v[132:135], v[80:83], v[40:43]
    ds_read_b128 v[72:75], v13 offset:3968
    v_mfma_f32_16x16x32_bf16 v[44:47], v[132:135], v[84:87], v[44:47]
    v_mfma_f32_16x16x32_bf16 v[48:51], v[136:139], v[80:83], v[48:51]
    ds_read_b128 v[76:79], v13 offset:8448
    v_mfma_f32_16x16x32_bf16 v[52:55], v[136:139], v[84:87], v[52:55]
    ds_read_b128 v[232:235], v15 offset:4032
    v_mfma_f32_16x16x32_bf16 v[56:59], v[140:143], v[80:83], v[56:59]
    ds_read_b128 v[236:239], v14 offset:4096
    v_mfma_f32_16x16x32_bf16 v[60:63], v[140:143], v[84:87], v[60:63]
    s_waitcnt lgkmcnt(8)
    v_mfma_f32_16x16x32_bf16 v[40:43], v[128:131], v[96:99], v[40:43]
    ds_read_b128 v[80:83], v13 offset:4032
    v_cvt_pk_bf16_f32 v240, v32, v33
    v_mfma_f32_16x16x32_bf16 v[44:47], v[128:131], v[100:103], v[44:47]
    v_mfma_f32_16x16x32_bf16 v[48:51], v[132:135], v[96:99], v[48:51]
    ds_read_b128 v[84:87], v13 offset:8512
    v_cvt_pk_bf16_f32 v241, v34, v35
    v_mfma_f32_16x16x32_bf16 v[52:55], v[132:135], v[100:103], v[52:55]
    v_mfma_f32_16x16x32_bf16 v[56:59], v[136:139], v[96:99], v[56:59]
    v_cvt_pk_bf16_f32 v242, v36, v37
    v_mfma_f32_16x16x32_bf16 v[60:63], v[136:139], v[100:103], v[60:63]
    ds_read_b128 v[88:91], v13 offset:4096
    v_mfma_f32_16x16x32_bf16 v[48:51], v[128:131], v[104:107], v[48:51]
    v_cvt_pk_bf16_f32 v243, v38, v39
    v_mfma_f32_16x16x32_bf16 v[52:55], v[128:131], v[108:111], v[52:55]
    ds_read_b128 v[92:95], v13 offset:8576
    v_mfma_f32_16x16x32_bf16 v[56:59], v[132:135], v[104:107], v[56:59]
    buffer_store_dwordx4 v[240:243], v12, s[12:15], s62 offen offset:0 sc1
    v_mfma_f32_16x16x32_bf16 v[60:63], v[132:135], v[108:111], v[60:63]
    s_waitcnt vmcnt(1)
    v_cmp_ne_u32 vcc, 0, v156
    s_nop 0
    s_or_b32 s47, s47, vcc_lo
    s_and_b32 s63, s47, 3
    s_cmp_eq_u32 s63, 3
    s_cbranch_scc0 CV_S9
CV_F9:
    s_mov_b32 s46, 2
    s_waitcnt lgkmcnt(6)
    v_mfma_f32_16x16x32_bf16 v[56:59], v[224:227], v[64:67], v[56:59]
    buffer_load_dwordx4 a[64:67], v16, s[16:19], s41 offen offset:0 sc1
    buffer_load_dwordx4 a[68:71], v16, s[16:19], s41 offen offset:1024 sc1
    buffer_load_dwordx4 a[192:195], v17, s[16:19], s41 offen offset:0 sc1
    buffer_load_dwordx4 a[196:199], v17, s[16:19], s41 offen offset:1024 sc1
    s_add_u32 s41, s41, 0x8000
    v_mfma_f32_16x16x32_bf16 v[60:63], v[224:227], v[68:71], v[60:63]
    v_cvt_pk_bf16_f32 v244, v40, v41
    v_cvt_pk_bf16_f32 v245, v42, v43
    buffer_load_dwordx4 a[96:99], v16, s[16:19], s42 offen offset:0 sc1
    buffer_load_dwordx4 a[100:103], v16, s[16:19], s42 offen offset:1024 sc1
    buffer_load_dwordx4 a[224:227], v17, s[16:19], s42 offen offset:0 sc1
    buffer_load_dwordx4 a[228:231], v17, s[16:19], s42 offen offset:1024 sc1
    s_add_u32 s42, s42, 0x8000
    v_mfma_f32_16x16x32_bf16 v[56:59], v[228:231], v[72:75], v[56:59]
    v_cvt_pk_bf16_f32 v246, v44, v45
    buffer_load_dwordx4 a[72:75], v16, s[16:19], s43 offen offset:0 sc1
    buffer_load_dwordx4 a[76:79], v16, s[16:19], s43 offen offset:1024 sc1
    buffer_load_dwordx4 a[200:203], v17, s[16:19], s43 offen offset:0 sc1
    buffer_load_dwordx4 a[204:207], v17, s[16:19], s43 offen offset:1024 sc1
    s_add_u32 s43, s43, 0x8000
    v_mfma_f32_16x16x32_bf16 v[60:63], v[228:231], v[76:79], v[60:63]
    v_cvt_pk_bf16_f32 v247, v46, v47
    buffer_store_dwordx4 v[244:247], v12, s[12:15], s62 offen offset:1024 sc1
    buffer_load_dwordx4 a[104:107], v16, s[16:19], s71 offen offset:0 sc1
    buffer_load_dwordx4 a[108:111], v16, s[16:19], s71 offen offset:1024 sc1
    buffer_load_dwordx4 a[232:235], v17, s[16:19], s71 offen offset:0 sc1
    buffer_load_dwordx4 a[236:239], v17, s[16:19], s71 offen offset:1024 sc1
    s_add_u32 s71, s71, 0x8000
    s_waitcnt lgkmcnt(0)
    v_mfma_f32_16x16x32_bf16 v[56:59], v[232:235], v[80:83], v[56:59]
    v_cvt_pk_bf16_f32 v248, v48, v49
    buffer_load_dwordx4 a[80:83], v16, s[16:19], s41 offen offset:0 sc1
    buffer_load_dwordx4 a[84:87], v16, s[16:19], s41 offen offset:1024 sc1
    buffer_load_dwordx4 a[208:211], v17, s[16:19], s41 offen offset:0 sc1
    buffer_load_dwordx4 a[212:215], v17, s[16:19], s41 offen offset:1024 sc1
    s_add_u32 s41, s41, 0x8000
    v_mfma_f32_16x16x32_bf16 v[60:63], v[232:235], v[84:87], v[60:63]
    v_cvt_pk_bf16_f32 v249, v50, v51
    v_cvt_pk_bf16_f32 v250, v52, v53
    buffer_load_dwordx4 a[112:115], v16, s[16:19], s42 offen offset:0 sc1
    buffer_load_dwordx4 a[116:119], v16, s[16:19], s42 offen offset:1024 sc1
    buffer_load_dwordx4 a[240:243], v17, s[16:19], s42 offen offset:0 sc1
    buffer_load_dwordx4 a[244:247], v17, s[16:19], s42 offen offset:1024 sc1
    s_add_u32 s42, s42, 0x8000
    v_mfma_f32_16x16x32_bf16 v[56:59], v[236:239], v[88:91], v[56:59]
    v_cvt_pk_bf16_f32 v251, v54, v55
    buffer_load_dwordx4 a[88:91], v16, s[16:19], s43 offen offset:0 sc1
    buffer_load_dwordx4 a[92:95], v16, s[16:19], s43 offen offset:1024 sc1
    buffer_load_dwordx4 a[216:219], v17, s[16:19], s43 offen offset:0 sc1
    buffer_load_dwordx4 a[220:223], v17, s[16:19], s43 offen offset:1024 sc1
    s_add_u32 s43, s43, 0x8000
    v_mfma_f32_16x16x32_bf16 v[60:63], v[236:239], v[92:95], v[60:63]
    buffer_store_dwordx4 v[248:251], v12, s[12:15], s62 offen offset:2048 sc1
    buffer_load_dwordx4 a[120:123], v16, s[16:19], s71 offen offset:0 sc1
    buffer_load_dwordx4 a[124:127], v16, s[16:19], s71 offen offset:1024 sc1
    buffer_load_dwordx4 a[248:251], v17, s[16:19], s71 offen offset:0 sc1
    buffer_load_dwordx4 a[252:255], v17, s[16:19], s71 offen offset:1024 sc1
    s_add_u32 s71, s71, 0x8000
    s_branch CV_CK
CV_S9:
    s_waitcnt lgkmcnt(6)
    v_mfma_f32_16x16x32_bf16 v[56:59], v[224:227], v[64:67], v[56:59]
    v_mfma_f32_16x16x32_bf16 v[60:63], v[224:227], v[68:71], v[60:63]
    v_cvt_pk_bf16_f32 v244, v40, v41
    v_cvt_pk_bf16_f32 v245, v42, v43
    v_mfma_f32_16x16x32_bf16 v[56:59], v[228:231], v[72:75], v[56:59]
    v_cvt_pk_bf16_f32 v246, v44, v45
    v_mfma_f32_16x16x32_bf16 v[60:63], v[228:231], v[76:79], v[60:63]
    v_cvt_pk_bf16_f32 v247, v46, v47
    buffer_store_dwordx4 v[244:247], v12, s[12:15], s62 offen offset:1024 sc1
    s_waitcnt lgkmcnt(0)
    v_mfma_f32_16x16x32_bf16 v[56:59], v[232:235], v[80:83], v[56:59]
    v_cvt_pk_bf16_f32 v248, v48, v49
    v_mfma_f32_16x16x32_bf16 v[60:63], v[232:235], v[84:87], v[60:63]
    v_cvt_pk_bf16_f32 v249, v50, v51
    v_cvt_pk_bf16_f32 v250, v52, v53
    v_mfma_f32_16x16x32_bf16 v[56:59], v[236:239], v[88:91], v[56:59]
    v_cvt_pk_bf16_f32 v251, v54, v55
    v_mfma_f32_16x16x32_bf16 v[60:63], v[236:239], v[92:95], v[60:63]
    buffer_store_dwordx4 v[248:251], v12, s[12:15], s62 offen offset:2048 sc1
    s_branch CV_CK
CV_NI:
    s_waitcnt vmcnt(1)
    v_cmp_ne_u32 vcc, 0, v3
    s_nop 0
    s_or_b32 s47, s47, vcc_lo
    s_and_b32 s50, s47, 3
    s_cmp_eq_u32 s50, 3
    s_cbranch_scc0 CV_SP
CV_SOK:
    buffer_load_dwordx4 a[64:67], v16, s[16:19], s41 offen offset:0 sc1
    buffer_load_dwordx4 a[68:71], v16, s[16:19], s41 offen offset:1024 sc1
    buffer_load_dwordx4 a[192:195], v17, s[16:19], s41 offen offset:0 sc1
    buffer_load_dwordx4 a[196:199], v17, s[16:19], s41 offen offset:1024 sc1
    s_add_u32 s41, s41, 0x8000
    buffer_load_dwordx4 a[96:99], v16, s[16:19], s42 offen offset:0 sc1
    buffer_load_dwordx4 a[100:103], v16, s[16:19], s42 offen offset:1024 sc1
    buffer_load_dwordx4 a[224:227], v17, s[16:19], s42 offen offset:0 sc1
    buffer_load_dwordx4 a[228:231], v17, s[16:19], s42 offen offset:1024 sc1
    s_add_u32 s42, s42, 0x8000
    buffer_load_dwordx4 a[72:75], v16, s[16:19], s43 offen offset:0 sc1
    buffer_load_dwordx4 a[76:79], v16, s[16:19], s43 offen offset:1024 sc1
    buffer_load_dwordx4 a[200:203], v17, s[16:19], s43 offen offset:0 sc1
    buffer_load_dwordx4 a[204:207], v17, s[16:19], s43 offen offset:1024 sc1
    s_add_u32 s43, s43, 0x8000
    buffer_load_dwordx4 a[104:107], v16, s[16:19], s71 offen offset:0 sc1
    buffer_load_dwordx4 a[108:111], v16, s[16:19], s71 offen offset:1024 sc1
    buffer_load_dwordx4 a[232:235], v17, s[16:19], s71 offen offset:0 sc1
    buffer_load_dwordx4 a[236:239], v17, s[16:19], s71 offen offset:1024 sc1
    s_add_u32 s71, s71, 0x8000
    buffer_load_dwordx4 a[80:83], v16, s[16:19], s41 offen offset:0 sc1
    buffer_load_dwordx4 a[84:87], v16, s[16:19], s41 offen offset:1024 sc1
    buffer_load_dwordx4 a[208:211], v17, s[16:19], s41 offen offset:0 sc1
    buffer_load_dwordx4 a[212:215], v17, s[16:19], s41 offen offset:1024 sc1
    s_add_u32 s41, s41, 0x8000
    buffer_load_dwordx4 a[112:115], v16, s[16:19], s42 offen offset:0 sc1
    buffer_load_dwordx4 a[116:119], v16, s[16:19], s42 offen offset:1024 sc1
    buffer_load_dwordx4 a[240:243], v17, s[16:19], s42 offen offset:0 sc1
    buffer_load_dwordx4 a[244:247], v17, s[16:19], s42 offen offset:1024 sc1
    s_add_u32 s42, s42, 0x8000
    buffer_load_dwordx4 a[88:91], v16, s[16:19], s43 offen offset:0 sc1
    buffer_load_dwordx4 a[92:95], v16, s[16:19], s43 offen offset:1024 sc1
    buffer_load_dwordx4 a[216:219], v17, s[16:19], s43 offen offset:0 sc1
    buffer_load_dwordx4 a[220:223], v17, s[16:19], s43 offen offset:1024 sc1
    s_add_u32 s43, s43, 0x8000
    buffer_load_dwordx4 a[120:123], v16, s[16:19], s71 offen offset:0 sc1
    buffer_load_dwordx4 a[124:127], v16, s[16:19], s71 offen offset:1024 sc1
    buffer_load_dwordx4 a[248:251], v17, s[16:19], s71 offen offset:0 sc1
    buffer_load_dwordx4 a[252:255], v17, s[16:19], s71 offen offset:1024 sc1
    s_add_u32 s71, s71, 0x8000
    s_branch CV_B
CV_SP:
    buffer_load_dword v3, v4, s[32:35], 0 offen sc1
    s_waitcnt vmcnt(0)
    v_cmp_ne_u32 vcc, 0, v3
    s_nop 0
    s_or_b32 s47, s47, vcc_lo
    s_and_b32 s50, s47, 0x3
    s_cmp_eq_u32 s50, 0x3
    s_cbranch_scc1 CV_SOK
    s_sub_u32 s59, s59, 1
    s_cmp_lt_i32 s59, 1
    s_cbranch_scc1 CV_SOK
    s_sleep 2
    s_branch CV_SP
G1_PREP:
    s_load_dwordx2 s[20:21], s[0:1], 8
    s_load_dwordx2 s[22:23], s[0:1], 16
    s_load_dwordx2 s[24:25], s[0:1], 24
    s_load_dwordx2 s[26:27], s[0:1], 104
    s_getpc_b64 s[48:49]
CT_PC2:
    s_add_u32 s48, s48, G1_PREP-CT_PC2
    s_addc_u32 s49, s49, ((G1_PREP-CT_PC2)>>32)
    s_mov_b32 s50, G1_END-G1_PREP
    s_mov_b32 s51, 0x00020000
    v_lshlrev_b32 v252, 7, v0
    buffer_load_dword v253, v252, s[48:51], 0 offen
    s_and_b32 s30, s2, 3
    s_lshl_b32 s30, s30, 8
    s_lshr_b32 s29, s2, 2
    s_lshl_b32 s31, s29, 8
    v_and_b32 v1, 7, v0
    v_lshrrev_b32 v2, 3, v0
    v_lshlrev_b32 v3, 3, v1
    v_add_u32 v3, s30, v3
    v_lshlrev_b32 v4, 3, v2
    v_add_u32 v4, s31, v4
    v_add_u32 v5, -4, v4
    v_lshlrev_b32 v5, 11, v5
    v_lshlrev_b32 v6, 1, v3
    v_add_u32 v5, v5, v6
    v_add_u32 v6, 0x1000, v5
    v_add_u32 v7, 0x2000, v5
    v_lshlrev_b32 v8, 3, v3
    s_movk_i32 s28, 4224
    v_and_b32 v1, 63, v0
    v_lshrrev_b32 v9, 3, v1
    v_lshlrev_b32 v11, 2, v9
    v_lshlrev_b32 v9, 3, v9
    v_add_u32 v9, s30, v9
    v_mul_lo_u32 v9, v9, s28
    v_and_b32 v10, 7, v0
    v_lshlrev_b32 v2, 4, v10
    v_add_u32 v9, v9, v2
    v_lshrrev_b32 v2, 6, v0
    v_lshlrev_b32 v2, 7, v2
    s_lshl_b32 s28, s31, 1
    s_sub_u32 s28, 0x1000, s28
    v_sub_u32 v2, s28, v2
    v_xor_b32 v3, 7, v10
    v_add_u32 v10, v9, v2
    v_lshlrev_b32 v3, 5, v3
    v_add_u32 v3, v3, v11
    s_waitcnt lgkmcnt(0)
    s_mov_b32 s4, s20
    s_mov_b32 s5, s21
    s_mov_b32 s6, 0x400000
    s_mov_b32 s7, 0x00020000
    s_mov_b32 s8, s22
    s_mov_b32 s9, s23
    s_mov_b32 s10, 0x400000
    s_mov_b32 s11, 0x00020000
    s_mov_b32 s12, s24
    s_mov_b32 s13, s25
    s_mov_b32 s14, 0x2000
    s_mov_b32 s15, 0x00020000
    s_add_u32 s16, s26, 0x1000000
    s_addc_u32 s17, s27, 0
    s_mov_b32 s18, 0x420000
    s_mov_b32 s19, 0x00020000
    v_lshrrev_b32 v250, 6, v0
    s_nop 0
    v_readfirstlane_b32 s52, v250
    s_cmp_lg_u32 s52, 0
    s_cbranch_scc1 SP_CLR
    s_add_u32 s48, s26, 0x2300000
    s_addc_u32 s49, s27, 0
    s_mov_b32 s50, 0x30000
    s_mov_b32 s51, 0x00020000
    s_lshl_b32 s53, s2, 11
    v_lshrrev_b32 v250, 3, v0
    v_lshlrev_b32 v250, 8, v250
    v_and_b32 v251, 7, v0
    v_add_lshl_u32 v250, v250, v251, 8
    v_mov_b32 v251, 0
    s_mov_b64 exec, 0xffffff
    buffer_store_dword v251, v250, s[48:51], s53 offen sc1
    s_mov_b64 exec, -1
SP_CLR:
    s_mov_b32 s28, 0xffff0000
    s_movk_i32 s32, 0
    s_movk_i32 s33, 4096
    s_movk_i32 s34, 8192
    s_movk_i32 s35, 12288
    s_mov_b32 s40, 0x0
    s_mov_b32 s41, 0x1080
    s_mov_b32 s42, 0x2100
    s_mov_b32 s43, 0x3180
    s_mov_b32 s44, 0x4200
    s_mov_b32 s45, 0x5280
    s_mov_b32 s46, 0x6300
    s_mov_b32 s47, 0x7380
    buffer_load_dwordx4 v[12:15], v8, s[12:15], 0 offen offset:0
    buffer_load_dwordx4 v[16:19], v8, s[12:15], 0 offen offset:16
    buffer_load_dwordx4 v[20:23], v8, s[12:15], 0 offen offset:32
    buffer_load_dwordx4 v[24:27], v8, s[12:15], 0 offen offset:48
    buffer_load_dwordx4 v[28:31], v5, s[4:7], 0 offen offset:2048
    buffer_load_dwordx4 v[32:35], v6, s[4:7], 0 offen offset:0
    buffer_load_dwordx4 v[36:39], v6, s[4:7], 0 offen offset:2048
    buffer_load_dwordx4 v[40:43], v7, s[4:7], s32 offen offset:0
    buffer_load_dwordx4 v[44:47], v7, s[4:7], s32 offen offset:2048
    buffer_load_dwordx4 v[48:51], v7, s[4:7], s33 offen offset:0
    buffer_load_dwordx4 v[52:55], v7, s[4:7], s33 offen offset:2048
    buffer_load_dwordx4 v[56:59], v7, s[4:7], s34 offen offset:0
    buffer_load_dwordx4 v[60:63], v7, s[4:7], s34 offen offset:2048
    buffer_load_dwordx4 v[64:67], v7, s[4:7], s35 offen offset:0
    buffer_load_dwordx4 v[68:71], v7, s[4:7], s35 offen offset:2048
    buffer_load_dwordx4 v[72:75], v7, s[8:11], s32 offen offset:0
    buffer_load_dwordx4 v[76:79], v7, s[8:11], s32 offen offset:2048
    buffer_load_dwordx4 v[80:83], v7, s[8:11], s33 offen offset:0
    buffer_load_dwordx4 v[84:87], v7, s[8:11], s33 offen offset:2048
    buffer_load_dwordx4 v[88:91], v7, s[8:11], s34 offen offset:0
    buffer_load_dwordx4 v[92:95], v7, s[8:11], s34 offen offset:2048
    buffer_load_dwordx4 v[96:99], v7, s[8:11], s35 offen offset:0
    buffer_load_dwordx4 v[100:103], v7, s[8:11], s35 offen offset:2048
    v_add_u32 v5, 128, v5
    v_add_u32 v6, 128, v6
    v_add_u32 v7, 128, v7
    buffer_load_dwordx4 a[160:163], v8, s[12:15], 0 offen offset:512
    buffer_load_dwordx4 a[164:167], v8, s[12:15], 0 offen offset:528
    buffer_load_dwordx4 a[168:171], v8, s[12:15], 0 offen offset:544
    buffer_load_dwordx4 a[172:175], v8, s[12:15], 0 offen offset:560
    buffer_load_dwordx4 a[176:179], v8, s[12:15], 0 offen offset:1024
    buffer_load_dwordx4 a[180:183], v8, s[12:15], 0 offen offset:1040
    buffer_load_dwordx4 a[184:187], v8, s[12:15], 0 offen offset:1056
    buffer_load_dwordx4 a[188:191], v8, s[12:15], 0 offen offset:1072
    buffer_load_dwordx4 a[192:195], v8, s[12:15], 0 offen offset:1536
    buffer_load_dwordx4 a[196:199], v8, s[12:15], 0 offen offset:1552
    buffer_load_dwordx4 a[200:203], v8, s[12:15], 0 offen offset:1568
    buffer_load_dwordx4 a[204:207], v8, s[12:15], 0 offen offset:1584
    buffer_load_dwordx4 v[104:107], v5, s[4:7], 0 offen offset:2048
    buffer_load_dwordx4 v[108:111], v6, s[4:7], 0 offen offset:0
    buffer_load_dwordx4 v[112:115], v6, s[4:7], 0 offen offset:2048
    buffer_load_dwordx4 v[116:119], v7, s[4:7], s32 offen offset:0
    buffer_load_dwordx4 v[120:123], v7, s[4:7], s32 offen offset:2048
    buffer_load_dwordx4 v[124:127], v7, s[4:7], s33 offen offset:0
    buffer_load_dwordx4 v[128:131], v7, s[4:7], s33 offen offset:2048
    buffer_load_dwordx4 v[132:135], v7, s[4:7], s34 offen offset:0
    buffer_load_dwordx4 v[136:139], v7, s[4:7], s34 offen offset:2048
    buffer_load_dwordx4 v[140:143], v7, s[4:7], s35 offen offset:0
    buffer_load_dwordx4 v[144:147], v7, s[4:7], s35 offen offset:2048
    buffer_load_dwordx4 v[148:151], v7, s[8:11], s32 offen offset:0
    buffer_load_dwordx4 v[152:155], v7, s[8:11], s32 offen offset:2048
    buffer_load_dwordx4 v[156:159], v7, s[8:11], s33 offen offset:0
    buffer_load_dwordx4 v[160:163], v7, s[8:11], s33 offen offset:2048
    buffer_load_dwordx4 v[164:167], v7, s[8:11], s34 offen offset:0
    buffer_load_dwordx4 v[168:171], v7, s[8:11], s34 offen offset:2048
    buffer_load_dwordx4 v[172:175], v7, s[8:11], s35 offen offset:0
    buffer_load_dwordx4 v[176:179], v7, s[8:11], s35 offen offset:2048
    v_add_u32 v5, 128, v5
    v_add_u32 v6, 128, v6
    v_add_u32 v7, 128, v7
    s_cmp_lg_u32 s29, 7
    s_cbranch_scc1 PREP6_NP
    v_mov_b32 v248, 0
    v_mov_b32 v249, 0
    v_mov_b32 v250, 0
    v_mov_b32 v251, 0
    v_lshrrev_b32 v1, 6, v0
    s_mov_b32 s36, 0x42000
    v_mul_lo_u32 v1, v1, s36
    v_add_u32 v9, v9, v1
    buffer_store_dwordx4 v[248:251], v9, s[16:19], s40 offen sc1
    buffer_store_dwordx4 v[248:251], v9, s[16:19], s41 offen sc1
    buffer_store_dwordx4 v[248:251], v9, s[16:19], s42 offen sc1
    buffer_store_dwordx4 v[248:251], v9, s[16:19], s43 offen sc1
    buffer_store_dwordx4 v[248:251], v9, s[16:19], s44 offen sc1
    buffer_store_dwordx4 v[248:251], v9, s[16:19], s45 offen sc1
    buffer_store_dwordx4 v[248:251], v9, s[16:19], s46 offen sc1
    buffer_store_dwordx4 v[248:251], v9, s[16:19], s47 offen sc1
PREP6_NP:
    s_waitcnt vmcnt(31)
    v_lshlrev_b32 v218, 16, v12
    v_and_b32 v220, s28, v12
    v_lshlrev_b32 v222, 16, v13
    v_and_b32 v224, s28, v13
    v_lshlrev_b32 v219, 16, v14
    v_and_b32 v221, s28, v14
    v_lshlrev_b32 v223, 16, v15
    v_and_b32 v225, s28, v15
    v_lshlrev_b32 v180, 16, v28
    v_and_b32 v181, s28, v28
    v_lshlrev_b32 v182, 16, v32
    v_and_b32 v183, s28, v32
    v_lshlrev_b32 v184, 16, v36
    v_and_b32 v185, s28, v36
    v_lshlrev_b32 v186, 16, v40
    v_and_b32 v187, s28, v40
    v_lshlrev_b32 v188, 16, v44
    buffer_load_dwordx4 a[0:3], v5, s[4:7], 0 offen offset:2048
    v_and_b32 v189, s28, v44
    v_lshlrev_b32 v190, 16, v48
    v_and_b32 v191, s28, v48
    v_lshlrev_b32 v192, 16, v52
    v_and_b32 v193, s28, v52
    v_lshlrev_b32 v194, 16, v56
    v_and_b32 v195, s28, v56
    v_lshlrev_b32 v196, 16, v60
    v_and_b32 v197, s28, v60
    v_lshlrev_b32 v198, 16, v64
    v_and_b32 v199, s28, v64
    v_lshlrev_b32 v200, 16, v68
    v_and_b32 v201, s28, v68
    v_pk_mul_f32 v[202:203], v[180:181], v[224:225]
    v_pk_mul_f32 v[204:205], v[182:183], v[224:225]
    v_pk_mul_f32 v[206:207], v[184:185], v[224:225]
    v_pk_mul_f32 v[208:209], v[186:187], v[224:225]
    buffer_load_dwordx4 a[4:7], v6, s[4:7], 0 offen offset:0
    v_pk_mul_f32 v[210:211], v[188:189], v[224:225]
    v_pk_mul_f32 v[212:213], v[190:191], v[224:225]
    v_pk_mul_f32 v[214:215], v[192:193], v[224:225]
    v_pk_mul_f32 v[216:217], v[194:195], v[224:225]
    v_pk_fma_f32 v[202:203], v[182:183], v[222:223], v[202:203]
    v_pk_fma_f32 v[204:205], v[184:185], v[222:223], v[204:205]
    v_pk_fma_f32 v[206:207], v[186:187], v[222:223], v[206:207]
    v_pk_fma_f32 v[208:209], v[188:189], v[222:223], v[208:209]
    v_pk_fma_f32 v[210:211], v[190:191], v[222:223], v[210:211]
    v_pk_fma_f32 v[212:213], v[192:193], v[222:223], v[212:213]
    v_pk_fma_f32 v[214:215], v[194:195], v[222:223], v[214:215]
    v_pk_fma_f32 v[216:217], v[196:197], v[222:223], v[216:217]
    v_pk_fma_f32 v[202:203], v[184:185], v[220:221], v[202:203]
    v_pk_fma_f32 v[204:205], v[186:187], v[220:221], v[204:205]
    v_pk_fma_f32 v[206:207], v[188:189], v[220:221], v[206:207]
    v_pk_fma_f32 v[208:209], v[190:191], v[220:221], v[208:209]
    v_pk_fma_f32 v[210:211], v[192:193], v[220:221], v[210:211]
    buffer_load_dwordx4 a[8:11], v6, s[4:7], 0 offen offset:2048
    v_pk_fma_f32 v[212:213], v[194:195], v[220:221], v[212:213]
    v_pk_fma_f32 v[214:215], v[196:197], v[220:221], v[214:215]
    v_pk_fma_f32 v[216:217], v[198:199], v[220:221], v[216:217]
    v_pk_fma_f32 v[202:203], v[186:187], v[218:219], v[202:203]
    v_pk_fma_f32 v[204:205], v[188:189], v[218:219], v[204:205]
    v_pk_fma_f32 v[206:207], v[190:191], v[218:219], v[206:207]
    v_pk_fma_f32 v[208:209], v[192:193], v[218:219], v[208:209]
    v_pk_fma_f32 v[210:211], v[194:195], v[218:219], v[210:211]
    v_pk_fma_f32 v[212:213], v[196:197], v[218:219], v[212:213]
    v_pk_fma_f32 v[214:215], v[198:199], v[218:219], v[214:215]
    v_pk_fma_f32 v[216:217], v[200:201], v[218:219], v[216:217]
    v_lshlrev_b32 v226, 16, v72
    v_and_b32 v227, s28, v72
    v_pk_mul_f32 v[202:203], v[202:203], v[226:227]
    v_lshlrev_b32 v228, 16, v76
    v_and_b32 v229, s28, v76
    v_pk_mul_f32 v[204:205], v[204:205], v[228:229]
    buffer_load_dwordx4 a[12:15], v7, s[4:7], s32 offen offset:0
    v_lshlrev_b32 v226, 16, v80
    v_and_b32 v227, s28, v80
    v_pk_mul_f32 v[206:207], v[206:207], v[226:227]
    v_lshlrev_b32 v228, 16, v84
    v_and_b32 v229, s28, v84
    v_pk_mul_f32 v[208:209], v[208:209], v[228:229]
    v_lshlrev_b32 v226, 16, v88
    v_and_b32 v227, s28, v88
    v_pk_mul_f32 v[210:211], v[210:211], v[226:227]
    v_lshlrev_b32 v228, 16, v92
    v_and_b32 v229, s28, v92
    v_pk_mul_f32 v[212:213], v[212:213], v[228:229]
    v_lshlrev_b32 v226, 16, v96
    v_and_b32 v227, s28, v96
    v_pk_mul_f32 v[214:215], v[214:215], v[226:227]
    v_lshlrev_b32 v228, 16, v100
    v_and_b32 v229, s28, v100
    buffer_load_dwordx4 a[16:19], v7, s[4:7], s32 offen offset:2048
    v_pk_mul_f32 v[216:217], v[216:217], v[228:229]
    v_cvt_pk_bf16_f32 v232, v216, v214
    v_cvt_pk_bf16_f32 v233, v212, v210
    v_cvt_pk_bf16_f32 v234, v208, v206
    v_cvt_pk_bf16_f32 v235, v204, v202
    ds_bpermute_b32 v232, v3, v232
    ds_bpermute_b32 v233, v3, v233
    ds_bpermute_b32 v234, v3, v234
    ds_bpermute_b32 v235, v3, v235
    v_cvt_pk_bf16_f32 v236, v217, v215
    v_cvt_pk_bf16_f32 v237, v213, v211
    v_cvt_pk_bf16_f32 v238, v209, v207
    v_cvt_pk_bf16_f32 v239, v205, v203
    ds_bpermute_b32 v236, v3, v236
    ds_bpermute_b32 v237, v3, v237
    ds_bpermute_b32 v238, v3, v238
    ds_bpermute_b32 v239, v3, v239
    buffer_load_dwordx4 a[20:23], v7, s[4:7], s33 offen offset:0
    v_lshlrev_b32 v218, 16, v16
    v_and_b32 v220, s28, v16
    v_lshlrev_b32 v222, 16, v17
    v_and_b32 v224, s28, v17
    v_lshlrev_b32 v219, 16, v18
    v_and_b32 v221, s28, v18
    v_lshlrev_b32 v223, 16, v19
    v_and_b32 v225, s28, v19
    v_lshlrev_b32 v180, 16, v29
    v_and_b32 v181, s28, v29
    v_lshlrev_b32 v182, 16, v33
    v_and_b32 v183, s28, v33
    v_lshlrev_b32 v184, 16, v37
    v_and_b32 v185, s28, v37
    v_lshlrev_b32 v186, 16, v41
    v_and_b32 v187, s28, v41
    v_lshlrev_b32 v188, 16, v45
    buffer_load_dwordx4 a[24:27], v7, s[4:7], s33 offen offset:2048
    v_and_b32 v189, s28, v45
    v_lshlrev_b32 v190, 16, v49
    v_and_b32 v191, s28, v49
    v_lshlrev_b32 v192, 16, v53
    v_and_b32 v193, s28, v53
    v_lshlrev_b32 v194, 16, v57
    v_and_b32 v195, s28, v57
    v_lshlrev_b32 v196, 16, v61
    v_and_b32 v197, s28, v61
    v_lshlrev_b32 v198, 16, v65
    v_and_b32 v199, s28, v65
    v_lshlrev_b32 v200, 16, v69
    v_and_b32 v201, s28, v69
    s_waitcnt lgkmcnt(0)
    buffer_store_dwordx4 v[232:235], v10, s[16:19], s40 offen sc1
    buffer_store_dwordx4 v[236:239], v10, s[16:19], s41 offen sc1
    v_pk_mul_f32 v[202:203], v[180:181], v[224:225]
    buffer_load_dwordx4 a[28:31], v7, s[4:7], s34 offen offset:0
    v_pk_mul_f32 v[204:205], v[182:183], v[224:225]
    v_pk_mul_f32 v[206:207], v[184:185], v[224:225]
    v_pk_mul_f32 v[208:209], v[186:187], v[224:225]
    v_pk_mul_f32 v[210:211], v[188:189], v[224:225]
    v_pk_mul_f32 v[212:213], v[190:191], v[224:225]
    v_pk_mul_f32 v[214:215], v[192:193], v[224:225]
    v_pk_mul_f32 v[216:217], v[194:195], v[224:225]
    v_pk_fma_f32 v[202:203], v[182:183], v[222:223], v[202:203]
    v_pk_fma_f32 v[204:205], v[184:185], v[222:223], v[204:205]
    v_pk_fma_f32 v[206:207], v[186:187], v[222:223], v[206:207]
    v_pk_fma_f32 v[208:209], v[188:189], v[222:223], v[208:209]
    v_pk_fma_f32 v[210:211], v[190:191], v[222:223], v[210:211]
    v_pk_fma_f32 v[212:213], v[192:193], v[222:223], v[212:213]
    v_pk_fma_f32 v[214:215], v[194:195], v[222:223], v[214:215]
    v_pk_fma_f32 v[216:217], v[196:197], v[222:223], v[216:217]
    v_pk_fma_f32 v[202:203], v[184:185], v[220:221], v[202:203]
    v_pk_fma_f32 v[204:205], v[186:187], v[220:221], v[204:205]
    buffer_load_dwordx4 a[32:35], v7, s[4:7], s34 offen offset:2048
    v_pk_fma_f32 v[206:207], v[188:189], v[220:221], v[206:207]
    v_pk_fma_f32 v[208:209], v[190:191], v[220:221], v[208:209]
    v_pk_fma_f32 v[210:211], v[192:193], v[220:221], v[210:211]
    v_pk_fma_f32 v[212:213], v[194:195], v[220:221], v[212:213]
    v_pk_fma_f32 v[214:215], v[196:197], v[220:221], v[214:215]
    v_pk_fma_f32 v[216:217], v[198:199], v[220:221], v[216:217]
    v_pk_fma_f32 v[202:203], v[186:187], v[218:219], v[202:203]
    v_pk_fma_f32 v[204:205], v[188:189], v[218:219], v[204:205]
    v_pk_fma_f32 v[206:207], v[190:191], v[218:219], v[206:207]
    v_pk_fma_f32 v[208:209], v[192:193], v[218:219], v[208:209]
    v_pk_fma_f32 v[210:211], v[194:195], v[218:219], v[210:211]
    v_pk_fma_f32 v[212:213], v[196:197], v[218:219], v[212:213]
    v_pk_fma_f32 v[214:215], v[198:199], v[218:219], v[214:215]
    v_pk_fma_f32 v[216:217], v[200:201], v[218:219], v[216:217]
    v_lshlrev_b32 v226, 16, v73
    v_and_b32 v227, s28, v73
    v_pk_mul_f32 v[202:203], v[202:203], v[226:227]
    buffer_load_dwordx4 a[36:39], v7, s[4:7], s35 offen offset:0
    v_lshlrev_b32 v228, 16, v77
    v_and_b32 v229, s28, v77
    v_pk_mul_f32 v[204:205], v[204:205], v[228:229]
    v_lshlrev_b32 v226, 16, v81
    v_and_b32 v227, s28, v81
    v_pk_mul_f32 v[206:207], v[206:207], v[226:227]
    v_lshlrev_b32 v228, 16, v85
    v_and_b32 v229, s28, v85
    v_pk_mul_f32 v[208:209], v[208:209], v[228:229]
    v_lshlrev_b32 v226, 16, v89
    v_and_b32 v227, s28, v89
    v_pk_mul_f32 v[210:211], v[210:211], v[226:227]
    v_lshlrev_b32 v228, 16, v93
    v_and_b32 v229, s28, v93
    v_pk_mul_f32 v[212:213], v[212:213], v[228:229]
    v_lshlrev_b32 v226, 16, v97
    v_and_b32 v227, s28, v97
    buffer_load_dwordx4 a[40:43], v7, s[4:7], s35 offen offset:2048
    v_pk_mul_f32 v[214:215], v[214:215], v[226:227]
    v_lshlrev_b32 v228, 16, v101
    v_and_b32 v229, s28, v101
    v_pk_mul_f32 v[216:217], v[216:217], v[228:229]
    v_cvt_pk_bf16_f32 v240, v216, v214
    v_cvt_pk_bf16_f32 v241, v212, v210
    v_cvt_pk_bf16_f32 v242, v208, v206
    v_cvt_pk_bf16_f32 v243, v204, v202
    ds_bpermute_b32 v240, v3, v240
    ds_bpermute_b32 v241, v3, v241
    ds_bpermute_b32 v242, v3, v242
    ds_bpermute_b32 v243, v3, v243
    v_cvt_pk_bf16_f32 v244, v217, v215
    v_cvt_pk_bf16_f32 v245, v213, v211
    v_cvt_pk_bf16_f32 v246, v209, v207
    v_cvt_pk_bf16_f32 v247, v205, v203
    ds_bpermute_b32 v244, v3, v244
    buffer_load_dwordx4 a[44:47], v7, s[8:11], s32 offen offset:0
    ds_bpermute_b32 v245, v3, v245
    ds_bpermute_b32 v246, v3, v246
    ds_bpermute_b32 v247, v3, v247
    v_lshlrev_b32 v218, 16, v20
    v_and_b32 v220, s28, v20
    v_lshlrev_b32 v222, 16, v21
    v_and_b32 v224, s28, v21
    v_lshlrev_b32 v219, 16, v22
    v_and_b32 v221, s28, v22
    v_lshlrev_b32 v223, 16, v23
    v_and_b32 v225, s28, v23
    v_lshlrev_b32 v180, 16, v30
    v_and_b32 v181, s28, v30
    v_lshlrev_b32 v182, 16, v34
    v_and_b32 v183, s28, v34
    v_lshlrev_b32 v184, 16, v38
    v_and_b32 v185, s28, v38
    buffer_load_dwordx4 a[48:51], v7, s[8:11], s32 offen offset:2048
    v_lshlrev_b32 v186, 16, v42
    v_and_b32 v187, s28, v42
    v_lshlrev_b32 v188, 16, v46
    v_and_b32 v189, s28, v46
    v_lshlrev_b32 v190, 16, v50
    v_and_b32 v191, s28, v50
    v_lshlrev_b32 v192, 16, v54
    v_and_b32 v193, s28, v54
    v_lshlrev_b32 v194, 16, v58
    v_and_b32 v195, s28, v58
    v_lshlrev_b32 v196, 16, v62
    v_and_b32 v197, s28, v62
    v_lshlrev_b32 v198, 16, v66
    v_and_b32 v199, s28, v66
    v_lshlrev_b32 v200, 16, v70
    v_and_b32 v201, s28, v70
    s_waitcnt lgkmcnt(0)
    buffer_load_dwordx4 a[52:55], v7, s[8:11], s33 offen offset:0
    buffer_store_dwordx4 v[240:243], v10, s[16:19], s42 offen sc1
    buffer_store_dwordx4 v[244:247], v10, s[16:19], s43 offen sc1
    v_pk_mul_f32 v[202:203], v[180:181], v[224:225]
    v_pk_mul_f32 v[204:205], v[182:183], v[224:225]
    v_pk_mul_f32 v[206:207], v[184:185], v[224:225]
    v_pk_mul_f32 v[208:209], v[186:187], v[224:225]
    v_pk_mul_f32 v[210:211], v[188:189], v[224:225]
    v_pk_mul_f32 v[212:213], v[190:191], v[224:225]
    v_pk_mul_f32 v[214:215], v[192:193], v[224:225]
    v_pk_mul_f32 v[216:217], v[194:195], v[224:225]
    v_pk_fma_f32 v[202:203], v[182:183], v[222:223], v[202:203]
    v_pk_fma_f32 v[204:205], v[184:185], v[222:223], v[204:205]
    v_pk_fma_f32 v[206:207], v[186:187], v[222:223], v[206:207]
    v_pk_fma_f32 v[208:209], v[188:189], v[222:223], v[208:209]
    v_pk_fma_f32 v[210:211], v[190:191], v[222:223], v[210:211]
    v_pk_fma_f32 v[212:213], v[192:193], v[222:223], v[212:213]
    v_pk_fma_f32 v[214:215], v[194:195], v[222:223], v[214:215]
    buffer_load_dwordx4 a[56:59], v7, s[8:11], s33 offen offset:2048
    v_pk_fma_f32 v[216:217], v[196:197], v[222:223], v[216:217]
    v_pk_fma_f32 v[202:203], v[184:185], v[220:221], v[202:203]
    v_pk_fma_f32 v[204:205], v[186:187], v[220:221], v[204:205]
    v_pk_fma_f32 v[206:207], v[188:189], v[220:221], v[206:207]
    v_pk_fma_f32 v[208:209], v[190:191], v[220:221], v[208:209]
    v_pk_fma_f32 v[210:211], v[192:193], v[220:221], v[210:211]
    v_pk_fma_f32 v[212:213], v[194:195], v[220:221], v[212:213]
    v_pk_fma_f32 v[214:215], v[196:197], v[220:221], v[214:215]
    v_pk_fma_f32 v[216:217], v[198:199], v[220:221], v[216:217]
    v_pk_fma_f32 v[202:203], v[186:187], v[218:219], v[202:203]
    v_pk_fma_f32 v[204:205], v[188:189], v[218:219], v[204:205]
    v_pk_fma_f32 v[206:207], v[190:191], v[218:219], v[206:207]
    v_pk_fma_f32 v[208:209], v[192:193], v[218:219], v[208:209]
    v_pk_fma_f32 v[210:211], v[194:195], v[218:219], v[210:211]
    v_pk_fma_f32 v[212:213], v[196:197], v[218:219], v[212:213]
    v_pk_fma_f32 v[214:215], v[198:199], v[218:219], v[214:215]
    v_pk_fma_f32 v[216:217], v[200:201], v[218:219], v[216:217]
    buffer_load_dwordx4 a[60:63], v7, s[8:11], s34 offen offset:0
    v_lshlrev_b32 v226, 16, v74
    v_and_b32 v227, s28, v74
    v_pk_mul_f32 v[202:203], v[202:203], v[226:227]
    v_lshlrev_b32 v228, 16, v78
    v_and_b32 v229, s28, v78
    v_pk_mul_f32 v[204:205], v[204:205], v[228:229]
    v_lshlrev_b32 v226, 16, v82
    v_and_b32 v227, s28, v82
    v_pk_mul_f32 v[206:207], v[206:207], v[226:227]
    v_lshlrev_b32 v228, 16, v86
    v_and_b32 v229, s28, v86
    v_pk_mul_f32 v[208:209], v[208:209], v[228:229]
    v_lshlrev_b32 v226, 16, v90
    v_and_b32 v227, s28, v90
    v_pk_mul_f32 v[210:211], v[210:211], v[226:227]
    v_lshlrev_b32 v228, 16, v94
    v_and_b32 v229, s28, v94
    buffer_load_dwordx4 a[64:67], v7, s[8:11], s34 offen offset:2048
    v_pk_mul_f32 v[212:213], v[212:213], v[228:229]
    v_lshlrev_b32 v226, 16, v98
    v_and_b32 v227, s28, v98
    v_pk_mul_f32 v[214:215], v[214:215], v[226:227]
    v_lshlrev_b32 v228, 16, v102
    v_and_b32 v229, s28, v102
    v_pk_mul_f32 v[216:217], v[216:217], v[228:229]
    v_cvt_pk_bf16_f32 v232, v216, v214
    v_cvt_pk_bf16_f32 v233, v212, v210
    v_cvt_pk_bf16_f32 v234, v208, v206
    v_cvt_pk_bf16_f32 v235, v204, v202
    ds_bpermute_b32 v232, v3, v232
    ds_bpermute_b32 v233, v3, v233
    ds_bpermute_b32 v234, v3, v234
    ds_bpermute_b32 v235, v3, v235
    v_cvt_pk_bf16_f32 v236, v217, v215
    v_cvt_pk_bf16_f32 v237, v213, v211
    buffer_load_dwordx4 a[68:71], v7, s[8:11], s35 offen offset:0
    v_cvt_pk_bf16_f32 v238, v209, v207
    v_cvt_pk_bf16_f32 v239, v205, v203
    ds_bpermute_b32 v236, v3, v236
    ds_bpermute_b32 v237, v3, v237
    ds_bpermute_b32 v238, v3, v238
    ds_bpermute_b32 v239, v3, v239
    v_lshlrev_b32 v218, 16, v24
    v_and_b32 v220, s28, v24
    v_lshlrev_b32 v222, 16, v25
    v_and_b32 v224, s28, v25
    v_lshlrev_b32 v219, 16, v26
    v_and_b32 v221, s28, v26
    v_lshlrev_b32 v223, 16, v27
    v_and_b32 v225, s28, v27
    v_lshlrev_b32 v180, 16, v31
    v_and_b32 v181, s28, v31
    v_lshlrev_b32 v182, 16, v35
    buffer_load_dwordx4 a[72:75], v7, s[8:11], s35 offen offset:2048
    v_and_b32 v183, s28, v35
    v_lshlrev_b32 v184, 16, v39
    v_and_b32 v185, s28, v39
    v_lshlrev_b32 v186, 16, v43
    v_and_b32 v187, s28, v43
    v_lshlrev_b32 v188, 16, v47
    v_and_b32 v189, s28, v47
    v_lshlrev_b32 v190, 16, v51
    v_and_b32 v191, s28, v51
    v_lshlrev_b32 v192, 16, v55
    v_and_b32 v193, s28, v55
    v_lshlrev_b32 v194, 16, v59
    v_and_b32 v195, s28, v59
    v_lshlrev_b32 v196, 16, v63
    v_and_b32 v197, s28, v63
    v_lshlrev_b32 v198, 16, v67
    v_and_b32 v199, s28, v67
    v_add_u32 v5, 128, v5
    v_lshlrev_b32 v200, 16, v71
    v_and_b32 v201, s28, v71
    s_waitcnt lgkmcnt(0)
    buffer_store_dwordx4 v[232:235], v10, s[16:19], s44 offen sc1
    buffer_store_dwordx4 v[236:239], v10, s[16:19], s45 offen sc1
    v_pk_mul_f32 v[202:203], v[180:181], v[224:225]
    v_pk_mul_f32 v[204:205], v[182:183], v[224:225]
    v_pk_mul_f32 v[206:207], v[184:185], v[224:225]
    v_pk_mul_f32 v[208:209], v[186:187], v[224:225]
    v_pk_mul_f32 v[210:211], v[188:189], v[224:225]
    v_pk_mul_f32 v[212:213], v[190:191], v[224:225]
    v_pk_mul_f32 v[214:215], v[192:193], v[224:225]
    v_pk_mul_f32 v[216:217], v[194:195], v[224:225]
    v_pk_fma_f32 v[202:203], v[182:183], v[222:223], v[202:203]
    v_pk_fma_f32 v[204:205], v[184:185], v[222:223], v[204:205]
    v_pk_fma_f32 v[206:207], v[186:187], v[222:223], v[206:207]
    v_pk_fma_f32 v[208:209], v[188:189], v[222:223], v[208:209]
    v_add_u32 v6, 128, v6
    v_pk_fma_f32 v[210:211], v[190:191], v[222:223], v[210:211]
    v_pk_fma_f32 v[212:213], v[192:193], v[222:223], v[212:213]
    v_pk_fma_f32 v[214:215], v[194:195], v[222:223], v[214:215]
    v_pk_fma_f32 v[216:217], v[196:197], v[222:223], v[216:217]
    v_pk_fma_f32 v[202:203], v[184:185], v[220:221], v[202:203]
    v_pk_fma_f32 v[204:205], v[186:187], v[220:221], v[204:205]
    v_pk_fma_f32 v[206:207], v[188:189], v[220:221], v[206:207]
    v_pk_fma_f32 v[208:209], v[190:191], v[220:221], v[208:209]
    v_pk_fma_f32 v[210:211], v[192:193], v[220:221], v[210:211]
    v_pk_fma_f32 v[212:213], v[194:195], v[220:221], v[212:213]
    v_pk_fma_f32 v[214:215], v[196:197], v[220:221], v[214:215]
    v_pk_fma_f32 v[216:217], v[198:199], v[220:221], v[216:217]
    v_pk_fma_f32 v[202:203], v[186:187], v[218:219], v[202:203]
    v_pk_fma_f32 v[204:205], v[188:189], v[218:219], v[204:205]
    v_pk_fma_f32 v[206:207], v[190:191], v[218:219], v[206:207]
    v_pk_fma_f32 v[208:209], v[192:193], v[218:219], v[208:209]
    v_pk_fma_f32 v[210:211], v[194:195], v[218:219], v[210:211]
    v_add_u32 v7, 128, v7
    v_pk_fma_f32 v[212:213], v[196:197], v[218:219], v[212:213]
    v_pk_fma_f32 v[214:215], v[198:199], v[218:219], v[214:215]
    v_pk_fma_f32 v[216:217], v[200:201], v[218:219], v[216:217]
    v_lshlrev_b32 v226, 16, v75
    v_and_b32 v227, s28, v75
    v_pk_mul_f32 v[202:203], v[202:203], v[226:227]
    v_lshlrev_b32 v228, 16, v79
    v_and_b32 v229, s28, v79
    v_pk_mul_f32 v[204:205], v[204:205], v[228:229]
    v_lshlrev_b32 v226, 16, v83
    v_and_b32 v227, s28, v83
    v_pk_mul_f32 v[206:207], v[206:207], v[226:227]
    v_lshlrev_b32 v228, 16, v87
    v_and_b32 v229, s28, v87
    v_pk_mul_f32 v[208:209], v[208:209], v[228:229]
    v_lshlrev_b32 v226, 16, v91
    v_and_b32 v227, s28, v91
    v_pk_mul_f32 v[210:211], v[210:211], v[226:227]
    v_lshlrev_b32 v228, 16, v95
    v_and_b32 v229, s28, v95
    v_pk_mul_f32 v[212:213], v[212:213], v[228:229]
    v_lshlrev_b32 v226, 16, v99
    v_and_b32 v227, s28, v99
    v_pk_mul_f32 v[214:215], v[214:215], v[226:227]
    v_lshlrev_b32 v228, 16, v103
    v_and_b32 v229, s28, v103
    v_pk_mul_f32 v[216:217], v[216:217], v[228:229]
    v_cvt_pk_bf16_f32 v240, v216, v214
    v_cvt_pk_bf16_f32 v241, v212, v210
    v_cvt_pk_bf16_f32 v242, v208, v206
    v_cvt_pk_bf16_f32 v243, v204, v202
    ds_bpermute_b32 v240, v3, v240
    ds_bpermute_b32 v241, v3, v241
    ds_bpermute_b32 v242, v3, v242
    ds_bpermute_b32 v243, v3, v243
    v_cvt_pk_bf16_f32 v244, v217, v215
    v_cvt_pk_bf16_f32 v245, v213, v211
    v_cvt_pk_bf16_f32 v246, v209, v207
    v_cvt_pk_bf16_f32 v247, v205, v203
    ds_bpermute_b32 v244, v3, v244
    ds_bpermute_b32 v245, v3, v245
    ds_bpermute_b32 v246, v3, v246
    ds_bpermute_b32 v247, v3, v247
    s_waitcnt vmcnt(25)
    v_accvgpr_read_b32 v12, a160
    v_accvgpr_read_b32 v13, a161
    v_accvgpr_read_b32 v14, a162
    v_accvgpr_read_b32 v15, a163
    v_accvgpr_read_b32 v16, a164
    v_accvgpr_read_b32 v17, a165
    v_accvgpr_read_b32 v18, a166
    v_accvgpr_read_b32 v19, a167
    v_accvgpr_read_b32 v20, a168
    v_accvgpr_read_b32 v21, a169
    v_accvgpr_read_b32 v22, a170
    v_accvgpr_read_b32 v23, a171
    v_accvgpr_read_b32 v24, a172
    v_accvgpr_read_b32 v25, a173
    v_accvgpr_read_b32 v26, a174
    v_accvgpr_read_b32 v27, a175
    v_lshlrev_b32 v218, 16, v12
    v_and_b32 v220, s28, v12
    v_lshlrev_b32 v222, 16, v13
    v_and_b32 v224, s28, v13
    v_lshlrev_b32 v219, 16, v14
    v_and_b32 v221, s28, v14
    v_lshlrev_b32 v223, 16, v15
    v_and_b32 v225, s28, v15
    v_lshlrev_b32 v180, 16, v104
    v_and_b32 v181, s28, v104
    v_lshlrev_b32 v182, 16, v108
    v_and_b32 v183, s28, v108
    v_lshlrev_b32 v184, 16, v112
    v_and_b32 v185, s28, v112
    v_lshlrev_b32 v186, 16, v116
    v_and_b32 v187, s28, v116
    v_lshlrev_b32 v188, 16, v120
    buffer_load_dwordx4 a[76:79], v5, s[4:7], 0 offen offset:2048
    v_and_b32 v189, s28, v120
    v_lshlrev_b32 v190, 16, v124
    v_and_b32 v191, s28, v124
    v_lshlrev_b32 v192, 16, v128
    v_and_b32 v193, s28, v128
    v_lshlrev_b32 v194, 16, v132
    v_and_b32 v195, s28, v132
    v_lshlrev_b32 v196, 16, v136
    v_and_b32 v197, s28, v136
    v_lshlrev_b32 v198, 16, v140
    v_and_b32 v199, s28, v140
    v_lshlrev_b32 v200, 16, v144
    v_and_b32 v201, s28, v144
    s_waitcnt lgkmcnt(0)
    buffer_store_dwordx4 v[240:243], v10, s[16:19], s46 offen sc1
    buffer_store_dwordx4 v[244:247], v10, s[16:19], s47 offen sc1
    v_add_u32 v10, 0x42000, v10
    buffer_load_dwordx4 a[80:83], v6, s[4:7], 0 offen offset:0
    v_pk_mul_f32 v[202:203], v[180:181], v[224:225]
    v_pk_mul_f32 v[204:205], v[182:183], v[224:225]
    v_pk_mul_f32 v[206:207], v[184:185], v[224:225]
    v_pk_mul_f32 v[208:209], v[186:187], v[224:225]
    v_pk_mul_f32 v[210:211], v[188:189], v[224:225]
    v_pk_mul_f32 v[212:213], v[190:191], v[224:225]
    v_pk_mul_f32 v[214:215], v[192:193], v[224:225]
    v_pk_mul_f32 v[216:217], v[194:195], v[224:225]
    v_pk_fma_f32 v[202:203], v[182:183], v[222:223], v[202:203]
    v_pk_fma_f32 v[204:205], v[184:185], v[222:223], v[204:205]
    v_pk_fma_f32 v[206:207], v[186:187], v[222:223], v[206:207]
    v_pk_fma_f32 v[208:209], v[188:189], v[222:223], v[208:209]
    v_pk_fma_f32 v[210:211], v[190:191], v[222:223], v[210:211]
    v_pk_fma_f32 v[212:213], v[192:193], v[222:223], v[212:213]
    v_pk_fma_f32 v[214:215], v[194:195], v[222:223], v[214:215]
    v_pk_fma_f32 v[216:217], v[196:197], v[222:223], v[216:217]
    v_pk_fma_f32 v[202:203], v[184:185], v[220:221], v[202:203]
    buffer_load_dwordx4 a[84:87], v6, s[4:7], 0 offen offset:2048
    v_pk_fma_f32 v[204:205], v[186:187], v[220:221], v[204:205]
    v_pk_fma_f32 v[206:207], v[188:189], v[220:221], v[206:207]
    v_pk_fma_f32 v[208:209], v[190:191], v[220:221], v[208:209]
    v_pk_fma_f32 v[210:211], v[192:193], v[220:221], v[210:211]
    v_pk_fma_f32 v[212:213], v[194:195], v[220:221], v[212:213]
    v_pk_fma_f32 v[214:215], v[196:197], v[220:221], v[214:215]
    v_pk_fma_f32 v[216:217], v[198:199], v[220:221], v[216:217]
    v_pk_fma_f32 v[202:203], v[186:187], v[218:219], v[202:203]
    v_pk_fma_f32 v[204:205], v[188:189], v[218:219], v[204:205]
    v_pk_fma_f32 v[206:207], v[190:191], v[218:219], v[206:207]
    v_pk_fma_f32 v[208:209], v[192:193], v[218:219], v[208:209]
    v_pk_fma_f32 v[210:211], v[194:195], v[218:219], v[210:211]
    v_pk_fma_f32 v[212:213], v[196:197], v[218:219], v[212:213]
    v_pk_fma_f32 v[214:215], v[198:199], v[218:219], v[214:215]
    v_pk_fma_f32 v[216:217], v[200:201], v[218:219], v[216:217]
    v_lshlrev_b32 v226, 16, v148
    v_and_b32 v227, s28, v148
    buffer_load_dwordx4 a[88:91], v7, s[4:7], s32 offen offset:0
    v_pk_mul_f32 v[202:203], v[202:203], v[226:227]
    v_lshlrev_b32 v228, 16, v152
    v_and_b32 v229, s28, v152
    v_pk_mul_f32 v[204:205], v[204:205], v[228:229]
    v_lshlrev_b32 v226, 16, v156
    v_and_b32 v227, s28, v156
    v_pk_mul_f32 v[206:207], v[206:207], v[226:227]
    v_lshlrev_b32 v228, 16, v160
    v_and_b32 v229, s28, v160
    v_pk_mul_f32 v[208:209], v[208:209], v[228:229]
    v_lshlrev_b32 v226, 16, v164
    v_and_b32 v227, s28, v164
    v_pk_mul_f32 v[210:211], v[210:211], v[226:227]
    v_lshlrev_b32 v228, 16, v168
    v_and_b32 v229, s28, v168
    v_pk_mul_f32 v[212:213], v[212:213], v[228:229]
    v_lshlrev_b32 v226, 16, v172
    buffer_load_dwordx4 a[92:95], v7, s[4:7], s32 offen offset:2048
    v_and_b32 v227, s28, v172
    v_pk_mul_f32 v[214:215], v[214:215], v[226:227]
    v_lshlrev_b32 v228, 16, v176
    v_and_b32 v229, s28, v176
    v_pk_mul_f32 v[216:217], v[216:217], v[228:229]
    v_cvt_pk_bf16_f32 v232, v216, v214
    v_cvt_pk_bf16_f32 v233, v212, v210
    v_cvt_pk_bf16_f32 v234, v208, v206
    v_cvt_pk_bf16_f32 v235, v204, v202
    ds_bpermute_b32 v232, v3, v232
    ds_bpermute_b32 v233, v3, v233
    ds_bpermute_b32 v234, v3, v234
    ds_bpermute_b32 v235, v3, v235
    v_cvt_pk_bf16_f32 v236, v217, v215
    v_cvt_pk_bf16_f32 v237, v213, v211
    v_cvt_pk_bf16_f32 v238, v209, v207
    v_cvt_pk_bf16_f32 v239, v205, v203
    buffer_load_dwordx4 a[96:99], v7, s[4:7], s33 offen offset:0
    ds_bpermute_b32 v236, v3, v236
    ds_bpermute_b32 v237, v3, v237
    ds_bpermute_b32 v238, v3, v238
    ds_bpermute_b32 v239, v3, v239
    v_lshlrev_b32 v218, 16, v16
    v_and_b32 v220, s28, v16
    v_lshlrev_b32 v222, 16, v17
    v_and_b32 v224, s28, v17
    v_lshlrev_b32 v219, 16, v18
    v_and_b32 v221, s28, v18
    v_lshlrev_b32 v223, 16, v19
    v_and_b32 v225, s28, v19
    v_lshlrev_b32 v180, 16, v105
    v_and_b32 v181, s28, v105
    v_lshlrev_b32 v182, 16, v109
    v_and_b32 v183, s28, v109
    v_lshlrev_b32 v184, 16, v113
    buffer_load_dwordx4 a[100:103], v7, s[4:7], s33 offen offset:2048
    v_and_b32 v185, s28, v113
    v_lshlrev_b32 v186, 16, v117
    v_and_b32 v187, s28, v117
    v_lshlrev_b32 v188, 16, v121
    v_and_b32 v189, s28, v121
    v_lshlrev_b32 v190, 16, v125
    v_and_b32 v191, s28, v125
    v_lshlrev_b32 v192, 16, v129
    v_and_b32 v193, s28, v129
    v_lshlrev_b32 v194, 16, v133
    v_and_b32 v195, s28, v133
    v_lshlrev_b32 v196, 16, v137
    v_and_b32 v197, s28, v137
    v_lshlrev_b32 v198, 16, v141
    v_and_b32 v199, s28, v141
    v_lshlrev_b32 v200, 16, v145
    v_and_b32 v201, s28, v145
    buffer_load_dwordx4 a[104:107], v7, s[4:7], s34 offen offset:0
    s_waitcnt lgkmcnt(0)
    buffer_store_dwordx4 v[232:235], v10, s[16:19], s40 offen sc1
    buffer_store_dwordx4 v[236:239], v10, s[16:19], s41 offen sc1
    v_pk_mul_f32 v[202:203], v[180:181], v[224:225]
    v_pk_mul_f32 v[204:205], v[182:183], v[224:225]
    v_pk_mul_f32 v[206:207], v[184:185], v[224:225]
    v_pk_mul_f32 v[208:209], v[186:187], v[224:225]
    v_pk_mul_f32 v[210:211], v[188:189], v[224:225]
    v_pk_mul_f32 v[212:213], v[190:191], v[224:225]
    v_pk_mul_f32 v[214:215], v[192:193], v[224:225]
    v_pk_mul_f32 v[216:217], v[194:195], v[224:225]
    v_pk_fma_f32 v[202:203], v[182:183], v[222:223], v[202:203]
    v_pk_fma_f32 v[204:205], v[184:185], v[222:223], v[204:205]
    v_pk_fma_f32 v[206:207], v[186:187], v[222:223], v[206:207]
    v_pk_fma_f32 v[208:209], v[188:189], v[222:223], v[208:209]
    v_pk_fma_f32 v[210:211], v[190:191], v[222:223], v[210:211]
    v_pk_fma_f32 v[212:213], v[192:193], v[222:223], v[212:213]
    buffer_load_dwordx4 a[108:111], v7, s[4:7], s34 offen offset:2048
    v_pk_fma_f32 v[214:215], v[194:195], v[222:223], v[214:215]
    v_pk_fma_f32 v[216:217], v[196:197], v[222:223], v[216:217]
    v_pk_fma_f32 v[202:203], v[184:185], v[220:221], v[202:203]
    v_pk_fma_f32 v[204:205], v[186:187], v[220:221], v[204:205]
    v_pk_fma_f32 v[206:207], v[188:189], v[220:221], v[206:207]
    v_pk_fma_f32 v[208:209], v[190:191], v[220:221], v[208:209]
    v_pk_fma_f32 v[210:211], v[192:193], v[220:221], v[210:211]
    v_pk_fma_f32 v[212:213], v[194:195], v[220:221], v[212:213]
    v_pk_fma_f32 v[214:215], v[196:197], v[220:221], v[214:215]
    v_pk_fma_f32 v[216:217], v[198:199], v[220:221], v[216:217]
    v_pk_fma_f32 v[202:203], v[186:187], v[218:219], v[202:203]
    v_pk_fma_f32 v[204:205], v[188:189], v[218:219], v[204:205]
    v_pk_fma_f32 v[206:207], v[190:191], v[218:219], v[206:207]
    v_pk_fma_f32 v[208:209], v[192:193], v[218:219], v[208:209]
    v_pk_fma_f32 v[210:211], v[194:195], v[218:219], v[210:211]
    v_pk_fma_f32 v[212:213], v[196:197], v[218:219], v[212:213]
    v_pk_fma_f32 v[214:215], v[198:199], v[218:219], v[214:215]
    buffer_load_dwordx4 a[112:115], v7, s[4:7], s35 offen offset:0
    v_pk_fma_f32 v[216:217], v[200:201], v[218:219], v[216:217]
    v_lshlrev_b32 v226, 16, v149
    v_and_b32 v227, s28, v149
    v_pk_mul_f32 v[202:203], v[202:203], v[226:227]
    v_lshlrev_b32 v228, 16, v153
    v_and_b32 v229, s28, v153
    v_pk_mul_f32 v[204:205], v[204:205], v[228:229]
    v_lshlrev_b32 v226, 16, v157
    v_and_b32 v227, s28, v157
    v_pk_mul_f32 v[206:207], v[206:207], v[226:227]
    v_lshlrev_b32 v228, 16, v161
    v_and_b32 v229, s28, v161
    v_pk_mul_f32 v[208:209], v[208:209], v[228:229]
    v_lshlrev_b32 v226, 16, v165
    v_and_b32 v227, s28, v165
    v_pk_mul_f32 v[210:211], v[210:211], v[226:227]
    v_lshlrev_b32 v228, 16, v169
    buffer_load_dwordx4 a[116:119], v7, s[4:7], s35 offen offset:2048
    v_and_b32 v229, s28, v169
    v_pk_mul_f32 v[212:213], v[212:213], v[228:229]
    v_lshlrev_b32 v226, 16, v173
    v_and_b32 v227, s28, v173
    v_pk_mul_f32 v[214:215], v[214:215], v[226:227]
    v_lshlrev_b32 v228, 16, v177
    v_and_b32 v229, s28, v177
    v_pk_mul_f32 v[216:217], v[216:217], v[228:229]
    v_cvt_pk_bf16_f32 v240, v216, v214
    v_cvt_pk_bf16_f32 v241, v212, v210
    v_cvt_pk_bf16_f32 v242, v208, v206
    v_cvt_pk_bf16_f32 v243, v204, v202
    ds_bpermute_b32 v240, v3, v240
    ds_bpermute_b32 v241, v3, v241
    ds_bpermute_b32 v242, v3, v242
    ds_bpermute_b32 v243, v3, v243
    v_cvt_pk_bf16_f32 v244, v217, v215
    buffer_load_dwordx4 a[120:123], v7, s[8:11], s32 offen offset:0
    v_cvt_pk_bf16_f32 v245, v213, v211
    v_cvt_pk_bf16_f32 v246, v209, v207
    v_cvt_pk_bf16_f32 v247, v205, v203
    ds_bpermute_b32 v244, v3, v244
    ds_bpermute_b32 v245, v3, v245
    ds_bpermute_b32 v246, v3, v246
    ds_bpermute_b32 v247, v3, v247
    v_lshlrev_b32 v218, 16, v20
    v_and_b32 v220, s28, v20
    v_lshlrev_b32 v222, 16, v21
    v_and_b32 v224, s28, v21
    v_lshlrev_b32 v219, 16, v22
    v_and_b32 v221, s28, v22
    v_lshlrev_b32 v223, 16, v23
    v_and_b32 v225, s28, v23
    v_lshlrev_b32 v180, 16, v106
    v_and_b32 v181, s28, v106
    buffer_load_dwordx4 a[124:127], v7, s[8:11], s32 offen offset:2048
    v_lshlrev_b32 v182, 16, v110
    v_and_b32 v183, s28, v110
    v_lshlrev_b32 v184, 16, v114
    v_and_b32 v185, s28, v114
    v_lshlrev_b32 v186, 16, v118
    v_and_b32 v187, s28, v118
    v_lshlrev_b32 v188, 16, v122
    v_and_b32 v189, s28, v122
    v_lshlrev_b32 v190, 16, v126
    v_and_b32 v191, s28, v126
    v_lshlrev_b32 v192, 16, v130
    v_and_b32 v193, s28, v130
    v_lshlrev_b32 v194, 16, v134
    v_and_b32 v195, s28, v134
    v_lshlrev_b32 v196, 16, v138
    v_and_b32 v197, s28, v138
    v_lshlrev_b32 v198, 16, v142
    buffer_load_dwordx4 a[128:131], v7, s[8:11], s33 offen offset:0
    v_and_b32 v199, s28, v142
    v_lshlrev_b32 v200, 16, v146
    v_and_b32 v201, s28, v146
    s_waitcnt lgkmcnt(0)
    buffer_store_dwordx4 v[240:243], v10, s[16:19], s42 offen sc1
    buffer_store_dwordx4 v[244:247], v10, s[16:19], s43 offen sc1
    v_pk_mul_f32 v[202:203], v[180:181], v[224:225]
    v_pk_mul_f32 v[204:205], v[182:183], v[224:225]
    v_pk_mul_f32 v[206:207], v[184:185], v[224:225]
    v_pk_mul_f32 v[208:209], v[186:187], v[224:225]
    v_pk_mul_f32 v[210:211], v[188:189], v[224:225]
    v_pk_mul_f32 v[212:213], v[190:191], v[224:225]
    v_pk_mul_f32 v[214:215], v[192:193], v[224:225]
    v_pk_mul_f32 v[216:217], v[194:195], v[224:225]
    v_pk_fma_f32 v[202:203], v[182:183], v[222:223], v[202:203]
    v_pk_fma_f32 v[204:205], v[184:185], v[222:223], v[204:205]
    v_pk_fma_f32 v[206:207], v[186:187], v[222:223], v[206:207]
    buffer_load_dwordx4 a[132:135], v7, s[8:11], s33 offen offset:2048
    v_pk_fma_f32 v[208:209], v[188:189], v[222:223], v[208:209]
    v_pk_fma_f32 v[210:211], v[190:191], v[222:223], v[210:211]
    v_pk_fma_f32 v[212:213], v[192:193], v[222:223], v[212:213]
    v_pk_fma_f32 v[214:215], v[194:195], v[222:223], v[214:215]
    v_pk_fma_f32 v[216:217], v[196:197], v[222:223], v[216:217]
    v_pk_fma_f32 v[202:203], v[184:185], v[220:221], v[202:203]
    v_pk_fma_f32 v[204:205], v[186:187], v[220:221], v[204:205]
    v_pk_fma_f32 v[206:207], v[188:189], v[220:221], v[206:207]
    v_pk_fma_f32 v[208:209], v[190:191], v[220:221], v[208:209]
    v_pk_fma_f32 v[210:211], v[192:193], v[220:221], v[210:211]
    v_pk_fma_f32 v[212:213], v[194:195], v[220:221], v[212:213]
    v_pk_fma_f32 v[214:215], v[196:197], v[220:221], v[214:215]
    v_pk_fma_f32 v[216:217], v[198:199], v[220:221], v[216:217]
    v_pk_fma_f32 v[202:203], v[186:187], v[218:219], v[202:203]
    v_pk_fma_f32 v[204:205], v[188:189], v[218:219], v[204:205]
    v_pk_fma_f32 v[206:207], v[190:191], v[218:219], v[206:207]
    v_pk_fma_f32 v[208:209], v[192:193], v[218:219], v[208:209]
    buffer_load_dwordx4 a[136:139], v7, s[8:11], s34 offen offset:0
    v_pk_fma_f32 v[210:211], v[194:195], v[218:219], v[210:211]
    v_pk_fma_f32 v[212:213], v[196:197], v[218:219], v[212:213]
    v_pk_fma_f32 v[214:215], v[198:199], v[218:219], v[214:215]
    v_pk_fma_f32 v[216:217], v[200:201], v[218:219], v[216:217]
    v_lshlrev_b32 v226, 16, v150
    v_and_b32 v227, s28, v150
    v_pk_mul_f32 v[202:203], v[202:203], v[226:227]
    v_lshlrev_b32 v228, 16, v154
    v_and_b32 v229, s28, v154
    v_pk_mul_f32 v[204:205], v[204:205], v[228:229]
    v_lshlrev_b32 v226, 16, v158
    v_and_b32 v227, s28, v158
    v_pk_mul_f32 v[206:207], v[206:207], v[226:227]
    v_lshlrev_b32 v228, 16, v162
    v_and_b32 v229, s28, v162
    v_pk_mul_f32 v[208:209], v[208:209], v[228:229]
    v_lshlrev_b32 v226, 16, v166
    buffer_load_dwordx4 a[140:143], v7, s[8:11], s34 offen offset:2048
    v_and_b32 v227, s28, v166
    v_pk_mul_f32 v[210:211], v[210:211], v[226:227]
    v_lshlrev_b32 v228, 16, v170
    v_and_b32 v229, s28, v170
    v_pk_mul_f32 v[212:213], v[212:213], v[228:229]
    v_lshlrev_b32 v226, 16, v174
    v_and_b32 v227, s28, v174
    v_pk_mul_f32 v[214:215], v[214:215], v[226:227]
    v_lshlrev_b32 v228, 16, v178
    v_and_b32 v229, s28, v178
    v_pk_mul_f32 v[216:217], v[216:217], v[228:229]
    v_cvt_pk_bf16_f32 v232, v216, v214
    v_cvt_pk_bf16_f32 v233, v212, v210
    v_cvt_pk_bf16_f32 v234, v208, v206
    v_cvt_pk_bf16_f32 v235, v204, v202
    ds_bpermute_b32 v232, v3, v232
    ds_bpermute_b32 v233, v3, v233
    buffer_load_dwordx4 a[144:147], v7, s[8:11], s35 offen offset:0
    ds_bpermute_b32 v234, v3, v234
    ds_bpermute_b32 v235, v3, v235
    v_cvt_pk_bf16_f32 v236, v217, v215
    v_cvt_pk_bf16_f32 v237, v213, v211
    v_cvt_pk_bf16_f32 v238, v209, v207
    v_cvt_pk_bf16_f32 v239, v205, v203
    ds_bpermute_b32 v236, v3, v236
    ds_bpermute_b32 v237, v3, v237
    ds_bpermute_b32 v238, v3, v238
    ds_bpermute_b32 v239, v3, v239
    v_lshlrev_b32 v218, 16, v24
    v_and_b32 v220, s28, v24
    v_lshlrev_b32 v222, 16, v25
    v_and_b32 v224, s28, v25
    v_lshlrev_b32 v219, 16, v26
    v_and_b32 v221, s28, v26
    v_lshlrev_b32 v223, 16, v27
    buffer_load_dwordx4 a[148:151], v7, s[8:11], s35 offen offset:2048
    v_and_b32 v225, s28, v27
    v_lshlrev_b32 v180, 16, v107
    v_and_b32 v181, s28, v107
    v_lshlrev_b32 v182, 16, v111
    v_and_b32 v183, s28, v111
    v_lshlrev_b32 v184, 16, v115
    v_and_b32 v185, s28, v115
    v_lshlrev_b32 v186, 16, v119
    v_and_b32 v187, s28, v119
    v_lshlrev_b32 v188, 16, v123
    v_and_b32 v189, s28, v123
    v_lshlrev_b32 v190, 16, v127
    v_and_b32 v191, s28, v127
    v_lshlrev_b32 v192, 16, v131
    v_and_b32 v193, s28, v131
    v_lshlrev_b32 v194, 16, v135
    v_and_b32 v195, s28, v135
    v_add_u32 v5, 128, v5
    v_lshlrev_b32 v196, 16, v139
    v_and_b32 v197, s28, v139
    v_lshlrev_b32 v198, 16, v143
    v_and_b32 v199, s28, v143
    v_lshlrev_b32 v200, 16, v147
    v_and_b32 v201, s28, v147
    s_waitcnt lgkmcnt(0)
    buffer_store_dwordx4 v[232:235], v10, s[16:19], s44 offen sc1
    buffer_store_dwordx4 v[236:239], v10, s[16:19], s45 offen sc1
    v_pk_mul_f32 v[202:203], v[180:181], v[224:225]
    v_pk_mul_f32 v[204:205], v[182:183], v[224:225]
    v_pk_mul_f32 v[206:207], v[184:185], v[224:225]
    v_pk_mul_f32 v[208:209], v[186:187], v[224:225]
    v_pk_mul_f32 v[210:211], v[188:189], v[224:225]
    v_pk_mul_f32 v[212:213], v[190:191], v[224:225]
    v_pk_mul_f32 v[214:215], v[192:193], v[224:225]
    v_pk_mul_f32 v[216:217], v[194:195], v[224:225]
    v_add_u32 v6, 128, v6
    v_pk_fma_f32 v[202:203], v[182:183], v[222:223], v[202:203]
    v_pk_fma_f32 v[204:205], v[184:185], v[222:223], v[204:205]
    v_pk_fma_f32 v[206:207], v[186:187], v[222:223], v[206:207]
    v_pk_fma_f32 v[208:209], v[188:189], v[222:223], v[208:209]
    v_pk_fma_f32 v[210:211], v[190:191], v[222:223], v[210:211]
    v_pk_fma_f32 v[212:213], v[192:193], v[222:223], v[212:213]
    v_pk_fma_f32 v[214:215], v[194:195], v[222:223], v[214:215]
    v_pk_fma_f32 v[216:217], v[196:197], v[222:223], v[216:217]
    v_pk_fma_f32 v[202:203], v[184:185], v[220:221], v[202:203]
    v_pk_fma_f32 v[204:205], v[186:187], v[220:221], v[204:205]
    v_pk_fma_f32 v[206:207], v[188:189], v[220:221], v[206:207]
    v_pk_fma_f32 v[208:209], v[190:191], v[220:221], v[208:209]
    v_pk_fma_f32 v[210:211], v[192:193], v[220:221], v[210:211]
    v_pk_fma_f32 v[212:213], v[194:195], v[220:221], v[212:213]
    v_pk_fma_f32 v[214:215], v[196:197], v[220:221], v[214:215]
    v_pk_fma_f32 v[216:217], v[198:199], v[220:221], v[216:217]
    v_pk_fma_f32 v[202:203], v[186:187], v[218:219], v[202:203]
    v_add_u32 v7, 128, v7
    v_pk_fma_f32 v[204:205], v[188:189], v[218:219], v[204:205]
    v_pk_fma_f32 v[206:207], v[190:191], v[218:219], v[206:207]
    v_pk_fma_f32 v[208:209], v[192:193], v[218:219], v[208:209]
    v_pk_fma_f32 v[210:211], v[194:195], v[218:219], v[210:211]
    v_pk_fma_f32 v[212:213], v[196:197], v[218:219], v[212:213]
    v_pk_fma_f32 v[214:215], v[198:199], v[218:219], v[214:215]
    v_pk_fma_f32 v[216:217], v[200:201], v[218:219], v[216:217]
    v_lshlrev_b32 v226, 16, v151
    v_and_b32 v227, s28, v151
    v_pk_mul_f32 v[202:203], v[202:203], v[226:227]
    v_lshlrev_b32 v228, 16, v155
    v_and_b32 v229, s28, v155
    v_pk_mul_f32 v[204:205], v[204:205], v[228:229]
    v_lshlrev_b32 v226, 16, v159
    v_and_b32 v227, s28, v159
    v_pk_mul_f32 v[206:207], v[206:207], v[226:227]
    v_lshlrev_b32 v228, 16, v163
    v_and_b32 v229, s28, v163
    v_pk_mul_f32 v[208:209], v[208:209], v[228:229]
    v_lshlrev_b32 v226, 16, v167
    v_and_b32 v227, s28, v167
    v_pk_mul_f32 v[210:211], v[210:211], v[226:227]
    v_lshlrev_b32 v228, 16, v171
    v_and_b32 v229, s28, v171
    v_pk_mul_f32 v[212:213], v[212:213], v[228:229]
    v_lshlrev_b32 v226, 16, v175
    v_and_b32 v227, s28, v175
    v_pk_mul_f32 v[214:215], v[214:215], v[226:227]
    v_lshlrev_b32 v228, 16, v179
    v_and_b32 v229, s28, v179
    v_pk_mul_f32 v[216:217], v[216:217], v[228:229]
    v_cvt_pk_bf16_f32 v240, v216, v214
    v_cvt_pk_bf16_f32 v241, v212, v210
    v_cvt_pk_bf16_f32 v242, v208, v206
    v_cvt_pk_bf16_f32 v243, v204, v202
    ds_bpermute_b32 v240, v3, v240
    ds_bpermute_b32 v241, v3, v241
    ds_bpermute_b32 v242, v3, v242
    ds_bpermute_b32 v243, v3, v243
    v_cvt_pk_bf16_f32 v244, v217, v215
    v_cvt_pk_bf16_f32 v245, v213, v211
    v_cvt_pk_bf16_f32 v246, v209, v207
    v_cvt_pk_bf16_f32 v247, v205, v203
    ds_bpermute_b32 v244, v3, v244
    ds_bpermute_b32 v245, v3, v245
    ds_bpermute_b32 v246, v3, v246
    ds_bpermute_b32 v247, v3, v247
    s_waitcnt vmcnt(27)
    v_accvgpr_read_b32 v12, a176
    v_accvgpr_read_b32 v13, a177
    v_accvgpr_read_b32 v14, a178
    v_accvgpr_read_b32 v15, a179
    v_accvgpr_read_b32 v16, a180
    v_accvgpr_read_b32 v17, a181
    v_accvgpr_read_b32 v18, a182
    v_accvgpr_read_b32 v19, a183
    v_accvgpr_read_b32 v20, a184
    v_accvgpr_read_b32 v21, a185
    v_accvgpr_read_b32 v22, a186
    v_accvgpr_read_b32 v23, a187
    v_accvgpr_read_b32 v24, a188
    v_accvgpr_read_b32 v25, a189
    v_accvgpr_read_b32 v26, a190
    v_accvgpr_read_b32 v27, a191
    v_accvgpr_read_b32 v28, a0
    v_accvgpr_read_b32 v29, a1
    v_accvgpr_read_b32 v30, a2
    v_accvgpr_read_b32 v31, a3
    v_accvgpr_read_b32 v32, a4
    v_accvgpr_read_b32 v33, a5
    v_accvgpr_read_b32 v34, a6
    v_accvgpr_read_b32 v35, a7
    v_accvgpr_read_b32 v36, a8
    v_accvgpr_read_b32 v37, a9
    v_accvgpr_read_b32 v38, a10
    v_accvgpr_read_b32 v39, a11
    v_accvgpr_read_b32 v40, a12
    v_accvgpr_read_b32 v41, a13
    v_accvgpr_read_b32 v42, a14
    v_accvgpr_read_b32 v43, a15
    v_accvgpr_read_b32 v44, a16
    v_accvgpr_read_b32 v45, a17
    v_accvgpr_read_b32 v46, a18
    v_accvgpr_read_b32 v47, a19
    v_accvgpr_read_b32 v48, a20
    v_accvgpr_read_b32 v49, a21
    v_accvgpr_read_b32 v50, a22
    v_accvgpr_read_b32 v51, a23
    v_accvgpr_read_b32 v52, a24
    v_accvgpr_read_b32 v53, a25
    v_accvgpr_read_b32 v54, a26
    v_accvgpr_read_b32 v55, a27
    v_accvgpr_read_b32 v56, a28
    v_accvgpr_read_b32 v57, a29
    v_accvgpr_read_b32 v58, a30
    v_accvgpr_read_b32 v59, a31
    v_accvgpr_read_b32 v60, a32
    v_accvgpr_read_b32 v61, a33
    v_accvgpr_read_b32 v62, a34
    v_accvgpr_read_b32 v63, a35
    v_accvgpr_read_b32 v64, a36
    v_accvgpr_read_b32 v65, a37
    v_accvgpr_read_b32 v66, a38
    v_accvgpr_read_b32 v67, a39
    v_accvgpr_read_b32 v68, a40
    v_accvgpr_read_b32 v69, a41
    v_accvgpr_read_b32 v70, a42
    v_accvgpr_read_b32 v71, a43
    v_accvgpr_read_b32 v72, a44
    v_accvgpr_read_b32 v73, a45
    v_accvgpr_read_b32 v74, a46
    v_accvgpr_read_b32 v75, a47
    v_accvgpr_read_b32 v76, a48
    v_accvgpr_read_b32 v77, a49
    v_accvgpr_read_b32 v78, a50
    v_accvgpr_read_b32 v79, a51
    v_accvgpr_read_b32 v80, a52
    v_accvgpr_read_b32 v81, a53
    v_accvgpr_read_b32 v82, a54
    v_accvgpr_read_b32 v83, a55
    v_accvgpr_read_b32 v84, a56
    v_accvgpr_read_b32 v85, a57
    v_accvgpr_read_b32 v86, a58
    v_accvgpr_read_b32 v87, a59
    v_accvgpr_read_b32 v88, a60
    v_accvgpr_read_b32 v89, a61
    v_accvgpr_read_b32 v90, a62
    v_accvgpr_read_b32 v91, a63
    v_accvgpr_read_b32 v92, a64
    v_accvgpr_read_b32 v93, a65
    v_accvgpr_read_b32 v94, a66
    v_accvgpr_read_b32 v95, a67
    v_accvgpr_read_b32 v96, a68
    v_accvgpr_read_b32 v97, a69
    v_accvgpr_read_b32 v98, a70
    v_accvgpr_read_b32 v99, a71
    v_accvgpr_read_b32 v100, a72
    v_accvgpr_read_b32 v101, a73
    v_accvgpr_read_b32 v102, a74
    v_accvgpr_read_b32 v103, a75
    v_lshlrev_b32 v218, 16, v12
    v_and_b32 v220, s28, v12
    v_lshlrev_b32 v222, 16, v13
    v_and_b32 v224, s28, v13
    v_lshlrev_b32 v219, 16, v14
    v_and_b32 v221, s28, v14
    v_lshlrev_b32 v223, 16, v15
    v_and_b32 v225, s28, v15
    v_lshlrev_b32 v180, 16, v28
    v_and_b32 v181, s28, v28
    v_lshlrev_b32 v182, 16, v32
    v_and_b32 v183, s28, v32
    v_lshlrev_b32 v184, 16, v36
    v_and_b32 v185, s28, v36
    v_lshlrev_b32 v186, 16, v40
    v_and_b32 v187, s28, v40
    v_lshlrev_b32 v188, 16, v44
    v_and_b32 v189, s28, v44
    v_lshlrev_b32 v190, 16, v48
    v_and_b32 v191, s28, v48
    v_lshlrev_b32 v192, 16, v52
    v_and_b32 v193, s28, v52
    v_lshlrev_b32 v194, 16, v56
    v_and_b32 v195, s28, v56
    v_lshlrev_b32 v196, 16, v60
    v_and_b32 v197, s28, v60
    v_lshlrev_b32 v198, 16, v64
    v_and_b32 v199, s28, v64
    v_lshlrev_b32 v200, 16, v68
    v_and_b32 v201, s28, v68
    s_waitcnt lgkmcnt(0)
    buffer_store_dwordx4 v[240:243], v10, s[16:19], s46 offen sc1
    buffer_store_dwordx4 v[244:247], v10, s[16:19], s47 offen sc1
    v_add_u32 v10, 0x42000, v10
    v_pk_mul_f32 v[202:203], v[180:181], v[224:225]
    v_pk_mul_f32 v[204:205], v[182:183], v[224:225]
    v_pk_mul_f32 v[206:207], v[184:185], v[224:225]
    v_pk_mul_f32 v[208:209], v[186:187], v[224:225]
    v_pk_mul_f32 v[210:211], v[188:189], v[224:225]
    v_pk_mul_f32 v[212:213], v[190:191], v[224:225]
    v_pk_mul_f32 v[214:215], v[192:193], v[224:225]
    v_pk_mul_f32 v[216:217], v[194:195], v[224:225]
    v_pk_fma_f32 v[202:203], v[182:183], v[222:223], v[202:203]
    v_pk_fma_f32 v[204:205], v[184:185], v[222:223], v[204:205]
    v_pk_fma_f32 v[206:207], v[186:187], v[222:223], v[206:207]
    v_pk_fma_f32 v[208:209], v[188:189], v[222:223], v[208:209]
    v_pk_fma_f32 v[210:211], v[190:191], v[222:223], v[210:211]
    v_pk_fma_f32 v[212:213], v[192:193], v[222:223], v[212:213]
    v_pk_fma_f32 v[214:215], v[194:195], v[222:223], v[214:215]
    v_pk_fma_f32 v[216:217], v[196:197], v[222:223], v[216:217]
    v_pk_fma_f32 v[202:203], v[184:185], v[220:221], v[202:203]
    v_pk_fma_f32 v[204:205], v[186:187], v[220:221], v[204:205]
    v_pk_fma_f32 v[206:207], v[188:189], v[220:221], v[206:207]
    v_pk_fma_f32 v[208:209], v[190:191], v[220:221], v[208:209]
    v_pk_fma_f32 v[210:211], v[192:193], v[220:221], v[210:211]
    v_pk_fma_f32 v[212:213], v[194:195], v[220:221], v[212:213]
    v_pk_fma_f32 v[214:215], v[196:197], v[220:221], v[214:215]
    v_pk_fma_f32 v[216:217], v[198:199], v[220:221], v[216:217]
    v_pk_fma_f32 v[202:203], v[186:187], v[218:219], v[202:203]
    v_pk_fma_f32 v[204:205], v[188:189], v[218:219], v[204:205]
    v_pk_fma_f32 v[206:207], v[190:191], v[218:219], v[206:207]
    v_pk_fma_f32 v[208:209], v[192:193], v[218:219], v[208:209]
    v_pk_fma_f32 v[210:211], v[194:195], v[218:219], v[210:211]
    v_pk_fma_f32 v[212:213], v[196:197], v[218:219], v[212:213]
    v_pk_fma_f32 v[214:215], v[198:199], v[218:219], v[214:215]
    v_pk_fma_f32 v[216:217], v[200:201], v[218:219], v[216:217]
    v_lshlrev_b32 v226, 16, v72
    v_and_b32 v227, s28, v72
    v_pk_mul_f32 v[202:203], v[202:203], v[226:227]
    v_lshlrev_b32 v228, 16, v76
    v_and_b32 v229, s28, v76
    v_pk_mul_f32 v[204:205], v[204:205], v[228:229]
    v_lshlrev_b32 v226, 16, v80
    v_and_b32 v227, s28, v80
    v_pk_mul_f32 v[206:207], v[206:207], v[226:227]
    v_lshlrev_b32 v228, 16, v84
    v_and_b32 v229, s28, v84
    v_pk_mul_f32 v[208:209], v[208:209], v[228:229]
    v_lshlrev_b32 v226, 16, v88
    v_and_b32 v227, s28, v88
    v_pk_mul_f32 v[210:211], v[210:211], v[226:227]
    v_lshlrev_b32 v228, 16, v92
    v_and_b32 v229, s28, v92
    v_pk_mul_f32 v[212:213], v[212:213], v[228:229]
    v_lshlrev_b32 v226, 16, v96
    v_and_b32 v227, s28, v96
    v_pk_mul_f32 v[214:215], v[214:215], v[226:227]
    v_lshlrev_b32 v228, 16, v100
    v_and_b32 v229, s28, v100
    v_pk_mul_f32 v[216:217], v[216:217], v[228:229]
    v_cvt_pk_bf16_f32 v232, v216, v214
    v_cvt_pk_bf16_f32 v233, v212, v210
    v_cvt_pk_bf16_f32 v234, v208, v206
    v_cvt_pk_bf16_f32 v235, v204, v202
    ds_bpermute_b32 v232, v3, v232
    ds_bpermute_b32 v233, v3, v233
    ds_bpermute_b32 v234, v3, v234
    ds_bpermute_b32 v235, v3, v235
    v_cvt_pk_bf16_f32 v236, v217, v215
    v_cvt_pk_bf16_f32 v237, v213, v211
    v_cvt_pk_bf16_f32 v238, v209, v207
    v_cvt_pk_bf16_f32 v239, v205, v203
    ds_bpermute_b32 v236, v3, v236
    ds_bpermute_b32 v237, v3, v237
    ds_bpermute_b32 v238, v3, v238
    ds_bpermute_b32 v239, v3, v239
    v_lshlrev_b32 v218, 16, v16
    v_and_b32 v220, s28, v16
    v_lshlrev_b32 v222, 16, v17
    v_and_b32 v224, s28, v17
    v_lshlrev_b32 v219, 16, v18
    v_and_b32 v221, s28, v18
    v_lshlrev_b32 v223, 16, v19
    v_and_b32 v225, s28, v19
    v_lshlrev_b32 v180, 16, v29
    v_and_b32 v181, s28, v29
    v_lshlrev_b32 v182, 16, v33
    v_and_b32 v183, s28, v33
    v_lshlrev_b32 v184, 16, v37
    v_and_b32 v185, s28, v37
    v_lshlrev_b32 v186, 16, v41
    v_and_b32 v187, s28, v41
    v_lshlrev_b32 v188, 16, v45
    v_and_b32 v189, s28, v45
    v_lshlrev_b32 v190, 16, v49
    v_and_b32 v191, s28, v49
    v_lshlrev_b32 v192, 16, v53
    v_and_b32 v193, s28, v53
    v_lshlrev_b32 v194, 16, v57
    v_and_b32 v195, s28, v57
    v_lshlrev_b32 v196, 16, v61
    v_and_b32 v197, s28, v61
    v_lshlrev_b32 v198, 16, v65
    v_and_b32 v199, s28, v65
    v_lshlrev_b32 v200, 16, v69
    v_and_b32 v201, s28, v69
    s_waitcnt lgkmcnt(0)
    buffer_store_dwordx4 v[232:235], v10, s[16:19], s40 offen sc1
    buffer_store_dwordx4 v[236:239], v10, s[16:19], s41 offen sc1
    v_pk_mul_f32 v[202:203], v[180:181], v[224:225]
    v_pk_mul_f32 v[204:205], v[182:183], v[224:225]
    v_pk_mul_f32 v[206:207], v[184:185], v[224:225]
    v_pk_mul_f32 v[208:209], v[186:187], v[224:225]
    v_pk_mul_f32 v[210:211], v[188:189], v[224:225]
    v_pk_mul_f32 v[212:213], v[190:191], v[224:225]
    v_pk_mul_f32 v[214:215], v[192:193], v[224:225]
    v_pk_mul_f32 v[216:217], v[194:195], v[224:225]
    v_pk_fma_f32 v[202:203], v[182:183], v[222:223], v[202:203]
    v_pk_fma_f32 v[204:205], v[184:185], v[222:223], v[204:205]
    v_pk_fma_f32 v[206:207], v[186:187], v[222:223], v[206:207]
    v_pk_fma_f32 v[208:209], v[188:189], v[222:223], v[208:209]
    v_pk_fma_f32 v[210:211], v[190:191], v[222:223], v[210:211]
    v_pk_fma_f32 v[212:213], v[192:193], v[222:223], v[212:213]
    v_pk_fma_f32 v[214:215], v[194:195], v[222:223], v[214:215]
    v_pk_fma_f32 v[216:217], v[196:197], v[222:223], v[216:217]
    v_pk_fma_f32 v[202:203], v[184:185], v[220:221], v[202:203]
    v_pk_fma_f32 v[204:205], v[186:187], v[220:221], v[204:205]
    v_pk_fma_f32 v[206:207], v[188:189], v[220:221], v[206:207]
    v_pk_fma_f32 v[208:209], v[190:191], v[220:221], v[208:209]
    v_pk_fma_f32 v[210:211], v[192:193], v[220:221], v[210:211]
    v_pk_fma_f32 v[212:213], v[194:195], v[220:221], v[212:213]
    v_pk_fma_f32 v[214:215], v[196:197], v[220:221], v[214:215]
    v_pk_fma_f32 v[216:217], v[198:199], v[220:221], v[216:217]
    v_pk_fma_f32 v[202:203], v[186:187], v[218:219], v[202:203]
    v_pk_fma_f32 v[204:205], v[188:189], v[218:219], v[204:205]
    v_pk_fma_f32 v[206:207], v[190:191], v[218:219], v[206:207]
    v_pk_fma_f32 v[208:209], v[192:193], v[218:219], v[208:209]
    v_pk_fma_f32 v[210:211], v[194:195], v[218:219], v[210:211]
    v_pk_fma_f32 v[212:213], v[196:197], v[218:219], v[212:213]
    v_pk_fma_f32 v[214:215], v[198:199], v[218:219], v[214:215]
    v_pk_fma_f32 v[216:217], v[200:201], v[218:219], v[216:217]
    v_lshlrev_b32 v226, 16, v73
    v_and_b32 v227, s28, v73
    v_pk_mul_f32 v[202:203], v[202:203], v[226:227]
    v_lshlrev_b32 v228, 16, v77
    v_and_b32 v229, s28, v77
    v_pk_mul_f32 v[204:205], v[204:205], v[228:229]
    v_lshlrev_b32 v226, 16, v81
    v_and_b32 v227, s28, v81
    v_pk_mul_f32 v[206:207], v[206:207], v[226:227]
    v_lshlrev_b32 v228, 16, v85
    v_and_b32 v229, s28, v85
    v_pk_mul_f32 v[208:209], v[208:209], v[228:229]
    v_lshlrev_b32 v226, 16, v89
    v_and_b32 v227, s28, v89
    v_pk_mul_f32 v[210:211], v[210:211], v[226:227]
    v_lshlrev_b32 v228, 16, v93
    v_and_b32 v229, s28, v93
    v_pk_mul_f32 v[212:213], v[212:213], v[228:229]
    v_lshlrev_b32 v226, 16, v97
    v_and_b32 v227, s28, v97
    v_pk_mul_f32 v[214:215], v[214:215], v[226:227]
    v_lshlrev_b32 v228, 16, v101
    v_and_b32 v229, s28, v101
    v_pk_mul_f32 v[216:217], v[216:217], v[228:229]
    v_cvt_pk_bf16_f32 v240, v216, v214
    v_cvt_pk_bf16_f32 v241, v212, v210
    v_cvt_pk_bf16_f32 v242, v208, v206
    v_cvt_pk_bf16_f32 v243, v204, v202
    ds_bpermute_b32 v240, v3, v240
    ds_bpermute_b32 v241, v3, v241
    ds_bpermute_b32 v242, v3, v242
    ds_bpermute_b32 v243, v3, v243
    v_cvt_pk_bf16_f32 v244, v217, v215
    v_cvt_pk_bf16_f32 v245, v213, v211
    v_cvt_pk_bf16_f32 v246, v209, v207
    v_cvt_pk_bf16_f32 v247, v205, v203
    ds_bpermute_b32 v244, v3, v244
    ds_bpermute_b32 v245, v3, v245
    ds_bpermute_b32 v246, v3, v246
    ds_bpermute_b32 v247, v3, v247
    v_lshlrev_b32 v218, 16, v20
    v_and_b32 v220, s28, v20
    v_lshlrev_b32 v222, 16, v21
    v_and_b32 v224, s28, v21
    v_lshlrev_b32 v219, 16, v22
    v_and_b32 v221, s28, v22
    v_lshlrev_b32 v223, 16, v23
    v_and_b32 v225, s28, v23
    v_lshlrev_b32 v180, 16, v30
    v_and_b32 v181, s28, v30
    v_lshlrev_b32 v182, 16, v34
    v_and_b32 v183, s28, v34
    v_lshlrev_b32 v184, 16, v38
    v_and_b32 v185, s28, v38
    v_lshlrev_b32 v186, 16, v42
    v_and_b32 v187, s28, v42
    v_lshlrev_b32 v188, 16, v46
    v_and_b32 v189, s28, v46
    v_lshlrev_b32 v190, 16, v50
    v_and_b32 v191, s28, v50
    v_lshlrev_b32 v192, 16, v54
    v_and_b32 v193, s28, v54
    v_lshlrev_b32 v194, 16, v58
    v_and_b32 v195, s28, v58
    v_lshlrev_b32 v196, 16, v62
    v_and_b32 v197, s28, v62
    v_lshlrev_b32 v198, 16, v66
    v_and_b32 v199, s28, v66
    v_lshlrev_b32 v200, 16, v70
    v_and_b32 v201, s28, v70
    s_waitcnt lgkmcnt(0)
    buffer_store_dwordx4 v[240:243], v10, s[16:19], s42 offen sc1
    buffer_store_dwordx4 v[244:247], v10, s[16:19], s43 offen sc1
    v_pk_mul_f32 v[202:203], v[180:181], v[224:225]
    v_pk_mul_f32 v[204:205], v[182:183], v[224:225]
    v_pk_mul_f32 v[206:207], v[184:185], v[224:225]
    v_pk_mul_f32 v[208:209], v[186:187], v[224:225]
    v_pk_mul_f32 v[210:211], v[188:189], v[224:225]
    v_pk_mul_f32 v[212:213], v[190:191], v[224:225]
    v_pk_mul_f32 v[214:215], v[192:193], v[224:225]
    v_pk_mul_f32 v[216:217], v[194:195], v[224:225]
    v_pk_fma_f32 v[202:203], v[182:183], v[222:223], v[202:203]
    v_pk_fma_f32 v[204:205], v[184:185], v[222:223], v[204:205]
    v_pk_fma_f32 v[206:207], v[186:187], v[222:223], v[206:207]
    v_pk_fma_f32 v[208:209], v[188:189], v[222:223], v[208:209]
    v_pk_fma_f32 v[210:211], v[190:191], v[222:223], v[210:211]
    v_pk_fma_f32 v[212:213], v[192:193], v[222:223], v[212:213]
    v_pk_fma_f32 v[214:215], v[194:195], v[222:223], v[214:215]
    v_pk_fma_f32 v[216:217], v[196:197], v[222:223], v[216:217]
    v_pk_fma_f32 v[202:203], v[184:185], v[220:221], v[202:203]
    v_pk_fma_f32 v[204:205], v[186:187], v[220:221], v[204:205]
    v_pk_fma_f32 v[206:207], v[188:189], v[220:221], v[206:207]
    v_pk_fma_f32 v[208:209], v[190:191], v[220:221], v[208:209]
    v_pk_fma_f32 v[210:211], v[192:193], v[220:221], v[210:211]
    v_pk_fma_f32 v[212:213], v[194:195], v[220:221], v[212:213]
    v_pk_fma_f32 v[214:215], v[196:197], v[220:221], v[214:215]
    v_pk_fma_f32 v[216:217], v[198:199], v[220:221], v[216:217]
    v_pk_fma_f32 v[202:203], v[186:187], v[218:219], v[202:203]
    v_pk_fma_f32 v[204:205], v[188:189], v[218:219], v[204:205]
    v_pk_fma_f32 v[206:207], v[190:191], v[218:219], v[206:207]
    v_pk_fma_f32 v[208:209], v[192:193], v[218:219], v[208:209]
    v_pk_fma_f32 v[210:211], v[194:195], v[218:219], v[210:211]
    v_pk_fma_f32 v[212:213], v[196:197], v[218:219], v[212:213]
    v_pk_fma_f32 v[214:215], v[198:199], v[218:219], v[214:215]
    v_pk_fma_f32 v[216:217], v[200:201], v[218:219], v[216:217]
    v_lshlrev_b32 v226, 16, v74
    v_and_b32 v227, s28, v74
    v_pk_mul_f32 v[202:203], v[202:203], v[226:227]
    v_lshlrev_b32 v228, 16, v78
    v_and_b32 v229, s28, v78
    v_pk_mul_f32 v[204:205], v[204:205], v[228:229]
    v_lshlrev_b32 v226, 16, v82
    v_and_b32 v227, s28, v82
    v_pk_mul_f32 v[206:207], v[206:207], v[226:227]
    v_lshlrev_b32 v228, 16, v86
    v_and_b32 v229, s28, v86
    v_pk_mul_f32 v[208:209], v[208:209], v[228:229]
    v_lshlrev_b32 v226, 16, v90
    v_and_b32 v227, s28, v90
    v_pk_mul_f32 v[210:211], v[210:211], v[226:227]
    v_lshlrev_b32 v228, 16, v94
    v_and_b32 v229, s28, v94
    v_pk_mul_f32 v[212:213], v[212:213], v[228:229]
    v_lshlrev_b32 v226, 16, v98
    v_and_b32 v227, s28, v98
    v_pk_mul_f32 v[214:215], v[214:215], v[226:227]
    v_lshlrev_b32 v228, 16, v102
    v_and_b32 v229, s28, v102
    v_pk_mul_f32 v[216:217], v[216:217], v[228:229]
    v_cvt_pk_bf16_f32 v232, v216, v214
    v_cvt_pk_bf16_f32 v233, v212, v210
    v_cvt_pk_bf16_f32 v234, v208, v206
    v_cvt_pk_bf16_f32 v235, v204, v202
    ds_bpermute_b32 v232, v3, v232
    ds_bpermute_b32 v233, v3, v233
    ds_bpermute_b32 v234, v3, v234
    ds_bpermute_b32 v235, v3, v235
    v_cvt_pk_bf16_f32 v236, v217, v215
    v_cvt_pk_bf16_f32 v237, v213, v211
    v_cvt_pk_bf16_f32 v238, v209, v207
    v_cvt_pk_bf16_f32 v239, v205, v203
    ds_bpermute_b32 v236, v3, v236
    ds_bpermute_b32 v237, v3, v237
    ds_bpermute_b32 v238, v3, v238
    ds_bpermute_b32 v239, v3, v239
    v_lshlrev_b32 v218, 16, v24
    v_and_b32 v220, s28, v24
    v_lshlrev_b32 v222, 16, v25
    v_and_b32 v224, s28, v25
    v_lshlrev_b32 v219, 16, v26
    v_and_b32 v221, s28, v26
    v_lshlrev_b32 v223, 16, v27
    v_and_b32 v225, s28, v27
    v_lshlrev_b32 v180, 16, v31
    v_and_b32 v181, s28, v31
    v_lshlrev_b32 v182, 16, v35
    v_and_b32 v183, s28, v35
    v_lshlrev_b32 v184, 16, v39
    v_and_b32 v185, s28, v39
    v_lshlrev_b32 v186, 16, v43
    v_and_b32 v187, s28, v43
    v_lshlrev_b32 v188, 16, v47
    v_and_b32 v189, s28, v47
    v_lshlrev_b32 v190, 16, v51
    v_and_b32 v191, s28, v51
    v_lshlrev_b32 v192, 16, v55
    v_and_b32 v193, s28, v55
    v_lshlrev_b32 v194, 16, v59
    v_and_b32 v195, s28, v59
    v_lshlrev_b32 v196, 16, v63
    v_and_b32 v197, s28, v63
    v_lshlrev_b32 v198, 16, v67
    v_and_b32 v199, s28, v67
    v_lshlrev_b32 v200, 16, v71
    v_and_b32 v201, s28, v71
    s_waitcnt lgkmcnt(0)
    buffer_store_dwordx4 v[232:235], v10, s[16:19], s44 offen sc1
    buffer_store_dwordx4 v[236:239], v10, s[16:19], s45 offen sc1
    v_pk_mul_f32 v[202:203], v[180:181], v[224:225]
    v_pk_mul_f32 v[204:205], v[182:183], v[224:225]
    v_pk_mul_f32 v[206:207], v[184:185], v[224:225]
    v_pk_mul_f32 v[208:209], v[186:187], v[224:225]
    v_pk_mul_f32 v[210:211], v[188:189], v[224:225]
    v_pk_mul_f32 v[212:213], v[190:191], v[224:225]
    v_pk_mul_f32 v[214:215], v[192:193], v[224:225]
    v_pk_mul_f32 v[216:217], v[194:195], v[224:225]
    v_pk_fma_f32 v[202:203], v[182:183], v[222:223], v[202:203]
    v_pk_fma_f32 v[204:205], v[184:185], v[222:223], v[204:205]
    v_pk_fma_f32 v[206:207], v[186:187], v[222:223], v[206:207]
    v_pk_fma_f32 v[208:209], v[188:189], v[222:223], v[208:209]
    v_pk_fma_f32 v[210:211], v[190:191], v[222:223], v[210:211]
    v_pk_fma_f32 v[212:213], v[192:193], v[222:223], v[212:213]
    v_pk_fma_f32 v[214:215], v[194:195], v[222:223], v[214:215]
    v_pk_fma_f32 v[216:217], v[196:197], v[222:223], v[216:217]
    v_pk_fma_f32 v[202:203], v[184:185], v[220:221], v[202:203]
    v_pk_fma_f32 v[204:205], v[186:187], v[220:221], v[204:205]
    v_pk_fma_f32 v[206:207], v[188:189], v[220:221], v[206:207]
    v_pk_fma_f32 v[208:209], v[190:191], v[220:221], v[208:209]
    v_pk_fma_f32 v[210:211], v[192:193], v[220:221], v[210:211]
    v_pk_fma_f32 v[212:213], v[194:195], v[220:221], v[212:213]
    v_pk_fma_f32 v[214:215], v[196:197], v[220:221], v[214:215]
    v_pk_fma_f32 v[216:217], v[198:199], v[220:221], v[216:217]
    v_pk_fma_f32 v[202:203], v[186:187], v[218:219], v[202:203]
    v_pk_fma_f32 v[204:205], v[188:189], v[218:219], v[204:205]
    v_pk_fma_f32 v[206:207], v[190:191], v[218:219], v[206:207]
    v_pk_fma_f32 v[208:209], v[192:193], v[218:219], v[208:209]
    v_pk_fma_f32 v[210:211], v[194:195], v[218:219], v[210:211]
    v_pk_fma_f32 v[212:213], v[196:197], v[218:219], v[212:213]
    v_pk_fma_f32 v[214:215], v[198:199], v[218:219], v[214:215]
    v_pk_fma_f32 v[216:217], v[200:201], v[218:219], v[216:217]
    v_lshlrev_b32 v226, 16, v75
    v_and_b32 v227, s28, v75
    v_pk_mul_f32 v[202:203], v[202:203], v[226:227]
    v_lshlrev_b32 v228, 16, v79
    v_and_b32 v229, s28, v79
    v_pk_mul_f32 v[204:205], v[204:205], v[228:229]
    v_lshlrev_b32 v226, 16, v83
    v_and_b32 v227, s28, v83
    v_pk_mul_f32 v[206:207], v[206:207], v[226:227]
    v_lshlrev_b32 v228, 16, v87
    v_and_b32 v229, s28, v87
    v_pk_mul_f32 v[208:209], v[208:209], v[228:229]
    v_lshlrev_b32 v226, 16, v91
    v_and_b32 v227, s28, v91
    v_pk_mul_f32 v[210:211], v[210:211], v[226:227]
    v_lshlrev_b32 v228, 16, v95
    v_and_b32 v229, s28, v95
    v_pk_mul_f32 v[212:213], v[212:213], v[228:229]
    v_lshlrev_b32 v226, 16, v99
    v_and_b32 v227, s28, v99
    v_pk_mul_f32 v[214:215], v[214:215], v[226:227]
    v_lshlrev_b32 v228, 16, v103
    v_and_b32 v229, s28, v103
    v_pk_mul_f32 v[216:217], v[216:217], v[228:229]
    v_cvt_pk_bf16_f32 v240, v216, v214
    v_cvt_pk_bf16_f32 v241, v212, v210
    v_cvt_pk_bf16_f32 v242, v208, v206
    v_cvt_pk_bf16_f32 v243, v204, v202
    ds_bpermute_b32 v240, v3, v240
    ds_bpermute_b32 v241, v3, v241
    ds_bpermute_b32 v242, v3, v242
    ds_bpermute_b32 v243, v3, v243
    v_cvt_pk_bf16_f32 v244, v217, v215
    v_cvt_pk_bf16_f32 v245, v213, v211
    v_cvt_pk_bf16_f32 v246, v209, v207
    v_cvt_pk_bf16_f32 v247, v205, v203
    ds_bpermute_b32 v244, v3, v244
    ds_bpermute_b32 v245, v3, v245
    ds_bpermute_b32 v246, v3, v246
    ds_bpermute_b32 v247, v3, v247
    s_waitcnt vmcnt(8)
    v_accvgpr_read_b32 v12, a192
    v_accvgpr_read_b32 v13, a193
    v_accvgpr_read_b32 v14, a194
    v_accvgpr_read_b32 v15, a195
    v_accvgpr_read_b32 v16, a196
    v_accvgpr_read_b32 v17, a197
    v_accvgpr_read_b32 v18, a198
    v_accvgpr_read_b32 v19, a199
    v_accvgpr_read_b32 v20, a200
    v_accvgpr_read_b32 v21, a201
    v_accvgpr_read_b32 v22, a202
    v_accvgpr_read_b32 v23, a203
    v_accvgpr_read_b32 v24, a204
    v_accvgpr_read_b32 v25, a205
    v_accvgpr_read_b32 v26, a206
    v_accvgpr_read_b32 v27, a207
    v_accvgpr_read_b32 v104, a76
    v_accvgpr_read_b32 v105, a77
    v_accvgpr_read_b32 v106, a78
    v_accvgpr_read_b32 v107, a79
    v_accvgpr_read_b32 v108, a80
    v_accvgpr_read_b32 v109, a81
    v_accvgpr_read_b32 v110, a82
    v_accvgpr_read_b32 v111, a83
    v_accvgpr_read_b32 v112, a84
    v_accvgpr_read_b32 v113, a85
    v_accvgpr_read_b32 v114, a86
    v_accvgpr_read_b32 v115, a87
    v_accvgpr_read_b32 v116, a88
    v_accvgpr_read_b32 v117, a89
    v_accvgpr_read_b32 v118, a90
    v_accvgpr_read_b32 v119, a91
    v_accvgpr_read_b32 v120, a92
    v_accvgpr_read_b32 v121, a93
    v_accvgpr_read_b32 v122, a94
    v_accvgpr_read_b32 v123, a95
    v_accvgpr_read_b32 v124, a96
    v_accvgpr_read_b32 v125, a97
    v_accvgpr_read_b32 v126, a98
    v_accvgpr_read_b32 v127, a99
    v_accvgpr_read_b32 v128, a100
    v_accvgpr_read_b32 v129, a101
    v_accvgpr_read_b32 v130, a102
    v_accvgpr_read_b32 v131, a103
    v_accvgpr_read_b32 v132, a104
    v_accvgpr_read_b32 v133, a105
    v_accvgpr_read_b32 v134, a106
    v_accvgpr_read_b32 v135, a107
    v_accvgpr_read_b32 v136, a108
    v_accvgpr_read_b32 v137, a109
    v_accvgpr_read_b32 v138, a110
    v_accvgpr_read_b32 v139, a111
    v_accvgpr_read_b32 v140, a112
    v_accvgpr_read_b32 v141, a113
    v_accvgpr_read_b32 v142, a114
    v_accvgpr_read_b32 v143, a115
    v_accvgpr_read_b32 v144, a116
    v_accvgpr_read_b32 v145, a117
    v_accvgpr_read_b32 v146, a118
    v_accvgpr_read_b32 v147, a119
    v_accvgpr_read_b32 v148, a120
    v_accvgpr_read_b32 v149, a121
    v_accvgpr_read_b32 v150, a122
    v_accvgpr_read_b32 v151, a123
    v_accvgpr_read_b32 v152, a124
    v_accvgpr_read_b32 v153, a125
    v_accvgpr_read_b32 v154, a126
    v_accvgpr_read_b32 v155, a127
    v_accvgpr_read_b32 v156, a128
    v_accvgpr_read_b32 v157, a129
    v_accvgpr_read_b32 v158, a130
    v_accvgpr_read_b32 v159, a131
    v_accvgpr_read_b32 v160, a132
    v_accvgpr_read_b32 v161, a133
    v_accvgpr_read_b32 v162, a134
    v_accvgpr_read_b32 v163, a135
    v_accvgpr_read_b32 v164, a136
    v_accvgpr_read_b32 v165, a137
    v_accvgpr_read_b32 v166, a138
    v_accvgpr_read_b32 v167, a139
    v_accvgpr_read_b32 v168, a140
    v_accvgpr_read_b32 v169, a141
    v_accvgpr_read_b32 v170, a142
    v_accvgpr_read_b32 v171, a143
    v_accvgpr_read_b32 v172, a144
    v_accvgpr_read_b32 v173, a145
    v_accvgpr_read_b32 v174, a146
    v_accvgpr_read_b32 v175, a147
    v_accvgpr_read_b32 v176, a148
    v_accvgpr_read_b32 v177, a149
    v_accvgpr_read_b32 v178, a150
    v_accvgpr_read_b32 v179, a151
    v_lshlrev_b32 v218, 16, v12
    v_and_b32 v220, s28, v12
    v_lshlrev_b32 v222, 16, v13
    v_and_b32 v224, s28, v13
    v_lshlrev_b32 v219, 16, v14
    v_and_b32 v221, s28, v14
    v_lshlrev_b32 v223, 16, v15
    v_and_b32 v225, s28, v15
    v_lshlrev_b32 v180, 16, v104
    v_and_b32 v181, s28, v104
    v_lshlrev_b32 v182, 16, v108
    v_and_b32 v183, s28, v108
    v_lshlrev_b32 v184, 16, v112
    v_and_b32 v185, s28, v112
    v_lshlrev_b32 v186, 16, v116
    v_and_b32 v187, s28, v116
    v_lshlrev_b32 v188, 16, v120
    v_and_b32 v189, s28, v120
    v_lshlrev_b32 v190, 16, v124
    v_and_b32 v191, s28, v124
    v_lshlrev_b32 v192, 16, v128
    v_and_b32 v193, s28, v128
    v_lshlrev_b32 v194, 16, v132
    v_and_b32 v195, s28, v132
    v_lshlrev_b32 v196, 16, v136
    v_and_b32 v197, s28, v136
    v_lshlrev_b32 v198, 16, v140
    v_and_b32 v199, s28, v140
    v_lshlrev_b32 v200, 16, v144
    v_and_b32 v201, s28, v144
    s_waitcnt lgkmcnt(0)
    buffer_store_dwordx4 v[240:243], v10, s[16:19], s46 offen sc1
    buffer_store_dwordx4 v[244:247], v10, s[16:19], s47 offen sc1
    v_add_u32 v10, 0x42000, v10
    v_pk_mul_f32 v[202:203], v[180:181], v[224:225]
    v_pk_mul_f32 v[204:205], v[182:183], v[224:225]
    v_pk_mul_f32 v[206:207], v[184:185], v[224:225]
    v_pk_mul_f32 v[208:209], v[186:187], v[224:225]
    v_pk_mul_f32 v[210:211], v[188:189], v[224:225]
    v_pk_mul_f32 v[212:213], v[190:191], v[224:225]
    v_pk_mul_f32 v[214:215], v[192:193], v[224:225]
    v_pk_mul_f32 v[216:217], v[194:195], v[224:225]
    v_pk_fma_f32 v[202:203], v[182:183], v[222:223], v[202:203]
    v_pk_fma_f32 v[204:205], v[184:185], v[222:223], v[204:205]
    v_pk_fma_f32 v[206:207], v[186:187], v[222:223], v[206:207]
    v_pk_fma_f32 v[208:209], v[188:189], v[222:223], v[208:209]
    v_pk_fma_f32 v[210:211], v[190:191], v[222:223], v[210:211]
    v_pk_fma_f32 v[212:213], v[192:193], v[222:223], v[212:213]
    v_pk_fma_f32 v[214:215], v[194:195], v[222:223], v[214:215]
    v_pk_fma_f32 v[216:217], v[196:197], v[222:223], v[216:217]
    v_pk_fma_f32 v[202:203], v[184:185], v[220:221], v[202:203]
    v_pk_fma_f32 v[204:205], v[186:187], v[220:221], v[204:205]
    v_pk_fma_f32 v[206:207], v[188:189], v[220:221], v[206:207]
    v_pk_fma_f32 v[208:209], v[190:191], v[220:221], v[208:209]
    v_pk_fma_f32 v[210:211], v[192:193], v[220:221], v[210:211]
    v_pk_fma_f32 v[212:213], v[194:195], v[220:221], v[212:213]
    v_pk_fma_f32 v[214:215], v[196:197], v[220:221], v[214:215]
    v_pk_fma_f32 v[216:217], v[198:199], v[220:221], v[216:217]
    v_pk_fma_f32 v[202:203], v[186:187], v[218:219], v[202:203]
    v_pk_fma_f32 v[204:205], v[188:189], v[218:219], v[204:205]
    v_pk_fma_f32 v[206:207], v[190:191], v[218:219], v[206:207]
    v_pk_fma_f32 v[208:209], v[192:193], v[218:219], v[208:209]
    v_pk_fma_f32 v[210:211], v[194:195], v[218:219], v[210:211]
    v_pk_fma_f32 v[212:213], v[196:197], v[218:219], v[212:213]
    v_pk_fma_f32 v[214:215], v[198:199], v[218:219], v[214:215]
    v_pk_fma_f32 v[216:217], v[200:201], v[218:219], v[216:217]
    v_lshlrev_b32 v226, 16, v148
    v_and_b32 v227, s28, v148
    v_pk_mul_f32 v[202:203], v[202:203], v[226:227]
    v_lshlrev_b32 v228, 16, v152
    v_and_b32 v229, s28, v152
    v_pk_mul_f32 v[204:205], v[204:205], v[228:229]
    v_lshlrev_b32 v226, 16, v156
    v_and_b32 v227, s28, v156
    v_pk_mul_f32 v[206:207], v[206:207], v[226:227]
    v_lshlrev_b32 v228, 16, v160
    v_and_b32 v229, s28, v160
    v_pk_mul_f32 v[208:209], v[208:209], v[228:229]
    v_lshlrev_b32 v226, 16, v164
    v_and_b32 v227, s28, v164
    v_pk_mul_f32 v[210:211], v[210:211], v[226:227]
    v_lshlrev_b32 v228, 16, v168
    v_and_b32 v229, s28, v168
    v_pk_mul_f32 v[212:213], v[212:213], v[228:229]
    v_lshlrev_b32 v226, 16, v172
    v_and_b32 v227, s28, v172
    v_pk_mul_f32 v[214:215], v[214:215], v[226:227]
    v_lshlrev_b32 v228, 16, v176
    v_and_b32 v229, s28, v176
    v_pk_mul_f32 v[216:217], v[216:217], v[228:229]
    v_cvt_pk_bf16_f32 v232, v216, v214
    v_cvt_pk_bf16_f32 v233, v212, v210
    v_cvt_pk_bf16_f32 v234, v208, v206
    v_cvt_pk_bf16_f32 v235, v204, v202
    ds_bpermute_b32 v232, v3, v232
    ds_bpermute_b32 v233, v3, v233
    ds_bpermute_b32 v234, v3, v234
    ds_bpermute_b32 v235, v3, v235
    v_cvt_pk_bf16_f32 v236, v217, v215
    v_cvt_pk_bf16_f32 v237, v213, v211
    v_cvt_pk_bf16_f32 v238, v209, v207
    v_cvt_pk_bf16_f32 v239, v205, v203
    ds_bpermute_b32 v236, v3, v236
    ds_bpermute_b32 v237, v3, v237
    ds_bpermute_b32 v238, v3, v238
    ds_bpermute_b32 v239, v3, v239
    v_lshlrev_b32 v218, 16, v16
    v_and_b32 v220, s28, v16
    v_lshlrev_b32 v222, 16, v17
    v_and_b32 v224, s28, v17
    v_lshlrev_b32 v219, 16, v18
    v_and_b32 v221, s28, v18
    v_lshlrev_b32 v223, 16, v19
    v_and_b32 v225, s28, v19
    v_lshlrev_b32 v180, 16, v105
    v_and_b32 v181, s28, v105
    v_lshlrev_b32 v182, 16, v109
    v_and_b32 v183, s28, v109
    v_lshlrev_b32 v184, 16, v113
    v_and_b32 v185, s28, v113
    v_lshlrev_b32 v186, 16, v117
    v_and_b32 v187, s28, v117
    v_lshlrev_b32 v188, 16, v121
    v_and_b32 v189, s28, v121
    v_lshlrev_b32 v190, 16, v125
    v_and_b32 v191, s28, v125
    v_lshlrev_b32 v192, 16, v129
    v_and_b32 v193, s28, v129
    v_lshlrev_b32 v194, 16, v133
    v_and_b32 v195, s28, v133
    v_lshlrev_b32 v196, 16, v137
    v_and_b32 v197, s28, v137
    v_lshlrev_b32 v198, 16, v141
    v_and_b32 v199, s28, v141
    v_lshlrev_b32 v200, 16, v145
    v_and_b32 v201, s28, v145
    s_waitcnt lgkmcnt(0)
    buffer_store_dwordx4 v[232:235], v10, s[16:19], s40 offen sc1
    buffer_store_dwordx4 v[236:239], v10, s[16:19], s41 offen sc1
    v_pk_mul_f32 v[202:203], v[180:181], v[224:225]
    v_pk_mul_f32 v[204:205], v[182:183], v[224:225]
    v_pk_mul_f32 v[206:207], v[184:185], v[224:225]
    v_pk_mul_f32 v[208:209], v[186:187], v[224:225]
    v_pk_mul_f32 v[210:211], v[188:189], v[224:225]
    v_pk_mul_f32 v[212:213], v[190:191], v[224:225]
    v_pk_mul_f32 v[214:215], v[192:193], v[224:225]
    v_pk_mul_f32 v[216:217], v[194:195], v[224:225]
    v_pk_fma_f32 v[202:203], v[182:183], v[222:223], v[202:203]
    v_pk_fma_f32 v[204:205], v[184:185], v[222:223], v[204:205]
    v_pk_fma_f32 v[206:207], v[186:187], v[222:223], v[206:207]
    v_pk_fma_f32 v[208:209], v[188:189], v[222:223], v[208:209]
    v_pk_fma_f32 v[210:211], v[190:191], v[222:223], v[210:211]
    v_pk_fma_f32 v[212:213], v[192:193], v[222:223], v[212:213]
    v_pk_fma_f32 v[214:215], v[194:195], v[222:223], v[214:215]
    v_pk_fma_f32 v[216:217], v[196:197], v[222:223], v[216:217]
    v_pk_fma_f32 v[202:203], v[184:185], v[220:221], v[202:203]
    v_pk_fma_f32 v[204:205], v[186:187], v[220:221], v[204:205]
    v_pk_fma_f32 v[206:207], v[188:189], v[220:221], v[206:207]
    v_pk_fma_f32 v[208:209], v[190:191], v[220:221], v[208:209]
    v_pk_fma_f32 v[210:211], v[192:193], v[220:221], v[210:211]
    v_pk_fma_f32 v[212:213], v[194:195], v[220:221], v[212:213]
    v_pk_fma_f32 v[214:215], v[196:197], v[220:221], v[214:215]
    v_pk_fma_f32 v[216:217], v[198:199], v[220:221], v[216:217]
    v_pk_fma_f32 v[202:203], v[186:187], v[218:219], v[202:203]
    v_pk_fma_f32 v[204:205], v[188:189], v[218:219], v[204:205]
    v_pk_fma_f32 v[206:207], v[190:191], v[218:219], v[206:207]
    v_pk_fma_f32 v[208:209], v[192:193], v[218:219], v[208:209]
    v_pk_fma_f32 v[210:211], v[194:195], v[218:219], v[210:211]
    v_pk_fma_f32 v[212:213], v[196:197], v[218:219], v[212:213]
    v_pk_fma_f32 v[214:215], v[198:199], v[218:219], v[214:215]
    v_pk_fma_f32 v[216:217], v[200:201], v[218:219], v[216:217]
    v_lshlrev_b32 v226, 16, v149
    v_and_b32 v227, s28, v149
    v_pk_mul_f32 v[202:203], v[202:203], v[226:227]
    v_lshlrev_b32 v228, 16, v153
    v_and_b32 v229, s28, v153
    v_pk_mul_f32 v[204:205], v[204:205], v[228:229]
    v_lshlrev_b32 v226, 16, v157
    v_and_b32 v227, s28, v157
    v_pk_mul_f32 v[206:207], v[206:207], v[226:227]
    v_lshlrev_b32 v228, 16, v161
    v_and_b32 v229, s28, v161
    v_pk_mul_f32 v[208:209], v[208:209], v[228:229]
    v_lshlrev_b32 v226, 16, v165
    v_and_b32 v227, s28, v165
    v_pk_mul_f32 v[210:211], v[210:211], v[226:227]
    v_lshlrev_b32 v228, 16, v169
    v_and_b32 v229, s28, v169
    v_pk_mul_f32 v[212:213], v[212:213], v[228:229]
    v_lshlrev_b32 v226, 16, v173
    v_and_b32 v227, s28, v173
    v_pk_mul_f32 v[214:215], v[214:215], v[226:227]
    v_lshlrev_b32 v228, 16, v177
    v_and_b32 v229, s28, v177
    v_pk_mul_f32 v[216:217], v[216:217], v[228:229]
    v_cvt_pk_bf16_f32 v240, v216, v214
    v_cvt_pk_bf16_f32 v241, v212, v210
    v_cvt_pk_bf16_f32 v242, v208, v206
    v_cvt_pk_bf16_f32 v243, v204, v202
    ds_bpermute_b32 v240, v3, v240
    ds_bpermute_b32 v241, v3, v241
    ds_bpermute_b32 v242, v3, v242
    ds_bpermute_b32 v243, v3, v243
    v_cvt_pk_bf16_f32 v244, v217, v215
    v_cvt_pk_bf16_f32 v245, v213, v211
    v_cvt_pk_bf16_f32 v246, v209, v207
    v_cvt_pk_bf16_f32 v247, v205, v203
    ds_bpermute_b32 v244, v3, v244
    ds_bpermute_b32 v245, v3, v245
    ds_bpermute_b32 v246, v3, v246
    ds_bpermute_b32 v247, v3, v247
    v_lshlrev_b32 v218, 16, v20
    v_and_b32 v220, s28, v20
    v_lshlrev_b32 v222, 16, v21
    v_and_b32 v224, s28, v21
    v_lshlrev_b32 v219, 16, v22
    v_and_b32 v221, s28, v22
    v_lshlrev_b32 v223, 16, v23
    v_and_b32 v225, s28, v23
    v_lshlrev_b32 v180, 16, v106
    v_and_b32 v181, s28, v106
    v_lshlrev_b32 v182, 16, v110
    v_and_b32 v183, s28, v110
    v_lshlrev_b32 v184, 16, v114
    v_and_b32 v185, s28, v114
    v_lshlrev_b32 v186, 16, v118
    v_and_b32 v187, s28, v118
    v_lshlrev_b32 v188, 16, v122
    v_and_b32 v189, s28, v122
    v_lshlrev_b32 v190, 16, v126
    v_and_b32 v191, s28, v126
    v_lshlrev_b32 v192, 16, v130
    v_and_b32 v193, s28, v130
    v_lshlrev_b32 v194, 16, v134
    v_and_b32 v195, s28, v134
    v_lshlrev_b32 v196, 16, v138
    v_and_b32 v197, s28, v138
    v_lshlrev_b32 v198, 16, v142
    v_and_b32 v199, s28, v142
    v_lshlrev_b32 v200, 16, v146
    v_and_b32 v201, s28, v146
    s_waitcnt lgkmcnt(0)
    buffer_store_dwordx4 v[240:243], v10, s[16:19], s42 offen sc1
    buffer_store_dwordx4 v[244:247], v10, s[16:19], s43 offen sc1
    v_pk_mul_f32 v[202:203], v[180:181], v[224:225]
    v_pk_mul_f32 v[204:205], v[182:183], v[224:225]
    v_pk_mul_f32 v[206:207], v[184:185], v[224:225]
    v_pk_mul_f32 v[208:209], v[186:187], v[224:225]
    v_pk_mul_f32 v[210:211], v[188:189], v[224:225]
    v_pk_mul_f32 v[212:213], v[190:191], v[224:225]
    v_pk_mul_f32 v[214:215], v[192:193], v[224:225]
    v_pk_mul_f32 v[216:217], v[194:195], v[224:225]
    v_pk_fma_f32 v[202:203], v[182:183], v[222:223], v[202:203]
    v_pk_fma_f32 v[204:205], v[184:185], v[222:223], v[204:205]
    v_pk_fma_f32 v[206:207], v[186:187], v[222:223], v[206:207]
    v_pk_fma_f32 v[208:209], v[188:189], v[222:223], v[208:209]
    v_pk_fma_f32 v[210:211], v[190:191], v[222:223], v[210:211]
    v_pk_fma_f32 v[212:213], v[192:193], v[222:223], v[212:213]
    v_pk_fma_f32 v[214:215], v[194:195], v[222:223], v[214:215]
    v_pk_fma_f32 v[216:217], v[196:197], v[222:223], v[216:217]
    v_pk_fma_f32 v[202:203], v[184:185], v[220:221], v[202:203]
    v_pk_fma_f32 v[204:205], v[186:187], v[220:221], v[204:205]
    v_pk_fma_f32 v[206:207], v[188:189], v[220:221], v[206:207]
    v_pk_fma_f32 v[208:209], v[190:191], v[220:221], v[208:209]
    v_pk_fma_f32 v[210:211], v[192:193], v[220:221], v[210:211]
    v_pk_fma_f32 v[212:213], v[194:195], v[220:221], v[212:213]
    v_pk_fma_f32 v[214:215], v[196:197], v[220:221], v[214:215]
    v_pk_fma_f32 v[216:217], v[198:199], v[220:221], v[216:217]
    v_pk_fma_f32 v[202:203], v[186:187], v[218:219], v[202:203]
    v_pk_fma_f32 v[204:205], v[188:189], v[218:219], v[204:205]
    v_pk_fma_f32 v[206:207], v[190:191], v[218:219], v[206:207]
    v_pk_fma_f32 v[208:209], v[192:193], v[218:219], v[208:209]
    v_pk_fma_f32 v[210:211], v[194:195], v[218:219], v[210:211]
    v_pk_fma_f32 v[212:213], v[196:197], v[218:219], v[212:213]
    v_pk_fma_f32 v[214:215], v[198:199], v[218:219], v[214:215]
    v_pk_fma_f32 v[216:217], v[200:201], v[218:219], v[216:217]
    v_lshlrev_b32 v226, 16, v150
    v_and_b32 v227, s28, v150
    v_pk_mul_f32 v[202:203], v[202:203], v[226:227]
    v_lshlrev_b32 v228, 16, v154
    v_and_b32 v229, s28, v154
    v_pk_mul_f32 v[204:205], v[204:205], v[228:229]
    v_lshlrev_b32 v226, 16, v158
    v_and_b32 v227, s28, v158
    v_pk_mul_f32 v[206:207], v[206:207], v[226:227]
    v_lshlrev_b32 v228, 16, v162
    v_and_b32 v229, s28, v162
    v_pk_mul_f32 v[208:209], v[208:209], v[228:229]
    v_lshlrev_b32 v226, 16, v166
    v_and_b32 v227, s28, v166
    v_pk_mul_f32 v[210:211], v[210:211], v[226:227]
    v_lshlrev_b32 v228, 16, v170
    v_and_b32 v229, s28, v170
    v_pk_mul_f32 v[212:213], v[212:213], v[228:229]
    v_lshlrev_b32 v226, 16, v174
    v_and_b32 v227, s28, v174
    v_pk_mul_f32 v[214:215], v[214:215], v[226:227]
    v_lshlrev_b32 v228, 16, v178
    v_and_b32 v229, s28, v178
    v_pk_mul_f32 v[216:217], v[216:217], v[228:229]
    v_cvt_pk_bf16_f32 v232, v216, v214
    v_cvt_pk_bf16_f32 v233, v212, v210
    v_cvt_pk_bf16_f32 v234, v208, v206
    v_cvt_pk_bf16_f32 v235, v204, v202
    ds_bpermute_b32 v232, v3, v232
    ds_bpermute_b32 v233, v3, v233
    ds_bpermute_b32 v234, v3, v234
    ds_bpermute_b32 v235, v3, v235
    v_cvt_pk_bf16_f32 v236, v217, v215
    v_cvt_pk_bf16_f32 v237, v213, v211
    v_cvt_pk_bf16_f32 v238, v209, v207
    v_cvt_pk_bf16_f32 v239, v205, v203
    ds_bpermute_b32 v236, v3, v236
    ds_bpermute_b32 v237, v3, v237
    ds_bpermute_b32 v238, v3, v238
    ds_bpermute_b32 v239, v3, v239
    v_lshlrev_b32 v218, 16, v24
    v_and_b32 v220, s28, v24
    v_lshlrev_b32 v222, 16, v25
    v_and_b32 v224, s28, v25
    v_lshlrev_b32 v219, 16, v26
    v_and_b32 v221, s28, v26
    v_lshlrev_b32 v223, 16, v27
    v_and_b32 v225, s28, v27
    v_lshlrev_b32 v180, 16, v107
    v_and_b32 v181, s28, v107
    v_lshlrev_b32 v182, 16, v111
    v_and_b32 v183, s28, v111
    v_lshlrev_b32 v184, 16, v115
    v_and_b32 v185, s28, v115
    v_lshlrev_b32 v186, 16, v119
    v_and_b32 v187, s28, v119
    v_lshlrev_b32 v188, 16, v123
    v_and_b32 v189, s28, v123
    v_lshlrev_b32 v190, 16, v127
    v_and_b32 v191, s28, v127
    v_lshlrev_b32 v192, 16, v131
    v_and_b32 v193, s28, v131
    v_lshlrev_b32 v194, 16, v135
    v_and_b32 v195, s28, v135
    v_lshlrev_b32 v196, 16, v139
    v_and_b32 v197, s28, v139
    v_lshlrev_b32 v198, 16, v143
    v_and_b32 v199, s28, v143
    v_lshlrev_b32 v200, 16, v147
    v_and_b32 v201, s28, v147
    s_waitcnt lgkmcnt(0)
    buffer_store_dwordx4 v[232:235], v10, s[16:19], s44 offen sc1
    buffer_store_dwordx4 v[236:239], v10, s[16:19], s45 offen sc1
    v_pk_mul_f32 v[202:203], v[180:181], v[224:225]
    v_pk_mul_f32 v[204:205], v[182:183], v[224:225]
    v_pk_mul_f32 v[206:207], v[184:185], v[224:225]
    v_pk_mul_f32 v[208:209], v[186:187], v[224:225]
    v_pk_mul_f32 v[210:211], v[188:189], v[224:225]
    v_pk_mul_f32 v[212:213], v[190:191], v[224:225]
    v_pk_mul_f32 v[214:215], v[192:193], v[224:225]
    v_pk_mul_f32 v[216:217], v[194:195], v[224:225]
    v_pk_fma_f32 v[202:203], v[182:183], v[222:223], v[202:203]
    v_pk_fma_f32 v[204:205], v[184:185], v[222:223], v[204:205]
    v_pk_fma_f32 v[206:207], v[186:187], v[222:223], v[206:207]
    v_pk_fma_f32 v[208:209], v[188:189], v[222:223], v[208:209]
    v_pk_fma_f32 v[210:211], v[190:191], v[222:223], v[210:211]
    v_pk_fma_f32 v[212:213], v[192:193], v[222:223], v[212:213]
    v_pk_fma_f32 v[214:215], v[194:195], v[222:223], v[214:215]
    v_pk_fma_f32 v[216:217], v[196:197], v[222:223], v[216:217]
    v_pk_fma_f32 v[202:203], v[184:185], v[220:221], v[202:203]
    v_pk_fma_f32 v[204:205], v[186:187], v[220:221], v[204:205]
    v_pk_fma_f32 v[206:207], v[188:189], v[220:221], v[206:207]
    v_pk_fma_f32 v[208:209], v[190:191], v[220:221], v[208:209]
    v_pk_fma_f32 v[210:211], v[192:193], v[220:221], v[210:211]
    v_pk_fma_f32 v[212:213], v[194:195], v[220:221], v[212:213]
    v_pk_fma_f32 v[214:215], v[196:197], v[220:221], v[214:215]
    v_pk_fma_f32 v[216:217], v[198:199], v[220:221], v[216:217]
    v_pk_fma_f32 v[202:203], v[186:187], v[218:219], v[202:203]
    v_pk_fma_f32 v[204:205], v[188:189], v[218:219], v[204:205]
    v_pk_fma_f32 v[206:207], v[190:191], v[218:219], v[206:207]
    v_pk_fma_f32 v[208:209], v[192:193], v[218:219], v[208:209]
    v_pk_fma_f32 v[210:211], v[194:195], v[218:219], v[210:211]
    v_pk_fma_f32 v[212:213], v[196:197], v[218:219], v[212:213]
    v_pk_fma_f32 v[214:215], v[198:199], v[218:219], v[214:215]
    v_pk_fma_f32 v[216:217], v[200:201], v[218:219], v[216:217]
    v_lshlrev_b32 v226, 16, v151
    v_and_b32 v227, s28, v151
    v_pk_mul_f32 v[202:203], v[202:203], v[226:227]
    v_lshlrev_b32 v228, 16, v155
    v_and_b32 v229, s28, v155
    v_pk_mul_f32 v[204:205], v[204:205], v[228:229]
    v_lshlrev_b32 v226, 16, v159
    v_and_b32 v227, s28, v159
    v_pk_mul_f32 v[206:207], v[206:207], v[226:227]
    v_lshlrev_b32 v228, 16, v163
    v_and_b32 v229, s28, v163
    v_pk_mul_f32 v[208:209], v[208:209], v[228:229]
    v_lshlrev_b32 v226, 16, v167
    v_and_b32 v227, s28, v167
    v_pk_mul_f32 v[210:211], v[210:211], v[226:227]
    v_lshlrev_b32 v228, 16, v171
    v_and_b32 v229, s28, v171
    v_pk_mul_f32 v[212:213], v[212:213], v[228:229]
    v_lshlrev_b32 v226, 16, v175
    v_and_b32 v227, s28, v175
    v_pk_mul_f32 v[214:215], v[214:215], v[226:227]
    v_lshlrev_b32 v228, 16, v179
    v_and_b32 v229, s28, v179
    v_pk_mul_f32 v[216:217], v[216:217], v[228:229]
    v_cvt_pk_bf16_f32 v240, v216, v214
    v_cvt_pk_bf16_f32 v241, v212, v210
    v_cvt_pk_bf16_f32 v242, v208, v206
    v_cvt_pk_bf16_f32 v243, v204, v202
    ds_bpermute_b32 v240, v3, v240
    ds_bpermute_b32 v241, v3, v241
    ds_bpermute_b32 v242, v3, v242
    ds_bpermute_b32 v243, v3, v243
    v_cvt_pk_bf16_f32 v244, v217, v215
    v_cvt_pk_bf16_f32 v245, v213, v211
    v_cvt_pk_bf16_f32 v246, v209, v207
    v_cvt_pk_bf16_f32 v247, v205, v203
    ds_bpermute_b32 v244, v3, v244
    ds_bpermute_b32 v245, v3, v245
    ds_bpermute_b32 v246, v3, v246
    ds_bpermute_b32 v247, v3, v247
    s_waitcnt lgkmcnt(0)
    buffer_store_dwordx4 v[240:243], v10, s[16:19], s46 offen sc1
    buffer_store_dwordx4 v[244:247], v10, s[16:19], s47 offen sc1
    v_add_u32 v10, 0x42000, v10
    v_lshrrev_b32 v1, 6, v0
    v_and_b32 v0, 63, v0
    s_nop 0
    v_readfirstlane_b32 s40, v1
    s_load_dwordx2 s[64:65], s[0:1], 32
    s_load_dwordx2 s[66:67], s[0:1], 40
    s_load_dwordx2 s[68:69], s[0:1], 80
    s_load_dwordx2 s[70:71], s[0:1], 96
    s_load_dwordx2 s[72:73], s[0:1], 104
    s_load_dwordx2 s[74:75], s[0:1], 0
    s_load_dwordx2 s[100:101], s[0:1], 72
    s_waitcnt vmcnt(0) lgkmcnt(0)
    s_mov_b32 s80, s70
    s_mov_b32 s81, s71
    s_mov_b32 s82, 0x100
    s_mov_b32 s83, 0x00020000
    s_lshl_b32 s84, s40, 6
    v_add_u32 v252, s84, v0
    s_getpc_b64 s[48:49]
CT_PC3:
    s_add_u32 s48, s48, CV_COMMON-CT_PC3
    s_addc_u32 s49, s49, ((CV_COMMON-CT_PC3)>>32)
    s_mov_b32 s50, G1_PREP-CV_COMMON
    s_mov_b32 s51, 0x00020000
    v_lshlrev_b32 v252, 7, v252
    buffer_load_dword v253, v252, s[48:51], 0 offen
    v_add_u32 v252, 0x8000, v252
    buffer_load_dword v253, v252, s[48:51], 0 offen
    s_barrier
    s_cmp_lg_u32 s40, 0
    s_cbranch_scc1 PREP_M1
    s_and_b32 s62, s2, 3
    s_lshl_b32 s62, s62, 6
    v_mov_b32 v209, 1
    s_mov_b64 exec, 1
    buffer_atomic_add v209, off, s[80:83], s62 sc1
    s_mov_b64 exec, -1
PREP_M1:
    s_lshl_b32 s60, s2, 2
    s_add_u32 s60, s60, s40
    s_lshl_b32 s62, s60, 12
    v_lshlrev_b32 v27, 4, v0
    s_mov_b32 s76, s68
    s_mov_b32 s77, s69
    s_mov_b32 s78, 0x800
    s_mov_b32 s79, 0x00020000
    buffer_load_dwordx4 v[212:215], v27, s[76:79], 0 offen
    buffer_load_dwordx4 v[216:219], v27, s[76:79], 0 offen offset:1024
    s_mov_b32 s76, s74
    s_mov_b32 s77, s75
    s_mov_b32 s78, 0x400000
    buffer_load_dwordx4 v[220:223], v27, s[76:79], s62 offen offset:0
    buffer_load_dwordx4 v[224:227], v27, s[76:79], s62 offen offset:1024
    buffer_load_dwordx4 v[228:231], v27, s[76:79], s62 offen offset:2048
    buffer_load_dwordx4 v[232:235], v27, s[76:79], s62 offen offset:3072
    s_mov_b32 s36, s100
    s_mov_b32 s37, s101
    s_mov_b32 s38, 0x700000
    s_mov_b32 s39, 0x00020000
    v_lshrrev_b32 v138, 3, v0
    v_lshlrev_b32 v138, 11, v138
    v_and_b32 v139, 7, v0
    v_lshlrev_b32 v139, 7, v139
    v_add_u32 v138, v138, v139
    s_lshr_b32 s62, s2, 1
    s_and_b32 s62, s62, 2
    s_lshr_b32 s63, s2, 3
    s_and_b32 s63, s63, 1
    s_add_u32 s62, s62, s63
    s_mul_i32 s62, s62, 896
    s_lshl_b32 s63, s40, 3
    s_add_u32 s62, s62, s63
    s_and_b32 s63, s2, 1
    s_mul_i32 s63, s63, 448
    s_add_u32 s62, s62, s63
    s_lshr_b32 s63, s2, 4
    s_mul_i32 s63, s63, 224
    s_add_u32 s62, s62, s63
    s_lshl_b32 s62, s62, 11
    s_and_b32 s63, s2, 2
    s_lshl_b32 s63, s63, 9
    s_add_u32 s62, s62, s63
    buffer_load_dword v139, v138, s[36:39], s62 offen
    s_add_u32 s62, s62, 0x10000
    buffer_load_dword v139, v138, s[36:39], s62 offen
    s_add_u32 s62, s62, 0x10000
    buffer_load_dword v139, v138, s[36:39], s62 offen
    s_add_u32 s62, s62, 0x10000
    buffer_load_dword v139, v138, s[36:39], s62 offen
    s_add_u32 s62, s62, 0x10000
    buffer_load_dword v139, v138, s[36:39], s62 offen
    s_add_u32 s62, s62, 0x10000
    buffer_load_dword v139, v138, s[36:39], s62 offen
    s_add_u32 s62, s62, 0x10000
    buffer_load_dword v139, v138, s[36:39], s62 offen
    s_add_u32 s62, s62, 0x10000
    s_lshl_b32 s60, s2, 2
    s_add_u32 s60, s60, s40
    s_mul_i32 s61, s40, 19712
    s_add_u32 s61, s61, 65536
    v_mov_b32 v204, 0
    v_mov_b32 v205, 0
    v_mov_b32 v206, 0
    v_mov_b32 v207, 0
    v_lshlrev_b32 v200, 4, v0
    v_add_u32 v210, s61, v200
    s_add_u32 s4, s72, 0x1000000
    s_addc_u32 s5, s73, 0
    s_mov_b32 s6, 0x420000
    s_mov_b32 s7, 0x00020000
    v_lshrrev_b32 v201, 4, v0
    v_and_b32 v201, 1, v201
    v_lshlrev_b32 v201, 1, v201
    v_xor_b32 v201, v201, v0
    v_lshlrev_b32 v201, 4, v201
    s_mul_i32 s77, s60, 4224
    v_mov_b32 v54, v210
    s_mul_i32 s85, s40, 8960
    v_add_u32 v211, s85, v200
    s_mov_b32 s8, s64
    s_mov_b32 s9, s65
    s_mov_b32 s10, 0x400000
    s_mov_b32 s11, 0x00020000
    s_add_u32 s12, s72, 0x1c00000
    s_addc_u32 s13, s73, 0
    s_mov_b32 s14, 0x400000
    s_mov_b32 s15, 0x00020000
    s_lshl_b32 s63, s2, 2
    s_add_u32 s63, s63, s40
    s_lshl_b32 s84, s63, 12
    s_load_dword s84, s[64:65], s84
    s_lshr_b32 s63, s63, 1
    s_lshl_b32 s63, s63, 2
    s_load_dword s49, s[66:67], s63
    s_load_dwordx2 s[68:69], s[0:1], 88
    v_and_b32 v8, 15, v0
    v_lshrrev_b32 v9, 4, v0
    v_lshlrev_b32 v10, 7, v9
    v_lshlrev_b32 v11, 3, v8
    v_add_u32 v10, v10, v11
    v_lshlrev_b32 v12, 1, v10
    v_add_u32 v13, v8, v9
    v_lshlrev_b32 v13, 4, v13
    v_add_u32 v13, s85, v13
    v_lshrrev_b32 v4, 2, v8
    v_and_b32 v5, 3, v8
    s_movk_i32 s63, 4928
    v_mul_lo_u32 v5, v5, s63
    v_sub_u32 v6, 3, v4
    v_lshlrev_b32 v6, 8, v6
    v_add_u32 v5, v5, v6
    v_add_u32 v5, s61, v5
    v_and_b32 v6, 1, v4
    v_lshlrev_b32 v6, 1, v6
    v_xor_b32 v7, v9, v6
    v_xor_b32 v6, 2, v7
    v_lshlrev_b32 v6, 4, v6
    v_lshlrev_b32 v7, 4, v7
    v_add_u32 v14, v5, v6
    v_add_u32 v15, v5, v7
    s_mov_b32 s76, 0xffff0000
    s_and_b32 s47, s2, 7
    s_lshr_b32 s48, s2, 3
    s_lshr_b32 s58, s47, 2
    s_and_b32 s63, s47, 2
    s_lshl_b32 s63, s63, 1
    s_lshr_b32 s59, s48, 3
    s_add_u32 s63, s63, s59
    s_add_u32 s30, s59, s48
    s_and_b32 s30, s30, 3
    s_lshr_b32 s47, s40, 1
    s_mul_i32 s59, s58, 56
    s_mul_i32 s48, s47, 28
    s_add_u32 s59, s59, s48
    s_add_u32 s70, s30, 3
    s_and_b32 s70, s70, 3
    s_add_u32 s70, s70, s59
    s_lshl_b32 s70, s70, 16
    s_add_u32 s28, s30, 0
    s_and_b32 s28, s28, 3
    s_add_u32 s28, s28, s59
    s_lshl_b32 s28, s28, 16
    s_add_u32 s29, s30, 1
    s_and_b32 s29, s29, 3
    s_add_u32 s29, s29, s59
    s_lshl_b32 s29, s29, 16
    s_add_u32 s30, s30, 2
    s_and_b32 s30, s30, 3
    s_add_u32 s30, s30, s59
    s_lshl_b32 s30, s30, 16
    s_and_b32 s62, s40, 1
    s_mul_i32 s31, s47, 98304
    s_lshl_b32 s59, s62, 12
    s_add_u32 s31, s31, s59
    s_lshl_b32 s63, s63, 7
    v_lshrrev_b32 v43, 3, v0
    s_lshl_b32 s59, s62, 4
    v_add_u32 v43, s59, v43
    v_lshlrev_b32 v43, 11, v43
    s_lshl_b32 s59, s58, 6
    s_add_u32 s59, s59, s63
    s_lshl_b32 s59, s59, 1
    v_add_u32 v43, s59, v43
    v_and_b32 v44, 7, v0
    v_lshrrev_b32 v45, 3, v0
    v_and_b32 v45, 2, v45
    v_xor_b32 v44, v44, v45
    v_lshlrev_b32 v44, 4, v44
    v_add_u32 v30, v43, v44
    v_xor_b32 v44, 64, v30
    v_xor_b32 v1, 0x80, v30
    v_xor_b32 v46, 0x80, v44
    v_add_u32 v29, 0x3c00, v46
    v_add_u32 v31, 0x3c00, v44
    s_mov_b32 s24, s100
    s_mov_b32 s25, s101
    s_mov_b32 s26, 0x700000
    s_mov_b32 s27, 0x00020000
    s_mov_b64 exec, 0xffff
    ds_write_b128 v211, v[204:207] offset:0
    ds_write_b128 v211, v[204:207] offset:4224
    ds_write_b128 v211, v[204:207] offset:4480
    ds_write_b128 v211, v[204:207] offset:8704
    s_mov_b64 exec, -1
    s_lshl_b32 s62, s60, 12
    s_waitcnt lgkmcnt(0)
    s_lshl_b32 s63, s49, 16
    s_and_b32 s78, s49, 0xffff0000
    s_bitcmp0_b32 s60, 0
    s_cselect_b32 s78, s63, s78
    s_lshl_b32 s79, s84, 16
    v_mov_b32 v202, s78
    v_add_f32 v202, s79, v202
    v_mov_b32 v203, s85
    v_cvt_pk_bf16_f32 v202, v202, v202
    s_add_u32 m0, s85, 256
    s_nop 0
    buffer_load_dwordx4 v200, s[8:11], s62 offen offset:0 lds
    buffer_load_dwordx4 v200, s[8:11], s62 offen offset:1024 lds
    buffer_load_dwordx4 v200, s[8:11], s62 offen offset:2048 lds
    buffer_load_dwordx4 v200, s[8:11], s62 offen offset:3072 lds
    s_add_u32 m0, s85, 4728
    s_nop 0
    buffer_load_dwordx4 v200, s[8:11], s62 offen offset:0 lds
    buffer_load_dwordx4 v200, s[8:11], s62 offen offset:1024 lds
    buffer_load_dwordx4 v200, s[8:11], s62 offen offset:2048 lds
    buffer_load_dwordx4 v200, s[8:11], s62 offen offset:3072 lds
    s_waitcnt vmcnt(15)
    v_lshlrev_b32 v236, 16, v212
    v_and_b32 v237, 0xffff0000, v212
    v_lshlrev_b32 v238, 16, v213
    v_and_b32 v239, 0xffff0000, v213
    v_lshlrev_b32 v240, 16, v214
    v_and_b32 v241, 0xffff0000, v214
    v_lshlrev_b32 v242, 16, v215
    v_and_b32 v243, 0xffff0000, v215
    v_lshlrev_b32 v244, 16, v216
    v_and_b32 v245, 0xffff0000, v216
    v_lshlrev_b32 v246, 16, v217
    v_and_b32 v247, 0xffff0000, v217
    v_lshlrev_b32 v248, 16, v218
    v_and_b32 v249, 0xffff0000, v218
    v_lshlrev_b32 v250, 16, v219
    v_and_b32 v251, 0xffff0000, v219
    v_lshlrev_b32 v252, 16, v220
    v_and_b32 v253, 0xffff0000, v220
    v_mul_f32 v252, v252, v236
    v_mul_f32 v253, v253, v237
    v_cvt_pk_bf16_f32 v252, v252, v253
    v_lshlrev_b32 v253, 16, v252
    v_and_b32 v252, 0xffff0000, v252
    v_add_f32 v26, v252, v253
    v_lshlrev_b32 v254, 16, v221
    v_and_b32 v255, 0xffff0000, v221
    v_mul_f32 v254, v254, v238
    v_mul_f32 v255, v255, v239
    v_cvt_pk_bf16_f32 v254, v254, v255
    v_lshlrev_b32 v255, 16, v254
    v_and_b32 v254, 0xffff0000, v254
    v_add_f32 v254, v254, v255
    v_add_f32 v26, v26, v254
    v_lshlrev_b32 v252, 16, v222
    v_and_b32 v253, 0xffff0000, v222
    v_mul_f32 v252, v252, v240
    v_mul_f32 v253, v253, v241
    v_cvt_pk_bf16_f32 v252, v252, v253
    v_lshlrev_b32 v253, 16, v252
    v_and_b32 v252, 0xffff0000, v252
    v_add_f32 v252, v252, v253
    v_add_f32 v26, v26, v252
    v_lshlrev_b32 v254, 16, v223
    v_and_b32 v255, 0xffff0000, v223
    v_mul_f32 v254, v254, v242
    v_mul_f32 v255, v255, v243
    v_cvt_pk_bf16_f32 v254, v254, v255
    v_lshlrev_b32 v255, 16, v254
    v_and_b32 v254, 0xffff0000, v254
    v_add_f32 v254, v254, v255
    v_add_f32 v26, v26, v254
    v_lshlrev_b32 v252, 16, v224
    v_and_b32 v253, 0xffff0000, v224
    v_mul_f32 v252, v252, v244
    v_mul_f32 v253, v253, v245
    v_cvt_pk_bf16_f32 v252, v252, v253
    v_lshlrev_b32 v253, 16, v252
    v_and_b32 v252, 0xffff0000, v252
    v_add_f32 v252, v252, v253
    v_add_f32 v26, v26, v252
    v_lshlrev_b32 v254, 16, v225
    v_and_b32 v255, 0xffff0000, v225
    v_mul_f32 v254, v254, v246
    v_mul_f32 v255, v255, v247
    v_cvt_pk_bf16_f32 v254, v254, v255
    v_lshlrev_b32 v255, 16, v254
    v_and_b32 v254, 0xffff0000, v254
    v_add_f32 v254, v254, v255
    v_add_f32 v26, v26, v254
    v_lshlrev_b32 v252, 16, v226
    v_and_b32 v253, 0xffff0000, v226
    v_mul_f32 v252, v252, v248
    v_mul_f32 v253, v253, v249
    v_cvt_pk_bf16_f32 v252, v252, v253
    v_lshlrev_b32 v253, 16, v252
    v_and_b32 v252, 0xffff0000, v252
    v_add_f32 v252, v252, v253
    v_add_f32 v26, v26, v252
    v_lshlrev_b32 v254, 16, v227
    v_and_b32 v255, 0xffff0000, v227
    v_mul_f32 v254, v254, v250
    v_mul_f32 v255, v255, v251
    v_cvt_pk_bf16_f32 v254, v254, v255
    v_lshlrev_b32 v255, 16, v254
    v_and_b32 v254, 0xffff0000, v254
    v_add_f32 v254, v254, v255
    v_add_f32 v26, v26, v254
    v_lshlrev_b32 v252, 16, v228
    v_and_b32 v253, 0xffff0000, v228
    v_mul_f32 v252, v252, v236
    v_mul_f32 v253, v253, v237
    v_cvt_pk_bf16_f32 v252, v252, v253
    v_lshlrev_b32 v253, 16, v252
    v_and_b32 v252, 0xffff0000, v252
    v_add_f32 v27, v252, v253
    v_lshlrev_b32 v254, 16, v229
    v_and_b32 v255, 0xffff0000, v229
    v_mul_f32 v254, v254, v238
    v_mul_f32 v255, v255, v239
    v_cvt_pk_bf16_f32 v254, v254, v255
    v_lshlrev_b32 v255, 16, v254
    v_and_b32 v254, 0xffff0000, v254
    v_add_f32 v254, v254, v255
    v_add_f32 v27, v27, v254
    v_lshlrev_b32 v252, 16, v230
    v_and_b32 v253, 0xffff0000, v230
    v_mul_f32 v252, v252, v240
    v_mul_f32 v253, v253, v241
    v_cvt_pk_bf16_f32 v252, v252, v253
    v_lshlrev_b32 v253, 16, v252
    v_and_b32 v252, 0xffff0000, v252
    v_add_f32 v252, v252, v253
    v_add_f32 v27, v27, v252
    v_lshlrev_b32 v254, 16, v231
    v_and_b32 v255, 0xffff0000, v231
    v_mul_f32 v254, v254, v242
    v_mul_f32 v255, v255, v243
    v_cvt_pk_bf16_f32 v254, v254, v255
    v_lshlrev_b32 v255, 16, v254
    v_and_b32 v254, 0xffff0000, v254
    v_add_f32 v254, v254, v255
    v_add_f32 v27, v27, v254
    v_lshlrev_b32 v252, 16, v232
    v_and_b32 v253, 0xffff0000, v232
    v_mul_f32 v252, v252, v244
    v_mul_f32 v253, v253, v245
    v_cvt_pk_bf16_f32 v252, v252, v253
    v_lshlrev_b32 v253, 16, v252
    v_and_b32 v252, 0xffff0000, v252
    v_add_f32 v252, v252, v253
    v_add_f32 v27, v27, v252
    v_lshlrev_b32 v254, 16, v233
    v_and_b32 v255, 0xffff0000, v233
    v_mul_f32 v254, v254, v246
    v_mul_f32 v255, v255, v247
    v_cvt_pk_bf16_f32 v254, v254, v255
    v_lshlrev_b32 v255, 16, v254
    v_and_b32 v254, 0xffff0000, v254
    v_add_f32 v254, v254, v255
    v_add_f32 v27, v27, v254
    v_lshlrev_b32 v252, 16, v234
    v_and_b32 v253, 0xffff0000, v234
    v_mul_f32 v252, v252, v248
    v_mul_f32 v253, v253, v249
    v_cvt_pk_bf16_f32 v252, v252, v253
    v_lshlrev_b32 v253, 16, v252
    v_and_b32 v252, 0xffff0000, v252
    v_add_f32 v252, v252, v253
    v_add_f32 v27, v27, v252
    v_lshlrev_b32 v254, 16, v235
    v_and_b32 v255, 0xffff0000, v235
    v_mul_f32 v254, v254, v250
    v_mul_f32 v255, v255, v251
    v_cvt_pk_bf16_f32 v254, v254, v255
    v_lshlrev_b32 v255, 16, v254
    v_and_b32 v254, 0xffff0000, v254
    v_add_f32 v254, v254, v255
    v_add_f32 v27, v27, v254
    s_nop 1
    v_add_f32_dpp v26, v26, v26 row_shr:1 row_mask:0xf bank_mask:0xf bound_ctrl:0
    v_add_f32_dpp v27, v27, v27 row_shr:1 row_mask:0xf bank_mask:0xf bound_ctrl:0
    s_nop 1
    v_add_f32_dpp v26, v26, v26 row_shr:2 row_mask:0xf bank_mask:0xf bound_ctrl:0
    v_add_f32_dpp v27, v27, v27 row_shr:2 row_mask:0xf bank_mask:0xf bound_ctrl:0
    s_nop 1
    v_add_f32_dpp v26, v26, v26 row_shr:4 row_mask:0xf bank_mask:0xf bound_ctrl:0
    v_add_f32_dpp v27, v27, v27 row_shr:4 row_mask:0xf bank_mask:0xf bound_ctrl:0
    s_nop 1
    v_add_f32_dpp v26, v26, v26 row_shr:8 row_mask:0xf bank_mask:0xf bound_ctrl:0
    v_add_f32_dpp v27, v27, v27 row_shr:8 row_mask:0xf bank_mask:0xf bound_ctrl:0
    s_nop 1
    v_add_f32_dpp v26, v26, v26 row_bcast:15 row_mask:0xa bank_mask:0xf
    v_add_f32_dpp v27, v27, v27 row_bcast:15 row_mask:0xa bank_mask:0xf
    s_nop 1
    v_add_f32_dpp v26, v26, v26 row_bcast:31 row_mask:0xc bank_mask:0xf
    v_add_f32_dpp v27, v27, v27 row_bcast:31 row_mask:0xc bank_mask:0xf
    v_cvt_pk_bf16_f32 v26, v26, v26
    v_cvt_pk_bf16_f32 v27, v27, v27
    v_lshlrev_b32 v26, 16, v26
    v_lshlrev_b32 v27, 16, v27
    v_mul_f32 v26, 0xbfb8aa3b, v26
    v_mul_f32 v27, 0xbfb8aa3b, v27
    v_exp_f32 v26, v26
    v_exp_f32 v27, v27
    s_nop 0
    v_add_f32 v26, 1.0, v26
    v_add_f32 v27, 1.0, v27
    v_rcp_f32 v26, v26
    v_rcp_f32 v27, v27
    s_nop 0
    v_cvt_pk_bf16_f32 v26, v26, v26
    v_cvt_pk_bf16_f32 v27, v27, v27
    v_lshlrev_b32 v26, 16, v26
    v_lshlrev_b32 v27, 16, v27
    s_lshl_b32 s62, s60, 3
    s_add_u32 s52, s72, 0x2100000
    s_addc_u32 s53, s73, 0
    s_mov_b32 s54, 0x2000
    s_mov_b32 s55, 0x00020000
    v_mov_b32 v252, 0
    s_mov_b32 exec_lo, 0
    s_mov_b32 exec_hi, 0x80000000
    buffer_store_dwordx2 v[26:27], v252, s[52:55], s62 offen sc1
    s_mov_b64 exec, -1
    s_cmp_lg_u32 s40, 0
    s_cbranch_scc1 PREP_P4
    s_mov_b32 s3, 0x4000
PREP_P3:
    v_and_b32 v208, 3, v0
    v_lshlrev_b32 v208, 6, v208
    buffer_load_dword v210, v208, s[80:83], 0 offen sc1
    s_waitcnt vmcnt(0)
    v_cmp_eq_u32 vcc, 8, v210
    s_nop 1
    s_and_b32 s47, vcc_lo, vcc_hi
    s_cmp_eq_u32 s47, -1
    s_cselect_b32 s47, 1, 0
    s_cmp_lg_u32 s47, 0
    s_cbranch_scc1 PREP_P4
    s_sub_u32 s3, s3, 1
    s_cmp_eq_u32 s3, 0
    s_cbranch_scc1 PREP_P4
    s_sleep 16
    s_branch PREP_P3
PREP_P4:
    s_barrier
    v_mov_b32 v210, v54
    s_mov_b32 s36, s100
    s_mov_b32 s37, s101
    s_mov_b32 s38, 0x700000
    s_mov_b32 s39, 0x00020000
    v_lshrrev_b32 v138, 3, v0
    v_lshlrev_b32 v138, 11, v138
    v_and_b32 v139, 7, v0
    v_lshlrev_b32 v139, 7, v139
    v_add_u32 v138, v138, v139
    s_lshr_b32 s62, s2, 1
    s_and_b32 s62, s62, 2
    s_lshr_b32 s63, s2, 3
    s_and_b32 s63, s63, 1
    s_add_u32 s62, s62, s63
    s_mul_i32 s62, s62, 896
    s_lshl_b32 s63, s40, 3
    s_add_u32 s62, s62, s63
    s_lshr_b32 s63, s2, 4
    s_mul_i32 s63, s63, 320
    s_add_u32 s62, s62, s63
    s_lshl_b32 s62, s62, 11
    s_and_b32 s63, s2, 2
    s_lshl_b32 s63, s63, 9
    s_add_u32 s62, s62, s63
    s_mov_b32 exec_hi, 0x7ffff
    ds_write_b128 v210, v[204:207] offset:18896
    s_mov_b32 exec_hi, -1
    s_add_u32 s79, s77, 0x78
    s_add_u32 m0, s61, 14784
    s_nop 0
    buffer_load_dwordx4 v201, s[4:7], s79 offen offset:0 sc1 lds
    buffer_load_dwordx4 v201, s[4:7], s79 offen offset:1024 sc1 lds
    buffer_load_dwordx4 v201, s[4:7], s79 offen offset:2048 sc1 lds
    buffer_load_dwordx4 v201, s[4:7], s79 offen offset:3072 sc1 lds
    s_add_u32 s79, s77, 0x1078
    s_add_u32 m0, s61, 18880
    s_mov_b64 exec, 1
    buffer_load_dwordx4 v201, s[4:7], s79 offen sc1 lds
    s_mov_b64 exec, -1
    buffer_load_dword v139, v138, s[36:39], s62 offen
    s_add_u32 s62, s62, 0x10000
    s_mov_b32 exec_hi, 0x7ffff
    ds_write_b128 v210, v[204:207] offset:9040
    s_mov_b32 exec_hi, -1
    s_add_u32 s79, s77, 0x7c
    s_add_u32 m0, s61, 4928
    s_nop 0
    buffer_load_dwordx4 v201, s[4:7], s79 offen offset:0 sc1 lds
    buffer_load_dword v139, v138, s[36:39], s62 offen
    s_add_u32 s62, s62, 0x10000
    buffer_load_dwordx4 v201, s[4:7], s79 offen offset:1024 sc1 lds
    buffer_load_dword v139, v138, s[36:39], s62 offen
    s_add_u32 s62, s62, 0x10000
    buffer_load_dwordx4 v201, s[4:7], s79 offen offset:2048 sc1 lds
    buffer_load_dword v139, v138, s[36:39], s62 offen
    s_add_u32 s62, s62, 0x10000
    buffer_load_dwordx4 v201, s[4:7], s79 offen offset:3072 sc1 lds
    buffer_load_dword v139, v138, s[36:39], s62 offen
    s_add_u32 s62, s62, 0x10000
    s_add_u32 s79, s77, 0x107c
    s_add_u32 m0, s61, 9024
    s_mov_b64 exec, 1
    buffer_load_dwordx4 v201, s[4:7], s79 offen sc1 lds
    s_mov_b64 exec, -1
    buffer_load_dword v139, v138, s[36:39], s62 offen
    s_add_u32 s62, s62, 0x10000
    s_mov_b32 exec_hi, 0x7ffff
    ds_write_b128 v210, v[204:207] offset:13968
    s_mov_b32 exec_hi, -1
    s_add_u32 s79, s77, 0x7a
    s_add_u32 m0, s61, 9856
    s_nop 0
    buffer_load_dwordx4 v201, s[4:7], s79 offen offset:0 sc1 lds
    buffer_load_dword v139, v138, s[36:39], s62 offen
    s_add_u32 s62, s62, 0x10000
    buffer_load_dwordx4 v201, s[4:7], s79 offen offset:1024 sc1 lds
    buffer_load_dword v139, v138, s[36:39], s62 offen
    s_add_u32 s62, s62, 0x10000
    buffer_load_dwordx4 v201, s[4:7], s79 offen offset:2048 sc1 lds
    buffer_load_dword v139, v138, s[36:39], s62 offen
    s_add_u32 s62, s62, 0x10000
    buffer_load_dwordx4 v201, s[4:7], s79 offen offset:3072 sc1 lds
    buffer_load_dword v139, v138, s[36:39], s62 offen
    s_add_u32 s62, s62, 0x10000
    s_add_u32 s79, s77, 0x107a
    s_add_u32 m0, s61, 13952
    s_mov_b64 exec, 1
    buffer_load_dwordx4 v201, s[4:7], s79 offen sc1 lds
    s_mov_b64 exec, -1
    s_mov_b32 exec_hi, 0x7ffff
    ds_write_b128 v210, v[204:207] offset:4112
    s_mov_b32 exec_hi, -1
    s_add_u32 s79, s77, 0x7e
    s_add_u32 m0, s61, 0
    s_nop 0
    buffer_load_dwordx4 v201, s[4:7], s79 offen offset:0 sc1 lds
    buffer_load_dwordx4 v201, s[4:7], s79 offen offset:1024 sc1 lds
    buffer_load_dwordx4 v201, s[4:7], s79 offen offset:2048 sc1 lds
    buffer_load_dwordx4 v201, s[4:7], s79 offen offset:3072 sc1 lds
    s_add_u32 s79, s77, 0x107e
    s_add_u32 m0, s61, 4096
    s_mov_b64 exec, 1
    buffer_load_dwordx4 v201, s[4:7], s79 offen sc1 lds
    s_mov_b64 exec, -1
    s_add_u32 m0, s31, 49152
    s_nop 0
    buffer_load_dwordx4 v1, s[24:27], s28 offen offset:0 lds
    buffer_load_dwordx4 v29, s[24:27], s28 offen offset:1024 lds
    s_add_u32 m0, s31, 51200
    s_nop 0
    buffer_load_dwordx4 v30, s[24:27], s28 offen offset:0 lds
    buffer_load_dwordx4 v31, s[24:27], s28 offen offset:1024 lds
    s_add_u32 s28, s28, 0x40000
    s_add_u32 m0, s31, 57344
    s_nop 0
    buffer_load_dwordx4 v1, s[24:27], s29 offen offset:0 lds
    buffer_load_dwordx4 v29, s[24:27], s29 offen offset:1024 lds
    s_add_u32 m0, s31, 59392
    s_nop 0
    buffer_load_dwordx4 v30, s[24:27], s29 offen offset:0 lds
    buffer_load_dwordx4 v31, s[24:27], s29 offen offset:1024 lds
    s_add_u32 s29, s29, 0x40000
    buffer_load_dwordx4 a[0:3], v1, s[24:27], s30 offen offset:0
    buffer_load_dwordx4 a[4:7], v29, s[24:27], s30 offen offset:1024
    buffer_load_dwordx4 a[128:131], v30, s[24:27], s30 offen offset:0
    buffer_load_dwordx4 a[132:135], v31, s[24:27], s30 offen offset:1024
    s_add_u32 s30, s30, 0x40000
    buffer_load_dwordx4 a[32:35], v1, s[24:27], s70 offen offset:0
    buffer_load_dwordx4 a[36:39], v29, s[24:27], s70 offen offset:1024
    buffer_load_dwordx4 a[160:163], v30, s[24:27], s70 offen offset:0
    buffer_load_dwordx4 a[164:167], v31, s[24:27], s70 offen offset:1024
    s_add_u32 s70, s70, 0x40000
    buffer_load_dwordx4 a[8:11], v1, s[24:27], s28 offen offset:0
    buffer_load_dwordx4 a[12:15], v29, s[24:27], s28 offen offset:1024
    buffer_load_dwordx4 a[136:139], v30, s[24:27], s28 offen offset:0
    buffer_load_dwordx4 a[140:143], v31, s[24:27], s28 offen offset:1024
    s_add_u32 s28, s28, 0x40000
    buffer_load_dwordx4 a[40:43], v1, s[24:27], s29 offen offset:0
    buffer_load_dwordx4 a[44:47], v29, s[24:27], s29 offen offset:1024
    buffer_load_dwordx4 a[168:171], v30, s[24:27], s29 offen offset:0
    buffer_load_dwordx4 a[172:175], v31, s[24:27], s29 offen offset:1024
    s_add_u32 s29, s29, 0x40000
    s_waitcnt vmcnt(24)
    s_mov_b64 exec, 1
    ds_write_b16 v203, v202 offset:256
    ds_write_b16 v203, v202 offset:4728
    s_mov_b64 exec, -1
    ds_read_b128 v[64:67], v13 offset:0
    ds_read_b128 v[68:71], v13 offset:4480
    ds_read_b128 v[112:115], v14 offset:3072
    ds_read_b128 v[116:119], v14 offset:2048
    ds_read_b128 v[120:123], v14 offset:1024
    ds_read_b128 v[124:127], v14 offset:0
    ds_read_b128 v[80:83], v13 offset:64
    ds_read_b128 v[84:87], v13 offset:4544
    ds_read_b128 v[128:131], v14 offset:3136
    ds_read_b128 v[132:135], v14 offset:2112
    ds_read_b128 v[136:139], v14 offset:1088
    ds_read_b128 v[140:143], v14 offset:64
    ds_read_b128 v[88:91], v13 offset:3136
    ds_read_b128 v[92:95], v13 offset:7616
    s_branch CV_COMMON
G1_END:
CODE_END:
.section .rodata,"a"
.p2align 6
.amdhsa_kernel gated_mix__ssm_conv_h3__geglu_ffn__prompt_kernel
  .amdhsa_next_free_vgpr 512
  .amdhsa_next_free_sgpr 102
  .amdhsa_accum_offset 256
  .amdhsa_group_segment_fixed_size 0
  .amdhsa_kernarg_size 112
  .amdhsa_user_sgpr_count 2
  .amdhsa_user_sgpr_kernarg_segment_ptr 1
  .amdhsa_system_sgpr_workgroup_id_x 1
.end_amdhsa_kernel
```
